```python
import torch

def _softmax(x, axis=-1):
    return torch.softmax(x, dim=axis)
def _gelu(x):
    return torch.nn.functional.gelu(x, approximate="tanh")
def _silu(x):
    return torch.nn.functional.silu(x)
def _sigmoid(x):
    return torch.sigmoid(x)
def _layernorm(x, axis=-1, eps=1e-5):
    m = x.mean(dim=axis, keepdim=True)
    v = x.var(dim=axis, keepdim=True, unbiased=False)
    return (x - m) / torch.sqrt(v + eps)
def _scatter_add(tgt, idx, src, axis=0):
    return tgt.clone().index_add_(axis, idx, src)
def _segment_sum(src, seg, n):
    out = torch.zeros((n,) + src.shape[1:], dtype=src.dtype)
    return out.index_add_(0, seg, src)
def _pad(x, pw):
    flat = tuple(v for pair in reversed(pw) for v in pair)
    return torch.nn.functional.pad(x, flat)

kernel_name = 'recurrent_scan__linear_kernel_hedgehog__glu_gated_glu__prompt'

def setup_inputs():

    _w = (lambda a: (lambda t: t.to(torch.bfloat16) if t.is_floating_point() else t)(torch.as_tensor(a)))
    def _A_setup():
        B, S, D, H = 1, 2048, 1024, 32
        Dh = D // H
        return {
            "x": _w((lambda *s: torch.randn(*s, dtype=torch.bfloat16) * 0.05)(B, S, D)),
            "wqkv": _w((lambda *s: torch.randn(*s, dtype=torch.bfloat16) * 0.2)(D, 3 * D)),
            "w_phi": _w((lambda *s: torch.randn(*s, dtype=torch.bfloat16) * 0.2)(H, Dh, Dh) * (Dh ** -0.5)),
            "wo": _w((lambda *s: torch.randn(*s, dtype=torch.bfloat16) * 0.05)(D, D)),
        }
    _A_in = _A_setup()

    def _B_setup():
        B, S, D, F = 1, 2048, 1024, 3584
        return {
            "x": _w((lambda *s: torch.randn(*s, dtype=torch.bfloat16) * 0.05)(B, S, D)),
            "w_gate": _w((lambda *s: torch.randn(*s, dtype=torch.bfloat16) * 0.05)(D, F)),
            "w_up": _w((lambda *s: torch.randn(*s, dtype=torch.bfloat16) * 0.05)(D, F)),
            "w_down": _w((lambda *s: torch.randn(*s, dtype=torch.bfloat16) * 0.05)(F, D)),
        }
    _B_in = _B_setup()

    return {
        "A_x": _A_in["x"],
        "A_wqkv": _A_in["wqkv"],
        "A_w_phi": _A_in["w_phi"],
        "A_wo": _A_in["wo"],
        "B_x": _B_in["x"],
        "B_w_gate": _B_in["w_gate"],
        "B_w_up": _B_in["w_up"],
        "B_w_down": _B_in["w_down"],
    }

def reference(A_x, A_wqkv, A_w_phi, A_wo, B_x, B_w_gate, B_w_up, B_w_down):
    def _A_ref(x, wqkv, w_phi, wo):
        B, S, D = x.shape
        H = 32; Dh = D // H
        qkv = (lambda x, *d: x.permute(*d))((x @ wqkv).reshape(B, S, 3, H, Dh), 2, 0, 3, 1, 4)
        q, k, v = qkv[0], qkv[1], qkv[2]
        pq = torch.einsum("bhsd,hdf->bhsf", q, w_phi)
        pk = torch.einsum("bhsd,hdf->bhsf", k, w_phi)
        phi_q = torch.concatenate([_softmax(pq, axis=-1), _softmax(-pq, axis=-1)], axis=-1)
        phi_k = torch.concatenate([_softmax(pk, axis=-1), _softmax(-pk, axis=-1)], axis=-1)
        kv = torch.einsum("bhsf,bhsd->bhfd", phi_k, v)
        z  = torch.einsum("bhsf->bhf", phi_k)
        num = torch.einsum("bhqf,bhfd->bhqd", phi_q, kv)
        den = torch.einsum("bhqf,bhf->bhq", phi_q, z)[..., None] + 1e-6
        o = num / den
        return (lambda x, *d: x.permute(*d))(o, 0, 2, 1, 3).reshape(B, S, D) @ wo

    def _B_ref(x, w_gate, w_up, w_down):
        g = torch.einsum("bsd,df->bsf", x, w_gate)
        u = torch.einsum("bsd,df->bsf", x, w_up)
        h = _sigmoid(g) * u
        return torch.einsum("bsf,fd->bsd", h, w_down)

    x = A_x
    xn = _layernorm(x, axis=-1)
    s = _A_ref(xn, A_wqkv, A_w_phi, A_wo)
    g = _silu(_B_ref(xn, B_w_gate, B_w_up, B_w_down))
    return x + s * g
```

```asm
; @launch grid=(256,1,1) block=(256,1,1) lds=163840
.amdgcn_target "amdgcn-amd-amdhsa--gfx950"
.text
.globl recurrent_scan__linear_kernel_hedgehog__glu_gated_glu__prompt_kernel
.p2align 8
.type recurrent_scan__linear_kernel_hedgehog__glu_gated_glu__prompt_kernel,@function
recurrent_scan__linear_kernel_hedgehog__glu_gated_glu__prompt_kernel:
    s_load_dwordx2 s[4:5], s[0:1], 0
    s_getpc_b64 s[20:21]
L_pc:
    s_bfe_u32 s8, s2, 0x30003
    s_lshl_b32 s8, s8, 14
    v_lshl_add_u32 v252, v0, 6, s8
    v_mov_b32 v253, 0
    v_min_u32 v252, L_end-L_pc-4, v252
    v_lshl_add_u64 v[250:251], v[252:253], 0, s[20:21]
    global_load_dword v252, v[250:251], off
    s_cmp_ge_u32 s2, 256
    s_cbranch_scc1 L_end
    v_lshrrev_b32 v2, 6, v0
    s_bfe_u32 s17, s2, 0x20001
    s_bfe_u32 s8, s2, 0x30003
    s_lshl_b32 s9, s17, 3
    s_add_u32 s9, s9, s8
    s_and_b32 s14, s2, 1
    s_lshl_b32 s14, s14, 2
    s_lshr_b32 s79, s2, 6
    s_add_u32 s14, s14, s79
    v_and_b32 v34, 7, v0
    v_bfe_u32 v33, v0, 3, 3
    v_lshlrev_b32 v36, 11, v33
    v_lshl_add_u32 v36, v2, 9, v36
    v_lshl_add_u32 v36, v34, 4, v36
    s_lshl_b32 s79, s14, 5
    s_add_u32 s79, s79, s9
    s_lshl_b32 s95, s79, 14
    s_add_u32 s95, s95, 2048
    s_mov_b32 s22, 4196352
    s_mov_b32 s23, 0x20000
    s_waitcnt lgkmcnt(0)
    s_sub_u32 s20, s4, 2048
    s_subb_u32 s21, s5, 0
    buffer_load_dwordx4 v[40:43], v36, s[20:23], s95 offen offset:0
    buffer_load_dwordx4 v[44:47], v36, s[20:23], s95 offen offset:128
    buffer_load_dwordx4 v[48:51], v36, s[20:23], s95 offen offset:256
    buffer_load_dwordx4 v[52:55], v36, s[20:23], s95 offen offset:384
    s_load_dwordx2 s[12:13], s[0:1], 80
    s_load_dwordx4 s[96:99], s[0:1], 8
    s_load_dwordx8 s[80:87], s[0:1], 40
    s_load_dwordx2 s[6:7], s[0:1], 24
    v_and_b32 v1, 63, v0
    v_readfirstlane_b32 s3, v2
    s_lshr_b32 s15, s9, 1
    s_and_b32 s16, s9, 1
    s_lshl_b32 s9, s14, 2
    s_add_u32 s9, s9, s3
    s_lshl_b32 s10, s9, 2
    s_add_u32 s10, s10, s17
    s_lshl_b32 s10, s10, 15
    s_mul_i32 s19, s3, 10240
    v_xor_b32 v241, v33, v34
    v_lshlrev_b32 v240, 11, v33
    v_lshl_add_u32 v240, v241, 4, v240
    v_add_u32 v240, s10, v240
    v_xor_b32 v242, 32768, v240
    v_xor_b32 v244, 65536, v240
    v_xor_b32 v246, 98304, v240
    v_add_u32 v241, 17408, v240
    v_add_u32 v243, 15360, v242
    v_add_u32 v245, 17408, v244
    v_add_u32 v247, 15360, v246
    v_add_u32 v240, 2048, v240
    v_add_u32 v244, 2048, v244
    s_add_u32 m0, s19, 81920
    s_nop 0
    buffer_load_dwordx4 v240, s[20:23], 0 offen offset:0 lds
    buffer_load_dwordx4 v241, s[20:23], 0 offen offset:1024 lds
    buffer_load_dwordx4 v242, s[20:23], 0 offen offset:2048 lds
    buffer_load_dwordx4 v243, s[20:23], 0 offen offset:3072 lds
    s_cmp_eq_u32 s3, 2
    s_movk_i32 s89, 7168
    s_cselect_b32 s89, 6144, s89
    s_movk_i32 s90, 1792
    s_cselect_b32 s90, 512, s90
    s_movk_i32 s91, 512
    s_cselect_b32 s91, 2048, s91
    s_cselect_b32 s92, 12, 14
    s_mul_i32 s90, s90, s17
    s_lshr_b32 s93, s2, 3
    v_lshrrev_b32 v237, 4, v1
    v_lshl_add_u32 v237, v237, 5, s93
    v_mul_lo_u32 v237, v237, s89
    v_bfe_u32 v238, v1, 2, 2
    v_mul_lo_u32 v238, v238, s91
    v_and_b32 v239, 3, v1
    v_lshl_add_u32 v238, v239, 7, v238
    v_add3_u32 v237, v237, v238, s90
    v_and_b32 v238, 15, v1
    v_bfrev_b32 v239, 1
    v_cmp_gt_u32 vcc, s92, v238
    s_nop 1
    v_cndmask_b32 v237, v239, v237, vcc
    s_and_b32 s93, s2, 1
    s_mul_i32 s93, s93, 64
    s_add_u32 s93, s93, 128
    s_mul_i32 s89, s89, s93
    s_lshl_b32 s90, s14, 3
    s_add_u32 s90, s90, s8
    s_lshl_b32 s90, s90, 16
    s_add_u32 s90, s90, 128
    v_and_b32 v238, 31, v1
    v_lshl_add_u32 v238, v238, 11, s90
    v_lshrrev_b32 v236, 5, v1
    v_lshlrev_b32 v236, 7, v236
    v_xor_b32 v238, v236, v238
    s_cmp_eq_u32 s3, 3
    s_cselect_b64 vcc, -1, 0
    v_add_u32 v236, s89, v237
    v_cndmask_b32 v237, v237, v238, vcc
    v_cndmask_b32 v236, v236, v239, vcc
    s_mov_b32 s63, 0x20000
    s_mov_b32 s62, 7340032
    s_cselect_b32 s62, 4194304, s62
    s_cmp_eq_u32 s3, 2
    s_cselect_b32 s62, 6291456, s62
    s_waitcnt lgkmcnt(0)
    s_cmp_eq_u32 s3, 1
    s_cselect_b64 s[60:61], s[82:83], s[80:81]
    s_cmp_eq_u32 s3, 3
    s_cselect_b64 s[60:61], s[4:5], s[60:61]
    s_cmp_eq_u32 s3, 2
    s_cselect_b64 s[60:61], s[96:97], s[60:61]
    buffer_load_dword v0, v237, s[60:63], 0 offen
    s_add_u32 s52, s12, 29360128
    s_addc_u32 s53, s13, 0
    s_mov_b32 s54, 86016
    s_mov_b32 s55, 0x20000
    s_load_dword s18, s[52:53], 65536
    v_lshlrev_b32 v37, 15, v2
    v_bfe_u32 v22, v1, 4, 1
    v_and_b32 v23, 3, v1
    v_lshlrev_b32 v24, 1, v22
    v_xor_b32 v24, v24, v23
    v_lshlrev_b32 v24, 4, v24
    v_bfe_u32 v25, v1, 2, 2
    v_lshl_add_u32 v26, v22, 3, v25
    v_lshrrev_b32 v27, 4, v1
    v_lshl_add_u32 v28, v27, 3, v25
    v_lshrrev_b32 v29, 5, v1
    v_lshl_add_u32 v29, v29, 6, v24
    s_lshr_b32 s89, s3, 1
    s_lshl_b32 s89, s89, 2
    s_and_b32 s90, s3, 1
    s_lshl_b32 s88, s90, 4
    s_add_u32 s88, s88, s89
    v_add_u32 v26, s88, v26
    v_add_u32 v28, s89, v28
    s_cmp_eq_u32 s16, 0
    s_mov_b32 s91, 7168
    s_cselect_b32 s88, s91, 6144
    s_cselect_b32 s89, 6144, s91
    v_mul_lo_u32 v7, v26, s91
    v_mul_lo_u32 v9, v26, s88
    v_mul_lo_u32 v11, v28, s89
    v_add_u32 v7, v7, v29
    v_add_u32 v9, v9, v29
    v_add_u32 v11, v11, v24
    s_lshl_b32 s67, s88, 6
    s_lshl_b32 s68, s89, 6
    s_lshl_b32 s88, s88, 5
    s_sub_u32 s88, s88, 1024
    s_lshl_b32 s89, s89, 5
    s_sub_u32 s89, s89, 1024
    v_add_u32 v8, 228352, v7
    v_add_u32 v10, s88, v9
    v_add_u32 v12, s89, v11
    v_lshlrev_b32 v2, 4, v1
    s_mul_i32 s91, s15, 448
    s_bitcmp0_b32 s15, 0
    s_cselect_b32 s88, 0, 192
    s_cselect_b32 s89, 256, 64
    s_cselect_b32 s92, 384, 0
    s_cmp_eq_u32 s16, 0
    s_cselect_b32 s88, s88, s89
    s_add_u32 s88, s88, s91
    s_add_u32 s92, s92, s91
    s_lshl_b32 s91, s15, 7
    s_mov_b32 s10, s88
    s_ashr_i32 s11, s10, 31
    s_add_u32 s24, s80, s10
    s_addc_u32 s25, s81, s11
    s_sub_u32 s26, 7340032, s10
    s_mov_b32 s27, 0x20000
    s_sub_u32 s10, s88, 2048
    s_ashr_i32 s11, s10, 31
    s_add_u32 s28, s82, s10
    s_addc_u32 s29, s83, s11
    s_sub_u32 s30, 7340032, s10
    s_mov_b32 s31, 0x20000
    s_cmp_eq_u32 s16, 0
    s_cbranch_scc0 L_srd_kv
    s_add_u32 s89, s88, 128
    s_mov_b32 s10, s89
    s_ashr_i32 s11, s10, 31
    s_add_u32 s32, s80, s10
    s_addc_u32 s33, s81, s11
    s_sub_u32 s34, 7340032, s10
    s_mov_b32 s35, 0x20000
    s_sub_u32 s10, s89, 2048
    s_ashr_i32 s11, s10, 31
    s_add_u32 s36, s82, s10
    s_addc_u32 s37, s83, s11
    s_sub_u32 s38, 7340032, s10
    s_mov_b32 s39, 0x20000
    s_lshl_b32 s89, s90, 6
    s_add_u32 s89, s89, s91
    s_mov_b32 s10, s89
    s_ashr_i32 s11, s10, 31
    s_add_u32 s40, s96, s10
    s_addc_u32 s41, s97, s11
    s_sub_u32 s42, 6291456, s10
    s_mov_b32 s43, 0x20000
    s_lshl_b32 s78, s88, 6
    s_add_u32 s78, s78, 8192
    s_branch L_srd_done
L_srd_kv:
    s_add_u32 s89, s91, 2048
    s_mov_b32 s10, s89
    s_ashr_i32 s11, s10, 31
    s_add_u32 s32, s96, s10
    s_addc_u32 s33, s97, s11
    s_sub_u32 s34, 6291456, s10
    s_mov_b32 s35, 0x20000
    s_add_u32 s89, s91, 4096
    s_sub_u32 s10, s89, 2048
    s_ashr_i32 s11, s10, 31
    s_add_u32 s36, s96, s10
    s_addc_u32 s37, s97, s11
    s_sub_u32 s38, 6291456, s10
    s_mov_b32 s39, 0x20000
    s_cmp_eq_u32 s90, 0
    s_cselect_b32 s94, s80, s82
    s_cselect_b32 s95, s81, s83
    s_mov_b32 s10, s92
    s_ashr_i32 s11, s10, 31
    s_add_u32 s40, s94, s10
    s_addc_u32 s41, s95, s11
    s_sub_u32 s42, 7340032, s10
    s_mov_b32 s43, 0x20000
    s_lshr_b32 s78, s92, 7
    s_lshl_b32 s78, s78, 13
    s_bfe_u32 s89, s92, 0x10006
    s_lshl_b32 s89, s89, 10
    s_add_u32 s78, s78, s89
L_srd_done:
    s_mov_b32 s70, s19
    s_mov_b32 s64, 0
    s_mov_b32 s65, 0
    s_mov_b32 s66, 0
    s_lshl_b32 s89, s15, 2
    s_add_u32 s89, s89, s3
    s_lshl_b32 s89, s89, 10
    s_add_u32 s44, s98, s89
    s_addc_u32 s45, s99, 0
    s_mov_b32 s46, 1024
    s_mov_b32 s47, 0x20000
    s_lshl_b32 s88, s17, 11
    v_add_u32 v3, s88, v2
    v_xor_b32 v4, 2048, v3
    v_xor_b32 v5, 4096, v3
    v_xor_b32 v6, 0x1800, v3
    v_lshlrev_b32 v26, 3, v23
    v_lshl_add_u32 v26, v25, 6, v26
    v_lshl_add_u32 v28, v22, 5, v26
    v_lshrrev_b32 v30, 5, v1
    v_mul_u32_u24 v30, 10240, v30
    v_lshl_add_u32 v30, v22, 8, v30
    v_add_u32 v13, v30, v28
    v_xor_b32 v14, 32, v13
    v_lshl_add_u32 v15, v27, 8, v28
    v_xor_b32 v16, 32, v15
    v_lshl_add_u32 v30, v27, 8, v26
    v_add_u32 v30, 131072, v30
    v_and_b32 v26, 7, v1
    v_xor_b32 v26, v26, v27
    v_and_b32 v28, 15, v1
    v_lshlrev_b32 v28, 7, v28
    v_lshl_add_u32 v26, v26, 4, v28
    s_add_u32 s88, s19, 81920
    v_xor_b32 v28, 64, v26
    v_add_u32 v190, s88, v26
    v_add_u32 v191, s88, v28
    s_lshl_b32 s88, s9, 9
    s_add_u32 s88, s88, 69632
    s_lshl_b32 s89, s17, 7
    v_lshlrev_b32 v188, 3, v1
    v_xor_b32 v188, s89, v188
    v_add_u32 v188, s88, v188
    v_bfe_u32 v26, v1, 2, 3
    v_lshl_add_u32 v26, v26, 11, v29
    s_lshl_b32 s88, s3, 14
    v_add_u32 v26, s88, v26
    v_add_u32 v17, 2048, v26
    v_add_u32 v18, 66560, v26
    v_add_u32 v19, 128, v26
    v_add_u32 v20, 64640, v26
    s_lshl_b32 s8, s8, 8
    s_sub_u32 s10, s8, 2048
    s_ashr_i32 s11, s10, 31
    s_add_u32 s56, s84, s10
    s_addc_u32 s57, s85, s11
    s_sub_u32 s58, 7340032, s10
    s_mov_b32 s59, 0x20000
    s_cmp_eq_u32 s3, 3
    s_cselect_b64 s[60:61], s[84:85], s[60:61]
    s_cselect_b32 s62, 7340032, s62
    s_cselect_b32 s10, 18, 14
    s_cselect_b32 s11, 0, 4
    s_cmp_eq_u32 s3, 2
    s_cselect_b32 s10, 12, s10
    s_lshl_b32 s11, s11, 8
    s_add_u32 s11, s11, s2
    s_mul_i32 s11, s11, s10
    s_lshl_b32 s89, s10, 15
    v_add_u32 v29, s11, v1
    v_lshlrev_b32 v29, 7, v29
    v_mov_b32 v28, s89
    v_bfrev_b32 v26, 1
    v_cmp_gt_u32 vcc, s10, v1
    s_nop 1
    v_cndmask_b32 v29, v26, v29, vcc
    s_mov_b32 s98, s86
    s_mov_b32 s99, s87
    s_and_b32 s96, s15, 3
    s_mul_i32 s97, s17, 114688
    s_xor_b32 s10, s96, 0
    s_lshr_b32 s11, s10, 1
    s_mul_i32 s11, s11, 57344
    s_add_u32 s11, s11, s97
    s_and_b32 s10, s10, 1
    s_add_u32 s92, s11, 24576
    s_mul_i32 s80, s10, 40960
    s_add_u32 s80, s80, s11
    s_add_u32 s81, s80, 8192
    s_lshl_b32 s10, s10, 14
    s_add_u32 s10, s10, s11
    s_add_u32 s88, s10, 16384
    s_xor_b32 s10, s96, 1
    s_lshr_b32 s11, s10, 1
    s_mul_i32 s11, s11, 57344
    s_add_u32 s11, s11, s97
    s_and_b32 s10, s10, 1
    s_mul_i32 s82, s10, 40960
    s_add_u32 s82, s82, s11
    s_add_u32 s83, s82, 8192
    s_lshl_b32 s10, s10, 14
    s_add_u32 s10, s10, s11
    s_add_u32 s89, s10, 16384
    s_xor_b32 s10, s96, 2
    s_lshr_b32 s11, s10, 1
    s_mul_i32 s11, s11, 57344
    s_add_u32 s11, s11, s97
    s_and_b32 s10, s10, 1
    s_add_u32 s93, s11, 24576
    s_mul_i32 s84, s10, 40960
    s_add_u32 s84, s84, s11
    s_add_u32 s85, s84, 8192
    s_lshl_b32 s10, s10, 14
    s_add_u32 s10, s10, s11
    s_add_u32 s90, s10, 16384
    s_xor_b32 s10, s96, 3
    s_lshr_b32 s11, s10, 1
    s_mul_i32 s11, s11, 57344
    s_add_u32 s11, s11, s97
    s_and_b32 s10, s10, 1
    s_mul_i32 s86, s10, 40960
    s_add_u32 s86, s86, s11
    s_add_u32 s87, s86, 8192
    s_lshl_b32 s10, s10, 14
    s_add_u32 s10, s10, s11
    s_add_u32 s91, s10, 16384
    s_mov_b32 s76, 0xbfb8aa3b
    s_mov_b32 s77, 0x3fb8aa3b
    s_mov_b32 s72, 1
    s_mov_b32 s73, 40960
    s_mov_b32 s71, 4
    s_mov_b32 s74, 40960
    s_mov_b32 s75, 0xfffe2000
    s_mov_b32 s69, 16384
    s_getpc_b64 s[10:11]
L_pc2:
    s_lshr_b32 s96, s2, 3
    s_lshl_b32 s96, s96, 2
    s_add_u32 s96, s96, s3
    s_mul_i32 s96, s96, 1024
    v_min_u32 v24, 7, v1
    v_lshl_add_u32 v24, v24, 7, s96
    v_add_u32 v24, L_st0-L_pc2, v24
    v_min_u32 v24, L_end-L_pc2-4, v24
    v_mov_b32 v25, s11
    v_add_co_u32 v24, vcc, s10, v24
    s_nop 1
    v_addc_co_u32 v25, vcc, 0, v25, vcc
    v_and_b32 v22, 31, v1
    v_lshlrev_b32 v22, 2, v22
    s_lshl_b32 s95, s9, 7
    s_mov_b32 s94, 0xffff0000
    v_lshl_add_u32 v37, v34, 4, v37
    v_lshrrev_b32 v38, 2, v33
    v_lshl_add_u32 v37, v38, 10, v37
    v_and_b32 v38, 3, v33
    v_lshl_add_u32 v37, v38, 8, v37
    v_xor_b32 v38, v33, v34
    v_lshlrev_b32 v38, 4, v38
    v_add_u32 v38, s19, v38
    v_lshl_add_u32 v182, v34, 7, v38
    v_lshl_add_u32 v183, v33, 7, v38
    v_lshlrev_b32 v35, 3, v33
    v_add_u32 v39, 132096, v35
    v_add_u32 v38, s19, v39
    s_add_u32 s48, s12, 0
    s_addc_u32 s49, s13, 0
    s_mov_b32 s50, 4194304
    s_mov_b32 s51, 0x20000
    s_lshr_b32 s96, s79, 3
    s_lshl_b32 s96, s96, 17
    s_bfe_u32 s10, s79, 0x20001
    s_lshl_b32 s10, s10, 11
    s_add_u32 s96, s96, s10
    s_and_b32 s10, s79, 1
    s_lshl_b32 s10, s10, 7
    s_add_u32 s96, s96, s10
    s_lshl_b32 s97, s79, 6
    s_add_u32 s97, s97, 69632
    s_lshl_b32 s79, s79, 2
    s_add_u32 s79, s79, s3
    s_lshl_b32 s79, s79, 2
    s_waitcnt vmcnt(8)
    v_lshlrev_b32 v64, 16, v40
    v_and_b32 v65, s94, v40
    v_lshlrev_b32 v66, 16, v41
    v_and_b32 v67, s94, v41
    v_lshlrev_b32 v68, 16, v42
    v_and_b32 v69, s94, v42
    v_lshlrev_b32 v70, 16, v43
    v_and_b32 v71, s94, v43
    s_waitcnt vmcnt(7)
    v_lshlrev_b32 v72, 16, v44
    v_and_b32 v73, s94, v44
    v_lshlrev_b32 v74, 16, v45
    v_and_b32 v75, s94, v45
    v_lshlrev_b32 v76, 16, v46
    v_and_b32 v77, s94, v46
    v_lshlrev_b32 v78, 16, v47
    v_and_b32 v79, s94, v47
    s_waitcnt vmcnt(6)
    v_lshlrev_b32 v80, 16, v48
    v_and_b32 v81, s94, v48
    v_lshlrev_b32 v82, 16, v49
    v_and_b32 v83, s94, v49
    v_lshlrev_b32 v84, 16, v50
    v_and_b32 v85, s94, v50
    v_lshlrev_b32 v86, 16, v51
    v_and_b32 v87, s94, v51
    s_waitcnt vmcnt(5)
    v_lshlrev_b32 v88, 16, v52
    v_and_b32 v89, s94, v52
    v_lshlrev_b32 v90, 16, v53
    v_and_b32 v91, s94, v53
    v_lshlrev_b32 v92, 16, v54
    v_and_b32 v93, s94, v54
    v_lshlrev_b32 v94, 16, v55
    v_and_b32 v95, s94, v55
    v_pk_add_f32 v[56:57], v[64:65], v[66:67]
    v_pk_add_f32 v[58:59], v[68:69], v[70:71]
    v_pk_add_f32 v[56:57], v[56:57], v[72:73]
    v_pk_add_f32 v[58:59], v[58:59], v[74:75]
    v_pk_add_f32 v[56:57], v[56:57], v[76:77]
    v_pk_add_f32 v[58:59], v[58:59], v[78:79]
    v_pk_add_f32 v[56:57], v[56:57], v[80:81]
    v_pk_add_f32 v[58:59], v[58:59], v[82:83]
    v_pk_add_f32 v[56:57], v[56:57], v[84:85]
    v_pk_add_f32 v[58:59], v[58:59], v[86:87]
    v_pk_add_f32 v[56:57], v[56:57], v[88:89]
    v_pk_add_f32 v[58:59], v[58:59], v[90:91]
    v_pk_add_f32 v[56:57], v[56:57], v[92:93]
    v_pk_add_f32 v[58:59], v[58:59], v[94:95]
    v_pk_add_f32 v[56:57], v[56:57], v[58:59]
    v_add_f32 v56, v56, v57
    s_nop 1
    v_add_f32_dpp v56, v56, v56 quad_perm:[1,0,3,2] row_mask:0xf bank_mask:0xf
    s_nop 1
    v_add_f32_dpp v56, v56, v56 quad_perm:[2,3,0,1] row_mask:0xf bank_mask:0xf
    s_nop 1
    v_add_f32_dpp v56, v56, v56 row_half_mirror row_mask:0xf bank_mask:0xf
    v_mul_f32 v58, 0x3b800000, v56
    v_pk_add_f32 v[40:41], v[64:65], v[58:59] op_sel_hi:[1,0] neg_lo:[0,1] neg_hi:[0,1]
    v_pk_mul_f32 v[60:61], v[40:41], v[40:41]
    v_pk_add_f32 v[42:43], v[66:67], v[58:59] op_sel_hi:[1,0] neg_lo:[0,1] neg_hi:[0,1]
    v_pk_mul_f32 v[62:63], v[42:43], v[42:43]
    v_pk_add_f32 v[44:45], v[68:69], v[58:59] op_sel_hi:[1,0] neg_lo:[0,1] neg_hi:[0,1]
    v_pk_fma_f32 v[60:61], v[44:45], v[44:45], v[60:61]
    v_pk_add_f32 v[46:47], v[70:71], v[58:59] op_sel_hi:[1,0] neg_lo:[0,1] neg_hi:[0,1]
    v_pk_fma_f32 v[62:63], v[46:47], v[46:47], v[62:63]
    v_pk_add_f32 v[48:49], v[72:73], v[58:59] op_sel_hi:[1,0] neg_lo:[0,1] neg_hi:[0,1]
    v_pk_fma_f32 v[60:61], v[48:49], v[48:49], v[60:61]
    v_pk_add_f32 v[50:51], v[74:75], v[58:59] op_sel_hi:[1,0] neg_lo:[0,1] neg_hi:[0,1]
    v_pk_fma_f32 v[62:63], v[50:51], v[50:51], v[62:63]
    v_pk_add_f32 v[52:53], v[76:77], v[58:59] op_sel_hi:[1,0] neg_lo:[0,1] neg_hi:[0,1]
    v_pk_fma_f32 v[60:61], v[52:53], v[52:53], v[60:61]
    v_pk_add_f32 v[54:55], v[78:79], v[58:59] op_sel_hi:[1,0] neg_lo:[0,1] neg_hi:[0,1]
    v_pk_fma_f32 v[62:63], v[54:55], v[54:55], v[62:63]
    v_pk_add_f32 v[40:41], v[80:81], v[58:59] op_sel_hi:[1,0] neg_lo:[0,1] neg_hi:[0,1]
    v_pk_fma_f32 v[60:61], v[40:41], v[40:41], v[60:61]
    v_pk_add_f32 v[42:43], v[82:83], v[58:59] op_sel_hi:[1,0] neg_lo:[0,1] neg_hi:[0,1]
    v_pk_fma_f32 v[62:63], v[42:43], v[42:43], v[62:63]
    v_pk_add_f32 v[44:45], v[84:85], v[58:59] op_sel_hi:[1,0] neg_lo:[0,1] neg_hi:[0,1]
    v_pk_fma_f32 v[60:61], v[44:45], v[44:45], v[60:61]
    v_pk_add_f32 v[46:47], v[86:87], v[58:59] op_sel_hi:[1,0] neg_lo:[0,1] neg_hi:[0,1]
    v_pk_fma_f32 v[62:63], v[46:47], v[46:47], v[62:63]
    v_pk_add_f32 v[48:49], v[88:89], v[58:59] op_sel_hi:[1,0] neg_lo:[0,1] neg_hi:[0,1]
    v_pk_fma_f32 v[60:61], v[48:49], v[48:49], v[60:61]
    v_pk_add_f32 v[50:51], v[90:91], v[58:59] op_sel_hi:[1,0] neg_lo:[0,1] neg_hi:[0,1]
    v_pk_fma_f32 v[62:63], v[50:51], v[50:51], v[62:63]
    v_pk_add_f32 v[52:53], v[92:93], v[58:59] op_sel_hi:[1,0] neg_lo:[0,1] neg_hi:[0,1]
    v_pk_fma_f32 v[60:61], v[52:53], v[52:53], v[60:61]
    v_pk_add_f32 v[54:55], v[94:95], v[58:59] op_sel_hi:[1,0] neg_lo:[0,1] neg_hi:[0,1]
    v_pk_fma_f32 v[62:63], v[54:55], v[54:55], v[62:63]
    v_pk_add_f32 v[60:61], v[60:61], v[62:63]
    v_add_f32 v59, v60, v61
    s_nop 1
    v_add_f32_dpp v59, v59, v59 quad_perm:[1,0,3,2] row_mask:0xf bank_mask:0xf
    s_nop 1
    v_add_f32_dpp v59, v59, v59 quad_perm:[2,3,0,1] row_mask:0xf bank_mask:0xf
    s_nop 1
    v_add_f32_dpp v59, v59, v59 row_half_mirror row_mask:0xf bank_mask:0xf
    ds_write_b64 v38, v[58:59]
    s_add_u32 m0, s19, 86016
    s_nop 0
    buffer_load_dwordx4 v244, s[20:23], 0 offen offset:0 lds
    s_waitcnt lgkmcnt(0)
    s_barrier
    ds_read_b64 v[40:41], v39 offset:0
    ds_read_b64 v[42:43], v39 offset:10240
    ds_read_b64 v[44:45], v39 offset:20480
    ds_read_b64 v[46:47], v39 offset:30720
    buffer_load_dwordx4 v245, s[20:23], 0 offen offset:1024 lds
    s_mul_i32 s18, s18, 0x9e3779b1
    s_add_u32 s18, s18, 0x7f4a7c15
    v_mov_b32 v21, s18
    v_mov_b32 v51, s18
    s_cmp_lg_u32 s3, 0
    s_waitcnt lgkmcnt(0)
    v_add_f32 v48, v40, v42
    v_add_f32 v49, v44, v46
    v_add_f32 v48, v48, v49
    v_mul_f32 v48, 0x3e800000, v48
    v_add_f32 v49, v41, v43
    v_add_f32 v50, v45, v47
    v_add_f32 v49, v49, v50
    v_sub_f32 v40, v40, v48
    v_sub_f32 v42, v42, v48
    v_sub_f32 v44, v44, v48
    v_sub_f32 v46, v46, v48
    v_mul_f32 v50, v40, v40
    v_fmac_f32 v50, v42, v42
    v_fmac_f32 v50, v44, v44
    v_fmac_f32 v50, v46, v46
    v_mul_f32 v49, 0x3a800000, v49
    v_fmac_f32 v49, 0x3e800000, v50
    v_cvt_pk_bf16_f32 v49, v49, v49
    v_lshlrev_b32 v49, 16, v49
    v_add_f32 v49, 0x3727c5ac, v49
    v_cvt_pk_bf16_f32 v49, v49, v49
    v_lshlrev_b32 v49, 16, v49
    v_sqrt_f32 v49, v49
    s_nop 0
    v_cvt_pk_bf16_f32 v50, v48, v49
    s_cbranch_scc1 L_nost
    s_mov_b32 exec_lo, 0x01010101
    s_mov_b32 exec_hi, 0x01010101
    buffer_store_dwordx2 v[50:51], v35, s[52:55], s97 offen sc1
    s_mov_b64 exec, -1
L_nost:
    v_and_b32 v49, s94, v50
    v_lshlrev_b32 v48, 16, v50
    v_rcp_f32 v49, v49
    s_nop 0
    v_pk_add_f32 v[64:65], v[64:65], v[48:49] op_sel_hi:[1,0] neg_lo:[0,1] neg_hi:[0,1]
    v_pk_add_f32 v[66:67], v[66:67], v[48:49] op_sel_hi:[1,0] neg_lo:[0,1] neg_hi:[0,1]
    v_pk_add_f32 v[68:69], v[68:69], v[48:49] op_sel_hi:[1,0] neg_lo:[0,1] neg_hi:[0,1]
    v_pk_add_f32 v[70:71], v[70:71], v[48:49] op_sel_hi:[1,0] neg_lo:[0,1] neg_hi:[0,1]
    buffer_load_dwordx4 v246, s[20:23], 0 offen offset:2048 lds
    v_cvt_pk_bf16_f32 v64, v64, v65
    v_cvt_pk_bf16_f32 v66, v66, v67
    v_cvt_pk_bf16_f32 v68, v68, v69
    v_cvt_pk_bf16_f32 v70, v70, v71
    v_and_b32 v65, s94, v64
    v_lshlrev_b32 v64, 16, v64
    v_and_b32 v67, s94, v66
    buffer_load_dwordx4 v247, s[20:23], 0 offen offset:3072 lds
    v_lshlrev_b32 v66, 16, v66
    v_and_b32 v69, s94, v68
    v_lshlrev_b32 v68, 16, v68
    v_and_b32 v71, s94, v70
    v_lshlrev_b32 v70, 16, v70
    v_pk_mul_f32 v[64:65], v[64:65], v[48:49] op_sel:[0,1] op_sel_hi:[1,1]
    v_pk_mul_f32 v[66:67], v[66:67], v[48:49] op_sel:[0,1] op_sel_hi:[1,1]
    s_mov_b32 m0, s70
    s_nop 0
    buffer_load_dwordx4 v7, s[24:27], s64 offen offset:0 lds
    v_pk_mul_f32 v[68:69], v[68:69], v[48:49] op_sel:[0,1] op_sel_hi:[1,1]
    v_pk_mul_f32 v[70:71], v[70:71], v[48:49] op_sel:[0,1] op_sel_hi:[1,1]
    v_cvt_pk_bf16_f32 v160, v64, v65
    v_cvt_pk_bf16_f32 v161, v66, v67
    v_cvt_pk_bf16_f32 v162, v68, v69
    v_cvt_pk_bf16_f32 v163, v70, v71
    ds_write_b128 v182, v[160:163] offset:40960
    v_pk_add_f32 v[72:73], v[72:73], v[48:49] op_sel_hi:[1,0] neg_lo:[0,1] neg_hi:[0,1]
    buffer_load_dwordx4 v8, s[24:27], s64 offen offset:1024 lds
    v_pk_add_f32 v[74:75], v[74:75], v[48:49] op_sel_hi:[1,0] neg_lo:[0,1] neg_hi:[0,1]
    v_pk_add_f32 v[76:77], v[76:77], v[48:49] op_sel_hi:[1,0] neg_lo:[0,1] neg_hi:[0,1]
    v_pk_add_f32 v[78:79], v[78:79], v[48:49] op_sel_hi:[1,0] neg_lo:[0,1] neg_hi:[0,1]
    v_cvt_pk_bf16_f32 v72, v72, v73
    v_cvt_pk_bf16_f32 v74, v74, v75
    v_cvt_pk_bf16_f32 v76, v76, v77
    v_cvt_pk_bf16_f32 v78, v78, v79
    buffer_load_dwordx4 v7, s[28:31], s64 offen offset:2048 lds
    v_and_b32 v73, s94, v72
    v_lshlrev_b32 v72, 16, v72
    v_and_b32 v75, s94, v74
    v_lshlrev_b32 v74, 16, v74
    v_and_b32 v77, s94, v76
    v_lshlrev_b32 v76, 16, v76
    v_and_b32 v79, s94, v78
    buffer_load_dwordx4 v8, s[28:31], s64 offen offset:3072 lds
    v_lshlrev_b32 v78, 16, v78
    v_pk_mul_f32 v[72:73], v[72:73], v[48:49] op_sel:[0,1] op_sel_hi:[1,1]
    v_pk_mul_f32 v[74:75], v[74:75], v[48:49] op_sel:[0,1] op_sel_hi:[1,1]
    v_pk_mul_f32 v[76:77], v[76:77], v[48:49] op_sel:[0,1] op_sel_hi:[1,1]
    v_pk_mul_f32 v[78:79], v[78:79], v[48:49] op_sel:[0,1] op_sel_hi:[1,1]
    v_cvt_pk_bf16_f32 v164, v72, v73
    v_cvt_pk_bf16_f32 v165, v74, v75
    s_add_u32 m0, s70, 4096
    s_nop 0
    buffer_load_dwordx4 v9, s[32:35], s65 offen offset:0 lds
    v_cvt_pk_bf16_f32 v166, v76, v77
    v_cvt_pk_bf16_f32 v167, v78, v79
    ds_write_b128 v182, v[164:167] offset:41984
    v_pk_add_f32 v[80:81], v[80:81], v[48:49] op_sel_hi:[1,0] neg_lo:[0,1] neg_hi:[0,1]
    v_pk_add_f32 v[82:83], v[82:83], v[48:49] op_sel_hi:[1,0] neg_lo:[0,1] neg_hi:[0,1]
    v_pk_add_f32 v[84:85], v[84:85], v[48:49] op_sel_hi:[1,0] neg_lo:[0,1] neg_hi:[0,1]
    v_pk_add_f32 v[86:87], v[86:87], v[48:49] op_sel_hi:[1,0] neg_lo:[0,1] neg_hi:[0,1]
    v_cvt_pk_bf16_f32 v80, v80, v81
    buffer_load_dwordx4 v10, s[32:35], s65 offen offset:1024 lds
    v_cvt_pk_bf16_f32 v82, v82, v83
    v_cvt_pk_bf16_f32 v84, v84, v85
    v_cvt_pk_bf16_f32 v86, v86, v87
    v_and_b32 v81, s94, v80
    v_lshlrev_b32 v80, 16, v80
    v_and_b32 v83, s94, v82
    v_lshlrev_b32 v82, 16, v82
    buffer_load_dwordx4 v9, s[36:39], s65 offen offset:2048 lds
    v_and_b32 v85, s94, v84
    v_lshlrev_b32 v84, 16, v84
    v_and_b32 v87, s94, v86
    v_lshlrev_b32 v86, 16, v86
    v_pk_mul_f32 v[80:81], v[80:81], v[48:49] op_sel:[0,1] op_sel_hi:[1,1]
    v_pk_mul_f32 v[82:83], v[82:83], v[48:49] op_sel:[0,1] op_sel_hi:[1,1]
    v_pk_mul_f32 v[84:85], v[84:85], v[48:49] op_sel:[0,1] op_sel_hi:[1,1]
    buffer_load_dwordx4 v10, s[36:39], s65 offen offset:3072 lds
    v_pk_mul_f32 v[86:87], v[86:87], v[48:49] op_sel:[0,1] op_sel_hi:[1,1]
    v_cvt_pk_bf16_f32 v168, v80, v81
    v_cvt_pk_bf16_f32 v169, v82, v83
    v_cvt_pk_bf16_f32 v170, v84, v85
    v_cvt_pk_bf16_f32 v171, v86, v87
    ds_write_b128 v182, v[168:171] offset:43008
    v_pk_add_f32 v[88:89], v[88:89], v[48:49] op_sel_hi:[1,0] neg_lo:[0,1] neg_hi:[0,1]
    v_pk_add_f32 v[90:91], v[90:91], v[48:49] op_sel_hi:[1,0] neg_lo:[0,1] neg_hi:[0,1]
    s_add_u32 m0, s70, 8192
    s_nop 0
    buffer_load_dwordx4 v11, s[40:43], s66 offen offset:0 lds
    v_pk_add_f32 v[92:93], v[92:93], v[48:49] op_sel_hi:[1,0] neg_lo:[0,1] neg_hi:[0,1]
    v_pk_add_f32 v[94:95], v[94:95], v[48:49] op_sel_hi:[1,0] neg_lo:[0,1] neg_hi:[0,1]
    v_cvt_pk_bf16_f32 v88, v88, v89
    v_cvt_pk_bf16_f32 v90, v90, v91
    v_cvt_pk_bf16_f32 v92, v92, v93
    v_cvt_pk_bf16_f32 v94, v94, v95
    v_and_b32 v89, s94, v88
    buffer_load_dwordx4 v12, s[40:43], s66 offen offset:1024 lds
    s_add_u32 s64, s64, 458752
    s_add_u32 s65, s65, s67
    s_add_u32 s66, s66, s68
    s_add_u32 s70, s70, 40960
    v_lshlrev_b32 v88, 16, v88
    v_and_b32 v91, s94, v90
    v_lshlrev_b32 v90, 16, v90
    v_and_b32 v93, s94, v92
    v_lshlrev_b32 v92, 16, v92
    v_and_b32 v95, s94, v94
    v_lshlrev_b32 v94, 16, v94
    s_add_u32 m0, s19, 131072
    s_nop 0
    buffer_load_dwordx4 v2, s[44:47], 0 offen lds
    s_mul_i32 s10, s9, 589824
    s_add_u32 s10, s10, 4194304
    s_add_u32 s44, s12, s10
    s_addc_u32 s45, s13, 0
    s_mov_b32 s46, 589824
    s_mov_b32 s47, 0x20000
    v_pk_mul_f32 v[88:89], v[88:89], v[48:49] op_sel:[0,1] op_sel_hi:[1,1]
    v_pk_mul_f32 v[90:91], v[90:91], v[48:49] op_sel:[0,1] op_sel_hi:[1,1]
    v_pk_mul_f32 v[92:93], v[92:93], v[48:49] op_sel:[0,1] op_sel_hi:[1,1]
    v_pk_mul_f32 v[94:95], v[94:95], v[48:49] op_sel:[0,1] op_sel_hi:[1,1]
    v_cvt_pk_bf16_f32 v172, v88, v89
    v_cvt_pk_bf16_f32 v173, v90, v91
    v_cvt_pk_bf16_f32 v174, v92, v93
    s_add_u32 m0, s19, 122752
    s_nop 0
    buffer_load_dwordx4 v240, s[20:23], 0 offen offset:128 lds
    v_cvt_pk_bf16_f32 v175, v94, v95
    ds_write_b128 v182, v[172:175] offset:44032
    ds_read_b128 v[160:163], v183 offset:40960
    ds_read_b128 v[164:167], v183 offset:41984
    ds_read_b128 v[168:171], v183 offset:43008
    ds_read_b128 v[172:175], v183 offset:44032
    s_waitcnt vmcnt(12)
    ds_read_b128 v[128:131], v190 offset:0
    ds_read_b128 v[132:135], v191 offset:0
    ds_read_b128 v[136:139], v190 offset:2048
    ds_read_b128 v[140:143], v191 offset:2048
    ds_read_b128 v[144:147], v190 offset:4096
    ds_read_b128 v[148:151], v191 offset:4096
    ds_read_b128 v[152:155], v190 offset:6144
    ds_read_b128 v[156:159], v191 offset:6144
    buffer_load_dwordx4 v241, s[20:23], 0 offen offset:1152 lds
    buffer_load_dwordx4 v242, s[20:23], 0 offen offset:2176 lds
    buffer_load_dwordx4 v243, s[20:23], 0 offen offset:3200 lds
    s_add_u32 m0, s19, 126848
    s_nop 0
    buffer_load_dwordx4 v244, s[20:23], 0 offen offset:128 lds
    buffer_load_dwordx4 v245, s[20:23], 0 offen offset:1152 lds
    buffer_load_dwordx4 v246, s[20:23], 0 offen offset:2176 lds
    buffer_load_dwordx4 v247, s[20:23], 0 offen offset:3200 lds
    buffer_load_dwordx2 v[184:185], v188, s[52:55], 0 offen sc1
    s_waitcnt lgkmcnt(8)
    buffer_store_dwordx4 v[160:163], v37, s[48:51], s96 offen sc1
    s_add_u32 s96, s96, 8192
    buffer_store_dwordx4 v[164:167], v37, s[48:51], s96 offen sc1
    s_add_u32 s96, s96, 8192
    buffer_store_dwordx4 v[168:171], v37, s[48:51], s96 offen sc1
    s_add_u32 s96, s96, 8192
    buffer_store_dwordx4 v[172:175], v37, s[48:51], s96 offen sc1
    s_lshl_b32 s10, s15, 2
    s_add_u32 s10, s10, s3
    s_lshl_b32 s10, s10, 15
    s_add_u32 s10, s10, 25165824
    s_add_u32 s48, s12, s10
    s_addc_u32 s49, s13, 0
    s_mov_b32 s50, 32768
    s_mov_b32 s51, 0x20000
    s_lshl_b32 s10, s9, 17
    s_add_u32 s20, s12, s10
    s_addc_u32 s21, s13, 0
    s_mov_b32 s22, 131072
    s_mov_b32 s23, 0x20000
    s_waitcnt lgkmcnt(0)
    v_lshlrev_b32 v96, 16, v128
    v_and_b32 v97, s94, v128
    v_lshlrev_b32 v98, 16, v129
    v_and_b32 v99, s94, v129
    v_lshlrev_b32 v100, 16, v130
    v_and_b32 v101, s94, v130
    v_lshlrev_b32 v102, 16, v131
    v_and_b32 v103, s94, v131
    v_lshlrev_b32 v104, 16, v132
    v_and_b32 v105, s94, v132
    v_lshlrev_b32 v106, 16, v133
    v_and_b32 v107, s94, v133
    v_lshlrev_b32 v108, 16, v134
    v_and_b32 v109, s94, v134
    v_lshlrev_b32 v110, 16, v135
    v_and_b32 v111, s94, v135
    v_lshlrev_b32 v112, 16, v136
    v_and_b32 v113, s94, v136
    v_lshlrev_b32 v114, 16, v137
    v_and_b32 v115, s94, v137
    v_lshlrev_b32 v116, 16, v138
    v_and_b32 v117, s94, v138
    v_lshlrev_b32 v118, 16, v139
    v_and_b32 v119, s94, v139
    v_lshlrev_b32 v120, 16, v140
    v_and_b32 v121, s94, v140
    v_lshlrev_b32 v122, 16, v141
    v_and_b32 v123, s94, v141
    v_lshlrev_b32 v124, 16, v142
    v_and_b32 v125, s94, v142
    v_lshlrev_b32 v126, 16, v143
    v_and_b32 v127, s94, v143
    v_lshlrev_b32 v128, 16, v144
    v_and_b32 v129, s94, v144
    v_lshlrev_b32 v130, 16, v145
    v_and_b32 v131, s94, v145
    v_lshlrev_b32 v132, 16, v146
    v_and_b32 v133, s94, v146
    v_lshlrev_b32 v134, 16, v147
    v_and_b32 v135, s94, v147
    v_lshlrev_b32 v136, 16, v148
    v_and_b32 v137, s94, v148
    v_lshlrev_b32 v138, 16, v149
    v_and_b32 v139, s94, v149
    v_lshlrev_b32 v140, 16, v150
    v_and_b32 v141, s94, v150
    v_lshlrev_b32 v142, 16, v151
    v_and_b32 v143, s94, v151
    v_lshlrev_b32 v144, 16, v152
    v_and_b32 v145, s94, v152
    v_lshlrev_b32 v146, 16, v153
    v_and_b32 v147, s94, v153
    v_lshlrev_b32 v148, 16, v154
    v_and_b32 v149, s94, v154
    v_lshlrev_b32 v150, 16, v155
    v_and_b32 v151, s94, v155
    v_lshlrev_b32 v152, 16, v156
    v_and_b32 v153, s94, v156
    v_lshlrev_b32 v154, 16, v157
    v_and_b32 v155, s94, v157
    v_lshlrev_b32 v156, 16, v158
    v_and_b32 v157, s94, v158
    v_lshlrev_b32 v158, 16, v159
    v_and_b32 v159, s94, v159
    buffer_load_dwordx2 v[186:187], v188, s[52:55], 0 offen sc1
    s_mov_b32 exec_hi, 0
    buffer_load_dword v0, v236, s[60:63], 0 offen
    s_mov_b32 exec_hi, -1
    s_cmp_eq_u32 s16, 0
    s_cbranch_scc1 L_Q
    s_waitcnt vmcnt(7)
    s_mov_b32 m0, s70
    s_nop 0
    buffer_load_dwordx4 v7, s[24:27], s64 offen offset:0 lds
    buffer_load_dwordx4 v8, s[24:27], s64 offen offset:1024 lds
    buffer_load_dwordx4 v7, s[28:31], s64 offen offset:2048 lds
    buffer_load_dwordx4 v8, s[28:31], s64 offen offset:3072 lds
    ds_read_b128 v[224:227], v190 offset:40960
    ds_read_b128 v[228:231], v191 offset:40960
    ds_read_b128 v[232:235], v190 offset:43008
    ds_read_b128 v[236:239], v191 offset:43008
    ds_read_b128 v[240:243], v190 offset:45056
    ds_read_b128 v[244:247], v191 offset:45056
    ds_read_b128 v[248:251], v190 offset:47104
    ds_read_b128 v[252:255], v191 offset:47104
    s_barrier
    s_waitcnt lgkmcnt(0)
    ds_read_b64_tr_b16 a[224:225], v30 offset:0
    ds_read_b64_tr_b16 a[226:227], v30 offset:10240
    ds_read_b64_tr_b16 a[228:229], v30 offset:32
    ds_read_b64_tr_b16 a[230:231], v30 offset:10272
    ds_read_b64_tr_b16 a[232:233], v30 offset:20480
    ds_read_b64_tr_b16 a[234:235], v30 offset:30720
    ds_read_b64_tr_b16 a[236:237], v30 offset:20512
    ds_read_b64_tr_b16 a[238:239], v30 offset:30752
    v_lshlrev_b32 v192, 16, v224
    v_and_b32 v193, s94, v224
    v_lshlrev_b32 v194, 16, v225
    v_and_b32 v195, s94, v225
    v_lshlrev_b32 v196, 16, v226
    v_and_b32 v197, s94, v226
    v_lshlrev_b32 v198, 16, v227
    v_and_b32 v199, s94, v227
    v_lshlrev_b32 v200, 16, v228
    v_and_b32 v201, s94, v228
    v_lshlrev_b32 v202, 16, v229
    v_and_b32 v203, s94, v229
    v_lshlrev_b32 v204, 16, v230
    v_and_b32 v205, s94, v230
    v_lshlrev_b32 v206, 16, v231
    v_and_b32 v207, s94, v231
    v_lshlrev_b32 v208, 16, v232
    v_and_b32 v209, s94, v232
    v_lshlrev_b32 v210, 16, v233
    v_and_b32 v211, s94, v233
    v_lshlrev_b32 v212, 16, v234
    v_and_b32 v213, s94, v234
    v_lshlrev_b32 v214, 16, v235
    v_and_b32 v215, s94, v235
    v_lshlrev_b32 v216, 16, v236
    v_and_b32 v217, s94, v236
    v_lshlrev_b32 v218, 16, v237
    v_and_b32 v219, s94, v237
    v_lshlrev_b32 v220, 16, v238
    v_and_b32 v221, s94, v238
    v_lshlrev_b32 v222, 16, v239
    v_and_b32 v223, s94, v239
    ds_read_b64_tr_b16 a[192:193], v13 offset:0
    ds_read_b64_tr_b16 a[194:195], v13 offset:20480
    ds_read_b64_tr_b16 a[196:197], v13 offset:1024
    ds_read_b64_tr_b16 a[198:199], v13 offset:21504
    ds_read_b64_tr_b16 a[200:201], v14 offset:0
    ds_read_b64_tr_b16 a[202:203], v14 offset:20480
    ds_read_b64_tr_b16 a[204:205], v14 offset:1024
    ds_read_b64_tr_b16 a[206:207], v14 offset:21504
    v_lshlrev_b32 v224, 16, v240
    v_and_b32 v225, s94, v240
    v_lshlrev_b32 v226, 16, v241
    v_and_b32 v227, s94, v241
    v_lshlrev_b32 v228, 16, v242
    v_and_b32 v229, s94, v242
    v_lshlrev_b32 v230, 16, v243
    v_and_b32 v231, s94, v243
    v_lshlrev_b32 v232, 16, v244
    v_and_b32 v233, s94, v244
    v_lshlrev_b32 v234, 16, v245
    v_and_b32 v235, s94, v245
    v_lshlrev_b32 v236, 16, v246
    v_and_b32 v237, s94, v246
    v_lshlrev_b32 v238, 16, v247
    v_and_b32 v239, s94, v247
    v_lshlrev_b32 v240, 16, v248
    v_and_b32 v241, s94, v248
    v_lshlrev_b32 v242, 16, v249
    v_and_b32 v243, s94, v249
    v_lshlrev_b32 v244, 16, v250
    v_and_b32 v245, s94, v250
    v_lshlrev_b32 v246, 16, v251
    v_and_b32 v247, s94, v251
    v_lshlrev_b32 v248, 16, v252
    v_and_b32 v249, s94, v252
    v_lshlrev_b32 v250, 16, v253
    v_and_b32 v251, s94, v253
    v_lshlrev_b32 v252, 16, v254
    v_and_b32 v253, s94, v254
    v_lshlrev_b32 v254, 16, v255
    v_and_b32 v255, s94, v255
    s_mov_b32 s10, 0x40000
    s_waitcnt vmcnt(10)
    v_cmp_ne_u32 vcc, s18, v185
    v_mov_b32 v176, v184
    s_cbranch_vccz L_ps_out
    buffer_load_dwordx2 v[184:185], v188, s[52:55], 0 offen sc1
    s_waitcnt vmcnt(6)
L_ps:
    v_cmp_ne_u32 vcc, s18, v187
    v_mov_b32 v176, v186
    s_cbranch_vccz L_ps_out
    buffer_load_dwordx2 v[186:187], v188, s[52:55], 0 offen sc1
    s_waitcnt vmcnt(1)
    v_cmp_ne_u32 vcc, s18, v185
    v_mov_b32 v176, v184
    s_cbranch_vccz L_ps_out
    buffer_load_dwordx2 v[184:185], v188, s[52:55], 0 offen sc1
    s_sub_u32 s10, s10, 1
    s_waitcnt vmcnt(1)
    s_cbranch_scc0 L_ps
L_ps_out:
    s_waitcnt vmcnt(6)
    s_mov_b64 exec, 1
    buffer_store_dword v21, off, s[52:55], s79 sc1
    s_mov_b64 exec, -1
    v_lshlrev_b32 v177, 16, v176
    v_and_b32 v176, s94, v176
    v_rcp_f32 v176, v176
    s_nop 0
    v_mul_f32_e64 v177, -v177, v176
    v_mov_b32 v180, v176
    v_mov_b32 v181, v177
    s_nop 0
    v_permlane32_swap_b32 v176, v180
    v_permlane32_swap_b32 v177, v181
    v_mov_b32 v178, v176
    v_mov_b32 v179, v177
    v_mov_b32 v26, v180
    v_mov_b32 v27, v181
    v_permlane16_swap_b32 v176, v178
    v_permlane16_swap_b32 v177, v179
    v_permlane16_swap_b32 v180, v26
    v_permlane16_swap_b32 v181, v27
    v_pk_fma_f32 v[96:97], v[96:97], v[176:177], v[176:177] op_sel:[0,0,1] op_sel_hi:[1,0,1]
    v_pk_fma_f32 v[98:99], v[98:99], v[176:177], v[176:177] op_sel:[0,0,1] op_sel_hi:[1,0,1]
    v_pk_fma_f32 v[100:101], v[100:101], v[176:177], v[176:177] op_sel:[0,0,1] op_sel_hi:[1,0,1]
    v_pk_fma_f32 v[102:103], v[102:103], v[176:177], v[176:177] op_sel:[0,0,1] op_sel_hi:[1,0,1]
    v_cvt_pk_bf16_f32 v96, v96, v97
    v_cvt_pk_bf16_f32 v98, v98, v99
    v_cvt_pk_bf16_f32 v100, v100, v101
    v_cvt_pk_bf16_f32 v102, v102, v103
    v_accvgpr_write_b32 a96, v96
    v_accvgpr_write_b32 a97, v98
    v_accvgpr_write_b32 a98, v100
    v_accvgpr_write_b32 a99, v102
    v_pk_fma_f32 v[104:105], v[104:105], v[176:177], v[176:177] op_sel:[0,0,1] op_sel_hi:[1,0,1]
    v_pk_fma_f32 v[106:107], v[106:107], v[176:177], v[176:177] op_sel:[0,0,1] op_sel_hi:[1,0,1]
    v_pk_fma_f32 v[108:109], v[108:109], v[176:177], v[176:177] op_sel:[0,0,1] op_sel_hi:[1,0,1]
    v_pk_fma_f32 v[110:111], v[110:111], v[176:177], v[176:177] op_sel:[0,0,1] op_sel_hi:[1,0,1]
    v_cvt_pk_bf16_f32 v104, v104, v105
    v_cvt_pk_bf16_f32 v106, v106, v107
    v_cvt_pk_bf16_f32 v108, v108, v109
    v_cvt_pk_bf16_f32 v110, v110, v111
    v_accvgpr_write_b32 a100, v104
    v_accvgpr_write_b32 a101, v106
    v_accvgpr_write_b32 a102, v108
    v_accvgpr_write_b32 a103, v110
    v_pk_fma_f32 v[112:113], v[112:113], v[178:179], v[178:179] op_sel:[0,0,1] op_sel_hi:[1,0,1]
    v_pk_fma_f32 v[114:115], v[114:115], v[178:179], v[178:179] op_sel:[0,0,1] op_sel_hi:[1,0,1]
    v_pk_fma_f32 v[116:117], v[116:117], v[178:179], v[178:179] op_sel:[0,0,1] op_sel_hi:[1,0,1]
    v_pk_fma_f32 v[118:119], v[118:119], v[178:179], v[178:179] op_sel:[0,0,1] op_sel_hi:[1,0,1]
    v_cvt_pk_bf16_f32 v112, v112, v113
    v_cvt_pk_bf16_f32 v114, v114, v115
    v_cvt_pk_bf16_f32 v116, v116, v117
    v_cvt_pk_bf16_f32 v118, v118, v119
    v_accvgpr_write_b32 a104, v112
    v_accvgpr_write_b32 a105, v114
    v_accvgpr_write_b32 a106, v116
    v_accvgpr_write_b32 a107, v118
    v_pk_fma_f32 v[120:121], v[120:121], v[178:179], v[178:179] op_sel:[0,0,1] op_sel_hi:[1,0,1]
    v_pk_fma_f32 v[122:123], v[122:123], v[178:179], v[178:179] op_sel:[0,0,1] op_sel_hi:[1,0,1]
    v_pk_fma_f32 v[124:125], v[124:125], v[178:179], v[178:179] op_sel:[0,0,1] op_sel_hi:[1,0,1]
    v_pk_fma_f32 v[126:127], v[126:127], v[178:179], v[178:179] op_sel:[0,0,1] op_sel_hi:[1,0,1]
    v_cvt_pk_bf16_f32 v120, v120, v121
    v_cvt_pk_bf16_f32 v122, v122, v123
    v_cvt_pk_bf16_f32 v124, v124, v125
    v_cvt_pk_bf16_f32 v126, v126, v127
    v_accvgpr_write_b32 a108, v120
    v_accvgpr_write_b32 a109, v122
    v_accvgpr_write_b32 a110, v124
    v_accvgpr_write_b32 a111, v126
    v_pk_fma_f32 v[128:129], v[128:129], v[180:181], v[180:181] op_sel:[0,0,1] op_sel_hi:[1,0,1]
    v_pk_fma_f32 v[130:131], v[130:131], v[180:181], v[180:181] op_sel:[0,0,1] op_sel_hi:[1,0,1]
    v_pk_fma_f32 v[132:133], v[132:133], v[180:181], v[180:181] op_sel:[0,0,1] op_sel_hi:[1,0,1]
    v_pk_fma_f32 v[134:135], v[134:135], v[180:181], v[180:181] op_sel:[0,0,1] op_sel_hi:[1,0,1]
    v_cvt_pk_bf16_f32 v128, v128, v129
    v_cvt_pk_bf16_f32 v130, v130, v131
    v_cvt_pk_bf16_f32 v132, v132, v133
    v_cvt_pk_bf16_f32 v134, v134, v135
    v_accvgpr_write_b32 a112, v128
    v_accvgpr_write_b32 a113, v130
    v_accvgpr_write_b32 a114, v132
    v_accvgpr_write_b32 a115, v134
    v_pk_fma_f32 v[136:137], v[136:137], v[180:181], v[180:181] op_sel:[0,0,1] op_sel_hi:[1,0,1]
    v_pk_fma_f32 v[138:139], v[138:139], v[180:181], v[180:181] op_sel:[0,0,1] op_sel_hi:[1,0,1]
    v_pk_fma_f32 v[140:141], v[140:141], v[180:181], v[180:181] op_sel:[0,0,1] op_sel_hi:[1,0,1]
    v_pk_fma_f32 v[142:143], v[142:143], v[180:181], v[180:181] op_sel:[0,0,1] op_sel_hi:[1,0,1]
    v_cvt_pk_bf16_f32 v136, v136, v137
    v_cvt_pk_bf16_f32 v138, v138, v139
    v_cvt_pk_bf16_f32 v140, v140, v141
    v_cvt_pk_bf16_f32 v142, v142, v143
    v_accvgpr_write_b32 a116, v136
    v_accvgpr_write_b32 a117, v138
    v_accvgpr_write_b32 a118, v140
    v_accvgpr_write_b32 a119, v142
    v_pk_fma_f32 v[144:145], v[144:145], v[26:27], v[26:27] op_sel:[0,0,1] op_sel_hi:[1,0,1]
    v_pk_fma_f32 v[146:147], v[146:147], v[26:27], v[26:27] op_sel:[0,0,1] op_sel_hi:[1,0,1]
    v_pk_fma_f32 v[148:149], v[148:149], v[26:27], v[26:27] op_sel:[0,0,1] op_sel_hi:[1,0,1]
    v_pk_fma_f32 v[150:151], v[150:151], v[26:27], v[26:27] op_sel:[0,0,1] op_sel_hi:[1,0,1]
    v_cvt_pk_bf16_f32 v144, v144, v145
    v_cvt_pk_bf16_f32 v146, v146, v147
    v_cvt_pk_bf16_f32 v148, v148, v149
    v_cvt_pk_bf16_f32 v150, v150, v151
    v_accvgpr_write_b32 a120, v144
    v_accvgpr_write_b32 a121, v146
    v_accvgpr_write_b32 a122, v148
    v_accvgpr_write_b32 a123, v150
    v_pk_fma_f32 v[152:153], v[152:153], v[26:27], v[26:27] op_sel:[0,0,1] op_sel_hi:[1,0,1]
    v_pk_fma_f32 v[154:155], v[154:155], v[26:27], v[26:27] op_sel:[0,0,1] op_sel_hi:[1,0,1]
    v_pk_fma_f32 v[156:157], v[156:157], v[26:27], v[26:27] op_sel:[0,0,1] op_sel_hi:[1,0,1]
    v_pk_fma_f32 v[158:159], v[158:159], v[26:27], v[26:27] op_sel:[0,0,1] op_sel_hi:[1,0,1]
    v_cvt_pk_bf16_f32 v152, v152, v153
    v_cvt_pk_bf16_f32 v154, v154, v155
    v_cvt_pk_bf16_f32 v156, v156, v157
    v_cvt_pk_bf16_f32 v158, v158, v159
    v_accvgpr_write_b32 a124, v152
    v_accvgpr_write_b32 a125, v154
    v_accvgpr_write_b32 a126, v156
    v_accvgpr_write_b32 a127, v158
L_st0:
    s_waitcnt lgkmcnt(4)
    v_mfma_f32_16x16x32_bf16 v[32:35], a[192:195], a[96:99], 0
    ds_read_b64_tr_b16 a[208:209], v13 offset:512
    v_fma_f32 v192, v192, v176, v177
    v_mfma_f32_16x16x32_bf16 v[32:35], a[196:199], a[100:103], v[32:35]
    v_fma_f32 v193, v193, v176, v177
    v_cvt_pk_bf16_f32 v192, v192, v193
    v_mfma_f32_16x16x32_bf16 v[36:39], a[196:199], a[108:111], 0
    ds_read_b64_tr_b16 a[210:211], v13 offset:20992
    v_accvgpr_write_b32 a128, v192
    v_mfma_f32_16x16x32_bf16 v[36:39], a[192:195], a[104:107], v[36:39]
    v_fma_f32 v194, v194, v176, v177
    v_fma_f32 v195, v195, v176, v177
    v_mfma_f32_16x16x32_bf16 v[40:43], a[192:195], a[112:115], 0
    ds_read_b64_tr_b16 a[212:213], v13 offset:1536
    v_cvt_pk_bf16_f32 v194, v194, v195
    v_mfma_f32_16x16x32_bf16 v[40:43], a[196:199], a[116:119], v[40:43]
    v_accvgpr_write_b32 a129, v194
    v_fma_f32 v196, v196, v176, v177
    v_mfma_f32_16x16x32_bf16 v[44:47], a[196:199], a[124:127], 0
    ds_read_b64_tr_b16 a[214:215], v13 offset:22016
    v_fma_f32 v197, v197, v176, v177
    v_mfma_f32_16x16x32_bf16 v[44:47], a[192:195], a[120:123], v[44:47]
    v_cvt_pk_bf16_f32 v196, v196, v197
    s_waitcnt lgkmcnt(4)
    s_barrier
    v_mfma_f32_16x16x32_bf16 v[60:63], a[200:203], a[120:123], 0
    ds_read_b64_tr_b16 a[216:217], v14 offset:512
    v_accvgpr_write_b32 a130, v196
    v_mfma_f32_16x16x32_bf16 v[60:63], a[204:207], a[124:127], v[60:63]
    v_fma_f32 v198, v198, v176, v177
    v_fma_f32 v199, v199, v176, v177
    v_mfma_f32_16x16x32_bf16 v[56:59], a[204:207], a[116:119], 0
    ds_read_b64_tr_b16 a[218:219], v14 offset:20992
    v_cvt_pk_bf16_f32 v198, v198, v199
    v_mfma_f32_16x16x32_bf16 v[56:59], a[200:203], a[112:115], v[56:59]
    v_accvgpr_write_b32 a131, v198
    v_fma_f32 v200, v200, v176, v177
    v_mfma_f32_16x16x32_bf16 v[52:55], a[200:203], a[104:107], 0
    s_add_u32 m0, s70, 4096
    ds_read_b64_tr_b16 a[220:221], v14 offset:1536
    v_mfma_f32_16x16x32_bf16 v[52:55], a[204:207], a[108:111], v[52:55]
    buffer_load_dwordx4 v9, s[32:35], s65 offen offset:0 lds
    v_mfma_f32_16x16x32_bf16 v[48:51], a[204:207], a[100:103], 0
    ds_read_b64_tr_b16 a[222:223], v14 offset:22016
    v_fma_f32 v201, v201, v176, v177
    v_mfma_f32_16x16x32_bf16 v[48:51], a[200:203], a[96:99], v[48:51]
    v_cvt_pk_bf16_f32 v200, v200, v201
    s_waitcnt lgkmcnt(4)
    v_mfma_f32_16x16x32_bf16 a[0:3], a[208:211], a[96:99], 0
    ds_read_b64_tr_b16 a[192:193], v13 offset:2048
    v_accvgpr_write_b32 a132, v200
    v_mfma_f32_16x16x32_bf16 a[0:3], a[212:215], a[100:103], a[0:3]
    buffer_load_dwordx4 v10, s[32:35], s65 offen offset:1024 lds
    v_mfma_f32_16x16x32_bf16 a[4:7], a[212:215], a[108:111], 0
    ds_read_b64_tr_b16 a[194:195], v13 offset:22528
    v_fma_f32 v202, v202, v176, v177
    v_mfma_f32_16x16x32_bf16 a[4:7], a[208:211], a[104:107], a[4:7]
    v_fma_f32 v203, v203, v176, v177
    v_cvt_pk_bf16_f32 v202, v202, v203
    v_mfma_f32_16x16x32_bf16 a[8:11], a[208:211], a[112:115], 0
    ds_read_b64_tr_b16 a[196:197], v13 offset:3072
    v_accvgpr_write_b32 a133, v202
    v_mfma_f32_16x16x32_bf16 a[8:11], a[212:215], a[116:119], a[8:11]
    buffer_load_dwordx4 v9, s[36:39], s65 offen offset:2048 lds
    v_mfma_f32_16x16x32_bf16 a[12:15], a[212:215], a[124:127], 0
    ds_read_b64_tr_b16 a[198:199], v13 offset:23552
    v_fma_f32 v204, v204, v176, v177
    v_mfma_f32_16x16x32_bf16 a[12:15], a[208:211], a[120:123], a[12:15]
    v_fma_f32 v205, v205, v176, v177
    s_waitcnt lgkmcnt(4)
    v_mfma_f32_16x16x32_bf16 a[28:31], a[216:219], a[120:123], 0
    ds_read_b64_tr_b16 a[200:201], v14 offset:2048
    v_cvt_pk_bf16_f32 v204, v204, v205
    v_mfma_f32_16x16x32_bf16 a[28:31], a[220:223], a[124:127], a[28:31]
    buffer_load_dwordx4 v10, s[36:39], s65 offen offset:3072 lds
    v_mfma_f32_16x16x32_bf16 a[24:27], a[220:223], a[116:119], 0
    ds_read_b64_tr_b16 a[202:203], v14 offset:22528
    v_accvgpr_write_b32 a134, v204
    v_mfma_f32_16x16x32_bf16 a[24:27], a[216:219], a[112:115], a[24:27]
    v_fma_f32 v206, v206, v176, v177
    v_fma_f32 v207, v207, v176, v177
    v_mfma_f32_16x16x32_bf16 a[20:23], a[216:219], a[104:107], 0
    s_add_u32 m0, s70, 8192
    ds_read_b64_tr_b16 a[204:205], v14 offset:3072
    v_mfma_f32_16x16x32_bf16 a[20:23], a[220:223], a[108:111], a[20:23]
    buffer_load_dwordx4 v11, s[40:43], s66 offen offset:0 lds
    v_mfma_f32_16x16x32_bf16 a[16:19], a[220:223], a[100:103], 0
    ds_read_b64_tr_b16 a[206:207], v14 offset:23552
    v_cvt_pk_bf16_f32 v206, v206, v207
    v_mfma_f32_16x16x32_bf16 a[16:19], a[216:219], a[96:99], a[16:19]
    v_accvgpr_write_b32 a135, v206
    s_waitcnt lgkmcnt(4)
    v_mfma_f32_16x16x32_bf16 a[32:35], a[192:195], a[96:99], 0
    ds_read_b64_tr_b16 a[208:209], v13 offset:2560
    v_fma_f32 v208, v208, v178, v179
    v_mfma_f32_16x16x32_bf16 a[32:35], a[196:199], a[100:103], a[32:35]
    buffer_load_dwordx4 v12, s[40:43], s66 offen offset:1024 lds
    v_mfma_f32_16x16x32_bf16 a[36:39], a[196:199], a[108:111], 0
    s_add_u32 s64, s64, 458752
    ds_read_b64_tr_b16 a[210:211], v13 offset:23040
    v_mfma_f32_16x16x32_bf16 a[36:39], a[192:195], a[104:107], a[36:39]
    s_add_u32 s65, s65, s67
    s_add_u32 s66, s66, s68
    v_mfma_f32_16x16x32_bf16 a[40:43], a[192:195], a[112:115], 0
    s_add_u32 s70, s70, 40960
    ds_read_b64_tr_b16 a[212:213], v13 offset:3584
    v_mfma_f32_16x16x32_bf16 a[40:43], a[196:199], a[116:119], a[40:43]
    v_fma_f32 v209, v209, v178, v179
    v_cvt_pk_bf16_f32 v208, v208, v209
    v_mfma_f32_16x16x32_bf16 a[44:47], a[196:199], a[124:127], 0
    s_mov_b32 m0, s70
    ds_read_b64_tr_b16 a[214:215], v13 offset:24064
    v_mfma_f32_16x16x32_bf16 a[44:47], a[192:195], a[120:123], a[44:47]
    buffer_load_dwordx4 v7, s[24:27], s64 offen offset:0 lds
    s_waitcnt lgkmcnt(4)
    v_mfma_f32_16x16x32_bf16 a[60:63], a[200:203], a[120:123], 0
    ds_read_b64_tr_b16 a[216:217], v14 offset:2560
    v_accvgpr_write_b32 a136, v208
    v_mfma_f32_16x16x32_bf16 a[60:63], a[204:207], a[124:127], a[60:63]
    v_fma_f32 v210, v210, v178, v179
    v_fma_f32 v211, v211, v178, v179
    v_mfma_f32_16x16x32_bf16 a[56:59], a[204:207], a[116:119], 0
    ds_read_b64_tr_b16 a[218:219], v14 offset:23040
    v_cvt_pk_bf16_f32 v210, v210, v211
    v_mfma_f32_16x16x32_bf16 a[56:59], a[200:203], a[112:115], a[56:59]
    buffer_load_dwordx4 v8, s[24:27], s64 offen offset:1024 lds
    v_mfma_f32_16x16x32_bf16 a[52:55], a[200:203], a[104:107], 0
    ds_read_b64_tr_b16 a[220:221], v14 offset:3584
    v_accvgpr_write_b32 a137, v210
    v_mfma_f32_16x16x32_bf16 a[52:55], a[204:207], a[108:111], a[52:55]
    v_fma_f32 v212, v212, v178, v179
    v_fma_f32 v213, v213, v178, v179
    v_mfma_f32_16x16x32_bf16 a[48:51], a[204:207], a[100:103], 0
    ds_read_b64_tr_b16 a[222:223], v14 offset:24064
    v_cvt_pk_bf16_f32 v212, v212, v213
    v_mfma_f32_16x16x32_bf16 a[48:51], a[200:203], a[96:99], a[48:51]
    buffer_load_dwordx4 v7, s[28:31], s64 offen offset:2048 lds
    s_waitcnt lgkmcnt(4)
    v_mfma_f32_16x16x32_bf16 a[64:67], a[208:211], a[96:99], 0
    ds_read_b64_tr_b16 a[192:193], v13 offset:4096
    v_accvgpr_write_b32 a138, v212
    v_mfma_f32_16x16x32_bf16 a[64:67], a[212:215], a[100:103], a[64:67]
    v_fma_f32 v214, v214, v178, v179
    v_fma_f32 v215, v215, v178, v179
    v_mfma_f32_16x16x32_bf16 a[68:71], a[212:215], a[108:111], 0
    ds_read_b64_tr_b16 a[194:195], v13 offset:24576
    v_cvt_pk_bf16_f32 v214, v214, v215
    v_mfma_f32_16x16x32_bf16 a[68:71], a[208:211], a[104:107], a[68:71]
    buffer_load_dwordx4 v8, s[28:31], s64 offen offset:3072 lds
    v_mfma_f32_16x16x32_bf16 a[72:75], a[208:211], a[112:115], 0
    ds_read_b64_tr_b16 a[196:197], v13 offset:5120
    v_accvgpr_write_b32 a139, v214
    v_mfma_f32_16x16x32_bf16 a[72:75], a[212:215], a[116:119], a[72:75]
    v_fma_f32 v216, v216, v178, v179
    v_fma_f32 v217, v217, v178, v179
    v_mfma_f32_16x16x32_bf16 a[76:79], a[212:215], a[124:127], 0
    s_add_u32 m0, s70, 4096
    ds_read_b64_tr_b16 a[198:199], v13 offset:25600
    v_mfma_f32_16x16x32_bf16 a[76:79], a[208:211], a[120:123], a[76:79]
    buffer_load_dwordx4 v9, s[32:35], s65 offen offset:0 lds
    s_waitcnt lgkmcnt(4)
    v_mfma_f32_16x16x32_bf16 a[92:95], a[216:219], a[120:123], 0
    ds_read_b64_tr_b16 a[200:201], v14 offset:4096
    v_cvt_pk_bf16_f32 v216, v216, v217
    v_mfma_f32_16x16x32_bf16 a[92:95], a[220:223], a[124:127], a[92:95]
    v_accvgpr_write_b32 a140, v216
    v_fma_f32 v218, v218, v178, v179
    v_mfma_f32_16x16x32_bf16 a[88:91], a[220:223], a[116:119], 0
    ds_read_b64_tr_b16 a[202:203], v14 offset:24576
    v_fma_f32 v219, v219, v178, v179
    v_mfma_f32_16x16x32_bf16 a[88:91], a[216:219], a[112:115], a[88:91]
    buffer_load_dwordx4 v10, s[32:35], s65 offen offset:1024 lds
    v_mfma_f32_16x16x32_bf16 a[84:87], a[216:219], a[104:107], 0
    ds_read_b64_tr_b16 a[204:205], v14 offset:5120
    v_cvt_pk_bf16_f32 v218, v218, v219
    v_mfma_f32_16x16x32_bf16 a[84:87], a[220:223], a[108:111], a[84:87]
    v_accvgpr_write_b32 a141, v218
    v_fma_f32 v220, v220, v178, v179
    v_mfma_f32_16x16x32_bf16 a[80:83], a[220:223], a[100:103], 0
    ds_read_b64_tr_b16 a[206:207], v14 offset:25600
    v_fma_f32 v221, v221, v178, v179
    v_mfma_f32_16x16x32_bf16 a[80:83], a[216:219], a[96:99], a[80:83]
    buffer_load_dwordx4 v9, s[36:39], s65 offen offset:2048 lds
    s_waitcnt lgkmcnt(4)
    v_mfma_f32_16x16x32_bf16 v[64:67], a[192:195], a[96:99], 0
    ds_read_b64_tr_b16 a[208:209], v13 offset:4608
    v_cvt_pk_bf16_f32 v220, v220, v221
    v_mfma_f32_16x16x32_bf16 v[64:67], a[196:199], a[100:103], v[64:67]
    v_accvgpr_write_b32 a142, v220
    v_fma_f32 v222, v222, v178, v179
    v_mfma_f32_16x16x32_bf16 v[68:71], a[196:199], a[108:111], 0
    ds_read_b64_tr_b16 a[210:211], v13 offset:25088
    v_fma_f32 v223, v223, v178, v179
    v_mfma_f32_16x16x32_bf16 v[68:71], a[192:195], a[104:107], v[68:71]
    buffer_load_dwordx4 v10, s[36:39], s65 offen offset:3072 lds
    v_mfma_f32_16x16x32_bf16 v[72:75], a[192:195], a[112:115], 0
    ds_read_b64_tr_b16 a[212:213], v13 offset:5632
    v_cvt_pk_bf16_f32 v222, v222, v223
    v_mfma_f32_16x16x32_bf16 v[72:75], a[196:199], a[116:119], v[72:75]
    v_accvgpr_write_b32 a143, v222
    v_fma_f32 v224, v224, v180, v181
    v_mfma_f32_16x16x32_bf16 v[76:79], a[196:199], a[124:127], 0
    s_add_u32 m0, s70, 8192
    ds_read_b64_tr_b16 a[214:215], v13 offset:26112
    v_mfma_f32_16x16x32_bf16 v[76:79], a[192:195], a[120:123], v[76:79]
    buffer_load_dwordx4 v11, s[40:43], s66 offen offset:0 lds
    s_waitcnt lgkmcnt(4)
    v_mfma_f32_16x16x32_bf16 v[92:95], a[200:203], a[120:123], 0
    ds_read_b64_tr_b16 a[216:217], v14 offset:4608
    v_fma_f32 v225, v225, v180, v181
    v_mfma_f32_16x16x32_bf16 v[92:95], a[204:207], a[124:127], v[92:95]
    v_cvt_pk_bf16_f32 v224, v224, v225
    v_accvgpr_write_b32 a144, v224
    v_mfma_f32_16x16x32_bf16 v[88:91], a[204:207], a[116:119], 0
    ds_read_b64_tr_b16 a[218:219], v14 offset:25088
    v_fma_f32 v226, v226, v180, v181
    v_mfma_f32_16x16x32_bf16 v[88:91], a[200:203], a[112:115], v[88:91]
    buffer_load_dword v23, v22, s[52:55], s95 offen sc1
    v_mfma_f32_16x16x32_bf16 v[84:87], a[200:203], a[104:107], 0
    ds_read_b64_tr_b16 a[220:221], v14 offset:5632
    v_fma_f32 v227, v227, v180, v181
    v_mfma_f32_16x16x32_bf16 v[84:87], a[204:207], a[108:111], v[84:87]
    v_cvt_pk_bf16_f32 v226, v226, v227
    v_accvgpr_write_b32 a145, v226
    v_mfma_f32_16x16x32_bf16 v[80:83], a[204:207], a[100:103], 0
    ds_read_b64_tr_b16 a[222:223], v14 offset:26112
    v_fma_f32 v228, v228, v180, v181
    v_mfma_f32_16x16x32_bf16 v[80:83], a[200:203], a[96:99], v[80:83]
    buffer_load_dwordx4 v12, s[40:43], s66 offen offset:1024 lds
    s_waitcnt lgkmcnt(4)
    v_mfma_f32_16x16x32_bf16 v[96:99], a[208:211], a[96:99], 0
    s_add_u32 s64, s64, 458752
    ds_read_b64_tr_b16 a[192:193], v13 offset:6144
    v_mfma_f32_16x16x32_bf16 v[96:99], a[212:215], a[100:103], v[96:99]
    s_add_u32 s65, s65, s67
    s_add_u32 s66, s66, s68
    v_mfma_f32_16x16x32_bf16 v[100:103], a[212:215], a[108:111], 0
    s_add_u32 s70, s70, 40960
    ds_read_b64_tr_b16 a[194:195], v13 offset:26624
    v_mfma_f32_16x16x32_bf16 v[100:103], a[208:211], a[104:107], v[100:103]
    v_fma_f32 v229, v229, v180, v181
    v_cvt_pk_bf16_f32 v228, v228, v229
    v_mfma_f32_16x16x32_bf16 v[104:107], a[208:211], a[112:115], 0
    ds_read_b64_tr_b16 a[196:197], v13 offset:7168
    v_accvgpr_write_b32 a146, v228
    v_mfma_f32_16x16x32_bf16 v[104:107], a[212:215], a[116:119], v[104:107]
    buffer_load_dword v0, v29, s[60:63], 0 offen
    v_mfma_f32_16x16x32_bf16 v[108:111], a[212:215], a[124:127], 0
    v_add_u32 v29, v28, v29
    ds_read_b64_tr_b16 a[198:199], v13 offset:27648
    v_mfma_f32_16x16x32_bf16 v[108:111], a[208:211], a[120:123], v[108:111]
    v_fma_f32 v230, v230, v180, v181
    s_waitcnt lgkmcnt(4)
    v_mfma_f32_16x16x32_bf16 v[124:127], a[216:219], a[120:123], 0
    s_mov_b32 m0, s70
    ds_read_b64_tr_b16 a[200:201], v14 offset:6144
    v_mfma_f32_16x16x32_bf16 v[124:127], a[220:223], a[124:127], v[124:127]
    buffer_load_dwordx4 v7, s[24:27], s64 offen offset:0 lds
    v_mfma_f32_16x16x32_bf16 v[120:123], a[220:223], a[116:119], 0
    ds_read_b64_tr_b16 a[202:203], v14 offset:26624
    v_fma_f32 v231, v231, v180, v181
    v_mfma_f32_16x16x32_bf16 v[120:123], a[216:219], a[112:115], v[120:123]
    v_cvt_pk_bf16_f32 v230, v230, v231
    v_accvgpr_write_b32 a147, v230
    v_mfma_f32_16x16x32_bf16 v[116:119], a[216:219], a[104:107], 0
    ds_read_b64_tr_b16 a[204:205], v14 offset:7168
    v_fma_f32 v232, v232, v180, v181
    v_mfma_f32_16x16x32_bf16 v[116:119], a[220:223], a[108:111], v[116:119]
    buffer_load_dwordx4 v8, s[24:27], s64 offen offset:1024 lds
    v_mfma_f32_16x16x32_bf16 v[112:115], a[220:223], a[100:103], 0
    ds_read_b64_tr_b16 a[206:207], v14 offset:27648
    v_fma_f32 v233, v233, v180, v181
    v_mfma_f32_16x16x32_bf16 v[112:115], a[216:219], a[96:99], v[112:115]
    v_cvt_pk_bf16_f32 v232, v232, v233
    s_waitcnt lgkmcnt(4)
    v_mfma_f32_16x16x32_bf16 v[128:131], a[192:195], a[96:99], 0
    ds_read_b64_tr_b16 a[208:209], v13 offset:6656
    v_accvgpr_write_b32 a148, v232
    v_mfma_f32_16x16x32_bf16 v[128:131], a[196:199], a[100:103], v[128:131]
    buffer_load_dwordx4 v7, s[28:31], s64 offen offset:2048 lds
    v_mfma_f32_16x16x32_bf16 v[132:135], a[196:199], a[108:111], 0
    ds_read_b64_tr_b16 a[210:211], v13 offset:27136
    v_fma_f32 v234, v234, v180, v181
    v_mfma_f32_16x16x32_bf16 v[132:135], a[192:195], a[104:107], v[132:135]
    v_fma_f32 v235, v235, v180, v181
    v_cvt_pk_bf16_f32 v234, v234, v235
    v_mfma_f32_16x16x32_bf16 v[136:139], a[192:195], a[112:115], 0
    ds_read_b64_tr_b16 a[212:213], v13 offset:7680
    v_accvgpr_write_b32 a149, v234
    v_mfma_f32_16x16x32_bf16 v[136:139], a[196:199], a[116:119], v[136:139]
    buffer_load_dwordx4 v8, s[28:31], s64 offen offset:3072 lds
    v_mfma_f32_16x16x32_bf16 v[140:143], a[196:199], a[124:127], 0
    ds_read_b64_tr_b16 a[214:215], v13 offset:28160
    v_fma_f32 v236, v236, v180, v181
    v_mfma_f32_16x16x32_bf16 v[140:143], a[192:195], a[120:123], v[140:143]
    v_fma_f32 v237, v237, v180, v181
    s_waitcnt lgkmcnt(4)
    v_mfma_f32_16x16x32_bf16 v[156:159], a[200:203], a[120:123], 0
    s_add_u32 m0, s70, 4096
    ds_read_b64_tr_b16 a[216:217], v14 offset:6656
    v_mfma_f32_16x16x32_bf16 v[156:159], a[204:207], a[124:127], v[156:159]
    buffer_load_dwordx4 v9, s[32:35], s65 offen offset:0 lds
    v_mfma_f32_16x16x32_bf16 v[152:155], a[204:207], a[116:119], 0
    ds_read_b64_tr_b16 a[218:219], v14 offset:27136
    v_cvt_pk_bf16_f32 v236, v236, v237
    v_mfma_f32_16x16x32_bf16 v[152:155], a[200:203], a[112:115], v[152:155]
    v_accvgpr_write_b32 a150, v236
    v_fma_f32 v238, v238, v180, v181
    v_mfma_f32_16x16x32_bf16 v[148:151], a[200:203], a[104:107], 0
    ds_read_b64_tr_b16 a[220:221], v14 offset:7680
    v_fma_f32 v239, v239, v180, v181
    v_mfma_f32_16x16x32_bf16 v[148:151], a[204:207], a[108:111], v[148:151]
    buffer_load_dwordx4 v10, s[32:35], s65 offen offset:1024 lds
    v_mfma_f32_16x16x32_bf16 v[144:147], a[204:207], a[100:103], 0
    ds_read_b64_tr_b16 a[222:223], v14 offset:28160
    v_cvt_pk_bf16_f32 v238, v238, v239
    v_mfma_f32_16x16x32_bf16 v[144:147], a[200:203], a[96:99], v[144:147]
    v_accvgpr_write_b32 a151, v238
    s_waitcnt lgkmcnt(4)
    v_mfma_f32_16x16x32_bf16 v[160:163], a[208:211], a[96:99], 0
    ds_read_b64_tr_b16 a[192:193], v15 offset:8192
    v_fma_f32 v240, v240, v26, v27
    v_mfma_f32_16x16x32_bf16 v[160:163], a[212:215], a[100:103], v[160:163]
    buffer_load_dwordx4 v9, s[36:39], s65 offen offset:2048 lds
    v_mfma_f32_16x16x32_bf16 v[164:167], a[212:215], a[108:111], 0
    ds_read_b64_tr_b16 a[194:195], v15 offset:28672
    v_fma_f32 v241, v241, v26, v27
    v_mfma_f32_16x16x32_bf16 v[164:167], a[208:211], a[104:107], v[164:167]
    v_cvt_pk_bf16_f32 v240, v240, v241
    v_accvgpr_write_b32 a152, v240
    v_mfma_f32_16x16x32_bf16 v[168:171], a[208:211], a[112:115], 0
    ds_read_b64_tr_b16 a[196:197], v15 offset:9216
    v_fma_f32 v242, v242, v26, v27
    v_mfma_f32_16x16x32_bf16 v[168:171], a[212:215], a[116:119], v[168:171]
    buffer_load_dwordx4 v10, s[36:39], s65 offen offset:3072 lds
    v_mfma_f32_16x16x32_bf16 v[172:175], a[212:215], a[124:127], 0
    ds_read_b64_tr_b16 a[198:199], v15 offset:29696
    v_fma_f32 v243, v243, v26, v27
    v_mfma_f32_16x16x32_bf16 v[172:175], a[208:211], a[120:123], v[172:175]
    v_cvt_pk_bf16_f32 v242, v242, v243
    s_waitcnt vmcnt(27) lgkmcnt(4)
    v_mfma_f32_16x16x32_bf16 v[188:191], a[216:219], a[120:123], 0
    s_add_u32 m0, s70, 8192
    ds_read_b64_tr_b16 a[200:201], v16 offset:8192
    v_mfma_f32_16x16x32_bf16 v[188:191], a[220:223], a[124:127], v[188:191]
    buffer_load_dwordx4 v11, s[40:43], s66 offen offset:0 lds
    v_mfma_f32_16x16x32_bf16 v[184:187], a[220:223], a[116:119], 0
    ds_read_b64_tr_b16 a[202:203], v16 offset:28672
    v_accvgpr_write_b32 a153, v242
    v_mfma_f32_16x16x32_bf16 v[184:187], a[216:219], a[112:115], v[184:187]
    v_fma_f32 v244, v244, v26, v27
    v_fma_f32 v245, v245, v26, v27
    v_mfma_f32_16x16x32_bf16 v[180:183], a[216:219], a[104:107], 0
    ds_read_b64_tr_b16 a[204:205], v16 offset:9216
    v_cvt_pk_bf16_f32 v244, v244, v245
    v_mfma_f32_16x16x32_bf16 v[180:183], a[220:223], a[108:111], v[180:183]
    buffer_load_dwordx4 v12, s[40:43], s66 offen offset:1024 lds
    v_add_u32 v13, s73, v13
    v_mfma_f32_16x16x32_bf16 v[176:179], a[220:223], a[100:103], 0
    ds_read_b64_tr_b16 a[206:207], v16 offset:29696
    v_accvgpr_write_b32 a154, v244
    v_mfma_f32_16x16x32_bf16 v[176:179], a[216:219], a[96:99], v[176:179]
    v_add_u32 v14, s73, v14
    s_waitcnt vmcnt(12) lgkmcnt(4)
    v_cmp_ne_u32 vcc, s18, v23
    s_cbranch_vccnz L_px
L_px_b:
    s_barrier
    v_mfma_f32_16x16x32_bf16 v[192:195], a[192:195], a[96:99], 0
    ds_read_b64_tr_b16 a[208:209], v15 offset:18432
    v_fma_f32 v246, v246, v26, v27
    v_mfma_f32_16x16x32_bf16 v[192:195], a[196:199], a[100:103], v[192:195]
    buffer_load_dwordx4 a[160:163], v3, s[20:23], s69 offen offset:0 sc1
    v_mfma_f32_16x16x32_bf16 v[196:199], a[196:199], a[108:111], 0
    ds_read_b64_tr_b16 a[210:211], v15 offset:38912
    v_fma_f32 v247, v247, v26, v27
    v_mfma_f32_16x16x32_bf16 v[196:199], a[192:195], a[104:107], v[196:199]
    v_cvt_pk_bf16_f32 v246, v246, v247
    v_accvgpr_write_b32 a155, v246
    v_mfma_f32_16x16x32_bf16 v[200:203], a[192:195], a[112:115], 0
    ds_read_b64_tr_b16 a[212:213], v15 offset:19456
    v_fma_f32 v248, v248, v26, v27
    v_mfma_f32_16x16x32_bf16 v[200:203], a[196:199], a[116:119], v[200:203]
    buffer_load_dwordx4 a[164:167], v3, s[20:23], s69 offen offset:1024 sc1
    v_mfma_f32_16x16x32_bf16 v[204:207], a[196:199], a[124:127], 0
    ds_read_b64_tr_b16 a[214:215], v15 offset:39936
    v_fma_f32 v249, v249, v26, v27
    v_mfma_f32_16x16x32_bf16 v[204:207], a[192:195], a[120:123], v[204:207]
    v_cvt_pk_bf16_f32 v248, v248, v249
    s_waitcnt lgkmcnt(4)
    v_mfma_f32_16x16x32_bf16 v[220:223], a[200:203], a[120:123], 0
    ds_read_b64_tr_b16 a[216:217], v16 offset:18432
    v_accvgpr_write_b32 a156, v248
    v_mfma_f32_16x16x32_bf16 v[220:223], a[204:207], a[124:127], v[220:223]
    buffer_load_dwordx4 a[168:171], v4, s[20:23], s69 offen offset:0 sc1
    v_mfma_f32_16x16x32_bf16 v[216:219], a[204:207], a[116:119], 0
    ds_read_b64_tr_b16 a[218:219], v16 offset:38912
    v_fma_f32 v250, v250, v26, v27
    v_mfma_f32_16x16x32_bf16 v[216:219], a[200:203], a[112:115], v[216:219]
    v_fma_f32 v251, v251, v26, v27
    v_cvt_pk_bf16_f32 v250, v250, v251
    v_mfma_f32_16x16x32_bf16 v[212:215], a[200:203], a[104:107], 0
    ds_read_b64_tr_b16 a[220:221], v16 offset:19456
    v_accvgpr_write_b32 a157, v250
    v_mfma_f32_16x16x32_bf16 v[212:215], a[204:207], a[108:111], v[212:215]
    buffer_load_dwordx4 a[172:175], v4, s[20:23], s69 offen offset:1024 sc1
    v_mfma_f32_16x16x32_bf16 v[208:211], a[204:207], a[100:103], 0
    ds_read_b64_tr_b16 a[222:223], v16 offset:39936
    v_fma_f32 v252, v252, v26, v27
    v_mfma_f32_16x16x32_bf16 v[208:211], a[200:203], a[96:99], v[208:211]
    v_fma_f32 v253, v253, v26, v27
    s_waitcnt lgkmcnt(4)
    v_mfma_f32_16x16x32_bf16 v[224:227], a[208:211], a[96:99], 0
    ds_read_b64_tr_b16 a[192:193], v13 offset:0
    v_cvt_pk_bf16_f32 v252, v252, v253
    v_mfma_f32_16x16x32_bf16 v[224:227], a[212:215], a[100:103], v[224:227]
    buffer_load_dwordx4 a[176:179], v5, s[20:23], s69 offen offset:0 sc1
    v_add_u32 v15, s73, v15
    v_mfma_f32_16x16x32_bf16 v[228:231], a[212:215], a[108:111], 0
    ds_read_b64_tr_b16 a[194:195], v13 offset:20480
    v_accvgpr_write_b32 a158, v252
    v_mfma_f32_16x16x32_bf16 v[228:231], a[208:211], a[104:107], v[228:231]
    v_fma_f32 v254, v254, v26, v27
    v_fma_f32 v255, v255, v26, v27
    v_mfma_f32_16x16x32_bf16 v[232:235], a[208:211], a[112:115], 0
    ds_read_b64_tr_b16 a[196:197], v13 offset:1024
    v_cvt_pk_bf16_f32 v254, v254, v255
    v_mfma_f32_16x16x32_bf16 v[232:235], a[212:215], a[116:119], v[232:235]
    buffer_load_dwordx4 a[180:183], v5, s[20:23], s69 offen offset:1024 sc1
    s_add_u32 s64, s64, 458752
    v_mfma_f32_16x16x32_bf16 v[236:239], a[212:215], a[124:127], 0
    ds_read_b64_tr_b16 a[198:199], v13 offset:21504
    v_accvgpr_write_b32 a159, v254
    v_mfma_f32_16x16x32_bf16 v[236:239], a[208:211], a[120:123], v[236:239]
    s_add_u32 s65, s65, s67
    s_waitcnt vmcnt(17) lgkmcnt(4)
    v_mfma_f32_16x16x32_bf16 v[252:255], a[216:219], a[120:123], 0
    ds_read_b64_tr_b16 a[200:201], v14 offset:0
    v_mfma_f32_16x16x32_bf16 v[252:255], a[220:223], a[124:127], v[252:255]
    buffer_load_dwordx4 a[184:187], v6, s[20:23], s69 offen offset:0 sc1
    s_add_u32 s66, s66, s68
    v_mfma_f32_16x16x32_bf16 v[248:251], a[220:223], a[116:119], 0
    ds_read_b64_tr_b16 a[202:203], v14 offset:20480
    v_mfma_f32_16x16x32_bf16 v[248:251], a[216:219], a[112:115], v[248:251]
    s_add_u32 s70, s70, 40960
    s_sub_u32 s10, s70, 163840
    v_mfma_f32_16x16x32_bf16 v[244:247], a[216:219], a[104:107], 0
    ds_read_b64_tr_b16 a[204:205], v14 offset:1024
    v_mfma_f32_16x16x32_bf16 v[244:247], a[220:223], a[108:111], v[244:247]
    buffer_load_dwordx4 a[188:191], v6, s[20:23], s69 offen offset:1024 sc1
    s_cmp_ge_u32 s70, 163840
    s_cselect_b32 s70, s10, s70
    v_mfma_f32_16x16x32_bf16 v[240:243], a[220:223], a[100:103], 0
    s_add_u32 s69, s69, 8192
    ds_read_b64_tr_b16 a[206:207], v14 offset:21504
    v_mfma_f32_16x16x32_bf16 v[240:243], a[216:219], a[96:99], v[240:243]
    buffer_load_dword v0, v29, s[60:63], 0 offen
    v_add_u32 v29, v28, v29
    v_add_u32 v16, s73, v16
L_loop:
    s_waitcnt vmcnt(30) lgkmcnt(4)
    v_mfma_f32_16x16x32_bf16 v[32:35], a[192:195], a[128:131], v[32:35]
    ds_read_b64_tr_b16 a[208:209], v13 offset:512
    v_mfma_f32_16x16x32_bf16 v[32:35], a[196:199], a[132:135], v[32:35]
    v_mfma_f32_16x16x32_bf16 v[36:39], a[196:199], a[140:143], v[36:39]
    ds_read_b64_tr_b16 a[210:211], v13 offset:20992
    v_mfma_f32_16x16x32_bf16 v[36:39], a[192:195], a[136:139], v[36:39]
    v_mfma_f32_16x16x32_bf16 v[40:43], a[192:195], a[144:147], v[40:43]
    ds_read_b64_tr_b16 a[212:213], v13 offset:1536
    v_mfma_f32_16x16x32_bf16 v[40:43], a[196:199], a[148:151], v[40:43]
    v_mfma_f32_16x16x32_bf16 v[44:47], a[196:199], a[156:159], v[44:47]
    ds_read_b64_tr_b16 a[214:215], v13 offset:22016
    v_mfma_f32_16x16x32_bf16 v[44:47], a[192:195], a[152:155], v[44:47]
    s_waitcnt vmcnt(20) lgkmcnt(4)
    s_barrier
    v_mfma_f32_16x16x32_bf16 v[60:63], a[200:203], a[152:155], v[60:63]
    ds_read_b64_tr_b16 a[216:217], v14 offset:512
    v_mfma_f32_16x16x32_bf16 v[60:63], a[204:207], a[156:159], v[60:63]
    v_mfma_f32_16x16x32_bf16 v[56:59], a[204:207], a[148:151], v[56:59]
    ds_read_b64_tr_b16 a[218:219], v14 offset:20992
    v_mfma_f32_16x16x32_bf16 v[56:59], a[200:203], a[144:147], v[56:59]
    buffer_load_dwordx4 a[96:99], v3, s[20:23], s69 offen offset:0 sc1
    v_mfma_f32_16x16x32_bf16 v[52:55], a[200:203], a[136:139], v[52:55]
    ds_read_b64_tr_b16 a[220:221], v14 offset:1536
    v_mfma_f32_16x16x32_bf16 v[52:55], a[204:207], a[140:143], v[52:55]
    v_mfma_f32_16x16x32_bf16 v[48:51], a[204:207], a[132:135], v[48:51]
    ds_read_b64_tr_b16 a[222:223], v14 offset:22016
    v_mfma_f32_16x16x32_bf16 v[48:51], a[200:203], a[128:131], v[48:51]
    s_waitcnt lgkmcnt(4)
    v_mfma_f32_16x16x32_bf16 a[0:3], a[208:211], a[128:131], a[0:3]
    ds_read_b64_tr_b16 a[192:193], v13 offset:2048
    v_mfma_f32_16x16x32_bf16 a[0:3], a[212:215], a[132:135], a[0:3]
    v_mfma_f32_16x16x32_bf16 a[4:7], a[212:215], a[140:143], a[4:7]
    ds_read_b64_tr_b16 a[194:195], v13 offset:22528
    v_mfma_f32_16x16x32_bf16 a[4:7], a[208:211], a[136:139], a[4:7]
    buffer_load_dwordx4 a[100:103], v3, s[20:23], s69 offen offset:1024 sc1
    v_mfma_f32_16x16x32_bf16 a[8:11], a[208:211], a[144:147], a[8:11]
    ds_read_b64_tr_b16 a[196:197], v13 offset:3072
    v_mfma_f32_16x16x32_bf16 a[8:11], a[212:215], a[148:151], a[8:11]
    v_mfma_f32_16x16x32_bf16 a[12:15], a[212:215], a[156:159], a[12:15]
    ds_read_b64_tr_b16 a[198:199], v13 offset:23552
    v_mfma_f32_16x16x32_bf16 a[12:15], a[208:211], a[152:155], a[12:15]
    s_waitcnt lgkmcnt(4)
    v_mfma_f32_16x16x32_bf16 a[28:31], a[216:219], a[152:155], a[28:31]
    ds_read_b64_tr_b16 a[200:201], v14 offset:2048
    v_mfma_f32_16x16x32_bf16 a[28:31], a[220:223], a[156:159], a[28:31]
    v_mfma_f32_16x16x32_bf16 a[24:27], a[220:223], a[148:151], a[24:27]
    ds_read_b64_tr_b16 a[202:203], v14 offset:22528
    v_mfma_f32_16x16x32_bf16 a[24:27], a[216:219], a[144:147], a[24:27]
    buffer_load_dwordx4 a[104:107], v4, s[20:23], s69 offen offset:0 sc1
    v_mfma_f32_16x16x32_bf16 a[20:23], a[216:219], a[136:139], a[20:23]
    ds_read_b64_tr_b16 a[204:205], v14 offset:3072
    v_mfma_f32_16x16x32_bf16 a[20:23], a[220:223], a[140:143], a[20:23]
    v_mfma_f32_16x16x32_bf16 a[16:19], a[220:223], a[132:135], a[16:19]
    ds_read_b64_tr_b16 a[206:207], v14 offset:23552
    v_mfma_f32_16x16x32_bf16 a[16:19], a[216:219], a[128:131], a[16:19]
    s_waitcnt lgkmcnt(4)
    v_mfma_f32_16x16x32_bf16 a[32:35], a[192:195], a[128:131], a[32:35]
    ds_read_b64_tr_b16 a[208:209], v13 offset:2560
    v_mfma_f32_16x16x32_bf16 a[32:35], a[196:199], a[132:135], a[32:35]
    v_mfma_f32_16x16x32_bf16 a[36:39], a[196:199], a[140:143], a[36:39]
    ds_read_b64_tr_b16 a[210:211], v13 offset:23040
    v_mfma_f32_16x16x32_bf16 a[36:39], a[192:195], a[136:139], a[36:39]
    buffer_load_dwordx4 a[108:111], v4, s[20:23], s69 offen offset:1024 sc1
    v_mfma_f32_16x16x32_bf16 a[40:43], a[192:195], a[144:147], a[40:43]
    ds_read_b64_tr_b16 a[212:213], v13 offset:3584
    v_mfma_f32_16x16x32_bf16 a[40:43], a[196:199], a[148:151], a[40:43]
    v_mfma_f32_16x16x32_bf16 a[44:47], a[196:199], a[156:159], a[44:47]
    ds_read_b64_tr_b16 a[214:215], v13 offset:24064
    v_mfma_f32_16x16x32_bf16 a[44:47], a[192:195], a[152:155], a[44:47]
    s_waitcnt lgkmcnt(4)
    v_mfma_f32_16x16x32_bf16 a[60:63], a[200:203], a[152:155], a[60:63]
    ds_read_b64_tr_b16 a[216:217], v14 offset:2560
    v_mfma_f32_16x16x32_bf16 a[60:63], a[204:207], a[156:159], a[60:63]
    v_mfma_f32_16x16x32_bf16 a[56:59], a[204:207], a[148:151], a[56:59]
    ds_read_b64_tr_b16 a[218:219], v14 offset:23040
    v_mfma_f32_16x16x32_bf16 a[56:59], a[200:203], a[144:147], a[56:59]
    buffer_load_dwordx4 a[112:115], v5, s[20:23], s69 offen offset:0 sc1
    v_mfma_f32_16x16x32_bf16 a[52:55], a[200:203], a[136:139], a[52:55]
    ds_read_b64_tr_b16 a[220:221], v14 offset:3584
    v_mfma_f32_16x16x32_bf16 a[52:55], a[204:207], a[140:143], a[52:55]
    v_mfma_f32_16x16x32_bf16 a[48:51], a[204:207], a[132:135], a[48:51]
    ds_read_b64_tr_b16 a[222:223], v14 offset:24064
    v_mfma_f32_16x16x32_bf16 a[48:51], a[200:203], a[128:131], a[48:51]
    s_waitcnt lgkmcnt(4)
    v_mfma_f32_16x16x32_bf16 a[64:67], a[208:211], a[128:131], a[64:67]
    ds_read_b64_tr_b16 a[192:193], v13 offset:4096
    v_mfma_f32_16x16x32_bf16 a[64:67], a[212:215], a[132:135], a[64:67]
    v_mfma_f32_16x16x32_bf16 a[68:71], a[212:215], a[140:143], a[68:71]
    ds_read_b64_tr_b16 a[194:195], v13 offset:24576
    v_mfma_f32_16x16x32_bf16 a[68:71], a[208:211], a[136:139], a[68:71]
    buffer_load_dwordx4 a[116:119], v5, s[20:23], s69 offen offset:1024 sc1
    v_mfma_f32_16x16x32_bf16 a[72:75], a[208:211], a[144:147], a[72:75]
    ds_read_b64_tr_b16 a[196:197], v13 offset:5120
    v_mfma_f32_16x16x32_bf16 a[72:75], a[212:215], a[148:151], a[72:75]
    v_mfma_f32_16x16x32_bf16 a[76:79], a[212:215], a[156:159], a[76:79]
    ds_read_b64_tr_b16 a[198:199], v13 offset:25600
    v_mfma_f32_16x16x32_bf16 a[76:79], a[208:211], a[152:155], a[76:79]
    s_waitcnt lgkmcnt(4)
    v_mfma_f32_16x16x32_bf16 a[92:95], a[216:219], a[152:155], a[92:95]
    ds_read_b64_tr_b16 a[200:201], v14 offset:4096
    v_mfma_f32_16x16x32_bf16 a[92:95], a[220:223], a[156:159], a[92:95]
    v_mfma_f32_16x16x32_bf16 a[88:91], a[220:223], a[148:151], a[88:91]
    ds_read_b64_tr_b16 a[202:203], v14 offset:24576
    v_mfma_f32_16x16x32_bf16 a[88:91], a[216:219], a[144:147], a[88:91]
    buffer_load_dwordx4 a[120:123], v6, s[20:23], s69 offen offset:0 sc1
    v_mfma_f32_16x16x32_bf16 a[84:87], a[216:219], a[136:139], a[84:87]
    ds_read_b64_tr_b16 a[204:205], v14 offset:5120
    v_mfma_f32_16x16x32_bf16 a[84:87], a[220:223], a[140:143], a[84:87]
    v_mfma_f32_16x16x32_bf16 a[80:83], a[220:223], a[132:135], a[80:83]
    ds_read_b64_tr_b16 a[206:207], v14 offset:25600
    v_mfma_f32_16x16x32_bf16 a[80:83], a[216:219], a[128:131], a[80:83]
    s_waitcnt lgkmcnt(4)
    v_mfma_f32_16x16x32_bf16 v[64:67], a[192:195], a[128:131], v[64:67]
    ds_read_b64_tr_b16 a[208:209], v13 offset:4608
    v_mfma_f32_16x16x32_bf16 v[64:67], a[196:199], a[132:135], v[64:67]
    v_mfma_f32_16x16x32_bf16 v[68:71], a[196:199], a[140:143], v[68:71]
    ds_read_b64_tr_b16 a[210:211], v13 offset:25088
    v_mfma_f32_16x16x32_bf16 v[68:71], a[192:195], a[136:139], v[68:71]
    buffer_load_dwordx4 a[124:127], v6, s[20:23], s69 offen offset:1024 sc1
    v_mfma_f32_16x16x32_bf16 v[72:75], a[192:195], a[144:147], v[72:75]
    ds_read_b64_tr_b16 a[212:213], v13 offset:5632
    v_mfma_f32_16x16x32_bf16 v[72:75], a[196:199], a[148:151], v[72:75]
    s_add_u32 s69, s69, 8192
    v_mfma_f32_16x16x32_bf16 v[76:79], a[196:199], a[156:159], v[76:79]
    ds_read_b64_tr_b16 a[214:215], v13 offset:26112
    v_mfma_f32_16x16x32_bf16 v[76:79], a[192:195], a[152:155], v[76:79]
    s_waitcnt lgkmcnt(4)
    v_mfma_f32_16x16x32_bf16 v[92:95], a[200:203], a[152:155], v[92:95]
    ds_read_b64_tr_b16 a[216:217], v14 offset:4608
    v_mfma_f32_16x16x32_bf16 v[92:95], a[204:207], a[156:159], v[92:95]
    s_add_u32 m0, s70, 4096
    v_mfma_f32_16x16x32_bf16 v[88:91], a[204:207], a[148:151], v[88:91]
    ds_read_b64_tr_b16 a[218:219], v14 offset:25088
    v_mfma_f32_16x16x32_bf16 v[88:91], a[200:203], a[144:147], v[88:91]
    buffer_load_dwordx4 v9, s[32:35], s65 offen offset:0 lds
    v_mfma_f32_16x16x32_bf16 v[84:87], a[200:203], a[136:139], v[84:87]
    ds_read_b64_tr_b16 a[220:221], v14 offset:5632
    v_mfma_f32_16x16x32_bf16 v[84:87], a[204:207], a[140:143], v[84:87]
    v_mfma_f32_16x16x32_bf16 v[80:83], a[204:207], a[132:135], v[80:83]
    ds_read_b64_tr_b16 a[222:223], v14 offset:26112
    v_mfma_f32_16x16x32_bf16 v[80:83], a[200:203], a[128:131], v[80:83]
    s_waitcnt lgkmcnt(4)
    v_mfma_f32_16x16x32_bf16 v[96:99], a[208:211], a[128:131], v[96:99]
    ds_read_b64_tr_b16 a[192:193], v13 offset:6144
    v_mfma_f32_16x16x32_bf16 v[96:99], a[212:215], a[132:135], v[96:99]
    v_mfma_f32_16x16x32_bf16 v[100:103], a[212:215], a[140:143], v[100:103]
    ds_read_b64_tr_b16 a[194:195], v13 offset:26624
    v_mfma_f32_16x16x32_bf16 v[100:103], a[208:211], a[136:139], v[100:103]
    buffer_load_dwordx4 v10, s[32:35], s65 offen offset:1024 lds
    v_mfma_f32_16x16x32_bf16 v[104:107], a[208:211], a[144:147], v[104:107]
    ds_read_b64_tr_b16 a[196:197], v13 offset:7168
    v_mfma_f32_16x16x32_bf16 v[104:107], a[212:215], a[148:151], v[104:107]
    v_mfma_f32_16x16x32_bf16 v[108:111], a[212:215], a[156:159], v[108:111]
    ds_read_b64_tr_b16 a[198:199], v13 offset:27648
    v_mfma_f32_16x16x32_bf16 v[108:111], a[208:211], a[152:155], v[108:111]
    s_waitcnt lgkmcnt(4)
    v_mfma_f32_16x16x32_bf16 v[124:127], a[216:219], a[152:155], v[124:127]
    ds_read_b64_tr_b16 a[200:201], v14 offset:6144
    v_mfma_f32_16x16x32_bf16 v[124:127], a[220:223], a[156:159], v[124:127]
    v_mfma_f32_16x16x32_bf16 v[120:123], a[220:223], a[148:151], v[120:123]
    ds_read_b64_tr_b16 a[202:203], v14 offset:26624
    v_mfma_f32_16x16x32_bf16 v[120:123], a[216:219], a[144:147], v[120:123]
    buffer_load_dwordx4 v9, s[36:39], s65 offen offset:2048 lds
    v_mfma_f32_16x16x32_bf16 v[116:119], a[216:219], a[136:139], v[116:119]
    ds_read_b64_tr_b16 a[204:205], v14 offset:7168
    v_mfma_f32_16x16x32_bf16 v[116:119], a[220:223], a[140:143], v[116:119]
    v_mfma_f32_16x16x32_bf16 v[112:115], a[220:223], a[132:135], v[112:115]
    ds_read_b64_tr_b16 a[206:207], v14 offset:27648
    v_mfma_f32_16x16x32_bf16 v[112:115], a[216:219], a[128:131], v[112:115]
    s_waitcnt lgkmcnt(4)
    v_mfma_f32_16x16x32_bf16 v[128:131], a[192:195], a[128:131], v[128:131]
    ds_read_b64_tr_b16 a[208:209], v13 offset:6656
    v_mfma_f32_16x16x32_bf16 v[128:131], a[196:199], a[132:135], v[128:131]
    v_mfma_f32_16x16x32_bf16 v[132:135], a[196:199], a[140:143], v[132:135]
    ds_read_b64_tr_b16 a[210:211], v13 offset:27136
    v_mfma_f32_16x16x32_bf16 v[132:135], a[192:195], a[136:139], v[132:135]
    buffer_load_dwordx4 v10, s[36:39], s65 offen offset:3072 lds
    v_mfma_f32_16x16x32_bf16 v[136:139], a[192:195], a[144:147], v[136:139]
    ds_read_b64_tr_b16 a[212:213], v13 offset:7680
    v_mfma_f32_16x16x32_bf16 v[136:139], a[196:199], a[148:151], v[136:139]
    v_mfma_f32_16x16x32_bf16 v[140:143], a[196:199], a[156:159], v[140:143]
    ds_read_b64_tr_b16 a[214:215], v13 offset:28160
    v_mfma_f32_16x16x32_bf16 v[140:143], a[192:195], a[152:155], v[140:143]
    s_waitcnt lgkmcnt(4)
    v_mfma_f32_16x16x32_bf16 v[156:159], a[200:203], a[152:155], v[156:159]
    ds_read_b64_tr_b16 a[216:217], v14 offset:6656
    v_mfma_f32_16x16x32_bf16 v[156:159], a[204:207], a[156:159], v[156:159]
    s_mov_b32 m0, s70
    v_mfma_f32_16x16x32_bf16 v[152:155], a[204:207], a[148:151], v[152:155]
    ds_read_b64_tr_b16 a[218:219], v14 offset:27136
    v_mfma_f32_16x16x32_bf16 v[152:155], a[200:203], a[144:147], v[152:155]
    buffer_load_dwordx4 v7, s[24:27], s64 offen offset:0 lds
    v_mfma_f32_16x16x32_bf16 v[148:151], a[200:203], a[136:139], v[148:151]
    ds_read_b64_tr_b16 a[220:221], v14 offset:7680
    v_mfma_f32_16x16x32_bf16 v[148:151], a[204:207], a[140:143], v[148:151]
    s_add_u32 s72, s72, 1
    s_and_b32 s72, s72, 3
    v_mfma_f32_16x16x32_bf16 v[144:147], a[204:207], a[132:135], v[144:147]
    ds_read_b64_tr_b16 a[222:223], v14 offset:28160
    v_mfma_f32_16x16x32_bf16 v[144:147], a[200:203], a[128:131], v[144:147]
    s_cselect_b32 s73, s74, s75
    s_waitcnt lgkmcnt(4)
    v_mfma_f32_16x16x32_bf16 v[160:163], a[208:211], a[128:131], v[160:163]
    ds_read_b64_tr_b16 a[192:193], v15 offset:8192
    v_mfma_f32_16x16x32_bf16 v[160:163], a[212:215], a[132:135], v[160:163]
    v_mfma_f32_16x16x32_bf16 v[164:167], a[212:215], a[140:143], v[164:167]
    ds_read_b64_tr_b16 a[194:195], v15 offset:28672
    v_mfma_f32_16x16x32_bf16 v[164:167], a[208:211], a[136:139], v[164:167]
    buffer_load_dwordx4 v8, s[24:27], s64 offen offset:1024 lds
    v_mfma_f32_16x16x32_bf16 v[168:171], a[208:211], a[144:147], v[168:171]
    ds_read_b64_tr_b16 a[196:197], v15 offset:9216
    v_mfma_f32_16x16x32_bf16 v[168:171], a[212:215], a[148:151], v[168:171]
    v_mfma_f32_16x16x32_bf16 v[172:175], a[212:215], a[156:159], v[172:175]
    ds_read_b64_tr_b16 a[198:199], v15 offset:29696
    v_mfma_f32_16x16x32_bf16 v[172:175], a[208:211], a[152:155], v[172:175]
    s_waitcnt lgkmcnt(4)
    v_mfma_f32_16x16x32_bf16 v[188:191], a[216:219], a[152:155], v[188:191]
    ds_read_b64_tr_b16 a[200:201], v16 offset:8192
    v_mfma_f32_16x16x32_bf16 v[188:191], a[220:223], a[156:159], v[188:191]
    v_mfma_f32_16x16x32_bf16 v[184:187], a[220:223], a[148:151], v[184:187]
    ds_read_b64_tr_b16 a[202:203], v16 offset:28672
    v_mfma_f32_16x16x32_bf16 v[184:187], a[216:219], a[144:147], v[184:187]
    buffer_load_dwordx4 v7, s[28:31], s64 offen offset:2048 lds
    v_mfma_f32_16x16x32_bf16 v[180:183], a[216:219], a[136:139], v[180:183]
    ds_read_b64_tr_b16 a[204:205], v16 offset:9216
    v_mfma_f32_16x16x32_bf16 v[180:183], a[220:223], a[140:143], v[180:183]
    v_add_u32 v13, s73, v13
    v_mfma_f32_16x16x32_bf16 v[176:179], a[220:223], a[132:135], v[176:179]
    ds_read_b64_tr_b16 a[206:207], v16 offset:29696
    v_mfma_f32_16x16x32_bf16 v[176:179], a[216:219], a[128:131], v[176:179]
    v_add_u32 v14, s73, v14
    s_waitcnt lgkmcnt(4)
    v_mfma_f32_16x16x32_bf16 v[192:195], a[192:195], a[128:131], v[192:195]
    ds_read_b64_tr_b16 a[208:209], v15 offset:18432
    v_mfma_f32_16x16x32_bf16 v[192:195], a[196:199], a[132:135], v[192:195]
    v_mfma_f32_16x16x32_bf16 v[196:199], a[196:199], a[140:143], v[196:199]
    ds_read_b64_tr_b16 a[210:211], v15 offset:38912
    v_mfma_f32_16x16x32_bf16 v[196:199], a[192:195], a[136:139], v[196:199]
    buffer_load_dwordx4 v8, s[28:31], s64 offen offset:3072 lds
    v_mfma_f32_16x16x32_bf16 v[200:203], a[192:195], a[144:147], v[200:203]
    ds_read_b64_tr_b16 a[212:213], v15 offset:19456
    v_mfma_f32_16x16x32_bf16 v[200:203], a[196:199], a[148:151], v[200:203]
    v_mfma_f32_16x16x32_bf16 v[204:207], a[196:199], a[156:159], v[204:207]
    ds_read_b64_tr_b16 a[214:215], v15 offset:39936
    v_mfma_f32_16x16x32_bf16 v[204:207], a[192:195], a[152:155], v[204:207]
    s_waitcnt lgkmcnt(4)
    v_mfma_f32_16x16x32_bf16 v[220:223], a[200:203], a[152:155], v[220:223]
    ds_read_b64_tr_b16 a[216:217], v16 offset:18432
    v_mfma_f32_16x16x32_bf16 v[220:223], a[204:207], a[156:159], v[220:223]
    s_add_u32 m0, s70, 8192
    v_mfma_f32_16x16x32_bf16 v[216:219], a[204:207], a[148:151], v[216:219]
    ds_read_b64_tr_b16 a[218:219], v16 offset:38912
    v_mfma_f32_16x16x32_bf16 v[216:219], a[200:203], a[144:147], v[216:219]
    buffer_load_dwordx4 v11, s[40:43], s66 offen offset:0 lds
    v_mfma_f32_16x16x32_bf16 v[212:215], a[200:203], a[136:139], v[212:215]
    ds_read_b64_tr_b16 a[220:221], v16 offset:19456
    v_mfma_f32_16x16x32_bf16 v[212:215], a[204:207], a[140:143], v[212:215]
    v_mfma_f32_16x16x32_bf16 v[208:211], a[204:207], a[132:135], v[208:211]
    ds_read_b64_tr_b16 a[222:223], v16 offset:39936
    v_mfma_f32_16x16x32_bf16 v[208:211], a[200:203], a[128:131], v[208:211]
    s_waitcnt lgkmcnt(4)
    v_mfma_f32_16x16x32_bf16 v[224:227], a[208:211], a[128:131], v[224:227]
    ds_read_b64_tr_b16 a[192:193], v13 offset:0
    v_mfma_f32_16x16x32_bf16 v[224:227], a[212:215], a[132:135], v[224:227]
    v_add_u32 v15, s73, v15
    v_mfma_f32_16x16x32_bf16 v[228:231], a[212:215], a[140:143], v[228:231]
    ds_read_b64_tr_b16 a[194:195], v13 offset:20480
    v_mfma_f32_16x16x32_bf16 v[228:231], a[208:211], a[136:139], v[228:231]
    buffer_load_dwordx4 v12, s[40:43], s66 offen offset:1024 lds
    v_mfma_f32_16x16x32_bf16 v[232:235], a[208:211], a[144:147], v[232:235]
    ds_read_b64_tr_b16 a[196:197], v13 offset:1024
    v_mfma_f32_16x16x32_bf16 v[232:235], a[212:215], a[148:151], v[232:235]
    s_add_u32 s64, s64, 458752
    v_mfma_f32_16x16x32_bf16 v[236:239], a[212:215], a[156:159], v[236:239]
    ds_read_b64_tr_b16 a[198:199], v13 offset:21504
    v_mfma_f32_16x16x32_bf16 v[236:239], a[208:211], a[152:155], v[236:239]
    s_add_u32 s65, s65, s67
    s_waitcnt lgkmcnt(4)
    v_mfma_f32_16x16x32_bf16 v[252:255], a[216:219], a[152:155], v[252:255]
    ds_read_b64_tr_b16 a[200:201], v14 offset:0
    v_mfma_f32_16x16x32_bf16 v[252:255], a[220:223], a[156:159], v[252:255]
    s_add_u32 s66, s66, s68
    v_mfma_f32_16x16x32_bf16 v[248:251], a[220:223], a[148:151], v[248:251]
    ds_read_b64_tr_b16 a[202:203], v14 offset:20480
    v_mfma_f32_16x16x32_bf16 v[248:251], a[216:219], a[144:147], v[248:251]
    buffer_load_dword v0, v29, s[60:63], 0 offen
    s_add_u32 s70, s70, 40960
    s_sub_u32 s10, s70, 163840
    v_mfma_f32_16x16x32_bf16 v[244:247], a[216:219], a[136:139], v[244:247]
    ds_read_b64_tr_b16 a[204:205], v14 offset:1024
    v_mfma_f32_16x16x32_bf16 v[244:247], a[220:223], a[140:143], v[244:247]
    v_add_u32 v29, v28, v29
    s_cmp_ge_u32 s70, 163840
    s_cselect_b32 s70, s10, s70
    v_mfma_f32_16x16x32_bf16 v[240:243], a[220:223], a[132:135], v[240:243]
    ds_read_b64_tr_b16 a[206:207], v14 offset:21504
    v_mfma_f32_16x16x32_bf16 v[240:243], a[216:219], a[128:131], v[240:243]
    v_add_u32 v16, s73, v16
    s_waitcnt vmcnt(20) lgkmcnt(4)
    v_mfma_f32_16x16x32_bf16 v[32:35], a[192:195], a[160:163], v[32:35]
    ds_read_b64_tr_b16 a[208:209], v13 offset:512
    v_mfma_f32_16x16x32_bf16 v[32:35], a[196:199], a[164:167], v[32:35]
    v_mfma_f32_16x16x32_bf16 v[36:39], a[196:199], a[172:175], v[36:39]
    ds_read_b64_tr_b16 a[210:211], v13 offset:20992
    v_mfma_f32_16x16x32_bf16 v[36:39], a[192:195], a[168:171], v[36:39]
    v_mfma_f32_16x16x32_bf16 v[40:43], a[192:195], a[176:179], v[40:43]
    ds_read_b64_tr_b16 a[212:213], v13 offset:1536
    v_mfma_f32_16x16x32_bf16 v[40:43], a[196:199], a[180:183], v[40:43]
    v_mfma_f32_16x16x32_bf16 v[44:47], a[196:199], a[188:191], v[44:47]
    ds_read_b64_tr_b16 a[214:215], v13 offset:22016
    v_mfma_f32_16x16x32_bf16 v[44:47], a[192:195], a[184:187], v[44:47]
    s_waitcnt vmcnt(20) lgkmcnt(4)
    s_barrier
    v_mfma_f32_16x16x32_bf16 v[60:63], a[200:203], a[184:187], v[60:63]
    ds_read_b64_tr_b16 a[216:217], v14 offset:512
    v_mfma_f32_16x16x32_bf16 v[60:63], a[204:207], a[188:191], v[60:63]
    v_mfma_f32_16x16x32_bf16 v[56:59], a[204:207], a[180:183], v[56:59]
    ds_read_b64_tr_b16 a[218:219], v14 offset:20992
    v_mfma_f32_16x16x32_bf16 v[56:59], a[200:203], a[176:179], v[56:59]
    buffer_load_dwordx4 a[128:131], v3, s[20:23], s69 offen offset:0 sc1
    v_mfma_f32_16x16x32_bf16 v[52:55], a[200:203], a[168:171], v[52:55]
    ds_read_b64_tr_b16 a[220:221], v14 offset:1536
    v_mfma_f32_16x16x32_bf16 v[52:55], a[204:207], a[172:175], v[52:55]
    v_mfma_f32_16x16x32_bf16 v[48:51], a[204:207], a[164:167], v[48:51]
    ds_read_b64_tr_b16 a[222:223], v14 offset:22016
    v_mfma_f32_16x16x32_bf16 v[48:51], a[200:203], a[160:163], v[48:51]
    s_waitcnt lgkmcnt(4)
    v_mfma_f32_16x16x32_bf16 a[0:3], a[208:211], a[160:163], a[0:3]
    ds_read_b64_tr_b16 a[192:193], v13 offset:2048
    v_mfma_f32_16x16x32_bf16 a[0:3], a[212:215], a[164:167], a[0:3]
    v_mfma_f32_16x16x32_bf16 a[4:7], a[212:215], a[172:175], a[4:7]
    ds_read_b64_tr_b16 a[194:195], v13 offset:22528
    v_mfma_f32_16x16x32_bf16 a[4:7], a[208:211], a[168:171], a[4:7]
    buffer_load_dwordx4 a[132:135], v3, s[20:23], s69 offen offset:1024 sc1
    v_mfma_f32_16x16x32_bf16 a[8:11], a[208:211], a[176:179], a[8:11]
    ds_read_b64_tr_b16 a[196:197], v13 offset:3072
    v_mfma_f32_16x16x32_bf16 a[8:11], a[212:215], a[180:183], a[8:11]
    v_mfma_f32_16x16x32_bf16 a[12:15], a[212:215], a[188:191], a[12:15]
    ds_read_b64_tr_b16 a[198:199], v13 offset:23552
    v_mfma_f32_16x16x32_bf16 a[12:15], a[208:211], a[184:187], a[12:15]
    s_waitcnt lgkmcnt(4)
    v_mfma_f32_16x16x32_bf16 a[28:31], a[216:219], a[184:187], a[28:31]
    ds_read_b64_tr_b16 a[200:201], v14 offset:2048
    v_mfma_f32_16x16x32_bf16 a[28:31], a[220:223], a[188:191], a[28:31]
    v_mfma_f32_16x16x32_bf16 a[24:27], a[220:223], a[180:183], a[24:27]
    ds_read_b64_tr_b16 a[202:203], v14 offset:22528
    v_mfma_f32_16x16x32_bf16 a[24:27], a[216:219], a[176:179], a[24:27]
    buffer_load_dwordx4 a[136:139], v4, s[20:23], s69 offen offset:0 sc1
    v_mfma_f32_16x16x32_bf16 a[20:23], a[216:219], a[168:171], a[20:23]
    ds_read_b64_tr_b16 a[204:205], v14 offset:3072
    v_mfma_f32_16x16x32_bf16 a[20:23], a[220:223], a[172:175], a[20:23]
    v_mfma_f32_16x16x32_bf16 a[16:19], a[220:223], a[164:167], a[16:19]
    ds_read_b64_tr_b16 a[206:207], v14 offset:23552
    v_mfma_f32_16x16x32_bf16 a[16:19], a[216:219], a[160:163], a[16:19]
    s_waitcnt lgkmcnt(4)
    v_mfma_f32_16x16x32_bf16 a[32:35], a[192:195], a[160:163], a[32:35]
    ds_read_b64_tr_b16 a[208:209], v13 offset:2560
    v_mfma_f32_16x16x32_bf16 a[32:35], a[196:199], a[164:167], a[32:35]
    v_mfma_f32_16x16x32_bf16 a[36:39], a[196:199], a[172:175], a[36:39]
    ds_read_b64_tr_b16 a[210:211], v13 offset:23040
    v_mfma_f32_16x16x32_bf16 a[36:39], a[192:195], a[168:171], a[36:39]
    buffer_load_dwordx4 a[140:143], v4, s[20:23], s69 offen offset:1024 sc1
    v_mfma_f32_16x16x32_bf16 a[40:43], a[192:195], a[176:179], a[40:43]
    ds_read_b64_tr_b16 a[212:213], v13 offset:3584
    v_mfma_f32_16x16x32_bf16 a[40:43], a[196:199], a[180:183], a[40:43]
    v_mfma_f32_16x16x32_bf16 a[44:47], a[196:199], a[188:191], a[44:47]
    ds_read_b64_tr_b16 a[214:215], v13 offset:24064
    v_mfma_f32_16x16x32_bf16 a[44:47], a[192:195], a[184:187], a[44:47]
    s_waitcnt lgkmcnt(4)
    v_mfma_f32_16x16x32_bf16 a[60:63], a[200:203], a[184:187], a[60:63]
    ds_read_b64_tr_b16 a[216:217], v14 offset:2560
    v_mfma_f32_16x16x32_bf16 a[60:63], a[204:207], a[188:191], a[60:63]
    v_mfma_f32_16x16x32_bf16 a[56:59], a[204:207], a[180:183], a[56:59]
    ds_read_b64_tr_b16 a[218:219], v14 offset:23040
    v_mfma_f32_16x16x32_bf16 a[56:59], a[200:203], a[176:179], a[56:59]
    buffer_load_dwordx4 a[144:147], v5, s[20:23], s69 offen offset:0 sc1
    v_mfma_f32_16x16x32_bf16 a[52:55], a[200:203], a[168:171], a[52:55]
    ds_read_b64_tr_b16 a[220:221], v14 offset:3584
    v_mfma_f32_16x16x32_bf16 a[52:55], a[204:207], a[172:175], a[52:55]
    v_mfma_f32_16x16x32_bf16 a[48:51], a[204:207], a[164:167], a[48:51]
    ds_read_b64_tr_b16 a[222:223], v14 offset:24064
    v_mfma_f32_16x16x32_bf16 a[48:51], a[200:203], a[160:163], a[48:51]
    s_waitcnt lgkmcnt(4)
    v_mfma_f32_16x16x32_bf16 a[64:67], a[208:211], a[160:163], a[64:67]
    ds_read_b64_tr_b16 a[192:193], v13 offset:4096
    v_mfma_f32_16x16x32_bf16 a[64:67], a[212:215], a[164:167], a[64:67]
    v_mfma_f32_16x16x32_bf16 a[68:71], a[212:215], a[172:175], a[68:71]
    ds_read_b64_tr_b16 a[194:195], v13 offset:24576
    v_mfma_f32_16x16x32_bf16 a[68:71], a[208:211], a[168:171], a[68:71]
    buffer_load_dwordx4 a[148:151], v5, s[20:23], s69 offen offset:1024 sc1
    v_mfma_f32_16x16x32_bf16 a[72:75], a[208:211], a[176:179], a[72:75]
    ds_read_b64_tr_b16 a[196:197], v13 offset:5120
    v_mfma_f32_16x16x32_bf16 a[72:75], a[212:215], a[180:183], a[72:75]
    v_mfma_f32_16x16x32_bf16 a[76:79], a[212:215], a[188:191], a[76:79]
    ds_read_b64_tr_b16 a[198:199], v13 offset:25600
    v_mfma_f32_16x16x32_bf16 a[76:79], a[208:211], a[184:187], a[76:79]
    s_waitcnt lgkmcnt(4)
    v_mfma_f32_16x16x32_bf16 a[92:95], a[216:219], a[184:187], a[92:95]
    ds_read_b64_tr_b16 a[200:201], v14 offset:4096
    v_mfma_f32_16x16x32_bf16 a[92:95], a[220:223], a[188:191], a[92:95]
    v_mfma_f32_16x16x32_bf16 a[88:91], a[220:223], a[180:183], a[88:91]
    ds_read_b64_tr_b16 a[202:203], v14 offset:24576
    v_mfma_f32_16x16x32_bf16 a[88:91], a[216:219], a[176:179], a[88:91]
    buffer_load_dwordx4 a[152:155], v6, s[20:23], s69 offen offset:0 sc1
    v_mfma_f32_16x16x32_bf16 a[84:87], a[216:219], a[168:171], a[84:87]
    ds_read_b64_tr_b16 a[204:205], v14 offset:5120
    v_mfma_f32_16x16x32_bf16 a[84:87], a[220:223], a[172:175], a[84:87]
    v_mfma_f32_16x16x32_bf16 a[80:83], a[220:223], a[164:167], a[80:83]
    ds_read_b64_tr_b16 a[206:207], v14 offset:25600
    v_mfma_f32_16x16x32_bf16 a[80:83], a[216:219], a[160:163], a[80:83]
    s_waitcnt lgkmcnt(4)
    v_mfma_f32_16x16x32_bf16 v[64:67], a[192:195], a[160:163], v[64:67]
    ds_read_b64_tr_b16 a[208:209], v13 offset:4608
    v_mfma_f32_16x16x32_bf16 v[64:67], a[196:199], a[164:167], v[64:67]
    v_mfma_f32_16x16x32_bf16 v[68:71], a[196:199], a[172:175], v[68:71]
    ds_read_b64_tr_b16 a[210:211], v13 offset:25088
    v_mfma_f32_16x16x32_bf16 v[68:71], a[192:195], a[168:171], v[68:71]
    buffer_load_dwordx4 a[156:159], v6, s[20:23], s69 offen offset:1024 sc1
    v_mfma_f32_16x16x32_bf16 v[72:75], a[192:195], a[176:179], v[72:75]
    ds_read_b64_tr_b16 a[212:213], v13 offset:5632
    v_mfma_f32_16x16x32_bf16 v[72:75], a[196:199], a[180:183], v[72:75]
    s_add_u32 s69, s69, 8192
    v_mfma_f32_16x16x32_bf16 v[76:79], a[196:199], a[188:191], v[76:79]
    ds_read_b64_tr_b16 a[214:215], v13 offset:26112
    v_mfma_f32_16x16x32_bf16 v[76:79], a[192:195], a[184:187], v[76:79]
    s_waitcnt lgkmcnt(4)
    v_mfma_f32_16x16x32_bf16 v[92:95], a[200:203], a[184:187], v[92:95]
    ds_read_b64_tr_b16 a[216:217], v14 offset:4608
    v_mfma_f32_16x16x32_bf16 v[92:95], a[204:207], a[188:191], v[92:95]
    s_add_u32 m0, s70, 4096
    v_mfma_f32_16x16x32_bf16 v[88:91], a[204:207], a[180:183], v[88:91]
    ds_read_b64_tr_b16 a[218:219], v14 offset:25088
    v_mfma_f32_16x16x32_bf16 v[88:91], a[200:203], a[176:179], v[88:91]
    buffer_load_dwordx4 v9, s[32:35], s65 offen offset:0 lds
    v_mfma_f32_16x16x32_bf16 v[84:87], a[200:203], a[168:171], v[84:87]
    ds_read_b64_tr_b16 a[220:221], v14 offset:5632
    v_mfma_f32_16x16x32_bf16 v[84:87], a[204:207], a[172:175], v[84:87]
    v_mfma_f32_16x16x32_bf16 v[80:83], a[204:207], a[164:167], v[80:83]
    ds_read_b64_tr_b16 a[222:223], v14 offset:26112
    v_mfma_f32_16x16x32_bf16 v[80:83], a[200:203], a[160:163], v[80:83]
    s_waitcnt lgkmcnt(4)
    v_mfma_f32_16x16x32_bf16 v[96:99], a[208:211], a[160:163], v[96:99]
    ds_read_b64_tr_b16 a[192:193], v13 offset:6144
    v_mfma_f32_16x16x32_bf16 v[96:99], a[212:215], a[164:167], v[96:99]
    v_mfma_f32_16x16x32_bf16 v[100:103], a[212:215], a[172:175], v[100:103]
    ds_read_b64_tr_b16 a[194:195], v13 offset:26624
    v_mfma_f32_16x16x32_bf16 v[100:103], a[208:211], a[168:171], v[100:103]
    buffer_load_dwordx4 v10, s[32:35], s65 offen offset:1024 lds
    v_mfma_f32_16x16x32_bf16 v[104:107], a[208:211], a[176:179], v[104:107]
    ds_read_b64_tr_b16 a[196:197], v13 offset:7168
    v_mfma_f32_16x16x32_bf16 v[104:107], a[212:215], a[180:183], v[104:107]
    v_mfma_f32_16x16x32_bf16 v[108:111], a[212:215], a[188:191], v[108:111]
    ds_read_b64_tr_b16 a[198:199], v13 offset:27648
    v_mfma_f32_16x16x32_bf16 v[108:111], a[208:211], a[184:187], v[108:111]
    s_waitcnt lgkmcnt(4)
    v_mfma_f32_16x16x32_bf16 v[124:127], a[216:219], a[184:187], v[124:127]
    ds_read_b64_tr_b16 a[200:201], v14 offset:6144
    v_mfma_f32_16x16x32_bf16 v[124:127], a[220:223], a[188:191], v[124:127]
    v_mfma_f32_16x16x32_bf16 v[120:123], a[220:223], a[180:183], v[120:123]
    ds_read_b64_tr_b16 a[202:203], v14 offset:26624
    v_mfma_f32_16x16x32_bf16 v[120:123], a[216:219], a[176:179], v[120:123]
    buffer_load_dwordx4 v9, s[36:39], s65 offen offset:2048 lds
    v_mfma_f32_16x16x32_bf16 v[116:119], a[216:219], a[168:171], v[116:119]
    ds_read_b64_tr_b16 a[204:205], v14 offset:7168
    v_mfma_f32_16x16x32_bf16 v[116:119], a[220:223], a[172:175], v[116:119]
    v_mfma_f32_16x16x32_bf16 v[112:115], a[220:223], a[164:167], v[112:115]
    ds_read_b64_tr_b16 a[206:207], v14 offset:27648
    v_mfma_f32_16x16x32_bf16 v[112:115], a[216:219], a[160:163], v[112:115]
    s_waitcnt lgkmcnt(4)
    v_mfma_f32_16x16x32_bf16 v[128:131], a[192:195], a[160:163], v[128:131]
    ds_read_b64_tr_b16 a[208:209], v13 offset:6656
    v_mfma_f32_16x16x32_bf16 v[128:131], a[196:199], a[164:167], v[128:131]
    v_mfma_f32_16x16x32_bf16 v[132:135], a[196:199], a[172:175], v[132:135]
    ds_read_b64_tr_b16 a[210:211], v13 offset:27136
    v_mfma_f32_16x16x32_bf16 v[132:135], a[192:195], a[168:171], v[132:135]
    buffer_load_dwordx4 v10, s[36:39], s65 offen offset:3072 lds
    v_mfma_f32_16x16x32_bf16 v[136:139], a[192:195], a[176:179], v[136:139]
    ds_read_b64_tr_b16 a[212:213], v13 offset:7680
    v_mfma_f32_16x16x32_bf16 v[136:139], a[196:199], a[180:183], v[136:139]
    v_mfma_f32_16x16x32_bf16 v[140:143], a[196:199], a[188:191], v[140:143]
    ds_read_b64_tr_b16 a[214:215], v13 offset:28160
    v_mfma_f32_16x16x32_bf16 v[140:143], a[192:195], a[184:187], v[140:143]
    s_waitcnt lgkmcnt(4)
    v_mfma_f32_16x16x32_bf16 v[156:159], a[200:203], a[184:187], v[156:159]
    ds_read_b64_tr_b16 a[216:217], v14 offset:6656
    v_mfma_f32_16x16x32_bf16 v[156:159], a[204:207], a[188:191], v[156:159]
    s_mov_b32 m0, s70
    v_mfma_f32_16x16x32_bf16 v[152:155], a[204:207], a[180:183], v[152:155]
    ds_read_b64_tr_b16 a[218:219], v14 offset:27136
    v_mfma_f32_16x16x32_bf16 v[152:155], a[200:203], a[176:179], v[152:155]
    buffer_load_dwordx4 v7, s[24:27], s64 offen offset:0 lds
    v_mfma_f32_16x16x32_bf16 v[148:151], a[200:203], a[168:171], v[148:151]
    ds_read_b64_tr_b16 a[220:221], v14 offset:7680
    v_mfma_f32_16x16x32_bf16 v[148:151], a[204:207], a[172:175], v[148:151]
    s_add_u32 s72, s72, 1
    s_and_b32 s72, s72, 3
    v_mfma_f32_16x16x32_bf16 v[144:147], a[204:207], a[164:167], v[144:147]
    ds_read_b64_tr_b16 a[222:223], v14 offset:28160
    v_mfma_f32_16x16x32_bf16 v[144:147], a[200:203], a[160:163], v[144:147]
    s_cselect_b32 s73, s74, s75
    s_waitcnt lgkmcnt(4)
    v_mfma_f32_16x16x32_bf16 v[160:163], a[208:211], a[160:163], v[160:163]
    ds_read_b64_tr_b16 a[192:193], v15 offset:8192
    v_mfma_f32_16x16x32_bf16 v[160:163], a[212:215], a[164:167], v[160:163]
    v_mfma_f32_16x16x32_bf16 v[164:167], a[212:215], a[172:175], v[164:167]
    ds_read_b64_tr_b16 a[194:195], v15 offset:28672
    v_mfma_f32_16x16x32_bf16 v[164:167], a[208:211], a[168:171], v[164:167]
    buffer_load_dwordx4 v8, s[24:27], s64 offen offset:1024 lds
    v_mfma_f32_16x16x32_bf16 v[168:171], a[208:211], a[176:179], v[168:171]
    ds_read_b64_tr_b16 a[196:197], v15 offset:9216
    v_mfma_f32_16x16x32_bf16 v[168:171], a[212:215], a[180:183], v[168:171]
    v_mfma_f32_16x16x32_bf16 v[172:175], a[212:215], a[188:191], v[172:175]
    ds_read_b64_tr_b16 a[198:199], v15 offset:29696
    v_mfma_f32_16x16x32_bf16 v[172:175], a[208:211], a[184:187], v[172:175]
    s_waitcnt lgkmcnt(4)
    v_mfma_f32_16x16x32_bf16 v[188:191], a[216:219], a[184:187], v[188:191]
    ds_read_b64_tr_b16 a[200:201], v16 offset:8192
    v_mfma_f32_16x16x32_bf16 v[188:191], a[220:223], a[188:191], v[188:191]
    v_mfma_f32_16x16x32_bf16 v[184:187], a[220:223], a[180:183], v[184:187]
    ds_read_b64_tr_b16 a[202:203], v16 offset:28672
    v_mfma_f32_16x16x32_bf16 v[184:187], a[216:219], a[176:179], v[184:187]
    buffer_load_dwordx4 v7, s[28:31], s64 offen offset:2048 lds
    v_mfma_f32_16x16x32_bf16 v[180:183], a[216:219], a[168:171], v[180:183]
    ds_read_b64_tr_b16 a[204:205], v16 offset:9216
    v_mfma_f32_16x16x32_bf16 v[180:183], a[220:223], a[172:175], v[180:183]
    v_add_u32 v13, s73, v13
    v_mfma_f32_16x16x32_bf16 v[176:179], a[220:223], a[164:167], v[176:179]
    ds_read_b64_tr_b16 a[206:207], v16 offset:29696
    v_mfma_f32_16x16x32_bf16 v[176:179], a[216:219], a[160:163], v[176:179]
    v_add_u32 v14, s73, v14
    s_waitcnt lgkmcnt(4)
    v_mfma_f32_16x16x32_bf16 v[192:195], a[192:195], a[160:163], v[192:195]
    ds_read_b64_tr_b16 a[208:209], v15 offset:18432
    v_mfma_f32_16x16x32_bf16 v[192:195], a[196:199], a[164:167], v[192:195]
    v_mfma_f32_16x16x32_bf16 v[196:199], a[196:199], a[172:175], v[196:199]
    ds_read_b64_tr_b16 a[210:211], v15 offset:38912
    v_mfma_f32_16x16x32_bf16 v[196:199], a[192:195], a[168:171], v[196:199]
    buffer_load_dwordx4 v8, s[28:31], s64 offen offset:3072 lds
    v_mfma_f32_16x16x32_bf16 v[200:203], a[192:195], a[176:179], v[200:203]
    ds_read_b64_tr_b16 a[212:213], v15 offset:19456
    v_mfma_f32_16x16x32_bf16 v[200:203], a[196:199], a[180:183], v[200:203]
    v_mfma_f32_16x16x32_bf16 v[204:207], a[196:199], a[188:191], v[204:207]
    ds_read_b64_tr_b16 a[214:215], v15 offset:39936
    v_mfma_f32_16x16x32_bf16 v[204:207], a[192:195], a[184:187], v[204:207]
    s_waitcnt lgkmcnt(4)
    v_mfma_f32_16x16x32_bf16 v[220:223], a[200:203], a[184:187], v[220:223]
    ds_read_b64_tr_b16 a[216:217], v16 offset:18432
    v_mfma_f32_16x16x32_bf16 v[220:223], a[204:207], a[188:191], v[220:223]
    s_add_u32 m0, s70, 8192
    v_mfma_f32_16x16x32_bf16 v[216:219], a[204:207], a[180:183], v[216:219]
    ds_read_b64_tr_b16 a[218:219], v16 offset:38912
    v_mfma_f32_16x16x32_bf16 v[216:219], a[200:203], a[176:179], v[216:219]
    buffer_load_dwordx4 v11, s[40:43], s66 offen offset:0 lds
    v_mfma_f32_16x16x32_bf16 v[212:215], a[200:203], a[168:171], v[212:215]
    ds_read_b64_tr_b16 a[220:221], v16 offset:19456
    v_mfma_f32_16x16x32_bf16 v[212:215], a[204:207], a[172:175], v[212:215]
    v_mfma_f32_16x16x32_bf16 v[208:211], a[204:207], a[164:167], v[208:211]
    ds_read_b64_tr_b16 a[222:223], v16 offset:39936
    v_mfma_f32_16x16x32_bf16 v[208:211], a[200:203], a[160:163], v[208:211]
    s_waitcnt lgkmcnt(4)
    v_mfma_f32_16x16x32_bf16 v[224:227], a[208:211], a[160:163], v[224:227]
    ds_read_b64_tr_b16 a[192:193], v13 offset:0
    v_mfma_f32_16x16x32_bf16 v[224:227], a[212:215], a[164:167], v[224:227]
    v_add_u32 v15, s73, v15
    v_mfma_f32_16x16x32_bf16 v[228:231], a[212:215], a[172:175], v[228:231]
    ds_read_b64_tr_b16 a[194:195], v13 offset:20480
    v_mfma_f32_16x16x32_bf16 v[228:231], a[208:211], a[168:171], v[228:231]
    buffer_load_dwordx4 v12, s[40:43], s66 offen offset:1024 lds
    v_mfma_f32_16x16x32_bf16 v[232:235], a[208:211], a[176:179], v[232:235]
    ds_read_b64_tr_b16 a[196:197], v13 offset:1024
    v_mfma_f32_16x16x32_bf16 v[232:235], a[212:215], a[180:183], v[232:235]
    s_add_u32 s64, s64, 458752
    v_mfma_f32_16x16x32_bf16 v[236:239], a[212:215], a[188:191], v[236:239]
    ds_read_b64_tr_b16 a[198:199], v13 offset:21504
    v_mfma_f32_16x16x32_bf16 v[236:239], a[208:211], a[184:187], v[236:239]
    s_add_u32 s65, s65, s67
    s_waitcnt lgkmcnt(4)
    v_mfma_f32_16x16x32_bf16 v[252:255], a[216:219], a[184:187], v[252:255]
    ds_read_b64_tr_b16 a[200:201], v14 offset:0
    v_mfma_f32_16x16x32_bf16 v[252:255], a[220:223], a[188:191], v[252:255]
    s_add_u32 s66, s66, s68
    v_mfma_f32_16x16x32_bf16 v[248:251], a[220:223], a[180:183], v[248:251]
    ds_read_b64_tr_b16 a[202:203], v14 offset:20480
    v_mfma_f32_16x16x32_bf16 v[248:251], a[216:219], a[176:179], v[248:251]
    buffer_load_dword v0, v29, s[60:63], 0 offen
    s_add_u32 s70, s70, 40960
    s_sub_u32 s10, s70, 163840
    v_mfma_f32_16x16x32_bf16 v[244:247], a[216:219], a[168:171], v[244:247]
    ds_read_b64_tr_b16 a[204:205], v14 offset:1024
    v_mfma_f32_16x16x32_bf16 v[244:247], a[220:223], a[172:175], v[244:247]
    v_add_u32 v29, v28, v29
    s_cmp_ge_u32 s70, 163840
    s_cselect_b32 s70, s10, s70
    v_mfma_f32_16x16x32_bf16 v[240:243], a[220:223], a[164:167], v[240:243]
    ds_read_b64_tr_b16 a[206:207], v14 offset:21504
    v_mfma_f32_16x16x32_bf16 v[240:243], a[216:219], a[160:163], v[240:243]
    v_add_u32 v16, s73, v16
    s_waitcnt vmcnt(30) lgkmcnt(4)
    v_mfma_f32_16x16x32_bf16 v[32:35], a[192:195], a[96:99], v[32:35]
    ds_read_b64_tr_b16 a[208:209], v13 offset:512
    v_mfma_f32_16x16x32_bf16 v[32:35], a[196:199], a[100:103], v[32:35]
    v_mfma_f32_16x16x32_bf16 v[36:39], a[196:199], a[108:111], v[36:39]
    ds_read_b64_tr_b16 a[210:211], v13 offset:20992
    v_mfma_f32_16x16x32_bf16 v[36:39], a[192:195], a[104:107], v[36:39]
    v_mfma_f32_16x16x32_bf16 v[40:43], a[192:195], a[112:115], v[40:43]
    ds_read_b64_tr_b16 a[212:213], v13 offset:1536
    v_mfma_f32_16x16x32_bf16 v[40:43], a[196:199], a[116:119], v[40:43]
    v_mfma_f32_16x16x32_bf16 v[44:47], a[196:199], a[124:127], v[44:47]
    ds_read_b64_tr_b16 a[214:215], v13 offset:22016
    v_mfma_f32_16x16x32_bf16 v[44:47], a[192:195], a[120:123], v[44:47]
    s_waitcnt vmcnt(20) lgkmcnt(4)
    s_barrier
    v_mfma_f32_16x16x32_bf16 v[60:63], a[200:203], a[120:123], v[60:63]
    ds_read_b64_tr_b16 a[216:217], v14 offset:512
    v_mfma_f32_16x16x32_bf16 v[60:63], a[204:207], a[124:127], v[60:63]
    v_mfma_f32_16x16x32_bf16 v[56:59], a[204:207], a[116:119], v[56:59]
    ds_read_b64_tr_b16 a[218:219], v14 offset:20992
    v_mfma_f32_16x16x32_bf16 v[56:59], a[200:203], a[112:115], v[56:59]
    buffer_load_dwordx4 a[160:163], v3, s[20:23], s69 offen offset:0 sc1
    v_mfma_f32_16x16x32_bf16 v[52:55], a[200:203], a[104:107], v[52:55]
    ds_read_b64_tr_b16 a[220:221], v14 offset:1536
    v_mfma_f32_16x16x32_bf16 v[52:55], a[204:207], a[108:111], v[52:55]
    v_mfma_f32_16x16x32_bf16 v[48:51], a[204:207], a[100:103], v[48:51]
    ds_read_b64_tr_b16 a[222:223], v14 offset:22016
    v_mfma_f32_16x16x32_bf16 v[48:51], a[200:203], a[96:99], v[48:51]
    s_waitcnt lgkmcnt(4)
    v_mfma_f32_16x16x32_bf16 a[0:3], a[208:211], a[96:99], a[0:3]
    ds_read_b64_tr_b16 a[192:193], v13 offset:2048
    v_mfma_f32_16x16x32_bf16 a[0:3], a[212:215], a[100:103], a[0:3]
    v_mfma_f32_16x16x32_bf16 a[4:7], a[212:215], a[108:111], a[4:7]
    ds_read_b64_tr_b16 a[194:195], v13 offset:22528
    v_mfma_f32_16x16x32_bf16 a[4:7], a[208:211], a[104:107], a[4:7]
    buffer_load_dwordx4 a[164:167], v3, s[20:23], s69 offen offset:1024 sc1
    v_mfma_f32_16x16x32_bf16 a[8:11], a[208:211], a[112:115], a[8:11]
    ds_read_b64_tr_b16 a[196:197], v13 offset:3072
    v_mfma_f32_16x16x32_bf16 a[8:11], a[212:215], a[116:119], a[8:11]
    v_mfma_f32_16x16x32_bf16 a[12:15], a[212:215], a[124:127], a[12:15]
    ds_read_b64_tr_b16 a[198:199], v13 offset:23552
    v_mfma_f32_16x16x32_bf16 a[12:15], a[208:211], a[120:123], a[12:15]
    s_waitcnt lgkmcnt(4)
    v_mfma_f32_16x16x32_bf16 a[28:31], a[216:219], a[120:123], a[28:31]
    ds_read_b64_tr_b16 a[200:201], v14 offset:2048
    v_mfma_f32_16x16x32_bf16 a[28:31], a[220:223], a[124:127], a[28:31]
    v_mfma_f32_16x16x32_bf16 a[24:27], a[220:223], a[116:119], a[24:27]
    ds_read_b64_tr_b16 a[202:203], v14 offset:22528
    v_mfma_f32_16x16x32_bf16 a[24:27], a[216:219], a[112:115], a[24:27]
    buffer_load_dwordx4 a[168:171], v4, s[20:23], s69 offen offset:0 sc1
    v_mfma_f32_16x16x32_bf16 a[20:23], a[216:219], a[104:107], a[20:23]
    ds_read_b64_tr_b16 a[204:205], v14 offset:3072
    v_mfma_f32_16x16x32_bf16 a[20:23], a[220:223], a[108:111], a[20:23]
    v_mfma_f32_16x16x32_bf16 a[16:19], a[220:223], a[100:103], a[16:19]
    ds_read_b64_tr_b16 a[206:207], v14 offset:23552
    v_mfma_f32_16x16x32_bf16 a[16:19], a[216:219], a[96:99], a[16:19]
    s_waitcnt lgkmcnt(4)
    v_mfma_f32_16x16x32_bf16 a[32:35], a[192:195], a[96:99], a[32:35]
    ds_read_b64_tr_b16 a[208:209], v13 offset:2560
    v_mfma_f32_16x16x32_bf16 a[32:35], a[196:199], a[100:103], a[32:35]
    v_mfma_f32_16x16x32_bf16 a[36:39], a[196:199], a[108:111], a[36:39]
    ds_read_b64_tr_b16 a[210:211], v13 offset:23040
    v_mfma_f32_16x16x32_bf16 a[36:39], a[192:195], a[104:107], a[36:39]
    buffer_load_dwordx4 a[172:175], v4, s[20:23], s69 offen offset:1024 sc1
    v_mfma_f32_16x16x32_bf16 a[40:43], a[192:195], a[112:115], a[40:43]
    ds_read_b64_tr_b16 a[212:213], v13 offset:3584
    v_mfma_f32_16x16x32_bf16 a[40:43], a[196:199], a[116:119], a[40:43]
    v_mfma_f32_16x16x32_bf16 a[44:47], a[196:199], a[124:127], a[44:47]
    ds_read_b64_tr_b16 a[214:215], v13 offset:24064
    v_mfma_f32_16x16x32_bf16 a[44:47], a[192:195], a[120:123], a[44:47]
    s_waitcnt lgkmcnt(4)
    v_mfma_f32_16x16x32_bf16 a[60:63], a[200:203], a[120:123], a[60:63]
    ds_read_b64_tr_b16 a[216:217], v14 offset:2560
    v_mfma_f32_16x16x32_bf16 a[60:63], a[204:207], a[124:127], a[60:63]
    v_mfma_f32_16x16x32_bf16 a[56:59], a[204:207], a[116:119], a[56:59]
    ds_read_b64_tr_b16 a[218:219], v14 offset:23040
    v_mfma_f32_16x16x32_bf16 a[56:59], a[200:203], a[112:115], a[56:59]
    buffer_load_dwordx4 a[176:179], v5, s[20:23], s69 offen offset:0 sc1
    v_mfma_f32_16x16x32_bf16 a[52:55], a[200:203], a[104:107], a[52:55]
    ds_read_b64_tr_b16 a[220:221], v14 offset:3584
    v_mfma_f32_16x16x32_bf16 a[52:55], a[204:207], a[108:111], a[52:55]
    v_mfma_f32_16x16x32_bf16 a[48:51], a[204:207], a[100:103], a[48:51]
    ds_read_b64_tr_b16 a[222:223], v14 offset:24064
    v_mfma_f32_16x16x32_bf16 a[48:51], a[200:203], a[96:99], a[48:51]
    s_waitcnt lgkmcnt(4)
    v_mfma_f32_16x16x32_bf16 a[64:67], a[208:211], a[96:99], a[64:67]
    ds_read_b64_tr_b16 a[192:193], v13 offset:4096
    v_mfma_f32_16x16x32_bf16 a[64:67], a[212:215], a[100:103], a[64:67]
    v_mfma_f32_16x16x32_bf16 a[68:71], a[212:215], a[108:111], a[68:71]
    ds_read_b64_tr_b16 a[194:195], v13 offset:24576
    v_mfma_f32_16x16x32_bf16 a[68:71], a[208:211], a[104:107], a[68:71]
    buffer_load_dwordx4 a[180:183], v5, s[20:23], s69 offen offset:1024 sc1
    v_mfma_f32_16x16x32_bf16 a[72:75], a[208:211], a[112:115], a[72:75]
    ds_read_b64_tr_b16 a[196:197], v13 offset:5120
    v_mfma_f32_16x16x32_bf16 a[72:75], a[212:215], a[116:119], a[72:75]
    v_mfma_f32_16x16x32_bf16 a[76:79], a[212:215], a[124:127], a[76:79]
    ds_read_b64_tr_b16 a[198:199], v13 offset:25600
    v_mfma_f32_16x16x32_bf16 a[76:79], a[208:211], a[120:123], a[76:79]
    s_waitcnt lgkmcnt(4)
    v_mfma_f32_16x16x32_bf16 a[92:95], a[216:219], a[120:123], a[92:95]
    ds_read_b64_tr_b16 a[200:201], v14 offset:4096
    v_mfma_f32_16x16x32_bf16 a[92:95], a[220:223], a[124:127], a[92:95]
    v_mfma_f32_16x16x32_bf16 a[88:91], a[220:223], a[116:119], a[88:91]
    ds_read_b64_tr_b16 a[202:203], v14 offset:24576
    v_mfma_f32_16x16x32_bf16 a[88:91], a[216:219], a[112:115], a[88:91]
    buffer_load_dwordx4 a[184:187], v6, s[20:23], s69 offen offset:0 sc1
    v_mfma_f32_16x16x32_bf16 a[84:87], a[216:219], a[104:107], a[84:87]
    ds_read_b64_tr_b16 a[204:205], v14 offset:5120
    v_mfma_f32_16x16x32_bf16 a[84:87], a[220:223], a[108:111], a[84:87]
    v_mfma_f32_16x16x32_bf16 a[80:83], a[220:223], a[100:103], a[80:83]
    ds_read_b64_tr_b16 a[206:207], v14 offset:25600
    v_mfma_f32_16x16x32_bf16 a[80:83], a[216:219], a[96:99], a[80:83]
    s_waitcnt lgkmcnt(4)
    v_mfma_f32_16x16x32_bf16 v[64:67], a[192:195], a[96:99], v[64:67]
    ds_read_b64_tr_b16 a[208:209], v13 offset:4608
    v_mfma_f32_16x16x32_bf16 v[64:67], a[196:199], a[100:103], v[64:67]
    v_mfma_f32_16x16x32_bf16 v[68:71], a[196:199], a[108:111], v[68:71]
    ds_read_b64_tr_b16 a[210:211], v13 offset:25088
    v_mfma_f32_16x16x32_bf16 v[68:71], a[192:195], a[104:107], v[68:71]
    buffer_load_dwordx4 a[188:191], v6, s[20:23], s69 offen offset:1024 sc1
    v_mfma_f32_16x16x32_bf16 v[72:75], a[192:195], a[112:115], v[72:75]
    ds_read_b64_tr_b16 a[212:213], v13 offset:5632
    v_mfma_f32_16x16x32_bf16 v[72:75], a[196:199], a[116:119], v[72:75]
    s_add_u32 s69, s69, 8192
    v_mfma_f32_16x16x32_bf16 v[76:79], a[196:199], a[124:127], v[76:79]
    ds_read_b64_tr_b16 a[214:215], v13 offset:26112
    v_mfma_f32_16x16x32_bf16 v[76:79], a[192:195], a[120:123], v[76:79]
    s_waitcnt lgkmcnt(4)
    v_mfma_f32_16x16x32_bf16 v[92:95], a[200:203], a[120:123], v[92:95]
    ds_read_b64_tr_b16 a[216:217], v14 offset:4608
    v_mfma_f32_16x16x32_bf16 v[92:95], a[204:207], a[124:127], v[92:95]
    s_add_u32 m0, s70, 4096
    v_mfma_f32_16x16x32_bf16 v[88:91], a[204:207], a[116:119], v[88:91]
    ds_read_b64_tr_b16 a[218:219], v14 offset:25088
    v_mfma_f32_16x16x32_bf16 v[88:91], a[200:203], a[112:115], v[88:91]
    buffer_load_dwordx4 v9, s[32:35], s65 offen offset:0 lds
    v_mfma_f32_16x16x32_bf16 v[84:87], a[200:203], a[104:107], v[84:87]
    ds_read_b64_tr_b16 a[220:221], v14 offset:5632
    v_mfma_f32_16x16x32_bf16 v[84:87], a[204:207], a[108:111], v[84:87]
    v_mfma_f32_16x16x32_bf16 v[80:83], a[204:207], a[100:103], v[80:83]
    ds_read_b64_tr_b16 a[222:223], v14 offset:26112
    v_mfma_f32_16x16x32_bf16 v[80:83], a[200:203], a[96:99], v[80:83]
    s_waitcnt lgkmcnt(4)
    v_mfma_f32_16x16x32_bf16 v[96:99], a[208:211], a[96:99], v[96:99]
    ds_read_b64_tr_b16 a[192:193], v13 offset:6144
    v_mfma_f32_16x16x32_bf16 v[96:99], a[212:215], a[100:103], v[96:99]
    v_mfma_f32_16x16x32_bf16 v[100:103], a[212:215], a[108:111], v[100:103]
    ds_read_b64_tr_b16 a[194:195], v13 offset:26624
    v_mfma_f32_16x16x32_bf16 v[100:103], a[208:211], a[104:107], v[100:103]
    buffer_load_dwordx4 v10, s[32:35], s65 offen offset:1024 lds
    v_mfma_f32_16x16x32_bf16 v[104:107], a[208:211], a[112:115], v[104:107]
    ds_read_b64_tr_b16 a[196:197], v13 offset:7168
    v_mfma_f32_16x16x32_bf16 v[104:107], a[212:215], a[116:119], v[104:107]
    v_mfma_f32_16x16x32_bf16 v[108:111], a[212:215], a[124:127], v[108:111]
    ds_read_b64_tr_b16 a[198:199], v13 offset:27648
    v_mfma_f32_16x16x32_bf16 v[108:111], a[208:211], a[120:123], v[108:111]
    s_waitcnt lgkmcnt(4)
    v_mfma_f32_16x16x32_bf16 v[124:127], a[216:219], a[120:123], v[124:127]
    ds_read_b64_tr_b16 a[200:201], v14 offset:6144
    v_mfma_f32_16x16x32_bf16 v[124:127], a[220:223], a[124:127], v[124:127]
    v_mfma_f32_16x16x32_bf16 v[120:123], a[220:223], a[116:119], v[120:123]
    ds_read_b64_tr_b16 a[202:203], v14 offset:26624
    v_mfma_f32_16x16x32_bf16 v[120:123], a[216:219], a[112:115], v[120:123]
    buffer_load_dwordx4 v9, s[36:39], s65 offen offset:2048 lds
    v_mfma_f32_16x16x32_bf16 v[116:119], a[216:219], a[104:107], v[116:119]
    ds_read_b64_tr_b16 a[204:205], v14 offset:7168
    v_mfma_f32_16x16x32_bf16 v[116:119], a[220:223], a[108:111], v[116:119]
    v_mfma_f32_16x16x32_bf16 v[112:115], a[220:223], a[100:103], v[112:115]
    ds_read_b64_tr_b16 a[206:207], v14 offset:27648
    v_mfma_f32_16x16x32_bf16 v[112:115], a[216:219], a[96:99], v[112:115]
    s_waitcnt lgkmcnt(4)
    v_mfma_f32_16x16x32_bf16 v[128:131], a[192:195], a[96:99], v[128:131]
    ds_read_b64_tr_b16 a[208:209], v13 offset:6656
    v_mfma_f32_16x16x32_bf16 v[128:131], a[196:199], a[100:103], v[128:131]
    v_mfma_f32_16x16x32_bf16 v[132:135], a[196:199], a[108:111], v[132:135]
    ds_read_b64_tr_b16 a[210:211], v13 offset:27136
    v_mfma_f32_16x16x32_bf16 v[132:135], a[192:195], a[104:107], v[132:135]
    buffer_load_dwordx4 v10, s[36:39], s65 offen offset:3072 lds
    v_mfma_f32_16x16x32_bf16 v[136:139], a[192:195], a[112:115], v[136:139]
    ds_read_b64_tr_b16 a[212:213], v13 offset:7680
    v_mfma_f32_16x16x32_bf16 v[136:139], a[196:199], a[116:119], v[136:139]
    v_mfma_f32_16x16x32_bf16 v[140:143], a[196:199], a[124:127], v[140:143]
    ds_read_b64_tr_b16 a[214:215], v13 offset:28160
    v_mfma_f32_16x16x32_bf16 v[140:143], a[192:195], a[120:123], v[140:143]
    s_waitcnt lgkmcnt(4)
    v_mfma_f32_16x16x32_bf16 v[156:159], a[200:203], a[120:123], v[156:159]
    ds_read_b64_tr_b16 a[216:217], v14 offset:6656
    v_mfma_f32_16x16x32_bf16 v[156:159], a[204:207], a[124:127], v[156:159]
    s_mov_b32 m0, s70
    v_mfma_f32_16x16x32_bf16 v[152:155], a[204:207], a[116:119], v[152:155]
    ds_read_b64_tr_b16 a[218:219], v14 offset:27136
    v_mfma_f32_16x16x32_bf16 v[152:155], a[200:203], a[112:115], v[152:155]
    buffer_load_dwordx4 v7, s[24:27], s64 offen offset:0 lds
    v_mfma_f32_16x16x32_bf16 v[148:151], a[200:203], a[104:107], v[148:151]
    ds_read_b64_tr_b16 a[220:221], v14 offset:7680
    v_mfma_f32_16x16x32_bf16 v[148:151], a[204:207], a[108:111], v[148:151]
    s_add_u32 s72, s72, 1
    s_and_b32 s72, s72, 3
    v_mfma_f32_16x16x32_bf16 v[144:147], a[204:207], a[100:103], v[144:147]
    ds_read_b64_tr_b16 a[222:223], v14 offset:28160
    v_mfma_f32_16x16x32_bf16 v[144:147], a[200:203], a[96:99], v[144:147]
    s_cselect_b32 s73, s74, s75
    s_waitcnt lgkmcnt(4)
    v_mfma_f32_16x16x32_bf16 v[160:163], a[208:211], a[96:99], v[160:163]
    ds_read_b64_tr_b16 a[192:193], v15 offset:8192
    v_mfma_f32_16x16x32_bf16 v[160:163], a[212:215], a[100:103], v[160:163]
    v_mfma_f32_16x16x32_bf16 v[164:167], a[212:215], a[108:111], v[164:167]
    ds_read_b64_tr_b16 a[194:195], v15 offset:28672
    v_mfma_f32_16x16x32_bf16 v[164:167], a[208:211], a[104:107], v[164:167]
    buffer_load_dwordx4 v8, s[24:27], s64 offen offset:1024 lds
    v_mfma_f32_16x16x32_bf16 v[168:171], a[208:211], a[112:115], v[168:171]
    ds_read_b64_tr_b16 a[196:197], v15 offset:9216
    v_mfma_f32_16x16x32_bf16 v[168:171], a[212:215], a[116:119], v[168:171]
    v_mfma_f32_16x16x32_bf16 v[172:175], a[212:215], a[124:127], v[172:175]
    ds_read_b64_tr_b16 a[198:199], v15 offset:29696
    v_mfma_f32_16x16x32_bf16 v[172:175], a[208:211], a[120:123], v[172:175]
    s_waitcnt lgkmcnt(4)
    v_mfma_f32_16x16x32_bf16 v[188:191], a[216:219], a[120:123], v[188:191]
    ds_read_b64_tr_b16 a[200:201], v16 offset:8192
    v_mfma_f32_16x16x32_bf16 v[188:191], a[220:223], a[124:127], v[188:191]
    v_mfma_f32_16x16x32_bf16 v[184:187], a[220:223], a[116:119], v[184:187]
    ds_read_b64_tr_b16 a[202:203], v16 offset:28672
    v_mfma_f32_16x16x32_bf16 v[184:187], a[216:219], a[112:115], v[184:187]
    buffer_load_dwordx4 v7, s[28:31], s64 offen offset:2048 lds
    v_mfma_f32_16x16x32_bf16 v[180:183], a[216:219], a[104:107], v[180:183]
    ds_read_b64_tr_b16 a[204:205], v16 offset:9216
    v_mfma_f32_16x16x32_bf16 v[180:183], a[220:223], a[108:111], v[180:183]
    v_add_u32 v13, s73, v13
    v_mfma_f32_16x16x32_bf16 v[176:179], a[220:223], a[100:103], v[176:179]
    ds_read_b64_tr_b16 a[206:207], v16 offset:29696
    v_mfma_f32_16x16x32_bf16 v[176:179], a[216:219], a[96:99], v[176:179]
    v_add_u32 v14, s73, v14
    s_waitcnt lgkmcnt(4)
    v_mfma_f32_16x16x32_bf16 v[192:195], a[192:195], a[96:99], v[192:195]
    ds_read_b64_tr_b16 a[208:209], v15 offset:18432
    v_mfma_f32_16x16x32_bf16 v[192:195], a[196:199], a[100:103], v[192:195]
    v_mfma_f32_16x16x32_bf16 v[196:199], a[196:199], a[108:111], v[196:199]
    ds_read_b64_tr_b16 a[210:211], v15 offset:38912
    v_mfma_f32_16x16x32_bf16 v[196:199], a[192:195], a[104:107], v[196:199]
    buffer_load_dwordx4 v8, s[28:31], s64 offen offset:3072 lds
    v_mfma_f32_16x16x32_bf16 v[200:203], a[192:195], a[112:115], v[200:203]
    ds_read_b64_tr_b16 a[212:213], v15 offset:19456
    v_mfma_f32_16x16x32_bf16 v[200:203], a[196:199], a[116:119], v[200:203]
    v_mfma_f32_16x16x32_bf16 v[204:207], a[196:199], a[124:127], v[204:207]
    ds_read_b64_tr_b16 a[214:215], v15 offset:39936
    v_mfma_f32_16x16x32_bf16 v[204:207], a[192:195], a[120:123], v[204:207]
    s_waitcnt lgkmcnt(4)
    v_mfma_f32_16x16x32_bf16 v[220:223], a[200:203], a[120:123], v[220:223]
    ds_read_b64_tr_b16 a[216:217], v16 offset:18432
    v_mfma_f32_16x16x32_bf16 v[220:223], a[204:207], a[124:127], v[220:223]
    s_add_u32 m0, s70, 8192
    v_mfma_f32_16x16x32_bf16 v[216:219], a[204:207], a[116:119], v[216:219]
    ds_read_b64_tr_b16 a[218:219], v16 offset:38912
    v_mfma_f32_16x16x32_bf16 v[216:219], a[200:203], a[112:115], v[216:219]
    buffer_load_dwordx4 v11, s[40:43], s66 offen offset:0 lds
    v_mfma_f32_16x16x32_bf16 v[212:215], a[200:203], a[104:107], v[212:215]
    ds_read_b64_tr_b16 a[220:221], v16 offset:19456
    v_mfma_f32_16x16x32_bf16 v[212:215], a[204:207], a[108:111], v[212:215]
    v_mfma_f32_16x16x32_bf16 v[208:211], a[204:207], a[100:103], v[208:211]
    ds_read_b64_tr_b16 a[222:223], v16 offset:39936
    v_mfma_f32_16x16x32_bf16 v[208:211], a[200:203], a[96:99], v[208:211]
    s_waitcnt lgkmcnt(4)
    v_mfma_f32_16x16x32_bf16 v[224:227], a[208:211], a[96:99], v[224:227]
    ds_read_b64_tr_b16 a[192:193], v13 offset:0
    v_mfma_f32_16x16x32_bf16 v[224:227], a[212:215], a[100:103], v[224:227]
    v_add_u32 v15, s73, v15
    v_mfma_f32_16x16x32_bf16 v[228:231], a[212:215], a[108:111], v[228:231]
    ds_read_b64_tr_b16 a[194:195], v13 offset:20480
    v_mfma_f32_16x16x32_bf16 v[228:231], a[208:211], a[104:107], v[228:231]
    buffer_load_dwordx4 v12, s[40:43], s66 offen offset:1024 lds
    v_mfma_f32_16x16x32_bf16 v[232:235], a[208:211], a[112:115], v[232:235]
    ds_read_b64_tr_b16 a[196:197], v13 offset:1024
    v_mfma_f32_16x16x32_bf16 v[232:235], a[212:215], a[116:119], v[232:235]
    s_add_u32 s64, s64, 458752
    v_mfma_f32_16x16x32_bf16 v[236:239], a[212:215], a[124:127], v[236:239]
    ds_read_b64_tr_b16 a[198:199], v13 offset:21504
    v_mfma_f32_16x16x32_bf16 v[236:239], a[208:211], a[120:123], v[236:239]
    s_add_u32 s65, s65, s67
    s_waitcnt lgkmcnt(4)
    v_mfma_f32_16x16x32_bf16 v[252:255], a[216:219], a[120:123], v[252:255]
    ds_read_b64_tr_b16 a[200:201], v14 offset:0
    v_mfma_f32_16x16x32_bf16 v[252:255], a[220:223], a[124:127], v[252:255]
    s_add_u32 s66, s66, s68
    v_mfma_f32_16x16x32_bf16 v[248:251], a[220:223], a[116:119], v[248:251]
    ds_read_b64_tr_b16 a[202:203], v14 offset:20480
    v_mfma_f32_16x16x32_bf16 v[248:251], a[216:219], a[112:115], v[248:251]
    buffer_load_dword v0, v29, s[60:63], 0 offen
    s_add_u32 s70, s70, 40960
    s_sub_u32 s10, s70, 163840
    v_mfma_f32_16x16x32_bf16 v[244:247], a[216:219], a[104:107], v[244:247]
    ds_read_b64_tr_b16 a[204:205], v14 offset:1024
    v_mfma_f32_16x16x32_bf16 v[244:247], a[220:223], a[108:111], v[244:247]
    v_add_u32 v29, v28, v29
    s_cmp_ge_u32 s70, 163840
    s_cselect_b32 s70, s10, s70
    v_mfma_f32_16x16x32_bf16 v[240:243], a[220:223], a[100:103], v[240:243]
    ds_read_b64_tr_b16 a[206:207], v14 offset:21504
    v_mfma_f32_16x16x32_bf16 v[240:243], a[216:219], a[96:99], v[240:243]
    global_load_dword v0, v[24:25], off
    v_add_u32 v16, s73, v16
    s_sub_u32 s71, s71, 1
    s_cmp_lg_u32 s71, 0
    s_cbranch_scc1 L_loop
    v_mov_b32 v9, v13
    v_subrev_u32 v7, 40960, v13
    v_add_u32 v11, 40960, v13
    v_add_u32 v13, 81920, v13
    v_mov_b32 v10, v14
    v_subrev_u32 v8, 40960, v14
    v_add_u32 v12, 40960, v14
    v_add_u32 v14, 81920, v14
    s_waitcnt vmcnt(31) lgkmcnt(4)
    v_mfma_f32_16x16x32_bf16 v[32:35], a[192:195], a[128:131], v[32:35]
    ds_read_b64_tr_b16 a[208:209], v9 offset:6144
    s_and_b32 s70, s14, 3
    v_mfma_f32_16x16x32_bf16 v[32:35], a[196:199], a[132:135], v[32:35]
    buffer_load_dwordx4 a[96:99], v3, s[20:23], s69 offen offset:0 sc1
    s_lshl_b32 s70, s70, 2
    v_mfma_f32_16x16x32_bf16 v[36:39], a[196:199], a[140:143], v[36:39]
    ds_read_b64_tr_b16 a[210:211], v9 offset:26624
    s_add_u32 s70, s70, s3
    v_mfma_f32_16x16x32_bf16 v[36:39], a[192:195], a[136:139], v[36:39]
    s_mul_i32 s96, s70, 114688
    s_mul_i32 s97, s17, 1835008
    v_mfma_f32_16x16x32_bf16 v[40:43], a[192:195], a[144:147], v[40:43]
    ds_read_b64_tr_b16 a[212:213], v9 offset:7168
    s_add_u32 s96, s96, s97
    v_mfma_f32_16x16x32_bf16 v[40:43], a[196:199], a[148:151], v[40:43]
    buffer_load_dwordx4 a[100:103], v3, s[20:23], s69 offen offset:1024 sc1
    s_add_u32 s97, s96, 49152
    v_mfma_f32_16x16x32_bf16 v[44:47], a[196:199], a[156:159], v[44:47]
    ds_read_b64_tr_b16 a[214:215], v9 offset:27648
    s_lshl_b32 s79, s70, 17
    v_mfma_f32_16x16x32_bf16 v[44:47], a[192:195], a[152:155], v[44:47]
    s_waitcnt vmcnt(23) lgkmcnt(4)
    s_barrier
    v_mfma_f32_16x16x32_bf16 v[60:63], a[200:203], a[152:155], v[60:63]
    ds_read_b64_tr_b16 a[216:217], v10 offset:6144
    s_add_u32 s72, s79, 65536
    v_mfma_f32_16x16x32_bf16 v[60:63], a[204:207], a[156:159], v[60:63]
    buffer_load_dwordx4 a[104:107], v4, s[20:23], s69 offen offset:0 sc1
    v_lshrrev_b32 v22, 1, v1
    v_mfma_f32_16x16x32_bf16 v[56:59], a[204:207], a[148:151], v[56:59]
    ds_read_b64_tr_b16 a[218:219], v10 offset:26624
    v_lshlrev_b32 v22, 11, v22
    v_mfma_f32_16x16x32_bf16 v[56:59], a[200:203], a[144:147], v[56:59]
    s_sub_u32 s71, s8, 2048
    s_ashr_i32 s74, s71, 31
    s_add_u32 s36, s6, s71
    s_addc_u32 s37, s7, s74
    v_mfma_f32_16x16x32_bf16 v[52:55], a[200:203], a[136:139], v[52:55]
    ds_read_b64_tr_b16 a[220:221], v10 offset:7168
    v_and_b32 v23, 1, v1
    v_mfma_f32_16x16x32_bf16 v[52:55], a[204:207], a[140:143], v[52:55]
    buffer_load_dwordx4 a[108:111], v4, s[20:23], s69 offen offset:1024 sc1
    v_lshl_add_u32 v22, v23, 7, v22
    v_mfma_f32_16x16x32_bf16 v[48:51], a[204:207], a[132:135], v[48:51]
    ds_read_b64_tr_b16 a[222:223], v10 offset:27648
    s_sub_u32 s38, 2097152, s71
    v_mfma_f32_16x16x32_bf16 v[48:51], a[200:203], a[128:131], v[48:51]
    s_mov_b32 s39, 0x20000
    s_waitcnt lgkmcnt(4)
    v_mfma_f32_16x16x32_bf16 v[128:131], a[208:211], a[128:131], v[128:131]
    ds_read_b64_tr_b16 a[192:193], v11 offset:6144
    v_lshrrev_b32 v24, 4, v1
    v_mfma_f32_16x16x32_bf16 v[128:131], a[212:215], a[132:135], v[128:131]
    buffer_load_dwordx4 a[112:115], v5, s[20:23], s69 offen offset:0 sc1
    v_lshlrev_b32 v23, 7, v1
    v_mfma_f32_16x16x32_bf16 v[132:135], a[212:215], a[140:143], v[132:135]
    ds_read_b64_tr_b16 a[194:195], v11 offset:26624
    v_lshl_add_u32 v23, v24, 28, v23
    v_mfma_f32_16x16x32_bf16 v[132:135], a[208:211], a[136:139], v[132:135]
    s_lshl_b32 s72, s2, 2
    s_add_u32 s72, s72, s3
    v_mfma_f32_16x16x32_bf16 v[136:139], a[208:211], a[144:147], v[136:139]
    ds_read_b64_tr_b16 a[196:197], v11 offset:7168
    s_lshl_b32 s72, s72, 11
    v_mfma_f32_16x16x32_bf16 v[136:139], a[212:215], a[148:151], v[136:139]
    buffer_load_dwordx4 a[116:119], v5, s[20:23], s69 offen offset:1024 sc1
    s_sub_u32 s72, s72, s8
    v_mfma_f32_16x16x32_bf16 v[140:143], a[212:215], a[156:159], v[140:143]
    ds_read_b64_tr_b16 a[198:199], v11 offset:27648
    s_lshl_b32 s64, s9, 7
    v_mfma_f32_16x16x32_bf16 v[140:143], a[208:211], a[152:155], v[140:143]
    s_lshl_b32 s66, s15, 2
    s_waitcnt lgkmcnt(4)
    v_mfma_f32_16x16x32_bf16 v[156:159], a[216:219], a[152:155], v[156:159]
    ds_read_b64_tr_b16 a[200:201], v12 offset:6144
    s_add_u32 s70, s66, s3
    v_mfma_f32_16x16x32_bf16 v[156:159], a[220:223], a[156:159], v[156:159]
    buffer_load_dwordx4 a[120:123], v6, s[20:23], s69 offen offset:0 sc1
    s_add_u32 s66, s66, s64
    v_mfma_f32_16x16x32_bf16 v[152:155], a[220:223], a[148:151], v[152:155]
    ds_read_b64_tr_b16 a[202:203], v12 offset:26624
    s_lshl_b32 s65, s70, 7
    v_mfma_f32_16x16x32_bf16 v[152:155], a[216:219], a[144:147], v[152:155]
    s_add_u32 s65, s65, 12288
    s_lshl_b32 s67, s17, 4
    v_mfma_f32_16x16x32_bf16 v[148:151], a[216:219], a[136:139], v[148:151]
    ds_read_b64_tr_b16 a[204:205], v12 offset:7168
    s_add_u32 s67, s67, s64
    v_mfma_f32_16x16x32_bf16 v[148:151], a[220:223], a[140:143], v[148:151]
    buffer_load_dwordx4 a[124:127], v6, s[20:23], s69 offen offset:1024 sc1
    s_add_u32 s73, s67, 57344
    v_mfma_f32_16x16x32_bf16 v[144:147], a[220:223], a[132:135], v[144:147]
    ds_read_b64_tr_b16 a[206:207], v12 offset:27648
    s_add_u32 s67, s67, 4096
    v_mfma_f32_16x16x32_bf16 v[144:147], a[216:219], a[128:131], v[144:147]
    s_add_u32 s64, s64, 8192
    s_waitcnt vmcnt(20) lgkmcnt(4)
    v_mfma_f32_16x16x32_bf16 v[128:131], a[192:195], a[160:163], v[128:131]
    ds_read_b64_tr_b16 a[208:209], v9 offset:4096
    s_lshl_b32 s70, s14, 3
    v_mfma_f32_16x16x32_bf16 v[128:131], a[196:199], a[164:167], v[128:131]
    s_lshr_b32 s71, s8, 8
    s_add_u32 s70, s70, s71
    v_mfma_f32_16x16x32_bf16 v[132:135], a[196:199], a[172:175], v[132:135]
    ds_read_b64_tr_b16 a[210:211], v9 offset:24576
    s_lshl_b32 s71, s70, 18
    v_mfma_f32_16x16x32_bf16 v[132:135], a[192:195], a[168:171], v[132:135]
    s_lshl_b32 s74, s3, 12
    s_add_u32 s71, s71, s74
    v_mfma_f32_16x16x32_bf16 v[136:139], a[192:195], a[176:179], v[136:139]
    ds_read_b64_tr_b16 a[212:213], v9 offset:5120
    s_add_u32 s71, s71, 33554432
    v_mfma_f32_16x16x32_bf16 v[136:139], a[196:199], a[180:183], v[136:139]
    buffer_load_dword v0, v22, s[56:59], s96 offen offset:2048
    v_mfma_f32_16x16x32_bf16 v[140:143], a[196:199], a[188:191], v[140:143]
    ds_read_b64_tr_b16 a[214:215], v9 offset:25600
    v_mfma_f32_16x16x32_bf16 v[140:143], a[192:195], a[184:187], v[140:143]
    s_waitcnt lgkmcnt(4)
    v_mfma_f32_16x16x32_bf16 v[156:159], a[200:203], a[184:187], v[156:159]
    ds_read_b64_tr_b16 a[216:217], v11 offset:4096
    v_mfma_f32_16x16x32_bf16 v[156:159], a[204:207], a[188:191], v[156:159]
    s_add_u32 s24, s12, s71
    s_addc_u32 s25, s13, 0
    s_mov_b32 s26, 262144
    s_mov_b32 s27, 0x20000
    v_mfma_f32_16x16x32_bf16 v[152:155], a[204:207], a[180:183], v[152:155]
    ds_read_b64_tr_b16 a[218:219], v11 offset:24576
    s_lshl_b32 s70, s70, 2
    v_mfma_f32_16x16x32_bf16 v[152:155], a[200:203], a[176:179], v[152:155]
    s_add_u32 s70, s70, s3
    s_lshl_b32 s70, s70, 7
    v_mfma_f32_16x16x32_bf16 v[148:151], a[200:203], a[168:171], v[148:151]
    ds_read_b64_tr_b16 a[220:221], v11 offset:5120
    s_add_u32 s68, s70, 20480
    v_mfma_f32_16x16x32_bf16 v[148:151], a[204:207], a[172:175], v[148:151]
    buffer_load_dword v0, v22, s[56:59], s97 offen offset:2048
    s_lshl_b32 s70, s9, 17
    v_mfma_f32_16x16x32_bf16 v[144:147], a[204:207], a[164:167], v[144:147]
    ds_read_b64_tr_b16 a[222:223], v11 offset:25600
    s_lshl_b32 s71, s17, 15
    v_mfma_f32_16x16x32_bf16 v[144:147], a[200:203], a[160:163], v[144:147]
    s_add_u32 s70, s70, s71
    s_waitcnt lgkmcnt(4)
    v_mfma_f32_16x16x32_bf16 v[64:67], a[208:211], a[128:131], v[64:67]
    ds_read_b64_tr_b16 a[192:193], v10 offset:4096
    s_add_u32 s70, s70, s8
    v_mfma_f32_16x16x32_bf16 v[64:67], a[212:215], a[132:135], v[64:67]
    s_sub_u32 s71, 4194304, s70
    v_mfma_f32_16x16x32_bf16 v[68:71], a[212:215], a[140:143], v[68:71]
    ds_read_b64_tr_b16 a[194:195], v10 offset:24576
    v_mfma_f32_16x16x32_bf16 v[68:71], a[208:211], a[136:139], v[68:71]
    s_add_u32 s28, s4, s70
    s_addc_u32 s29, s5, 0
    s_mov_b32 s30, s71
    s_mov_b32 s31, 0x20000
    v_mfma_f32_16x16x32_bf16 v[72:75], a[208:211], a[144:147], v[72:75]
    ds_read_b64_tr_b16 a[196:197], v10 offset:5120
    v_mfma_f32_16x16x32_bf16 v[72:75], a[212:215], a[148:151], v[72:75]
    buffer_load_dword v0, v23, s[36:39], s72 offen offset:2048
    v_mfma_f32_16x16x32_bf16 v[76:79], a[212:215], a[156:159], v[76:79]
    ds_read_b64_tr_b16 a[198:199], v10 offset:25600
    v_mfma_f32_16x16x32_bf16 v[76:79], a[208:211], a[152:155], v[76:79]
    s_waitcnt lgkmcnt(4)
    v_mfma_f32_16x16x32_bf16 v[76:79], a[216:219], a[184:187], v[76:79]
    ds_read_b64_tr_b16 a[200:201], v12 offset:4096
    v_mfma_f32_16x16x32_bf16 v[76:79], a[220:223], a[188:191], v[76:79]
    s_add_u32 s32, s98, s70
    s_addc_u32 s33, s99, 0
    s_mov_b32 s34, s71
    s_mov_b32 s35, 0x20000
    v_mfma_f32_16x16x32_bf16 v[72:75], a[220:223], a[180:183], v[72:75]
    ds_read_b64_tr_b16 a[202:203], v12 offset:24576
    s_xor_b32 s70, s17, 1
    v_mfma_f32_16x16x32_bf16 v[72:75], a[216:219], a[176:179], v[72:75]
    s_lshl_b32 s40, s70, 16
    s_lshl_b32 s71, s17, 14
    v_mfma_f32_16x16x32_bf16 v[68:71], a[216:219], a[168:171], v[68:71]
    ds_read_b64_tr_b16 a[204:205], v12 offset:5120
    s_add_u32 s40, s40, s71
    v_mfma_f32_16x16x32_bf16 v[68:71], a[220:223], a[172:175], v[68:71]
    s_lshl_b32 s60, s70, 14
    s_lshl_b32 s71, s17, 16
    v_mfma_f32_16x16x32_bf16 v[64:67], a[220:223], a[164:167], v[64:67]
    ds_read_b64_tr_b16 a[206:207], v12 offset:25600
    s_add_u32 s60, s60, s71
    v_mfma_f32_16x16x32_bf16 v[64:67], a[216:219], a[160:163], v[64:67]
    s_waitcnt vmcnt(19) lgkmcnt(4)
    s_barrier
    v_mfma_f32_16x16x32_bf16 v[80:83], a[192:195], a[128:131], v[80:83]
    ds_read_b64_tr_b16 a[208:209], v13 offset:6144
    s_xor_b32 s70, s17, 2
    v_mfma_f32_16x16x32_bf16 v[80:83], a[196:199], a[132:135], v[80:83]
    s_lshl_b32 s41, s70, 16
    s_lshl_b32 s71, s17, 14
    v_mfma_f32_16x16x32_bf16 v[84:87], a[196:199], a[140:143], v[84:87]
    ds_read_b64_tr_b16 a[210:211], v13 offset:26624
    s_add_u32 s41, s41, s71
    v_mfma_f32_16x16x32_bf16 v[84:87], a[192:195], a[136:139], v[84:87]
    s_lshl_b32 s61, s70, 14
    s_lshl_b32 s71, s17, 16
    v_mfma_f32_16x16x32_bf16 v[88:91], a[192:195], a[144:147], v[88:91]
    ds_read_b64_tr_b16 a[212:213], v13 offset:7168
    s_add_u32 s61, s61, s71
    v_mfma_f32_16x16x32_bf16 v[88:91], a[196:199], a[148:151], v[88:91]
    s_xor_b32 s70, s17, 3
    s_lshl_b32 s42, s70, 16
    v_mfma_f32_16x16x32_bf16 v[92:95], a[196:199], a[156:159], v[92:95]
    ds_read_b64_tr_b16 a[214:215], v13 offset:27648
    s_lshl_b32 s71, s17, 14
    v_mfma_f32_16x16x32_bf16 v[92:95], a[192:195], a[152:155], v[92:95]
    s_add_u32 s42, s42, s71
    s_waitcnt lgkmcnt(4)
    v_mfma_f32_16x16x32_bf16 v[92:95], a[200:203], a[184:187], v[92:95]
    ds_read_b64_tr_b16 a[216:217], v14 offset:6144
    s_lshl_b32 s62, s70, 14
    v_mfma_f32_16x16x32_bf16 v[92:95], a[204:207], a[188:191], v[92:95]
    s_lshl_b32 s71, s17, 16
    s_add_u32 s62, s62, s71
    v_mfma_f32_16x16x32_bf16 v[88:91], a[204:207], a[180:183], v[88:91]
    ds_read_b64_tr_b16 a[218:219], v14 offset:26624
    s_lshl_b32 s63, s17, 2
    v_mfma_f32_16x16x32_bf16 v[88:91], a[200:203], a[176:179], v[88:91]
    v_mfma_f32_16x16x32_bf16 v[84:87], a[200:203], a[168:171], v[84:87]
    ds_read_b64_tr_b16 a[220:221], v14 offset:7168
    v_mfma_f32_16x16x32_bf16 v[84:87], a[204:207], a[172:175], v[84:87]
    v_mfma_f32_16x16x32_bf16 v[80:83], a[204:207], a[164:167], v[80:83]
    ds_read_b64_tr_b16 a[222:223], v14 offset:27648
    v_mfma_f32_16x16x32_bf16 v[80:83], a[200:203], a[160:163], v[80:83]
    s_waitcnt vmcnt(3) lgkmcnt(4)
    v_mfma_f32_16x16x32_bf16 v[128:131], a[208:211], a[96:99], v[128:131]
    ds_read_b64_tr_b16 a[192:193], v13 offset:4096
    v_and_b32 v30, 15, v1
    v_mfma_f32_16x16x32_bf16 v[128:131], a[212:215], a[100:103], v[128:131]
    v_bfe_u32 v24, v1, 1, 2
    v_lshrrev_b32 v25, 4, v1
    v_mfma_f32_16x16x32_bf16 v[132:135], a[212:215], a[108:111], v[132:135]
    ds_read_b64_tr_b16 a[194:195], v13 offset:24576
    v_xor_b32 v24, v24, v25
    v_mfma_f32_16x16x32_bf16 v[132:135], a[208:211], a[104:107], v[132:135]
    v_lshlrev_b32 v30, 6, v30
    v_lshl_add_u32 v30, v24, 4, v30
    v_mfma_f32_16x16x32_bf16 v[136:139], a[208:211], a[112:115], v[136:139]
    ds_read_b64_tr_b16 a[196:197], v13 offset:5120
    v_add_u32 v30, s19, v30
    v_mfma_f32_16x16x32_bf16 v[136:139], a[212:215], a[116:119], v[136:139]
    s_mul_i32 s97, s3, 40960
    s_add_u32 s97, s97, 40960
    v_mfma_f32_16x16x32_bf16 v[140:143], a[212:215], a[124:127], v[140:143]
    ds_read_b64_tr_b16 a[198:199], v13 offset:25600
    s_movk_i32 s94, 2048
    v_mfma_f32_16x16x32_bf16 v[140:143], a[208:211], a[120:123], v[140:143]
    s_waitcnt lgkmcnt(4)
    v_mfma_f32_16x16x32_bf16 v[156:159], a[216:219], a[120:123], v[156:159]
    ds_read_b64_tr_b16 a[200:201], v14 offset:4096
    v_mfma_f32_16x16x32_bf16 v[156:159], a[220:223], a[124:127], v[156:159]
    s_cmp_eq_u32 s3, 3
    s_cselect_b32 s97, 90112, s97
    s_cselect_b32 s94, 40960, s94
    v_mfma_f32_16x16x32_bf16 v[152:155], a[220:223], a[116:119], v[152:155]
    ds_read_b64_tr_b16 a[202:203], v14 offset:24576
    s_lshr_b32 s96, s3, 1
    v_mfma_f32_16x16x32_bf16 v[152:155], a[216:219], a[112:115], v[152:155]
    s_lshl_b32 s96, s96, 12
    s_lshl_b32 s70, s14, 2
    v_mfma_f32_16x16x32_bf16 v[148:151], a[216:219], a[104:107], v[148:151]
    ds_read_b64_tr_b16 a[204:205], v14 offset:5120
    s_add_u32 s65, s65, s70
    v_mfma_f32_16x16x32_bf16 v[148:151], a[220:223], a[108:111], v[148:151]
    s_lshl_b32 s70, s14, 11
    s_lshl_b32 s71, s14, 7
    v_mfma_f32_16x16x32_bf16 v[144:147], a[220:223], a[100:103], v[144:147]
    ds_read_b64_tr_b16 a[206:207], v14 offset:25600
    s_add_u32 s71, s71, 16384
    v_mfma_f32_16x16x32_bf16 v[144:147], a[216:219], a[96:99], v[144:147]
    s_waitcnt lgkmcnt(4)
    v_mfma_f32_16x16x32_bf16 v[64:67], a[192:195], a[96:99], v[64:67]
    ds_read_b64_tr_b16 a[208:209], v9 offset:6656
    v_mfma_f32_16x16x32_bf16 v[64:67], a[196:199], a[100:103], v[64:67]
    v_cvt_pk_bf16_f32 v128, v128, v129
    v_cvt_pk_bf16_f32 v129, v130, v131
    v_mfma_f32_16x16x32_bf16 v[68:71], a[196:199], a[108:111], v[68:71]
    ds_read_b64_tr_b16 a[210:211], v9 offset:27136
    v_cvt_pk_bf16_f32 v130, v144, v145
    v_mfma_f32_16x16x32_bf16 v[68:71], a[192:195], a[104:107], v[68:71]
    v_cvt_pk_bf16_f32 v131, v146, v147
    v_cvt_pk_bf16_f32 v132, v132, v133
    v_mfma_f32_16x16x32_bf16 v[72:75], a[192:195], a[112:115], v[72:75]
    ds_read_b64_tr_b16 a[212:213], v9 offset:7680
    v_cvt_pk_bf16_f32 v133, v134, v135
    v_mfma_f32_16x16x32_bf16 v[72:75], a[196:199], a[116:119], v[72:75]
    ds_write_b128 v30, v[128:131] offset:0
    v_mfma_f32_16x16x32_bf16 v[76:79], a[196:199], a[124:127], v[76:79]
    ds_read_b64_tr_b16 a[214:215], v9 offset:28160
    v_cvt_pk_bf16_f32 v134, v148, v149
    v_mfma_f32_16x16x32_bf16 v[76:79], a[192:195], a[120:123], v[76:79]
    v_cvt_pk_bf16_f32 v135, v150, v151
    s_waitcnt lgkmcnt(5)
    v_mfma_f32_16x16x32_bf16 v[92:95], a[200:203], a[120:123], v[92:95]
    ds_read_b64_tr_b16 a[216:217], v11 offset:6656
    v_cvt_pk_bf16_f32 v136, v136, v137
    v_mfma_f32_16x16x32_bf16 v[92:95], a[204:207], a[124:127], v[92:95]
    ds_write_b128 v30, v[132:135] offset:1024
    v_mfma_f32_16x16x32_bf16 v[88:91], a[204:207], a[116:119], v[88:91]
    ds_read_b64_tr_b16 a[218:219], v11 offset:27136
    v_cvt_pk_bf16_f32 v137, v138, v139
    v_mfma_f32_16x16x32_bf16 v[88:91], a[200:203], a[112:115], v[88:91]
    v_cvt_pk_bf16_f32 v138, v152, v153
    v_cvt_pk_bf16_f32 v139, v154, v155
    v_mfma_f32_16x16x32_bf16 v[84:87], a[200:203], a[104:107], v[84:87]
    ds_read_b64_tr_b16 a[220:221], v11 offset:7680
    v_cvt_pk_bf16_f32 v140, v140, v141
    v_mfma_f32_16x16x32_bf16 v[84:87], a[204:207], a[108:111], v[84:87]
    ds_write_b128 v30, v[136:139] offset:2048
    v_mfma_f32_16x16x32_bf16 v[80:83], a[204:207], a[100:103], v[80:83]
    ds_read_b64_tr_b16 a[222:223], v11 offset:28160
    v_cvt_pk_bf16_f32 v141, v142, v143
    v_mfma_f32_16x16x32_bf16 v[80:83], a[200:203], a[96:99], v[80:83]
    v_cvt_pk_bf16_f32 v142, v156, v157
    s_waitcnt lgkmcnt(6)
    v_mfma_f32_16x16x32_bf16 v[160:163], a[208:211], a[128:131], v[160:163]
    ds_read_b64_tr_b16 a[192:193], v13 offset:6656
    v_cvt_pk_bf16_f32 v143, v158, v159
    v_mfma_f32_16x16x32_bf16 v[160:163], a[212:215], a[132:135], v[160:163]
    ds_write_b128 v30, v[140:143] offset:3072
    v_mfma_f32_16x16x32_bf16 v[164:167], a[212:215], a[140:143], v[164:167]
    ds_read_b64_tr_b16 a[194:195], v13 offset:27136
    v_cvt_pk_bf16_f32 v64, v64, v65
    v_mfma_f32_16x16x32_bf16 v[164:167], a[208:211], a[136:139], v[164:167]
    v_cvt_pk_bf16_f32 v65, v66, v67
    v_cvt_pk_bf16_f32 v66, v80, v81
    v_mfma_f32_16x16x32_bf16 v[168:171], a[208:211], a[144:147], v[168:171]
    ds_read_b64_tr_b16 a[196:197], v13 offset:7680
    v_cvt_pk_bf16_f32 v67, v82, v83
    v_mfma_f32_16x16x32_bf16 v[168:171], a[212:215], a[148:151], v[168:171]
    v_cvt_pk_bf16_f32 v68, v68, v69
    v_cvt_pk_bf16_f32 v69, v70, v71
    v_mfma_f32_16x16x32_bf16 v[172:175], a[212:215], a[156:159], v[172:175]
    ds_read_b64_tr_b16 a[198:199], v13 offset:28160
    v_cvt_pk_bf16_f32 v70, v84, v85
    v_mfma_f32_16x16x32_bf16 v[172:175], a[208:211], a[152:155], v[172:175]
    v_cvt_pk_bf16_f32 v71, v86, v87
    s_waitcnt lgkmcnt(5)
    v_mfma_f32_16x16x32_bf16 v[172:175], a[216:219], a[184:187], v[172:175]
    ds_read_b64_tr_b16 a[200:201], v10 offset:6656
    v_cvt_pk_bf16_f32 v72, v72, v73
    v_mfma_f32_16x16x32_bf16 v[172:175], a[220:223], a[188:191], v[172:175]
    v_cvt_pk_bf16_f32 v73, v74, v75
    v_cvt_pk_bf16_f32 v74, v88, v89
    v_mfma_f32_16x16x32_bf16 v[168:171], a[220:223], a[180:183], v[168:171]
    ds_read_b64_tr_b16 a[202:203], v10 offset:27136
    v_cvt_pk_bf16_f32 v75, v90, v91
    v_mfma_f32_16x16x32_bf16 v[168:171], a[216:219], a[176:179], v[168:171]
    v_cvt_pk_bf16_f32 v76, v76, v77
    v_cvt_pk_bf16_f32 v77, v78, v79
    v_mfma_f32_16x16x32_bf16 v[164:167], a[216:219], a[168:171], v[164:167]
    ds_read_b64_tr_b16 a[204:205], v10 offset:7680
    v_cvt_pk_bf16_f32 v78, v92, v93
    v_mfma_f32_16x16x32_bf16 v[164:167], a[220:223], a[172:175], v[164:167]
    v_cvt_pk_bf16_f32 v79, v94, v95
    s_waitcnt lgkmcnt(6)
    v_mfma_f32_16x16x32_bf16 v[128:131], a[224:227], v[64:67], 0
    v_mfma_f32_16x16x32_bf16 v[132:135], a[228:231], v[64:67], 0
    v_mfma_f32_16x16x32_bf16 v[144:147], a[224:227], v[68:71], 0
    v_mfma_f32_16x16x32_bf16 v[148:151], a[228:231], v[68:71], 0
    v_mfma_f32_16x16x32_bf16 v[160:163], a[220:223], a[164:167], v[160:163]
    ds_read_b64_tr_b16 a[206:207], v10 offset:28160
    v_mfma_f32_16x16x32_bf16 v[160:163], a[216:219], a[160:163], v[160:163]
    s_waitcnt lgkmcnt(4)
    v_mfma_f32_16x16x32_bf16 v[160:163], a[192:195], a[96:99], v[160:163]
    ds_read_b64_tr_b16 a[208:209], v12 offset:6656
    v_max3_f32 v22, v128, v129, v130
    v_mfma_f32_16x16x32_bf16 v[160:163], a[196:199], a[100:103], v[160:163]
    v_max3_f32 v23, -v128, -v129, -v130
    v_max3_f32 v22, v22, v131, v132
    v_mfma_f32_16x16x32_bf16 v[164:167], a[196:199], a[108:111], v[164:167]
    ds_read_b64_tr_b16 a[210:211], v12 offset:27136
    v_max3_f32 v23, v23, -v131, -v132
    v_mfma_f32_16x16x32_bf16 v[164:167], a[192:195], a[104:107], v[164:167]
    v_max3_f32 v22, v22, v133, v134
    v_max3_f32 v23, v23, -v133, -v134
    v_mfma_f32_16x16x32_bf16 v[168:171], a[192:195], a[112:115], v[168:171]
    ds_read_b64_tr_b16 a[212:213], v12 offset:7680
    v_max_f32 v22, v22, v135
    v_mfma_f32_16x16x32_bf16 v[168:171], a[196:199], a[116:119], v[168:171]
    v_max_f32_e64 v23, v23, -v135
    v_max3_f32 v24, v144, v145, v146
    v_mfma_f32_16x16x32_bf16 v[172:175], a[196:199], a[124:127], v[172:175]
    ds_read_b64_tr_b16 a[214:215], v12 offset:28160
    v_max3_f32 v25, -v144, -v145, -v146
    v_mfma_f32_16x16x32_bf16 v[172:175], a[192:195], a[120:123], v[172:175]
    v_max3_f32 v24, v24, v147, v148
    s_waitcnt lgkmcnt(4)
    v_mfma_f32_16x16x32_bf16 v[188:191], a[200:203], a[152:155], v[188:191]
    ds_read_b64_tr_b16 a[216:217], v14 offset:6656
    v_max3_f32 v25, v25, -v147, -v148
    v_mfma_f32_16x16x32_bf16 v[188:191], a[204:207], a[156:159], v[188:191]
    v_max3_f32 v24, v24, v149, v150
    v_max3_f32 v25, v25, -v149, -v150
    v_mfma_f32_16x16x32_bf16 v[184:187], a[204:207], a[148:151], v[184:187]
    ds_read_b64_tr_b16 a[218:219], v14 offset:27136
    v_max_f32 v24, v24, v151
    v_mfma_f32_16x16x32_bf16 v[184:187], a[200:203], a[144:147], v[184:187]
    v_max_f32_e64 v25, v25, -v151
    v_permlane32_swap_b32 v22, v23
    v_mfma_f32_16x16x32_bf16 v[180:183], a[200:203], a[136:139], v[180:183]
    ds_read_b64_tr_b16 a[220:221], v14 offset:7680
    v_permlane32_swap_b32 v24, v25
    v_mfma_f32_16x16x32_bf16 v[180:183], a[204:207], a[140:143], v[180:183]
    v_max_f32 v22, v22, v23
    v_max_f32 v24, v24, v25
    v_mfma_f32_16x16x32_bf16 v[176:179], a[204:207], a[132:135], v[176:179]
    ds_read_b64_tr_b16 a[222:223], v14 offset:28160
    v_permlane16_swap_b32 v22, v24
    v_mfma_f32_16x16x32_bf16 v[176:179], a[200:203], a[128:131], v[176:179]
    v_max_f32 v22, v22, v24
    s_waitcnt lgkmcnt(4)
    v_mfma_f32_16x16x32_bf16 v[176:179], a[208:211], a[160:163], v[176:179]
    ds_read_b64_tr_b16 a[192:193], v9 offset:4608
    v_mul_f32 v22, s76, v22
    v_mfma_f32_16x16x32_bf16 v[176:179], a[212:215], a[164:167], v[176:179]
    v_mov_b32 v24, v22
    v_mfma_f32_16x16x32_bf16 v[180:183], a[212:215], a[172:175], v[180:183]
    ds_read_b64_tr_b16 a[194:195], v9 offset:25088
    v_permlane16_swap_b32 v22, v24
    v_mfma_f32_16x16x32_bf16 v[180:183], a[208:211], a[168:171], v[180:183]
    v_mov_b32 v23, v22
    v_mov_b32 v25, v24
    v_mfma_f32_16x16x32_bf16 v[184:187], a[208:211], a[176:179], v[184:187]
    ds_read_b64_tr_b16 a[196:197], v9 offset:5632
    v_permlane32_swap_b32 v22, v23
    v_mfma_f32_16x16x32_bf16 v[184:187], a[212:215], a[180:183], v[184:187]
    v_permlane32_swap_b32 v24, v25
    v_fma_f32 v136, v128, s77, v22
    v_mfma_f32_16x16x32_bf16 v[188:191], a[212:215], a[188:191], v[188:191]
    ds_read_b64_tr_b16 a[198:199], v9 offset:26112
    v_fma_f32 v137, v129, s77, v22
    v_mfma_f32_16x16x32_bf16 v[188:191], a[208:211], a[184:187], v[188:191]
    v_fma_f32 v138, v130, s77, v22
    s_waitcnt lgkmcnt(4)
    v_mfma_f32_16x16x32_bf16 v[188:191], a[216:219], a[120:123], v[188:191]
    ds_read_b64_tr_b16 a[200:201], v11 offset:4608
    v_fma_f32 v139, v131, s77, v22
    v_mfma_f32_16x16x32_bf16 v[188:191], a[220:223], a[124:127], v[188:191]
    v_exp_f32 v136, v136
    v_mfma_f32_16x16x32_bf16 v[184:187], a[220:223], a[116:119], v[184:187]
    ds_read_b64_tr_b16 a[202:203], v11 offset:25088
    v_fma_f32 v140, v132, s77, v22
    v_mfma_f32_16x16x32_bf16 v[184:187], a[216:219], a[112:115], v[184:187]
    v_exp_f32 v137, v137
    v_mfma_f32_16x16x32_bf16 v[180:183], a[216:219], a[104:107], v[180:183]
    ds_read_b64_tr_b16 a[204:205], v11 offset:5632
    v_fma_f32 v141, v133, s77, v22
    v_mfma_f32_16x16x32_bf16 v[180:183], a[220:223], a[108:111], v[180:183]
    v_exp_f32 v138, v138
    v_mfma_f32_16x16x32_bf16 v[176:179], a[220:223], a[100:103], v[176:179]
    ds_read_b64_tr_b16 a[206:207], v11 offset:26112
    v_fma_f32 v142, v134, s77, v22
    v_mfma_f32_16x16x32_bf16 v[176:179], a[216:219], a[96:99], v[176:179]
    v_fma_f32 v143, v135, s77, v22
    s_waitcnt lgkmcnt(4)
    v_mfma_f32_16x16x32_bf16 v[96:99], a[192:195], a[128:131], v[96:99]
    ds_read_b64_tr_b16 a[208:209], v13 offset:4608
    v_fma_f32 v128, v128, s76, v23
    v_mfma_f32_16x16x32_bf16 v[96:99], a[196:199], a[132:135], v[96:99]
    v_exp_f32 v139, v139
    v_mfma_f32_16x16x32_bf16 v[100:103], a[196:199], a[140:143], v[100:103]
    ds_read_b64_tr_b16 a[210:211], v13 offset:25088
    v_fma_f32 v129, v129, s76, v23
    v_mfma_f32_16x16x32_bf16 v[100:103], a[192:195], a[136:139], v[100:103]
    v_exp_f32 v140, v140
    v_mfma_f32_16x16x32_bf16 v[104:107], a[192:195], a[144:147], v[104:107]
    ds_read_b64_tr_b16 a[212:213], v13 offset:5632
    v_fma_f32 v130, v130, s76, v23
    v_mfma_f32_16x16x32_bf16 v[104:107], a[196:199], a[148:151], v[104:107]
    v_exp_f32 v141, v141
    v_mfma_f32_16x16x32_bf16 v[108:111], a[196:199], a[156:159], v[108:111]
    ds_read_b64_tr_b16 a[214:215], v13 offset:26112
    v_fma_f32 v131, v131, s76, v23
    v_mfma_f32_16x16x32_bf16 v[108:111], a[192:195], a[152:155], v[108:111]
    v_fma_f32 v132, v132, s76, v23
    s_waitcnt lgkmcnt(4)
    v_mfma_f32_16x16x32_bf16 v[108:111], a[200:203], a[184:187], v[108:111]
    ds_read_b64_tr_b16 a[216:217], v10 offset:4608
    v_fma_f32 v133, v133, s76, v23
    v_mfma_f32_16x16x32_bf16 v[108:111], a[204:207], a[188:191], v[108:111]
    v_exp_f32 v142, v142
    v_mfma_f32_16x16x32_bf16 v[104:107], a[204:207], a[180:183], v[104:107]
    ds_read_b64_tr_b16 a[218:219], v10 offset:25088
    v_fma_f32 v134, v134, s76, v23
    v_mfma_f32_16x16x32_bf16 v[104:107], a[200:203], a[176:179], v[104:107]
    v_exp_f32 v143, v143
    v_mfma_f32_16x16x32_bf16 v[100:103], a[200:203], a[168:171], v[100:103]
    ds_read_b64_tr_b16 a[220:221], v10 offset:5632
    v_fma_f32 v135, v135, s76, v23
    v_mfma_f32_16x16x32_bf16 v[100:103], a[204:207], a[172:175], v[100:103]
    v_exp_f32 v128, v128
    v_mfma_f32_16x16x32_bf16 v[96:99], a[204:207], a[164:167], v[96:99]
    ds_read_b64_tr_b16 a[222:223], v10 offset:26112
    v_exp_f32 v129, v129
    v_mfma_f32_16x16x32_bf16 v[96:99], a[200:203], a[160:163], v[96:99]
    v_exp_f32 v130, v130
    s_waitcnt lgkmcnt(4)
    v_mfma_f32_16x16x32_bf16 v[96:99], a[208:211], a[96:99], v[96:99]
    ds_read_b64_tr_b16 a[192:193], v12 offset:4608
    v_exp_f32 v131, v131
    v_mfma_f32_16x16x32_bf16 v[96:99], a[212:215], a[100:103], v[96:99]
    v_exp_f32 v132, v132
    v_mfma_f32_16x16x32_bf16 v[100:103], a[212:215], a[108:111], v[100:103]
    ds_read_b64_tr_b16 a[194:195], v12 offset:25088
    v_cvt_pk_bf16_f32 v160, v160, v161
    v_mfma_f32_16x16x32_bf16 v[100:103], a[208:211], a[104:107], v[100:103]
    v_exp_f32 v133, v133
    v_mfma_f32_16x16x32_bf16 v[104:107], a[208:211], a[112:115], v[104:107]
    ds_read_b64_tr_b16 a[196:197], v12 offset:5632
    v_cvt_pk_bf16_f32 v161, v162, v163
    v_mfma_f32_16x16x32_bf16 v[104:107], a[212:215], a[116:119], v[104:107]
    v_exp_f32 v134, v134
    v_mfma_f32_16x16x32_bf16 v[108:111], a[212:215], a[124:127], v[108:111]
    ds_read_b64_tr_b16 a[198:199], v12 offset:26112
    v_cvt_pk_bf16_f32 v162, v176, v177
    v_mfma_f32_16x16x32_bf16 v[108:111], a[208:211], a[120:123], v[108:111]
    v_cvt_pk_bf16_f32 v163, v178, v179
    s_waitcnt lgkmcnt(4)
    v_mfma_f32_16x16x32_bf16 v[124:127], a[216:219], a[152:155], v[124:127]
    ds_read_b64_tr_b16 a[200:201], v14 offset:4608
    v_cvt_pk_bf16_f32 v164, v164, v165
    v_mfma_f32_16x16x32_bf16 v[124:127], a[220:223], a[156:159], v[124:127]
    ds_write_b128 v30, v[160:163] offset:4096
    v_mfma_f32_16x16x32_bf16 v[120:123], a[220:223], a[148:151], v[120:123]
    ds_read_b64_tr_b16 a[202:203], v14 offset:25088
    v_cvt_pk_bf16_f32 v165, v166, v167
    v_mfma_f32_16x16x32_bf16 v[120:123], a[216:219], a[144:147], v[120:123]
    v_exp_f32 v135, v135
    v_mfma_f32_16x16x32_bf16 v[116:119], a[216:219], a[136:139], v[116:119]
    ds_read_b64_tr_b16 a[204:205], v14 offset:5632
    v_cvt_pk_bf16_f32 v166, v180, v181
    v_mfma_f32_16x16x32_bf16 v[116:119], a[220:223], a[140:143], v[116:119]
    v_cvt_pk_bf16_f32 v167, v182, v183
    v_cvt_pk_bf16_f32 v168, v168, v169
    v_mfma_f32_16x16x32_bf16 v[112:115], a[220:223], a[132:135], v[112:115]
    ds_read_b64_tr_b16 a[206:207], v14 offset:26112
    v_cvt_pk_bf16_f32 v169, v170, v171
    v_mfma_f32_16x16x32_bf16 v[112:115], a[216:219], a[128:131], v[112:115]
    v_cvt_pk_bf16_f32 v170, v184, v185
    s_waitcnt lgkmcnt(5)
    v_mfma_f32_16x16x32_bf16 v[112:115], a[192:195], a[160:163], v[112:115]
    ds_read_b64_tr_b16 a[208:209], v11 offset:0
    v_cvt_pk_bf16_f32 v171, v186, v187
    v_mfma_f32_16x16x32_bf16 v[112:115], a[196:199], a[164:167], v[112:115]
    ds_write_b128 v30, v[164:167] offset:5120
    v_mfma_f32_16x16x32_bf16 v[116:119], a[196:199], a[172:175], v[116:119]
    ds_read_b64_tr_b16 a[210:211], v11 offset:20480
    v_cvt_pk_bf16_f32 v172, v172, v173
    v_mfma_f32_16x16x32_bf16 v[116:119], a[192:195], a[168:171], v[116:119]
    ds_write_b128 v30, v[168:171] offset:6144
    v_mfma_f32_16x16x32_bf16 v[120:123], a[192:195], a[176:179], v[120:123]
    ds_read_b64_tr_b16 a[212:213], v11 offset:1024
    v_cvt_pk_bf16_f32 v173, v174, v175
    v_mfma_f32_16x16x32_bf16 v[120:123], a[196:199], a[180:183], v[120:123]
    v_cvt_pk_bf16_f32 v174, v188, v189
    v_cvt_pk_bf16_f32 v175, v190, v191
    v_mfma_f32_16x16x32_bf16 v[124:127], a[196:199], a[188:191], v[124:127]
    ds_read_b64_tr_b16 a[214:215], v11 offset:21504
    v_fma_f32 v152, v144, s77, v24
    v_mfma_f32_16x16x32_bf16 v[124:127], a[192:195], a[184:187], v[124:127]
    v_fma_f32 v153, v145, s77, v24
    s_waitcnt lgkmcnt(6)
    v_mfma_f32_16x16x32_bf16 v[124:127], a[200:203], a[120:123], v[124:127]
    ds_read_b64_tr_b16 a[216:217], v12 offset:0
    v_fma_f32 v154, v146, s77, v24
    v_mfma_f32_16x16x32_bf16 v[124:127], a[204:207], a[124:127], v[124:127]
    ds_write_b128 v30, v[172:175] offset:7168
    v_mfma_f32_16x16x32_bf16 v[120:123], a[204:207], a[116:119], v[120:123]
    ds_read_b64_tr_b16 a[218:219], v12 offset:20480
    v_fma_f32 v155, v147, s77, v24
    v_mfma_f32_16x16x32_bf16 v[120:123], a[200:203], a[112:115], v[120:123]
    v_exp_f32 v152, v152
    v_mfma_f32_16x16x32_bf16 v[116:119], a[200:203], a[104:107], v[116:119]
    ds_read_b64_tr_b16 a[220:221], v12 offset:1024
    v_fma_f32 v156, v148, s77, v24
    v_mfma_f32_16x16x32_bf16 v[116:119], a[204:207], a[108:111], v[116:119]
    v_exp_f32 v153, v153
    v_mfma_f32_16x16x32_bf16 v[112:115], a[204:207], a[100:103], v[112:115]
    ds_read_b64_tr_b16 a[222:223], v12 offset:21504
    v_fma_f32 v157, v149, s77, v24
    v_mfma_f32_16x16x32_bf16 v[112:115], a[200:203], a[96:99], v[112:115]
    s_waitcnt vmcnt(13) lgkmcnt(3)
    s_barrier
    v_mfma_f32_16x16x32_bf16 v[32:35], a[208:211], a[160:163], v[32:35]
    ds_read_b64_tr_b16 a[192:193], v13 offset:0
    s_add_u32 m0, s19, 45056
    v_mfma_f32_16x16x32_bf16 v[32:35], a[212:215], a[164:167], v[32:35]
    s_lshl_b32 s11, s81, 4
    v_fma_f32 v158, v150, s77, v24
    v_mfma_f32_16x16x32_bf16 v[36:39], a[212:215], a[172:175], v[36:39]
    ds_read_b64_tr_b16 a[194:195], v13 offset:20480
    v_fma_f32 v159, v151, s77, v24
    v_mfma_f32_16x16x32_bf16 v[36:39], a[208:211], a[168:171], v[36:39]
    buffer_load_dwordx4 v17, s[56:59], s11 offen offset:0 lds
    v_fma_f32 v144, v144, s76, v25
    v_mfma_f32_16x16x32_bf16 v[40:43], a[208:211], a[176:179], v[40:43]
    ds_read_b64_tr_b16 a[196:197], v13 offset:1024
    v_fma_f32 v145, v145, s76, v25
    v_mfma_f32_16x16x32_bf16 v[40:43], a[212:215], a[180:183], v[40:43]
    v_exp_f32 v154, v154
    v_mfma_f32_16x16x32_bf16 v[44:47], a[212:215], a[188:191], v[44:47]
    ds_read_b64_tr_b16 a[198:199], v13 offset:21504
    v_fma_f32 v146, v146, s76, v25
    v_mfma_f32_16x16x32_bf16 v[44:47], a[208:211], a[184:187], v[44:47]
    v_fma_f32 v147, v147, s76, v25
    s_waitcnt lgkmcnt(4)
    v_mfma_f32_16x16x32_bf16 v[60:63], a[216:219], a[184:187], v[60:63]
    ds_read_b64_tr_b16 a[200:201], v14 offset:0
    v_fma_f32 v148, v148, s76, v25
    v_mfma_f32_16x16x32_bf16 v[60:63], a[220:223], a[188:191], v[60:63]
    v_exp_f32 v155, v155
    v_mfma_f32_16x16x32_bf16 v[56:59], a[220:223], a[180:183], v[56:59]
    ds_read_b64_tr_b16 a[202:203], v14 offset:20480
    v_fma_f32 v149, v149, s76, v25
    v_mfma_f32_16x16x32_bf16 v[56:59], a[216:219], a[176:179], v[56:59]
    buffer_load_dwordx4 v18, s[56:59], s11 offen offset:1024 lds
    v_fma_f32 v150, v150, s76, v25
    v_mfma_f32_16x16x32_bf16 v[52:55], a[216:219], a[168:171], v[52:55]
    ds_read_b64_tr_b16 a[204:205], v14 offset:1024
    v_fma_f32 v151, v151, s76, v25
    v_mfma_f32_16x16x32_bf16 v[52:55], a[220:223], a[172:175], v[52:55]
    v_exp_f32 v156, v156
    v_mfma_f32_16x16x32_bf16 v[48:51], a[220:223], a[164:167], v[48:51]
    ds_read_b64_tr_b16 a[206:207], v14 offset:21504
    v_add_f32 v64, v136, v138
    v_mfma_f32_16x16x32_bf16 v[48:51], a[216:219], a[160:163], v[48:51]
    v_add_f32 v65, v137, v139
    s_waitcnt lgkmcnt(4)
    v_mfma_f32_16x16x32_bf16 v[32:35], a[192:195], a[96:99], v[32:35]
    ds_read_b64_tr_b16 a[208:209], v9 offset:2048
    v_add_f32 v66, v128, v130
    v_mfma_f32_16x16x32_bf16 v[32:35], a[196:199], a[100:103], v[32:35]
    v_exp_f32 v157, v157
    v_mfma_f32_16x16x32_bf16 v[36:39], a[196:199], a[108:111], v[36:39]
    ds_read_b64_tr_b16 a[210:211], v9 offset:22528
    v_add_f32 v67, v129, v131
    v_mfma_f32_16x16x32_bf16 v[36:39], a[192:195], a[104:107], v[36:39]
    buffer_load_dwordx4 v19, s[56:59], s11 offen offset:2048 lds
    v_add_f32 v64, v64, v140
    v_mfma_f32_16x16x32_bf16 v[40:43], a[192:195], a[112:115], v[40:43]
    ds_read_b64_tr_b16 a[212:213], v9 offset:3072
    v_add_f32 v65, v65, v141
    v_mfma_f32_16x16x32_bf16 v[40:43], a[196:199], a[116:119], v[40:43]
    v_exp_f32 v158, v158
    v_mfma_f32_16x16x32_bf16 v[44:47], a[196:199], a[124:127], v[44:47]
    ds_read_b64_tr_b16 a[214:215], v9 offset:23552
    v_add_f32 v66, v66, v132
    v_mfma_f32_16x16x32_bf16 v[44:47], a[192:195], a[120:123], v[44:47]
    v_add_f32 v67, v67, v133
    s_waitcnt lgkmcnt(4)
    v_mfma_f32_16x16x32_bf16 v[60:63], a[200:203], a[120:123], v[60:63]
    ds_read_b64_tr_b16 a[216:217], v11 offset:2048
    v_add_f32 v64, v64, v142
    v_mfma_f32_16x16x32_bf16 v[60:63], a[204:207], a[124:127], v[60:63]
    v_exp_f32 v159, v159
    v_mfma_f32_16x16x32_bf16 v[56:59], a[204:207], a[116:119], v[56:59]
    ds_read_b64_tr_b16 a[218:219], v11 offset:22528
    v_add_f32 v65, v65, v143
    v_mfma_f32_16x16x32_bf16 v[56:59], a[200:203], a[112:115], v[56:59]
    buffer_load_dwordx4 v20, s[56:59], s11 offen offset:3072 lds
    v_add_f32 v66, v66, v134
    v_mfma_f32_16x16x32_bf16 v[52:55], a[200:203], a[104:107], v[52:55]
    ds_read_b64_tr_b16 a[220:221], v11 offset:3072
    v_add_f32 v67, v67, v135
    v_mfma_f32_16x16x32_bf16 v[52:55], a[204:207], a[108:111], v[52:55]
    v_exp_f32 v144, v144
    v_mfma_f32_16x16x32_bf16 v[48:51], a[204:207], a[100:103], v[48:51]
    ds_read_b64_tr_b16 a[222:223], v11 offset:23552
    v_add_f32 v22, v64, v65
    v_mfma_f32_16x16x32_bf16 v[48:51], a[200:203], a[96:99], v[48:51]
    v_add_f32 v23, v66, v67
    s_waitcnt lgkmcnt(4)
    v_mfma_f32_16x16x32_bf16 a[32:35], a[208:211], a[128:131], a[32:35]
    ds_read_b64_tr_b16 a[192:193], v13 offset:2048
    v_add_f32 v68, v152, v154
    v_mfma_f32_16x16x32_bf16 a[32:35], a[212:215], a[132:135], a[32:35]
    v_exp_f32 v145, v145
    v_mfma_f32_16x16x32_bf16 a[36:39], a[212:215], a[140:143], a[36:39]
    ds_read_b64_tr_b16 a[194:195], v13 offset:22528
    s_add_u32 m0, s19, 86016
    v_mfma_f32_16x16x32_bf16 a[36:39], a[208:211], a[136:139], a[36:39]
    s_lshl_b32 s11, s83, 4
    v_add_f32 v69, v153, v155
    v_mfma_f32_16x16x32_bf16 a[40:43], a[208:211], a[144:147], a[40:43]
    ds_read_b64_tr_b16 a[196:197], v13 offset:3072
    v_add_f32 v68, v68, v156
    v_mfma_f32_16x16x32_bf16 a[40:43], a[212:215], a[148:151], a[40:43]
    buffer_load_dwordx4 v17, s[56:59], s11 offen offset:0 lds
    v_add_f32 v69, v69, v157
    v_mfma_f32_16x16x32_bf16 a[44:47], a[212:215], a[156:159], a[44:47]
    ds_read_b64_tr_b16 a[198:199], v13 offset:23552
    v_add_f32 v68, v68, v158
    v_mfma_f32_16x16x32_bf16 a[44:47], a[208:211], a[152:155], a[44:47]
    v_add_f32 v69, v69, v159
    s_waitcnt lgkmcnt(4)
    v_mfma_f32_16x16x32_bf16 a[44:47], a[216:219], a[184:187], a[44:47]
    ds_read_b64_tr_b16 a[200:201], v10 offset:2048
    v_add_f32 v24, v68, v69
    v_mfma_f32_16x16x32_bf16 a[44:47], a[220:223], a[188:191], a[44:47]
    v_exp_f32 v146, v146
    v_mfma_f32_16x16x32_bf16 a[40:43], a[220:223], a[180:183], a[40:43]
    ds_read_b64_tr_b16 a[202:203], v10 offset:22528
    v_permlane32_swap_b32 v22, v23
    v_mfma_f32_16x16x32_bf16 a[40:43], a[216:219], a[176:179], a[40:43]
    v_exp_f32 v147, v147
    v_mfma_f32_16x16x32_bf16 a[36:39], a[216:219], a[168:171], a[36:39]
    ds_read_b64_tr_b16 a[204:205], v10 offset:3072
    v_add_f32 v70, v144, v146
    v_mfma_f32_16x16x32_bf16 a[36:39], a[220:223], a[172:175], a[36:39]
    buffer_load_dwordx4 v18, s[56:59], s11 offen offset:1024 lds
    v_add_f32 v71, v145, v147
    v_mfma_f32_16x16x32_bf16 a[32:35], a[220:223], a[164:167], a[32:35]
    ds_read_b64_tr_b16 a[206:207], v10 offset:23552
    v_add_f32 v22, v22, v23
    v_mfma_f32_16x16x32_bf16 a[32:35], a[216:219], a[160:163], a[32:35]
    v_exp_f32 v148, v148
    s_waitcnt lgkmcnt(4)
    v_mfma_f32_16x16x32_bf16 a[32:35], a[192:195], a[96:99], a[32:35]
    ds_read_b64_tr_b16 a[208:209], v12 offset:2048
    v_exp_f32 v149, v149
    v_mfma_f32_16x16x32_bf16 a[32:35], a[196:199], a[100:103], a[32:35]
    v_exp_f32 v150, v150
    v_mfma_f32_16x16x32_bf16 a[36:39], a[196:199], a[108:111], a[36:39]
    ds_read_b64_tr_b16 a[210:211], v12 offset:22528
    v_add_f32 v70, v70, v148
    v_mfma_f32_16x16x32_bf16 a[36:39], a[192:195], a[104:107], a[36:39]
    v_exp_f32 v151, v151
    v_mfma_f32_16x16x32_bf16 a[40:43], a[192:195], a[112:115], a[40:43]
    ds_read_b64_tr_b16 a[212:213], v12 offset:3072
    v_add_f32 v71, v71, v149
    v_mfma_f32_16x16x32_bf16 a[40:43], a[196:199], a[116:119], a[40:43]
    buffer_load_dwordx4 v19, s[56:59], s11 offen offset:2048 lds
    v_add_f32 v70, v70, v150
    v_mfma_f32_16x16x32_bf16 a[44:47], a[196:199], a[124:127], a[44:47]
    ds_read_b64_tr_b16 a[214:215], v12 offset:23552
    v_add_f32 v71, v71, v151
    v_mfma_f32_16x16x32_bf16 a[44:47], a[192:195], a[120:123], a[44:47]
    v_add_f32 v25, v70, v71
    s_waitcnt lgkmcnt(4)
    v_mfma_f32_16x16x32_bf16 a[60:63], a[200:203], a[152:155], a[60:63]
    ds_read_b64_tr_b16 a[216:217], v14 offset:2048
    v_permlane32_swap_b32 v24, v25
    v_mfma_f32_16x16x32_bf16 a[60:63], a[204:207], a[156:159], a[60:63]
    v_add_f32 v24, v24, v25
    v_mfma_f32_16x16x32_bf16 a[56:59], a[204:207], a[148:151], a[56:59]
    ds_read_b64_tr_b16 a[218:219], v14 offset:22528
    v_permlane16_swap_b32 v22, v24
    v_mfma_f32_16x16x32_bf16 a[56:59], a[200:203], a[144:147], a[56:59]
    v_add_f32 v22, v22, v24
    v_mfma_f32_16x16x32_bf16 a[52:55], a[200:203], a[136:139], a[52:55]
    ds_read_b64_tr_b16 a[220:221], v14 offset:3072
    v_rcp_f32 v22, v22
    v_mfma_f32_16x16x32_bf16 a[52:55], a[204:207], a[140:143], a[52:55]
    buffer_load_dwordx4 v20, s[56:59], s11 offen offset:3072 lds
    v_mov_b32 v24, v22
    v_mfma_f32_16x16x32_bf16 a[48:51], a[204:207], a[132:135], a[48:51]
    ds_read_b64_tr_b16 a[222:223], v14 offset:23552
    v_permlane16_swap_b32 v22, v24
    v_mfma_f32_16x16x32_bf16 a[48:51], a[200:203], a[128:131], a[48:51]
    v_mov_b32 v23, v22
    s_waitcnt lgkmcnt(4)
    v_mfma_f32_16x16x32_bf16 a[48:51], a[208:211], a[160:163], a[48:51]
    ds_read_b64_tr_b16 a[192:193], v9 offset:512
    v_mov_b32 v25, v24
    v_mfma_f32_16x16x32_bf16 a[48:51], a[212:215], a[164:167], a[48:51]
    v_permlane32_swap_b32 v22, v23
    v_permlane32_swap_b32 v24, v25
    v_mfma_f32_16x16x32_bf16 a[52:55], a[212:215], a[172:175], a[52:55]
    ds_read_b64_tr_b16 a[194:195], v9 offset:20992
    v_mul_f32 v136, v136, v22
    v_mfma_f32_16x16x32_bf16 a[52:55], a[208:211], a[168:171], a[52:55]
    v_mul_f32 v137, v137, v22
    v_mul_f32 v138, v138, v22
    v_mfma_f32_16x16x32_bf16 a[56:59], a[208:211], a[176:179], a[56:59]
    ds_read_b64_tr_b16 a[196:197], v9 offset:1536
    s_add_u32 m0, s19, 126976
    v_mfma_f32_16x16x32_bf16 a[56:59], a[212:215], a[180:183], a[56:59]
    s_lshl_b32 s11, s85, 4
    v_mul_f32 v139, v139, v22
    v_mfma_f32_16x16x32_bf16 a[60:63], a[212:215], a[188:191], a[60:63]
    ds_read_b64_tr_b16 a[198:199], v9 offset:22016
    v_mul_f32 v140, v140, v22
    v_mfma_f32_16x16x32_bf16 a[60:63], a[208:211], a[184:187], a[60:63]
    v_mul_f32 v141, v141, v22
    s_waitcnt lgkmcnt(4)
    v_mfma_f32_16x16x32_bf16 a[60:63], a[216:219], a[120:123], a[60:63]
    ds_read_b64_tr_b16 a[200:201], v11 offset:512
    v_mul_f32 v142, v142, v22
    v_mfma_f32_16x16x32_bf16 a[60:63], a[220:223], a[124:127], a[60:63]
    buffer_load_dwordx4 v17, s[56:59], s11 offen offset:0 lds
    v_mul_f32 v143, v143, v22
    v_mfma_f32_16x16x32_bf16 a[56:59], a[220:223], a[116:119], a[56:59]
    ds_read_b64_tr_b16 a[202:203], v11 offset:20992
    v_mul_f32 v128, v128, v23
    v_mfma_f32_16x16x32_bf16 a[56:59], a[216:219], a[112:115], a[56:59]
    v_mul_f32 v129, v129, v23
    v_mul_f32 v130, v130, v23
    v_mfma_f32_16x16x32_bf16 a[52:55], a[216:219], a[104:107], a[52:55]
    ds_read_b64_tr_b16 a[204:205], v11 offset:1536
    v_mul_f32 v131, v131, v23
    v_mfma_f32_16x16x32_bf16 a[52:55], a[220:223], a[108:111], a[52:55]
    v_mul_f32 v132, v132, v23
    v_mul_f32 v133, v133, v23
    v_mfma_f32_16x16x32_bf16 a[48:51], a[220:223], a[100:103], a[48:51]
    ds_read_b64_tr_b16 a[206:207], v11 offset:22016
    v_mul_f32 v134, v134, v23
    v_mfma_f32_16x16x32_bf16 a[48:51], a[216:219], a[96:99], a[48:51]
    v_mul_f32 v135, v135, v23
    s_waitcnt lgkmcnt(4)
    v_mfma_f32_16x16x32_bf16 a[0:3], a[192:195], a[128:131], a[0:3]
    ds_read_b64_tr_b16 a[208:209], v13 offset:512
    v_mul_f32 v152, v152, v24
    v_mfma_f32_16x16x32_bf16 a[0:3], a[196:199], a[132:135], a[0:3]
    buffer_load_dwordx4 v18, s[56:59], s11 offen offset:1024 lds
    v_mul_f32 v153, v153, v24
    v_mfma_f32_16x16x32_bf16 a[4:7], a[196:199], a[140:143], a[4:7]
    ds_read_b64_tr_b16 a[210:211], v13 offset:20992
    v_mul_f32 v154, v154, v24
    v_mfma_f32_16x16x32_bf16 a[4:7], a[192:195], a[136:139], a[4:7]
    v_mul_f32 v155, v155, v24
    v_mul_f32 v156, v156, v24
    v_mfma_f32_16x16x32_bf16 a[8:11], a[192:195], a[144:147], a[8:11]
    ds_read_b64_tr_b16 a[212:213], v13 offset:1536
    v_mul_f32 v157, v157, v24
    v_mfma_f32_16x16x32_bf16 a[8:11], a[196:199], a[148:151], a[8:11]
    v_mul_f32 v158, v158, v24
    v_mul_f32 v159, v159, v24
    v_mfma_f32_16x16x32_bf16 a[12:15], a[196:199], a[156:159], a[12:15]
    ds_read_b64_tr_b16 a[214:215], v13 offset:22016
    v_mul_f32 v144, v144, v25
    v_mfma_f32_16x16x32_bf16 a[12:15], a[192:195], a[152:155], a[12:15]
    v_mul_f32 v145, v145, v25
    s_waitcnt lgkmcnt(4)
    v_mfma_f32_16x16x32_bf16 a[12:15], a[200:203], a[184:187], a[12:15]
    ds_read_b64_tr_b16 a[216:217], v10 offset:512
    v_mul_f32 v146, v146, v25
    v_mfma_f32_16x16x32_bf16 a[12:15], a[204:207], a[188:191], a[12:15]
    buffer_load_dwordx4 v19, s[56:59], s11 offen offset:2048 lds
    v_mul_f32 v147, v147, v25
    v_mfma_f32_16x16x32_bf16 a[8:11], a[204:207], a[180:183], a[8:11]
    ds_read_b64_tr_b16 a[218:219], v10 offset:20992
    v_mul_f32 v148, v148, v25
    v_mfma_f32_16x16x32_bf16 a[8:11], a[200:203], a[176:179], a[8:11]
    v_mul_f32 v149, v149, v25
    v_mul_f32 v150, v150, v25
    v_mfma_f32_16x16x32_bf16 a[4:7], a[200:203], a[168:171], a[4:7]
    ds_read_b64_tr_b16 a[220:221], v10 offset:1536
    v_mul_f32 v151, v151, v25
    v_mfma_f32_16x16x32_bf16 a[4:7], a[204:207], a[172:175], a[4:7]
    v_cvt_pk_bf16_f32 v80, v136, v137
    v_cvt_pk_bf16_f32 v81, v138, v139
    v_mfma_f32_16x16x32_bf16 a[0:3], a[204:207], a[164:167], a[0:3]
    ds_read_b64_tr_b16 a[222:223], v10 offset:22016
    v_cvt_pk_bf16_f32 v82, v140, v141
    v_mfma_f32_16x16x32_bf16 a[0:3], a[200:203], a[160:163], a[0:3]
    v_cvt_pk_bf16_f32 v83, v142, v143
    s_waitcnt lgkmcnt(4)
    v_mfma_f32_16x16x32_bf16 a[0:3], a[208:211], a[96:99], a[0:3]
    ds_read_b64_tr_b16 a[192:193], v12 offset:512
    v_cvt_pk_bf16_f32 v64, v128, v129
    v_mfma_f32_16x16x32_bf16 a[0:3], a[212:215], a[100:103], a[0:3]
    buffer_load_dwordx4 v20, s[56:59], s11 offen offset:3072 lds
    v_cvt_pk_bf16_f32 v65, v130, v131
    v_mfma_f32_16x16x32_bf16 a[4:7], a[212:215], a[108:111], a[4:7]
    ds_read_b64_tr_b16 a[194:195], v12 offset:20992
    v_cvt_pk_bf16_f32 v66, v132, v133
    v_mfma_f32_16x16x32_bf16 a[4:7], a[208:211], a[104:107], a[4:7]
    v_cvt_pk_bf16_f32 v67, v134, v135
    v_cvt_pk_bf16_f32 v84, v152, v153
    v_mfma_f32_16x16x32_bf16 a[8:11], a[208:211], a[112:115], a[8:11]
    ds_read_b64_tr_b16 a[196:197], v12 offset:1536
    v_cvt_pk_bf16_f32 v85, v154, v155
    v_mfma_f32_16x16x32_bf16 a[8:11], a[212:215], a[116:119], a[8:11]
    v_cvt_pk_bf16_f32 v86, v156, v157
    v_cvt_pk_bf16_f32 v87, v158, v159
    v_mfma_f32_16x16x32_bf16 a[12:15], a[212:215], a[124:127], a[12:15]
    ds_read_b64_tr_b16 a[198:199], v12 offset:22016
    v_cvt_pk_bf16_f32 v68, v144, v145
    v_mfma_f32_16x16x32_bf16 a[12:15], a[208:211], a[120:123], a[12:15]
    v_cvt_pk_bf16_f32 v69, v146, v147
    s_waitcnt lgkmcnt(4)
    v_mfma_f32_16x16x32_bf16 a[28:31], a[216:219], a[152:155], a[28:31]
    ds_read_b64_tr_b16 a[200:201], v14 offset:512
    v_cvt_pk_bf16_f32 v70, v148, v149
    v_mfma_f32_16x16x32_bf16 a[28:31], a[220:223], a[156:159], a[28:31]
    v_cvt_pk_bf16_f32 v71, v150, v151
    s_waitcnt lgkmcnt(15)
    v_mfma_f32_16x16x32_bf16 v[160:163], a[224:227], v[72:75], 0
    v_mfma_f32_16x16x32_bf16 v[164:167], a[228:231], v[72:75], 0
    v_mfma_f32_16x16x32_bf16 v[176:179], a[224:227], v[76:79], 0
    v_mfma_f32_16x16x32_bf16 v[180:183], a[228:231], v[76:79], 0
    v_mfma_f32_16x16x32_bf16 a[24:27], a[220:223], a[148:151], a[24:27]
    ds_read_b64_tr_b16 a[202:203], v14 offset:20992
    v_mfma_f32_16x16x32_bf16 a[24:27], a[216:219], a[144:147], a[24:27]
    v_mfma_f32_16x16x32_bf16 a[20:23], a[216:219], a[136:139], a[20:23]
    ds_read_b64_tr_b16 a[204:205], v14 offset:1536
    v_max3_f32 v26, v160, v161, v162
    v_mfma_f32_16x16x32_bf16 a[20:23], a[220:223], a[140:143], a[20:23]
    v_max3_f32 v27, -v160, -v161, -v162
    v_max3_f32 v26, v26, v163, v164
    v_mfma_f32_16x16x32_bf16 a[16:19], a[220:223], a[132:135], a[16:19]
    ds_read_b64_tr_b16 a[206:207], v14 offset:22016
    v_max3_f32 v27, v27, -v163, -v164
    v_mfma_f32_16x16x32_bf16 a[16:19], a[216:219], a[128:131], a[16:19]
    v_max3_f32 v26, v26, v165, v166
    s_waitcnt lgkmcnt(4)
    v_mfma_f32_16x16x32_bf16 a[16:19], a[192:195], a[160:163], a[16:19]
    ds_read_b64_tr_b16 a[208:209], v9 offset:2560
    v_max3_f32 v27, v27, -v165, -v166
    v_mfma_f32_16x16x32_bf16 a[16:19], a[196:199], a[164:167], a[16:19]
    v_max_f32 v26, v26, v167
    v_max_f32_e64 v27, v27, -v167
    v_mfma_f32_16x16x32_bf16 a[20:23], a[196:199], a[172:175], a[20:23]
    ds_read_b64_tr_b16 a[210:211], v9 offset:23040
    v_max3_f32 v28, v176, v177, v178
    v_mfma_f32_16x16x32_bf16 a[20:23], a[192:195], a[168:171], a[20:23]
    v_max3_f32 v29, -v176, -v177, -v178
    v_max3_f32 v28, v28, v179, v180
    v_mfma_f32_16x16x32_bf16 a[24:27], a[192:195], a[176:179], a[24:27]
    ds_read_b64_tr_b16 a[212:213], v9 offset:3584
    v_max3_f32 v29, v29, -v179, -v180
    v_mfma_f32_16x16x32_bf16 a[24:27], a[196:199], a[180:183], a[24:27]
    v_max3_f32 v28, v28, v181, v182
    v_max3_f32 v29, v29, -v181, -v182
    v_mfma_f32_16x16x32_bf16 a[28:31], a[196:199], a[188:191], a[28:31]
    ds_read_b64_tr_b16 a[214:215], v9 offset:24064
    v_max_f32 v28, v28, v183
    v_mfma_f32_16x16x32_bf16 a[28:31], a[192:195], a[184:187], a[28:31]
    v_max_f32_e64 v29, v29, -v183
    s_waitcnt lgkmcnt(4)
    v_mfma_f32_16x16x32_bf16 a[28:31], a[200:203], a[120:123], a[28:31]
    ds_read_b64_tr_b16 a[216:217], v11 offset:2560
    v_permlane32_swap_b32 v26, v27
    v_mfma_f32_16x16x32_bf16 a[28:31], a[204:207], a[124:127], a[28:31]
    v_permlane32_swap_b32 v28, v29
    v_max_f32 v26, v26, v27
    v_mfma_f32_16x16x32_bf16 a[24:27], a[204:207], a[116:119], a[24:27]
    ds_read_b64_tr_b16 a[218:219], v11 offset:23040
    v_max_f32 v28, v28, v29
    v_mfma_f32_16x16x32_bf16 a[24:27], a[200:203], a[112:115], a[24:27]
    v_mfma_f32_16x16x32_bf16 a[20:23], a[200:203], a[104:107], a[20:23]
    ds_read_b64_tr_b16 a[220:221], v11 offset:3584
    v_permlane16_swap_b32 v26, v28
    v_mfma_f32_16x16x32_bf16 a[20:23], a[204:207], a[108:111], a[20:23]
    v_max_f32 v26, v26, v28
    v_mul_f32 v26, s76, v26
    v_mfma_f32_16x16x32_bf16 a[16:19], a[204:207], a[100:103], a[16:19]
    ds_read_b64_tr_b16 a[222:223], v11 offset:24064
    v_mov_b32 v28, v26
    v_mfma_f32_16x16x32_bf16 a[16:19], a[200:203], a[96:99], a[16:19]
    s_waitcnt lgkmcnt(4)
    v_mfma_f32_16x16x32_bf16 a[64:67], a[208:211], a[128:131], a[64:67]
    ds_read_b64_tr_b16 a[192:193], v13 offset:2560
    v_permlane16_swap_b32 v26, v28
    v_mfma_f32_16x16x32_bf16 a[64:67], a[212:215], a[132:135], a[64:67]
    v_mov_b32 v27, v26
    v_mov_b32 v29, v28
    v_mfma_f32_16x16x32_bf16 a[68:71], a[212:215], a[140:143], a[68:71]
    ds_read_b64_tr_b16 a[194:195], v13 offset:23040
    v_permlane32_swap_b32 v26, v27
    v_mfma_f32_16x16x32_bf16 a[68:71], a[208:211], a[136:139], a[68:71]
    v_permlane32_swap_b32 v28, v29
    v_fma_f32 v168, v160, s77, v26
    v_mfma_f32_16x16x32_bf16 a[72:75], a[208:211], a[144:147], a[72:75]
    ds_read_b64_tr_b16 a[196:197], v13 offset:3584
    v_fma_f32 v169, v161, s77, v26
    v_mfma_f32_16x16x32_bf16 a[72:75], a[212:215], a[148:151], a[72:75]
    v_exp_f32 v168, v168
    v_mfma_f32_16x16x32_bf16 a[76:79], a[212:215], a[156:159], a[76:79]
    ds_read_b64_tr_b16 a[198:199], v13 offset:24064
    v_fma_f32 v170, v162, s77, v26
    v_mfma_f32_16x16x32_bf16 a[76:79], a[208:211], a[152:155], a[76:79]
    v_fma_f32 v171, v163, s77, v26
    s_waitcnt lgkmcnt(4)
    v_mfma_f32_16x16x32_bf16 a[76:79], a[216:219], a[184:187], a[76:79]
    ds_read_b64_tr_b16 a[200:201], v10 offset:2560
    v_fma_f32 v172, v164, s77, v26
    v_mfma_f32_16x16x32_bf16 a[76:79], a[220:223], a[188:191], a[76:79]
    v_exp_f32 v169, v169
    v_mfma_f32_16x16x32_bf16 a[72:75], a[220:223], a[180:183], a[72:75]
    ds_read_b64_tr_b16 a[202:203], v10 offset:23040
    v_fma_f32 v173, v165, s77, v26
    v_mfma_f32_16x16x32_bf16 a[72:75], a[216:219], a[176:179], a[72:75]
    v_exp_f32 v170, v170
    v_mfma_f32_16x16x32_bf16 a[68:71], a[216:219], a[168:171], a[68:71]
    ds_read_b64_tr_b16 a[204:205], v10 offset:3584
    v_fma_f32 v174, v166, s77, v26
    v_mfma_f32_16x16x32_bf16 a[68:71], a[220:223], a[172:175], a[68:71]
    v_exp_f32 v171, v171
    v_mfma_f32_16x16x32_bf16 a[64:67], a[220:223], a[164:167], a[64:67]
    ds_read_b64_tr_b16 a[206:207], v10 offset:24064
    v_fma_f32 v175, v167, s77, v26
    v_mfma_f32_16x16x32_bf16 a[64:67], a[216:219], a[160:163], a[64:67]
    v_fma_f32 v160, v160, s76, v27
    s_waitcnt lgkmcnt(4)
    v_mfma_f32_16x16x32_bf16 a[64:67], a[192:195], a[96:99], a[64:67]
    ds_read_b64_tr_b16 a[208:209], v12 offset:2560
    v_fma_f32 v161, v161, s76, v27
    v_mfma_f32_16x16x32_bf16 a[64:67], a[196:199], a[100:103], a[64:67]
    v_exp_f32 v172, v172
    v_mfma_f32_16x16x32_bf16 a[68:71], a[196:199], a[108:111], a[68:71]
    ds_read_b64_tr_b16 a[210:211], v12 offset:23040
    v_fma_f32 v162, v162, s76, v27
    v_mfma_f32_16x16x32_bf16 a[68:71], a[192:195], a[104:107], a[68:71]
    v_exp_f32 v173, v173
    v_mfma_f32_16x16x32_bf16 a[72:75], a[192:195], a[112:115], a[72:75]
    ds_read_b64_tr_b16 a[212:213], v12 offset:3584
    v_fma_f32 v163, v163, s76, v27
    v_mfma_f32_16x16x32_bf16 a[72:75], a[196:199], a[116:119], a[72:75]
    v_exp_f32 v174, v174
    v_mfma_f32_16x16x32_bf16 a[76:79], a[196:199], a[124:127], a[76:79]
    ds_read_b64_tr_b16 a[214:215], v12 offset:24064
    v_fma_f32 v164, v164, s76, v27
    v_mfma_f32_16x16x32_bf16 a[76:79], a[192:195], a[120:123], a[76:79]
    v_fma_f32 v165, v165, s76, v27
    s_waitcnt lgkmcnt(4)
    v_mfma_f32_16x16x32_bf16 a[92:95], a[200:203], a[152:155], a[92:95]
    ds_read_b64_tr_b16 a[216:217], v14 offset:2560
    v_fma_f32 v166, v166, s76, v27
    v_mfma_f32_16x16x32_bf16 a[92:95], a[204:207], a[156:159], a[92:95]
    v_exp_f32 v175, v175
    v_mfma_f32_16x16x32_bf16 a[88:91], a[204:207], a[148:151], a[88:91]
    ds_read_b64_tr_b16 a[218:219], v14 offset:23040
    v_fma_f32 v167, v167, s76, v27
    v_mfma_f32_16x16x32_bf16 a[88:91], a[200:203], a[144:147], a[88:91]
    v_exp_f32 v160, v160
    v_mfma_f32_16x16x32_bf16 a[84:87], a[200:203], a[136:139], a[84:87]
    ds_read_b64_tr_b16 a[220:221], v14 offset:3584
    v_fma_f32 v184, v176, s77, v28
    v_mfma_f32_16x16x32_bf16 a[84:87], a[204:207], a[140:143], a[84:87]
    v_exp_f32 v161, v161
    v_mfma_f32_16x16x32_bf16 a[80:83], a[204:207], a[132:135], a[80:83]
    ds_read_b64_tr_b16 a[222:223], v14 offset:24064
    v_fma_f32 v185, v177, s77, v28
    v_mfma_f32_16x16x32_bf16 a[80:83], a[200:203], a[128:131], a[80:83]
    v_fma_f32 v186, v178, s77, v28
    s_waitcnt lgkmcnt(4)
    v_mfma_f32_16x16x32_bf16 a[80:83], a[208:211], a[160:163], a[80:83]
    ds_read_b64_tr_b16 a[192:193], v15 offset:8192
    v_fma_f32 v187, v179, s77, v28
    v_mfma_f32_16x16x32_bf16 a[80:83], a[212:215], a[164:167], a[80:83]
    v_exp_f32 v162, v162
    v_mfma_f32_16x16x32_bf16 a[84:87], a[212:215], a[172:175], a[84:87]
    ds_read_b64_tr_b16 a[194:195], v15 offset:28672
    v_fma_f32 v188, v180, s77, v28
    v_mfma_f32_16x16x32_bf16 a[84:87], a[208:211], a[168:171], a[84:87]
    v_exp_f32 v163, v163
    v_mfma_f32_16x16x32_bf16 a[88:91], a[208:211], a[176:179], a[88:91]
    ds_read_b64_tr_b16 a[196:197], v15 offset:9216
    v_fma_f32 v189, v181, s77, v28
    v_mfma_f32_16x16x32_bf16 a[88:91], a[212:215], a[180:183], a[88:91]
    v_exp_f32 v164, v164
    v_mfma_f32_16x16x32_bf16 a[92:95], a[212:215], a[188:191], a[92:95]
    ds_read_b64_tr_b16 a[198:199], v15 offset:29696
    v_fma_f32 v190, v182, s77, v28
    v_mfma_f32_16x16x32_bf16 a[92:95], a[208:211], a[184:187], a[92:95]
    v_fma_f32 v191, v183, s77, v28
    s_waitcnt lgkmcnt(4)
    v_mfma_f32_16x16x32_bf16 a[92:95], a[216:219], a[120:123], a[92:95]
    ds_read_b64_tr_b16 a[200:201], v16 offset:8192
    v_fma_f32 v176, v176, s76, v29
    v_mfma_f32_16x16x32_bf16 a[92:95], a[220:223], a[124:127], a[92:95]
    v_exp_f32 v165, v165
    v_mfma_f32_16x16x32_bf16 a[88:91], a[220:223], a[116:119], a[88:91]
    ds_read_b64_tr_b16 a[202:203], v16 offset:28672
    v_fma_f32 v177, v177, s76, v29
    v_mfma_f32_16x16x32_bf16 a[88:91], a[216:219], a[112:115], a[88:91]
    v_exp_f32 v166, v166
    v_mfma_f32_16x16x32_bf16 a[84:87], a[216:219], a[104:107], a[84:87]
    ds_read_b64_tr_b16 a[204:205], v16 offset:9216
    v_fma_f32 v178, v178, s76, v29
    v_mfma_f32_16x16x32_bf16 a[84:87], a[220:223], a[108:111], a[84:87]
    v_exp_f32 v167, v167
    v_mfma_f32_16x16x32_bf16 a[80:83], a[220:223], a[100:103], a[80:83]
    ds_read_b64_tr_b16 a[206:207], v16 offset:29696
    v_fma_f32 v179, v179, s76, v29
    v_mfma_f32_16x16x32_bf16 a[80:83], a[216:219], a[96:99], a[80:83]
    v_fma_f32 v180, v180, s76, v29
    s_waitcnt lgkmcnt(4)
    v_mfma_f32_16x16x32_bf16 v[192:195], a[192:195], a[128:131], v[192:195]
    ds_read_b64_tr_b16 a[208:209], v15 offset:18432
    v_fma_f32 v181, v181, s76, v29
    v_mfma_f32_16x16x32_bf16 v[192:195], a[196:199], a[132:135], v[192:195]
    v_exp_f32 v184, v184
    v_mfma_f32_16x16x32_bf16 v[196:199], a[196:199], a[140:143], v[196:199]
    ds_read_b64_tr_b16 a[210:211], v15 offset:38912
    v_fma_f32 v182, v182, s76, v29
    v_mfma_f32_16x16x32_bf16 v[196:199], a[192:195], a[136:139], v[196:199]
    v_exp_f32 v185, v185
    v_mfma_f32_16x16x32_bf16 v[200:203], a[192:195], a[144:147], v[200:203]
    ds_read_b64_tr_b16 a[212:213], v15 offset:19456
    v_fma_f32 v183, v183, s76, v29
    v_mfma_f32_16x16x32_bf16 v[200:203], a[196:199], a[148:151], v[200:203]
    v_exp_f32 v186, v186
    v_mfma_f32_16x16x32_bf16 v[204:207], a[196:199], a[156:159], v[204:207]
    ds_read_b64_tr_b16 a[214:215], v15 offset:39936
    v_add_f32 v72, v168, v170
    v_mfma_f32_16x16x32_bf16 v[204:207], a[192:195], a[152:155], v[204:207]
    v_add_f32 v73, v169, v171
    s_waitcnt lgkmcnt(4)
    v_mfma_f32_16x16x32_bf16 v[220:223], a[200:203], a[152:155], v[220:223]
    ds_read_b64_tr_b16 a[216:217], v16 offset:18432
    v_add_f32 v74, v160, v162
    v_mfma_f32_16x16x32_bf16 v[220:223], a[204:207], a[156:159], v[220:223]
    v_exp_f32 v187, v187
    v_mfma_f32_16x16x32_bf16 v[216:219], a[204:207], a[148:151], v[216:219]
    ds_read_b64_tr_b16 a[218:219], v16 offset:38912
    v_add_f32 v75, v161, v163
    v_mfma_f32_16x16x32_bf16 v[216:219], a[200:203], a[144:147], v[216:219]
    v_exp_f32 v188, v188
    v_mfma_f32_16x16x32_bf16 v[212:215], a[200:203], a[136:139], v[212:215]
    ds_read_b64_tr_b16 a[220:221], v16 offset:19456
    v_add_f32 v72, v72, v172
    v_mfma_f32_16x16x32_bf16 v[212:215], a[204:207], a[140:143], v[212:215]
    v_exp_f32 v189, v189
    v_mfma_f32_16x16x32_bf16 v[208:211], a[204:207], a[132:135], v[208:211]
    ds_read_b64_tr_b16 a[222:223], v16 offset:39936
    v_add_f32 v73, v73, v173
    v_mfma_f32_16x16x32_bf16 v[208:211], a[200:203], a[128:131], v[208:211]
    v_add_u32 v15, 40960, v15
    v_add_u32 v16, 40960, v16
    s_waitcnt lgkmcnt(4)
    v_mfma_f32_16x16x32_bf16 v[224:227], a[208:211], a[128:131], v[224:227]
    ds_read_b64_tr_b16 a[192:193], v15 offset:8192
    v_add_f32 v74, v74, v164
    v_mfma_f32_16x16x32_bf16 v[224:227], a[212:215], a[132:135], v[224:227]
    v_exp_f32 v190, v190
    v_mfma_f32_16x16x32_bf16 v[228:231], a[212:215], a[140:143], v[228:231]
    ds_read_b64_tr_b16 a[194:195], v15 offset:28672
    v_add_f32 v75, v75, v165
    v_mfma_f32_16x16x32_bf16 v[228:231], a[208:211], a[136:139], v[228:231]
    v_exp_f32 v191, v191
    v_mfma_f32_16x16x32_bf16 v[232:235], a[208:211], a[144:147], v[232:235]
    ds_read_b64_tr_b16 a[196:197], v15 offset:9216
    v_add_f32 v72, v72, v174
    v_mfma_f32_16x16x32_bf16 v[232:235], a[212:215], a[148:151], v[232:235]
    v_exp_f32 v176, v176
    v_mfma_f32_16x16x32_bf16 v[236:239], a[212:215], a[156:159], v[236:239]
    ds_read_b64_tr_b16 a[198:199], v15 offset:29696
    v_add_f32 v73, v73, v175
    v_mfma_f32_16x16x32_bf16 v[236:239], a[208:211], a[152:155], v[236:239]
    v_add_f32 v74, v74, v166
    s_waitcnt lgkmcnt(4)
    v_mfma_f32_16x16x32_bf16 v[252:255], a[216:219], a[152:155], v[252:255]
    ds_read_b64_tr_b16 a[200:201], v16 offset:8192
    v_add_f32 v75, v75, v167
    v_mfma_f32_16x16x32_bf16 v[252:255], a[220:223], a[156:159], v[252:255]
    v_exp_f32 v177, v177
    v_mfma_f32_16x16x32_bf16 v[248:251], a[220:223], a[148:151], v[248:251]
    ds_read_b64_tr_b16 a[202:203], v16 offset:28672
    v_add_f32 v26, v72, v73
    v_mfma_f32_16x16x32_bf16 v[248:251], a[216:219], a[144:147], v[248:251]
    v_exp_f32 v178, v178
    v_mfma_f32_16x16x32_bf16 v[244:247], a[216:219], a[136:139], v[244:247]
    ds_read_b64_tr_b16 a[204:205], v16 offset:9216
    v_add_f32 v27, v74, v75
    v_mfma_f32_16x16x32_bf16 v[244:247], a[220:223], a[140:143], v[244:247]
    v_exp_f32 v179, v179
    v_mfma_f32_16x16x32_bf16 v[240:243], a[220:223], a[132:135], v[240:243]
    ds_read_b64_tr_b16 a[206:207], v16 offset:29696
    v_add_f32 v76, v184, v186
    v_mfma_f32_16x16x32_bf16 v[240:243], a[216:219], a[128:131], v[240:243]
    v_add_f32 v77, v185, v187
    s_waitcnt lgkmcnt(4)
    v_mfma_f32_16x16x32_bf16 v[192:195], a[192:195], a[160:163], v[192:195]
    ds_read_b64_tr_b16 a[208:209], v15 offset:18432
    v_add_f32 v78, v176, v178
    v_mfma_f32_16x16x32_bf16 v[192:195], a[196:199], a[164:167], v[192:195]
    v_exp_f32 v180, v180
    v_mfma_f32_16x16x32_bf16 v[196:199], a[196:199], a[172:175], v[196:199]
    ds_read_b64_tr_b16 a[210:211], v15 offset:38912
    v_add_f32 v79, v177, v179
    v_mfma_f32_16x16x32_bf16 v[196:199], a[192:195], a[168:171], v[196:199]
    v_exp_f32 v181, v181
    v_mfma_f32_16x16x32_bf16 v[200:203], a[192:195], a[176:179], v[200:203]
    ds_read_b64_tr_b16 a[212:213], v15 offset:19456
    v_add_f32 v76, v76, v188
    v_mfma_f32_16x16x32_bf16 v[200:203], a[196:199], a[180:183], v[200:203]
    v_exp_f32 v182, v182
    v_mfma_f32_16x16x32_bf16 v[204:207], a[196:199], a[188:191], v[204:207]
    ds_read_b64_tr_b16 a[214:215], v15 offset:39936
    v_add_f32 v77, v77, v189
    v_mfma_f32_16x16x32_bf16 v[204:207], a[192:195], a[184:187], v[204:207]
    v_add_f32 v78, v78, v180
    s_waitcnt lgkmcnt(4)
    v_mfma_f32_16x16x32_bf16 v[220:223], a[200:203], a[184:187], v[220:223]
    ds_read_b64_tr_b16 a[216:217], v16 offset:18432
    v_add_f32 v79, v79, v181
    v_mfma_f32_16x16x32_bf16 v[220:223], a[204:207], a[188:191], v[220:223]
    v_exp_f32 v183, v183
    v_mfma_f32_16x16x32_bf16 v[216:219], a[204:207], a[180:183], v[216:219]
    ds_read_b64_tr_b16 a[218:219], v16 offset:38912
    v_add_f32 v76, v76, v190
    v_mfma_f32_16x16x32_bf16 v[216:219], a[200:203], a[176:179], v[216:219]
    v_add_f32 v77, v77, v191
    v_add_f32 v78, v78, v182
    v_mfma_f32_16x16x32_bf16 v[212:215], a[200:203], a[168:171], v[212:215]
    ds_read_b64_tr_b16 a[220:221], v16 offset:19456
    v_add_f32 v79, v79, v183
    v_mfma_f32_16x16x32_bf16 v[212:215], a[204:207], a[172:175], v[212:215]
    v_add_f32 v28, v76, v77
    v_add_f32 v29, v78, v79
    v_mfma_f32_16x16x32_bf16 v[208:211], a[204:207], a[164:167], v[208:211]
    ds_read_b64_tr_b16 a[222:223], v16 offset:39936
    v_permlane32_swap_b32 v26, v27
    v_mfma_f32_16x16x32_bf16 v[208:211], a[200:203], a[160:163], v[208:211]
    v_add_u32 v15, 40960, v15
    v_add_u32 v16, 40960, v16
    s_waitcnt lgkmcnt(4)
    v_mfma_f32_16x16x32_bf16 v[224:227], a[208:211], a[160:163], v[224:227]
    ds_read_b64_tr_b16 a[192:193], v15 offset:8192
    v_permlane32_swap_b32 v28, v29
    v_mfma_f32_16x16x32_bf16 v[224:227], a[212:215], a[164:167], v[224:227]
    v_add_f32 v26, v26, v27
    v_add_f32 v28, v28, v29
    v_mfma_f32_16x16x32_bf16 v[228:231], a[212:215], a[172:175], v[228:231]
    ds_read_b64_tr_b16 a[194:195], v15 offset:28672
    v_permlane16_swap_b32 v26, v28
    v_mfma_f32_16x16x32_bf16 v[228:231], a[208:211], a[168:171], v[228:231]
    v_add_f32 v26, v26, v28
    v_mfma_f32_16x16x32_bf16 v[232:235], a[208:211], a[176:179], v[232:235]
    ds_read_b64_tr_b16 a[196:197], v15 offset:9216
    v_rcp_f32 v26, v26
    v_mfma_f32_16x16x32_bf16 v[232:235], a[212:215], a[180:183], v[232:235]
    v_mov_b32 v28, v26
    v_mfma_f32_16x16x32_bf16 v[236:239], a[212:215], a[188:191], v[236:239]
    ds_read_b64_tr_b16 a[198:199], v15 offset:29696
    v_permlane16_swap_b32 v26, v28
    v_mfma_f32_16x16x32_bf16 v[236:239], a[208:211], a[184:187], v[236:239]
    v_mov_b32 v27, v26
    s_waitcnt lgkmcnt(4)
    v_mfma_f32_16x16x32_bf16 v[252:255], a[216:219], a[184:187], v[252:255]
    ds_read_b64_tr_b16 a[200:201], v16 offset:8192
    v_mov_b32 v29, v28
    v_mfma_f32_16x16x32_bf16 v[252:255], a[220:223], a[188:191], v[252:255]
    v_permlane32_swap_b32 v26, v27
    v_permlane32_swap_b32 v28, v29
    v_mfma_f32_16x16x32_bf16 v[248:251], a[220:223], a[180:183], v[248:251]
    ds_read_b64_tr_b16 a[202:203], v16 offset:28672
    v_mul_f32 v168, v168, v26
    v_mfma_f32_16x16x32_bf16 v[248:251], a[216:219], a[176:179], v[248:251]
    v_mul_f32 v169, v169, v26
    v_mul_f32 v170, v170, v26
    v_mfma_f32_16x16x32_bf16 v[244:247], a[216:219], a[168:171], v[244:247]
    ds_read_b64_tr_b16 a[204:205], v16 offset:9216
    v_mul_f32 v171, v171, v26
    v_mfma_f32_16x16x32_bf16 v[244:247], a[220:223], a[172:175], v[244:247]
    v_mul_f32 v172, v172, v26
    v_mul_f32 v173, v173, v26
    v_mfma_f32_16x16x32_bf16 v[240:243], a[220:223], a[164:167], v[240:243]
    ds_read_b64_tr_b16 a[206:207], v16 offset:29696
    v_mul_f32 v174, v174, v26
    v_mfma_f32_16x16x32_bf16 v[240:243], a[216:219], a[160:163], v[240:243]
    v_mul_f32 v175, v175, v26
    s_waitcnt lgkmcnt(4)
    v_mfma_f32_16x16x32_bf16 v[192:195], a[192:195], a[96:99], v[192:195]
    ds_read_b64_tr_b16 a[208:209], v15 offset:18432
    v_mul_f32 v160, v160, v27
    v_mfma_f32_16x16x32_bf16 v[192:195], a[196:199], a[100:103], v[192:195]
    v_mul_f32 v161, v161, v27
    v_mul_f32 v162, v162, v27
    v_mfma_f32_16x16x32_bf16 v[196:199], a[196:199], a[108:111], v[196:199]
    ds_read_b64_tr_b16 a[210:211], v15 offset:38912
    v_mul_f32 v163, v163, v27
    v_mfma_f32_16x16x32_bf16 v[196:199], a[192:195], a[104:107], v[196:199]
    v_mul_f32 v164, v164, v27
    v_mul_f32 v165, v165, v27
    v_mfma_f32_16x16x32_bf16 v[200:203], a[192:195], a[112:115], v[200:203]
    ds_read_b64_tr_b16 a[212:213], v15 offset:19456
    v_mul_f32 v166, v166, v27
    v_mfma_f32_16x16x32_bf16 v[200:203], a[196:199], a[116:119], v[200:203]
    v_mul_f32 v167, v167, v27
    v_mul_f32 v184, v184, v28
    v_mfma_f32_16x16x32_bf16 v[204:207], a[196:199], a[124:127], v[204:207]
    ds_read_b64_tr_b16 a[214:215], v15 offset:39936
    v_mul_f32 v185, v185, v28
    v_mfma_f32_16x16x32_bf16 v[204:207], a[192:195], a[120:123], v[204:207]
    v_mul_f32 v186, v186, v28
    s_waitcnt lgkmcnt(4)
    v_mfma_f32_16x16x32_bf16 v[220:223], a[200:203], a[120:123], v[220:223]
    ds_read_b64_tr_b16 a[216:217], v16 offset:18432
    v_mul_f32 v187, v187, v28
    v_mfma_f32_16x16x32_bf16 v[220:223], a[204:207], a[124:127], v[220:223]
    v_mul_f32 v188, v188, v28
    v_mul_f32 v189, v189, v28
    v_mfma_f32_16x16x32_bf16 v[216:219], a[204:207], a[116:119], v[216:219]
    ds_read_b64_tr_b16 a[218:219], v16 offset:38912
    v_mul_f32 v190, v190, v28
    v_mfma_f32_16x16x32_bf16 v[216:219], a[200:203], a[112:115], v[216:219]
    v_mul_f32 v191, v191, v28
    v_mul_f32 v176, v176, v29
    v_mfma_f32_16x16x32_bf16 v[212:215], a[200:203], a[104:107], v[212:215]
    ds_read_b64_tr_b16 a[220:221], v16 offset:19456
    v_mul_f32 v177, v177, v29
    v_mfma_f32_16x16x32_bf16 v[212:215], a[204:207], a[108:111], v[212:215]
    v_mul_f32 v178, v178, v29
    v_mul_f32 v179, v179, v29
    v_mfma_f32_16x16x32_bf16 v[208:211], a[204:207], a[100:103], v[208:211]
    ds_read_b64_tr_b16 a[222:223], v16 offset:39936
    v_mul_f32 v180, v180, v29
    v_mfma_f32_16x16x32_bf16 v[208:211], a[200:203], a[96:99], v[208:211]
    v_mul_f32 v181, v181, v29
    s_waitcnt lgkmcnt(4)
    v_mfma_f32_16x16x32_bf16 v[224:227], a[208:211], a[96:99], v[224:227]
    v_mul_f32 v182, v182, v29
    v_mul_f32 v183, v183, v29
    v_mfma_f32_16x16x32_bf16 v[224:227], a[212:215], a[100:103], v[224:227]
    v_cvt_pk_bf16_f32 v88, v168, v169
    v_cvt_pk_bf16_f32 v89, v170, v171
    v_mfma_f32_16x16x32_bf16 v[228:231], a[212:215], a[108:111], v[228:231]
    v_cvt_pk_bf16_f32 v90, v172, v173
    v_cvt_pk_bf16_f32 v91, v174, v175
    v_mfma_f32_16x16x32_bf16 v[228:231], a[208:211], a[104:107], v[228:231]
    v_cvt_pk_bf16_f32 v72, v160, v161
    v_cvt_pk_bf16_f32 v73, v162, v163
    v_mfma_f32_16x16x32_bf16 v[232:235], a[208:211], a[112:115], v[232:235]
    v_cvt_pk_bf16_f32 v74, v164, v165
    v_cvt_pk_bf16_f32 v75, v166, v167
    v_mfma_f32_16x16x32_bf16 v[232:235], a[212:215], a[116:119], v[232:235]
    v_cvt_pk_bf16_f32 v92, v184, v185
    v_cvt_pk_bf16_f32 v93, v186, v187
    v_mfma_f32_16x16x32_bf16 v[236:239], a[212:215], a[124:127], v[236:239]
    v_cvt_pk_bf16_f32 v94, v188, v189
    v_cvt_pk_bf16_f32 v95, v190, v191
    v_mfma_f32_16x16x32_bf16 v[236:239], a[208:211], a[120:123], v[236:239]
    v_cvt_pk_bf16_f32 v76, v176, v177
    s_waitcnt lgkmcnt(0)
    v_mfma_f32_16x16x32_bf16 v[252:255], a[216:219], a[120:123], v[252:255]
    v_cvt_pk_bf16_f32 v77, v178, v179
    v_cvt_pk_bf16_f32 v78, v180, v181
    v_mfma_f32_16x16x32_bf16 v[252:255], a[220:223], a[124:127], v[252:255]
    v_cvt_pk_bf16_f32 v79, v182, v183
    v_cvt_pk_bf16_f32 v96, v96, v97
    v_mfma_f32_16x16x32_bf16 v[248:251], a[220:223], a[116:119], v[248:251]
    v_cvt_pk_bf16_f32 v97, v98, v99
    v_cvt_pk_bf16_f32 v98, v112, v113
    v_mfma_f32_16x16x32_bf16 v[248:251], a[216:219], a[112:115], v[248:251]
    v_cvt_pk_bf16_f32 v99, v114, v115
    v_cvt_pk_bf16_f32 v100, v100, v101
    v_mfma_f32_16x16x32_bf16 v[244:247], a[216:219], a[104:107], v[244:247]
    v_cvt_pk_bf16_f32 v101, v102, v103
    v_cvt_pk_bf16_f32 v102, v116, v117
    v_mfma_f32_16x16x32_bf16 v[128:131], a[232:235], v[96:99], 0
    v_cvt_pk_bf16_f32 v103, v118, v119
    v_cvt_pk_bf16_f32 v104, v104, v105
    v_mfma_f32_16x16x32_bf16 v[132:135], a[236:239], v[96:99], 0
    v_cvt_pk_bf16_f32 v105, v106, v107
    v_cvt_pk_bf16_f32 v106, v120, v121
    v_mfma_f32_16x16x32_bf16 v[144:147], a[232:235], v[100:103], 0
    v_cvt_pk_bf16_f32 v107, v122, v123
    v_cvt_pk_bf16_f32 v108, v108, v109
    v_mfma_f32_16x16x32_bf16 v[148:151], a[236:239], v[100:103], 0
    v_cvt_pk_bf16_f32 v109, v110, v111
    v_cvt_pk_bf16_f32 v110, v124, v125
    v_mfma_f32_16x16x32_bf16 v[160:163], a[232:235], v[104:107], 0
    v_cvt_pk_bf16_f32 v111, v126, v127
    v_max3_f32 v22, v128, v129, v130
    v_mfma_f32_16x16x32_bf16 v[164:167], a[236:239], v[104:107], 0
    v_max3_f32 v23, -v128, -v129, -v130
    v_max3_f32 v22, v22, v131, v132
    v_mfma_f32_16x16x32_bf16 v[176:179], a[232:235], v[108:111], 0
    v_max3_f32 v23, v23, -v131, -v132
    v_max3_f32 v22, v22, v133, v134
    v_mfma_f32_16x16x32_bf16 v[180:183], a[236:239], v[108:111], 0
    v_max3_f32 v23, v23, -v133, -v134
    v_max_f32 v22, v22, v135
    v_mfma_f32_16x16x32_bf16 v[244:247], a[220:223], a[108:111], v[244:247]
    v_max_f32_e64 v23, v23, -v135
    v_max3_f32 v24, v144, v145, v146
    v_mfma_f32_16x16x32_bf16 v[240:243], a[220:223], a[100:103], v[240:243]
    v_max3_f32 v25, -v144, -v145, -v146
    v_max3_f32 v24, v24, v147, v148
    v_mfma_f32_16x16x32_bf16 v[240:243], a[216:219], a[96:99], v[240:243]
    v_max3_f32 v25, v25, -v147, -v148
    s_barrier
    v_max3_f32 v24, v24, v149, v150
    v_max3_f32 v25, v25, -v149, -v150
    v_max_f32 v24, v24, v151
    v_max_f32_e64 v25, v25, -v151
    v_max3_f32 v26, v160, v161, v162
    v_max3_f32 v27, -v160, -v161, -v162
    v_max3_f32 v26, v26, v163, v164
    v_max3_f32 v27, v27, -v163, -v164
    ds_write_b128 v30, v[80:83] offset:40960
    v_max3_f32 v26, v26, v165, v166
    v_max3_f32 v27, v27, -v165, -v166
    v_max_f32 v26, v26, v167
    v_max_f32_e64 v27, v27, -v167
    v_max3_f32 v28, v176, v177, v178
    v_max3_f32 v29, -v176, -v177, -v178
    v_max3_f32 v28, v28, v179, v180
    v_max3_f32 v29, v29, -v179, -v180
    ds_write_b128 v30, v[84:87] offset:41984
    v_max3_f32 v28, v28, v181, v182
    v_max3_f32 v29, v29, -v181, -v182
    v_max_f32 v28, v28, v183
    v_max_f32_e64 v29, v29, -v183
    v_permlane32_swap_b32 v22, v23
    v_permlane32_swap_b32 v24, v25
    s_add_u32 m0, s19, 8192
    s_lshl_b32 s11, s87, 4
    buffer_load_dwordx4 v17, s[56:59], s11 offen offset:0 lds
    v_permlane32_swap_b32 v26, v27
    v_permlane32_swap_b32 v28, v29
    ds_write_b128 v30, v[88:91] offset:43008
    v_max_f32 v22, v22, v23
    v_max_f32 v24, v24, v25
    v_max_f32 v26, v26, v27
    v_max_f32 v28, v28, v29
    v_permlane16_swap_b32 v22, v24
    s_nop 0
    v_permlane16_swap_b32 v26, v28
    v_max_f32 v22, v22, v24
    v_max_f32 v26, v26, v28
    ds_write_b128 v30, v[92:95] offset:44032
    v_mul_f32 v22, s76, v22
    v_mul_f32 v26, s76, v26
    v_mov_b32 v24, v22
    v_mov_b32 v28, v26
    s_nop 0
    v_permlane16_swap_b32 v22, v24
    v_permlane16_swap_b32 v26, v28
    v_mov_b32 v23, v22
    v_mov_b32 v25, v24
    v_add_u32 v30, 81920, v30
    v_mov_b32 v27, v26
    v_mov_b32 v29, v28
    v_permlane32_swap_b32 v22, v23
    buffer_load_dwordx4 v18, s[56:59], s11 offen offset:1024 lds
    v_permlane32_swap_b32 v24, v25
    v_permlane32_swap_b32 v26, v27
    v_permlane32_swap_b32 v28, v29
    v_pk_fma_f32 v[136:137], v[128:129], s[76:77], v[22:23] op_sel:[0,1,0] op_sel_hi:[1,1,0]
    v_pk_fma_f32 v[138:139], v[130:131], s[76:77], v[22:23] op_sel:[0,1,0] op_sel_hi:[1,1,0]
    ds_write_b128 v30, v[64:67] offset:0
    v_pk_fma_f32 v[140:141], v[132:133], s[76:77], v[22:23] op_sel:[0,1,0] op_sel_hi:[1,1,0]
    v_pk_fma_f32 v[142:143], v[134:135], s[76:77], v[22:23] op_sel:[0,1,0] op_sel_hi:[1,1,0]
    v_pk_fma_f32 v[128:129], v[128:129], s[76:77], v[22:23] op_sel:[0,0,1] op_sel_hi:[1,0,1]
    v_pk_fma_f32 v[130:131], v[130:131], s[76:77], v[22:23] op_sel:[0,0,1] op_sel_hi:[1,0,1]
    v_pk_fma_f32 v[132:133], v[132:133], s[76:77], v[22:23] op_sel:[0,0,1] op_sel_hi:[1,0,1]
    v_pk_fma_f32 v[134:135], v[134:135], s[76:77], v[22:23] op_sel:[0,0,1] op_sel_hi:[1,0,1]
    v_exp_f32 v136, v136
    ds_write_b128 v30, v[68:71] offset:1024
    v_exp_f32 v137, v137
    v_exp_f32 v138, v138
    v_and_b32 v16, 3, v1
    v_lshlrev_b32 v16, 2, v16
    buffer_load_dword v16, v16, s[52:55], s67 offen offset:0 sc1
    v_exp_f32 v139, v139
    s_add_u32 m0, s19, 47104
    s_nop 0
    buffer_load_dwordx4 v19, s[56:59], s11 offen offset:2048 lds
    v_exp_f32 v140, v140
    ds_write_b128 v30, v[72:75] offset:2048
    v_exp_f32 v141, v141
    v_exp_f32 v142, v142
    v_exp_f32 v143, v143
    v_exp_f32 v128, v128
    ds_write_b128 v30, v[76:79] offset:3072
    v_exp_f32 v129, v129
    v_exp_f32 v130, v130
    v_exp_f32 v131, v131
    v_exp_f32 v132, v132
    v_exp_f32 v133, v133
    v_exp_f32 v134, v134
    buffer_load_dwordx4 v20, s[56:59], s11 offen offset:3072 lds
    v_exp_f32 v135, v135
    v_pk_fma_f32 v[152:153], v[144:145], s[76:77], v[24:25] op_sel:[0,1,0] op_sel_hi:[1,1,0]
    v_pk_fma_f32 v[154:155], v[146:147], s[76:77], v[24:25] op_sel:[0,1,0] op_sel_hi:[1,1,0]
    v_pk_fma_f32 v[156:157], v[148:149], s[76:77], v[24:25] op_sel:[0,1,0] op_sel_hi:[1,1,0]
    v_pk_fma_f32 v[158:159], v[150:151], s[76:77], v[24:25] op_sel:[0,1,0] op_sel_hi:[1,1,0]
    v_pk_fma_f32 v[144:145], v[144:145], s[76:77], v[24:25] op_sel:[0,0,1] op_sel_hi:[1,0,1]
    v_pk_fma_f32 v[146:147], v[146:147], s[76:77], v[24:25] op_sel:[0,0,1] op_sel_hi:[1,0,1]
    v_pk_fma_f32 v[148:149], v[148:149], s[76:77], v[24:25] op_sel:[0,0,1] op_sel_hi:[1,0,1]
    v_pk_fma_f32 v[150:151], v[150:151], s[76:77], v[24:25] op_sel:[0,0,1] op_sel_hi:[1,0,1]
    v_exp_f32 v152, v152
    v_exp_f32 v153, v153
    v_exp_f32 v154, v154
    v_exp_f32 v155, v155
    v_exp_f32 v156, v156
    v_exp_f32 v157, v157
    v_exp_f32 v158, v158
    v_exp_f32 v159, v159
    v_exp_f32 v144, v144
    v_exp_f32 v145, v145
    v_exp_f32 v146, v146
    v_exp_f32 v147, v147
    v_exp_f32 v148, v148
    v_exp_f32 v149, v149
    v_exp_f32 v150, v150
    v_exp_f32 v151, v151
    v_pk_fma_f32 v[168:169], v[160:161], s[76:77], v[26:27] op_sel:[0,1,0] op_sel_hi:[1,1,0]
    v_pk_fma_f32 v[170:171], v[162:163], s[76:77], v[26:27] op_sel:[0,1,0] op_sel_hi:[1,1,0]
    v_pk_fma_f32 v[172:173], v[164:165], s[76:77], v[26:27] op_sel:[0,1,0] op_sel_hi:[1,1,0]
    v_pk_fma_f32 v[174:175], v[166:167], s[76:77], v[26:27] op_sel:[0,1,0] op_sel_hi:[1,1,0]
    v_pk_fma_f32 v[160:161], v[160:161], s[76:77], v[26:27] op_sel:[0,0,1] op_sel_hi:[1,0,1]
    v_pk_fma_f32 v[162:163], v[162:163], s[76:77], v[26:27] op_sel:[0,0,1] op_sel_hi:[1,0,1]
    v_pk_fma_f32 v[164:165], v[164:165], s[76:77], v[26:27] op_sel:[0,0,1] op_sel_hi:[1,0,1]
    v_pk_fma_f32 v[166:167], v[166:167], s[76:77], v[26:27] op_sel:[0,0,1] op_sel_hi:[1,0,1]
    v_exp_f32 v168, v168
    v_exp_f32 v169, v169
    v_exp_f32 v170, v170
    v_exp_f32 v171, v171
    v_exp_f32 v172, v172
    v_exp_f32 v173, v173
    v_exp_f32 v174, v174
    v_exp_f32 v175, v175
    v_exp_f32 v160, v160
    v_exp_f32 v161, v161
    v_exp_f32 v162, v162
    v_exp_f32 v163, v163
    v_exp_f32 v164, v164
    v_exp_f32 v165, v165
    v_exp_f32 v166, v166
    v_exp_f32 v167, v167
    v_pk_fma_f32 v[184:185], v[176:177], s[76:77], v[28:29] op_sel:[0,1,0] op_sel_hi:[1,1,0]
    v_pk_fma_f32 v[186:187], v[178:179], s[76:77], v[28:29] op_sel:[0,1,0] op_sel_hi:[1,1,0]
    v_pk_fma_f32 v[188:189], v[180:181], s[76:77], v[28:29] op_sel:[0,1,0] op_sel_hi:[1,1,0]
    v_pk_fma_f32 v[190:191], v[182:183], s[76:77], v[28:29] op_sel:[0,1,0] op_sel_hi:[1,1,0]
    v_pk_fma_f32 v[176:177], v[176:177], s[76:77], v[28:29] op_sel:[0,0,1] op_sel_hi:[1,0,1]
    v_pk_fma_f32 v[178:179], v[178:179], s[76:77], v[28:29] op_sel:[0,0,1] op_sel_hi:[1,0,1]
    v_pk_fma_f32 v[180:181], v[180:181], s[76:77], v[28:29] op_sel:[0,0,1] op_sel_hi:[1,0,1]
    v_pk_fma_f32 v[182:183], v[182:183], s[76:77], v[28:29] op_sel:[0,0,1] op_sel_hi:[1,0,1]
    v_exp_f32 v184, v184
    v_exp_f32 v185, v185
    v_exp_f32 v186, v186
    v_exp_f32 v187, v187
    v_exp_f32 v188, v188
    v_exp_f32 v189, v189
    v_exp_f32 v190, v190
    v_exp_f32 v191, v191
    v_exp_f32 v176, v176
    v_exp_f32 v177, v177
    v_exp_f32 v178, v178
    v_exp_f32 v179, v179
    v_exp_f32 v180, v180
    v_exp_f32 v181, v181
    v_exp_f32 v182, v182
    v_exp_f32 v183, v183
    v_pk_add_f32 v[96:97], v[136:137], v[138:139]
    v_pk_add_f32 v[98:99], v[128:129], v[130:131]
    v_pk_add_f32 v[96:97], v[96:97], v[140:141]
    v_pk_add_f32 v[98:99], v[98:99], v[132:133]
    v_pk_add_f32 v[96:97], v[96:97], v[142:143]
    v_pk_add_f32 v[98:99], v[98:99], v[134:135]
    v_add_f32 v22, v96, v97
    v_add_f32 v23, v98, v99
    v_pk_add_f32 v[100:101], v[152:153], v[154:155]
    v_pk_add_f32 v[102:103], v[144:145], v[146:147]
    v_pk_add_f32 v[100:101], v[100:101], v[156:157]
    v_pk_add_f32 v[102:103], v[102:103], v[148:149]
    v_pk_add_f32 v[100:101], v[100:101], v[158:159]
    v_pk_add_f32 v[102:103], v[102:103], v[150:151]
    v_add_f32 v24, v100, v101
    v_add_f32 v25, v102, v103
    v_pk_add_f32 v[104:105], v[168:169], v[170:171]
    v_pk_add_f32 v[106:107], v[160:161], v[162:163]
    v_pk_add_f32 v[104:105], v[104:105], v[172:173]
    v_pk_add_f32 v[106:107], v[106:107], v[164:165]
    v_pk_add_f32 v[104:105], v[104:105], v[174:175]
    v_pk_add_f32 v[106:107], v[106:107], v[166:167]
    v_add_f32 v26, v104, v105
    v_add_f32 v27, v106, v107
    v_pk_add_f32 v[108:109], v[184:185], v[186:187]
    v_pk_add_f32 v[110:111], v[176:177], v[178:179]
    v_pk_add_f32 v[108:109], v[108:109], v[188:189]
    v_pk_add_f32 v[110:111], v[110:111], v[180:181]
    v_pk_add_f32 v[108:109], v[108:109], v[190:191]
    v_pk_add_f32 v[110:111], v[110:111], v[182:183]
    v_add_f32 v28, v108, v109
    v_add_f32 v29, v110, v111
    v_permlane32_swap_b32 v22, v23
    v_permlane32_swap_b32 v24, v25
    v_permlane32_swap_b32 v26, v27
    v_permlane32_swap_b32 v28, v29
    v_add_f32 v22, v22, v23
    v_add_f32 v24, v24, v25
    v_add_f32 v26, v26, v27
    v_add_f32 v28, v28, v29
    v_permlane16_swap_b32 v22, v24
    s_nop 0
    v_permlane16_swap_b32 v26, v28
    v_add_f32 v22, v22, v24
    v_add_f32 v26, v26, v28
    v_rcp_f32 v22, v22
    v_rcp_f32 v26, v26
    v_mov_b32 v24, v22
    s_waitcnt vmcnt(2)
    v_cmp_ne_u32 vcc, s18, v16
    s_cbranch_vccnz L_pl1
L_pl1_b:
    v_mov_b32 v28, v26
    v_permlane16_swap_b32 v22, v24
    s_nop 0
    v_permlane16_swap_b32 v26, v28
    v_mov_b32 v23, v22
    v_mov_b32 v25, v24
    v_mov_b32 v27, v26
    v_mov_b32 v29, v28
    v_permlane32_swap_b32 v22, v23
    buffer_load_dwordx4 a[160:163], v3, s[44:47], s81 offen offset:0 sc1
    v_permlane32_swap_b32 v24, v25
    v_permlane32_swap_b32 v26, v27
    v_permlane32_swap_b32 v28, v29
    v_pk_mul_f32 v[136:137], v[136:137], v[22:23] op_sel_hi:[1,0]
    v_pk_mul_f32 v[138:139], v[138:139], v[22:23] op_sel_hi:[1,0]
    v_pk_mul_f32 v[140:141], v[140:141], v[22:23] op_sel_hi:[1,0]
    v_pk_mul_f32 v[142:143], v[142:143], v[22:23] op_sel_hi:[1,0]
    v_cvt_pk_bf16_f32 v112, v136, v137
    v_cvt_pk_bf16_f32 v113, v138, v139
    v_cvt_pk_bf16_f32 v114, v140, v141
    v_cvt_pk_bf16_f32 v115, v142, v143
    ds_write_b128 v30, v[112:115] offset:40960
    v_pk_mul_f32 v[128:129], v[128:129], v[22:23] op_sel:[0,1]
    v_pk_mul_f32 v[130:131], v[130:131], v[22:23] op_sel:[0,1]
    v_pk_mul_f32 v[132:133], v[132:133], v[22:23] op_sel:[0,1]
    v_pk_mul_f32 v[134:135], v[134:135], v[22:23] op_sel:[0,1]
    v_cvt_pk_bf16_f32 v96, v128, v129
    v_cvt_pk_bf16_f32 v97, v130, v131
    v_cvt_pk_bf16_f32 v98, v132, v133
    v_cvt_pk_bf16_f32 v99, v134, v135
    ds_write_b128 v30, v[96:99] offset:8192
    v_pk_mul_f32 v[152:153], v[152:153], v[24:25] op_sel_hi:[1,0]
    v_pk_mul_f32 v[154:155], v[154:155], v[24:25] op_sel_hi:[1,0]
    v_pk_mul_f32 v[156:157], v[156:157], v[24:25] op_sel_hi:[1,0]
    buffer_load_dwordx4 a[164:167], v3, s[44:47], s81 offen offset:1024 sc1
    v_pk_mul_f32 v[158:159], v[158:159], v[24:25] op_sel_hi:[1,0]
    v_cvt_pk_bf16_f32 v116, v152, v153
    v_cvt_pk_bf16_f32 v117, v154, v155
    v_cvt_pk_bf16_f32 v118, v156, v157
    v_cvt_pk_bf16_f32 v119, v158, v159
    ds_write_b128 v30, v[116:119] offset:41984
    v_pk_mul_f32 v[144:145], v[144:145], v[24:25] op_sel:[0,1]
    v_pk_mul_f32 v[146:147], v[146:147], v[24:25] op_sel:[0,1]
    v_pk_mul_f32 v[148:149], v[148:149], v[24:25] op_sel:[0,1]
    v_pk_mul_f32 v[150:151], v[150:151], v[24:25] op_sel:[0,1]
    v_cvt_pk_bf16_f32 v100, v144, v145
    v_cvt_pk_bf16_f32 v101, v146, v147
    v_cvt_pk_bf16_f32 v102, v148, v149
    v_cvt_pk_bf16_f32 v103, v150, v151
    ds_write_b128 v30, v[100:103] offset:9216
    v_pk_mul_f32 v[168:169], v[168:169], v[26:27] op_sel_hi:[1,0]
    v_pk_mul_f32 v[170:171], v[170:171], v[26:27] op_sel_hi:[1,0]
    v_pk_mul_f32 v[172:173], v[172:173], v[26:27] op_sel_hi:[1,0]
    v_pk_mul_f32 v[174:175], v[174:175], v[26:27] op_sel_hi:[1,0]
    v_cvt_pk_bf16_f32 v120, v168, v169
    v_cvt_pk_bf16_f32 v121, v170, v171
    v_cvt_pk_bf16_f32 v122, v172, v173
    v_cvt_pk_bf16_f32 v123, v174, v175
    ds_write_b128 v30, v[120:123] offset:43008
    buffer_load_dwordx4 a[168:171], v4, s[44:47], s81 offen offset:0 sc1
    v_pk_mul_f32 v[160:161], v[160:161], v[26:27] op_sel:[0,1]
    v_pk_mul_f32 v[162:163], v[162:163], v[26:27] op_sel:[0,1]
    v_pk_mul_f32 v[164:165], v[164:165], v[26:27] op_sel:[0,1]
    v_pk_mul_f32 v[166:167], v[166:167], v[26:27] op_sel:[0,1]
    v_cvt_pk_bf16_f32 v104, v160, v161
    v_cvt_pk_bf16_f32 v105, v162, v163
    v_cvt_pk_bf16_f32 v106, v164, v165
    v_cvt_pk_bf16_f32 v107, v166, v167
    ds_write_b128 v30, v[104:107] offset:49152
    v_pk_mul_f32 v[184:185], v[184:185], v[28:29] op_sel_hi:[1,0]
    v_pk_mul_f32 v[186:187], v[186:187], v[28:29] op_sel_hi:[1,0]
    v_pk_mul_f32 v[188:189], v[188:189], v[28:29] op_sel_hi:[1,0]
    v_pk_mul_f32 v[190:191], v[190:191], v[28:29] op_sel_hi:[1,0]
    v_cvt_pk_bf16_f32 v124, v184, v185
    v_cvt_pk_bf16_f32 v125, v186, v187
    v_cvt_pk_bf16_f32 v126, v188, v189
    v_cvt_pk_bf16_f32 v127, v190, v191
    ds_write_b128 v30, v[124:127] offset:44032
    v_pk_mul_f32 v[176:177], v[176:177], v[28:29] op_sel:[0,1]
    v_pk_mul_f32 v[178:179], v[178:179], v[28:29] op_sel:[0,1]
    v_pk_mul_f32 v[180:181], v[180:181], v[28:29] op_sel:[0,1]
    v_pk_mul_f32 v[182:183], v[182:183], v[28:29] op_sel:[0,1]
    v_cvt_pk_bf16_f32 v108, v176, v177
    v_cvt_pk_bf16_f32 v109, v178, v179
    buffer_load_dwordx4 a[172:175], v4, s[44:47], s81 offen offset:1024 sc1
    v_cvt_pk_bf16_f32 v110, v180, v181
    v_cvt_pk_bf16_f32 v111, v182, v183
    ds_write_b128 v30, v[108:111] offset:50176
    v_lshrrev_b32 v22, 2, v1
    v_bfe_u32 v23, v1, 3, 2
    v_and_b32 v24, 3, v1
    v_xor_b32 v23, v23, v24
    v_lshlrev_b32 v22, 6, v22
    v_lshl_add_u32 v22, v23, 4, v22
    v_add_u32 v23, s96, v22
    v_add_u32 v22, s97, v22
    v_add_u32 v29, s94, v22
    v_mov_b32 v24, 0x3f803f80
    v_mov_b32 v25, v24
    v_mov_b32 v26, v24
    v_mov_b32 v27, v24
    v_and_b32 v28, 48, v1
    s_waitcnt lgkmcnt(0)
    s_barrier
    v_lshlrev_b32 v30, 7, v1
    ds_read_b64_tr_b16 a[192:193], v22 offset:0
    ds_read_b64_tr_b16 a[194:195], v22 offset:1024
    ds_read_b64_tr_b16 a[196:197], v22 offset:8
    ds_read_b64_tr_b16 a[198:199], v22 offset:1032
    ds_read_b64_tr_b16 a[200:201], v23 offset:0
    ds_read_b64_tr_b16 a[202:203], v23 offset:1024
    ds_read_b64_tr_b16 a[204:205], v23 offset:8
    ds_read_b64_tr_b16 a[206:207], v23 offset:1032
    ds_read_b64_tr_b16 a[208:209], v29 offset:0
    ds_read_b64_tr_b16 a[210:211], v29 offset:1024
    ds_read_b64_tr_b16 a[212:213], v29 offset:8
    ds_read_b64_tr_b16 a[214:215], v29 offset:1032
    ds_read_b64_tr_b16 a[216:217], v23 offset:2048
    ds_read_b64_tr_b16 a[218:219], v23 offset:3072
    ds_read_b64_tr_b16 a[220:221], v23 offset:2056
    ds_read_b64_tr_b16 a[222:223], v23 offset:3080
    v_pk_mul_f32 v[192:193], v[192:193], s[76:77] op_sel_hi:[1,0]
    v_pk_mul_f32 v[194:195], v[194:195], s[76:77] op_sel_hi:[1,0]
    v_pk_mul_f32 v[208:209], v[208:209], s[76:77] op_sel_hi:[1,0]
    v_pk_mul_f32 v[210:211], v[210:211], s[76:77] op_sel_hi:[1,0]
    v_exp_f32 v192, v192
    v_exp_f32 v193, v193
    v_exp_f32 v194, v194
    v_exp_f32 v195, v195
    v_exp_f32 v208, v208
    v_exp_f32 v209, v209
    v_exp_f32 v210, v210
    v_exp_f32 v211, v211
    s_waitcnt lgkmcnt(8)
    v_mfma_f32_16x16x32_bf16 v[128:131], a[192:195], a[200:203], 0
    ds_read_b64_tr_b16 a[224:225], v22 offset:10240
    ds_read_b64_tr_b16 a[226:227], v22 offset:11264
    v_mfma_f32_16x16x32_bf16 v[136:139], a[192:195], a[204:207], 0
    ds_read_b64_tr_b16 a[228:229], v22 offset:10248
    ds_read_b64_tr_b16 a[230:231], v22 offset:11272
    v_mfma_f32_16x16x32_bf16 v[144:147], a[192:195], v[24:27], 0
    ds_read_b64_tr_b16 a[232:233], v23 offset:10240
    ds_read_b64_tr_b16 a[234:235], v23 offset:11264
    v_mfma_f32_16x16x32_bf16 v[132:135], a[196:199], a[200:203], 0
    ds_read_b64_tr_b16 a[236:237], v23 offset:10248
    ds_read_b64_tr_b16 a[238:239], v23 offset:11272
    v_mfma_f32_16x16x32_bf16 v[140:143], a[196:199], a[204:207], 0
    buffer_load_dwordx4 a[176:179], v5, s[44:47], s81 offen offset:0 sc1
    v_add_f32 v192, 1.0, v192
    v_mfma_f32_16x16x32_bf16 v[148:151], a[196:199], v[24:27], 0
    v_add_f32 v193, 1.0, v193
    s_waitcnt lgkmcnt(8)
    v_mfma_f32_16x16x32_bf16 v[128:131], a[208:211], a[216:219], v[128:131]
    ds_read_b64_tr_b16 a[240:241], v29 offset:10240
    ds_read_b64_tr_b16 a[242:243], v29 offset:11264
    v_mfma_f32_16x16x32_bf16 v[136:139], a[208:211], a[220:223], v[136:139]
    ds_read_b64_tr_b16 a[244:245], v29 offset:10248
    ds_read_b64_tr_b16 a[246:247], v29 offset:11272
    v_mfma_f32_16x16x32_bf16 v[144:147], a[208:211], v[24:27], v[144:147]
    ds_read_b64_tr_b16 a[248:249], v23 offset:12288
    ds_read_b64_tr_b16 a[250:251], v23 offset:13312
    v_mfma_f32_16x16x32_bf16 v[132:135], a[212:215], a[216:219], v[132:135]
    ds_read_b64_tr_b16 a[252:253], v23 offset:12296
    ds_read_b64_tr_b16 a[254:255], v23 offset:13320
    v_mfma_f32_16x16x32_bf16 v[140:143], a[212:215], a[220:223], v[140:143]
    buffer_load_dwordx4 a[180:183], v5, s[44:47], s81 offen offset:1024 sc1
    v_add_f32 v194, 1.0, v194
    v_mfma_f32_16x16x32_bf16 v[148:151], a[212:215], v[24:27], v[148:151]
    v_add_f32 v195, 1.0, v195
    s_waitcnt lgkmcnt(8)
    v_mfma_f32_16x16x32_bf16 v[128:131], a[224:227], a[232:235], v[128:131]
    ds_read_b64_tr_b16 a[192:193], v22 offset:20480
    ds_read_b64_tr_b16 a[194:195], v22 offset:21504
    v_mfma_f32_16x16x32_bf16 v[136:139], a[224:227], a[236:239], v[136:139]
    ds_read_b64_tr_b16 a[196:197], v22 offset:20488
    ds_read_b64_tr_b16 a[198:199], v22 offset:21512
    v_mfma_f32_16x16x32_bf16 v[144:147], a[224:227], v[24:27], v[144:147]
    ds_read_b64_tr_b16 a[200:201], v23 offset:20480
    ds_read_b64_tr_b16 a[202:203], v23 offset:21504
    v_mfma_f32_16x16x32_bf16 v[132:135], a[228:231], a[232:235], v[132:135]
    ds_read_b64_tr_b16 a[204:205], v23 offset:20488
    ds_read_b64_tr_b16 a[206:207], v23 offset:21512
    v_mfma_f32_16x16x32_bf16 v[140:143], a[228:231], a[236:239], v[140:143]
    buffer_load_dwordx4 a[184:187], v6, s[44:47], s81 offen offset:0 sc1
    v_add_f32 v208, 1.0, v208
    v_mfma_f32_16x16x32_bf16 v[148:151], a[228:231], v[24:27], v[148:151]
    v_add_f32 v209, 1.0, v209
    s_waitcnt lgkmcnt(8)
    v_mfma_f32_16x16x32_bf16 v[128:131], a[240:243], a[248:251], v[128:131]
    ds_read_b64_tr_b16 a[208:209], v29 offset:20480
    ds_read_b64_tr_b16 a[210:211], v29 offset:21504
    v_mfma_f32_16x16x32_bf16 v[136:139], a[240:243], a[252:255], v[136:139]
    ds_read_b64_tr_b16 a[212:213], v29 offset:20488
    ds_read_b64_tr_b16 a[214:215], v29 offset:21512
    v_mfma_f32_16x16x32_bf16 v[144:147], a[240:243], v[24:27], v[144:147]
    ds_read_b64_tr_b16 a[216:217], v23 offset:22528
    ds_read_b64_tr_b16 a[218:219], v23 offset:23552
    v_mfma_f32_16x16x32_bf16 v[132:135], a[244:247], a[248:251], v[132:135]
    ds_read_b64_tr_b16 a[220:221], v23 offset:22536
    ds_read_b64_tr_b16 a[222:223], v23 offset:23560
    v_mfma_f32_16x16x32_bf16 v[140:143], a[244:247], a[252:255], v[140:143]
    buffer_load_dwordx4 a[188:191], v6, s[44:47], s81 offen offset:1024 sc1
    v_add_f32 v210, 1.0, v210
    v_mfma_f32_16x16x32_bf16 v[148:151], a[244:247], v[24:27], v[148:151]
    v_add_f32 v211, 1.0, v211
    s_waitcnt lgkmcnt(8)
    v_mfma_f32_16x16x32_bf16 v[128:131], a[192:195], a[200:203], v[128:131]
    ds_read_b64_tr_b16 a[224:225], v22 offset:30720
    ds_read_b64_tr_b16 a[226:227], v22 offset:31744
    v_mfma_f32_16x16x32_bf16 v[136:139], a[192:195], a[204:207], v[136:139]
    ds_read_b64_tr_b16 a[228:229], v22 offset:30728
    ds_read_b64_tr_b16 a[230:231], v22 offset:31752
    v_mfma_f32_16x16x32_bf16 v[144:147], a[192:195], v[24:27], v[144:147]
    ds_read_b64_tr_b16 a[232:233], v23 offset:30720
    ds_read_b64_tr_b16 a[234:235], v23 offset:31744
    v_mfma_f32_16x16x32_bf16 v[132:135], a[196:199], a[200:203], v[132:135]
    ds_read_b64_tr_b16 a[236:237], v23 offset:30728
    ds_read_b64_tr_b16 a[238:239], v23 offset:31752
    v_mfma_f32_16x16x32_bf16 v[140:143], a[196:199], a[204:207], v[140:143]
    buffer_load_dwordx4 a[128:131], v3, s[44:47], s83 offen offset:0 sc1
    v_mul_f32 v196, s76, v196
    v_mfma_f32_16x16x32_bf16 v[148:151], a[196:199], v[24:27], v[148:151]
    v_mul_f32 v197, s76, v197
    s_waitcnt lgkmcnt(8)
    v_mfma_f32_16x16x32_bf16 v[128:131], a[208:211], a[216:219], v[128:131]
    ds_read_b64_tr_b16 a[240:241], v29 offset:30720
    ds_read_b64_tr_b16 a[242:243], v29 offset:31744
    v_mfma_f32_16x16x32_bf16 v[136:139], a[208:211], a[220:223], v[136:139]
    ds_read_b64_tr_b16 a[244:245], v29 offset:30728
    ds_read_b64_tr_b16 a[246:247], v29 offset:31752
    v_mfma_f32_16x16x32_bf16 v[144:147], a[208:211], v[24:27], v[144:147]
    ds_read_b64_tr_b16 a[248:249], v23 offset:32768
    ds_read_b64_tr_b16 a[250:251], v23 offset:33792
    v_mfma_f32_16x16x32_bf16 v[132:135], a[212:215], a[216:219], v[132:135]
    ds_read_b64_tr_b16 a[252:253], v23 offset:32776
    ds_read_b64_tr_b16 a[254:255], v23 offset:33800
    v_mfma_f32_16x16x32_bf16 v[140:143], a[212:215], a[220:223], v[140:143]
    buffer_load_dwordx4 a[132:135], v3, s[44:47], s83 offen offset:1024 sc1
    v_mul_f32 v198, s76, v198
    v_mfma_f32_16x16x32_bf16 v[148:151], a[212:215], v[24:27], v[148:151]
    v_mul_f32 v199, s76, v199
    s_waitcnt lgkmcnt(8)
    v_mfma_f32_16x16x32_bf16 v[128:131], a[224:227], a[232:235], v[128:131]
    v_rcp_f32 v192, v192
    v_mfma_f32_16x16x32_bf16 v[136:139], a[224:227], a[236:239], v[136:139]
    v_rcp_f32 v193, v193
    v_mfma_f32_16x16x32_bf16 v[144:147], a[224:227], v[24:27], v[144:147]
    buffer_load_dwordx4 a[136:139], v4, s[44:47], s83 offen offset:0 sc1
    v_mul_f32 v192, v192, v224
    v_mfma_f32_16x16x32_bf16 v[132:135], a[228:231], a[232:235], v[132:135]
    v_rcp_f32 v194, v194
    v_mfma_f32_16x16x32_bf16 v[140:143], a[228:231], a[236:239], v[140:143]
    v_rcp_f32 v195, v195
    v_mfma_f32_16x16x32_bf16 v[148:151], a[228:231], v[24:27], v[148:151]
    v_mul_f32 v193, v193, v225
    s_waitcnt vmcnt(20) lgkmcnt(0)
    s_barrier
    v_mfma_f32_16x16x32_bf16 v[128:131], a[240:243], a[248:251], v[128:131]
    buffer_load_dwordx4 a[140:143], v4, s[44:47], s83 offen offset:1024 sc1
    v_mul_f32 v194, v194, v226
    v_mfma_f32_16x16x32_bf16 v[136:139], a[240:243], a[252:255], v[136:139]
    v_rcp_f32 v208, v208
    v_mfma_f32_16x16x32_bf16 v[144:147], a[240:243], v[24:27], v[144:147]
    v_rcp_f32 v209, v209
    v_mfma_f32_16x16x32_bf16 v[132:135], a[244:247], a[248:251], v[132:135]
    v_rcp_f32 v210, v210
    v_mfma_f32_16x16x32_bf16 v[140:143], a[244:247], a[252:255], v[140:143]
    buffer_load_dwordx4 a[144:147], v5, s[44:47], s83 offen offset:0 sc1
    v_mul_f32 v195, v195, v227
    v_mfma_f32_16x16x32_bf16 v[148:151], a[244:247], v[24:27], v[148:151]
    v_mul_f32 v208, v208, v240
    v_rcp_f32 v211, v211
    v_mul_f32 v209, v209, v241
    v_pk_mul_f32 v[210:211], v[210:211], v[242:243]
    v_cvt_pk_bf16_f32 v224, v192, v193
    v_cvt_pk_bf16_f32 v225, v194, v195
    v_cvt_pk_bf16_f32 v226, v208, v209
    v_cvt_pk_bf16_f32 v227, v210, v211
    v_pk_mul_f32 v[212:213], v[212:213], s[76:77] op_sel_hi:[1,0]
    v_cvt_pk_bf16_f32 v128, v128, v129
    v_cvt_pk_bf16_f32 v129, v130, v131
    v_cvt_pk_bf16_f32 v130, v132, v133
    v_cvt_pk_bf16_f32 v131, v134, v135
    v_cvt_pk_bf16_f32 v136, v136, v137
    v_cvt_pk_bf16_f32 v137, v138, v139
    v_cvt_pk_bf16_f32 v138, v140, v141
    v_cvt_pk_bf16_f32 v139, v142, v143
    buffer_store_dwordx4 v[128:131], v2, s[48:51], s70 offen offset:0 sc1
    buffer_store_dwordx4 v[136:139], v2, s[48:51], s70 offen offset:1024 sc1
    s_mov_b32 exec_lo, 0x00010001
    s_mov_b32 exec_hi, 0x00010001
    buffer_store_dwordx4 v[144:147], v28, s[48:51], s71 offen offset:0 sc1
    buffer_store_dwordx4 v[148:151], v28, s[48:51], s71 offen offset:64 sc1
    s_mov_b64 exec, -1
    v_pk_mul_f32 v[214:215], v[214:215], s[76:77] op_sel_hi:[1,0]
    v_exp_f32 v196, v196
    v_exp_f32 v197, v197
    v_exp_f32 v198, v198
    v_exp_f32 v199, v199
    v_exp_f32 v212, v212
    v_exp_f32 v213, v213
    v_exp_f32 v214, v214
    v_exp_f32 v215, v215
    v_pk_add_f32 v[196:197], v[196:197], 1.0 op_sel_hi:[1,0]
    v_pk_add_f32 v[198:199], v[198:199], 1.0 op_sel_hi:[1,0]
    v_pk_add_f32 v[212:213], v[212:213], 1.0 op_sel_hi:[1,0]
    v_pk_add_f32 v[214:215], v[214:215], 1.0 op_sel_hi:[1,0]
    v_rcp_f32 v196, v196
    v_rcp_f32 v197, v197
    v_rcp_f32 v198, v198
    buffer_load_dwordx4 a[148:151], v5, s[44:47], s83 offen offset:1024 sc1
    v_rcp_f32 v199, v199
    v_rcp_f32 v212, v212
    v_rcp_f32 v213, v213
    v_rcp_f32 v214, v214
    v_rcp_f32 v215, v215
    v_pk_mul_f32 v[196:197], v[196:197], v[228:229]
    v_pk_mul_f32 v[198:199], v[198:199], v[230:231]
    v_pk_mul_f32 v[212:213], v[212:213], v[244:245]
    v_pk_mul_f32 v[214:215], v[214:215], v[246:247]
    v_cvt_pk_bf16_f32 v228, v196, v197
    v_cvt_pk_bf16_f32 v229, v198, v199
    v_cvt_pk_bf16_f32 v230, v212, v213
    v_cvt_pk_bf16_f32 v231, v214, v215
    v_pk_mul_f32 v[200:201], v[200:201], s[76:77] op_sel_hi:[1,0]
    v_pk_mul_f32 v[202:203], v[202:203], s[76:77] op_sel_hi:[1,0]
    v_pk_mul_f32 v[216:217], v[216:217], s[76:77] op_sel_hi:[1,0]
    v_pk_mul_f32 v[218:219], v[218:219], s[76:77] op_sel_hi:[1,0]
    v_exp_f32 v200, v200
    v_exp_f32 v201, v201
    buffer_load_dwordx4 a[152:155], v6, s[44:47], s83 offen offset:0 sc1
    v_exp_f32 v202, v202
    v_exp_f32 v203, v203
    v_exp_f32 v216, v216
    v_exp_f32 v217, v217
    v_exp_f32 v218, v218
    v_exp_f32 v219, v219
    v_pk_add_f32 v[200:201], v[200:201], 1.0 op_sel_hi:[1,0]
    v_pk_add_f32 v[202:203], v[202:203], 1.0 op_sel_hi:[1,0]
    v_pk_add_f32 v[216:217], v[216:217], 1.0 op_sel_hi:[1,0]
    v_pk_add_f32 v[218:219], v[218:219], 1.0 op_sel_hi:[1,0]
    v_rcp_f32 v200, v200
    v_rcp_f32 v201, v201
    v_rcp_f32 v202, v202
    v_rcp_f32 v203, v203
    v_rcp_f32 v216, v216
    buffer_load_dwordx4 a[156:159], v6, s[44:47], s83 offen offset:1024 sc1
    v_rcp_f32 v217, v217
    v_rcp_f32 v218, v218
    v_rcp_f32 v219, v219
    v_pk_mul_f32 v[200:201], v[200:201], v[232:233]
    v_pk_mul_f32 v[202:203], v[202:203], v[234:235]
    v_pk_mul_f32 v[216:217], v[216:217], v[248:249]
    v_pk_mul_f32 v[218:219], v[218:219], v[250:251]
    v_cvt_pk_bf16_f32 v232, v200, v201
    v_cvt_pk_bf16_f32 v233, v202, v203
    v_cvt_pk_bf16_f32 v234, v216, v217
    v_cvt_pk_bf16_f32 v235, v218, v219
    v_pk_mul_f32 v[204:205], v[204:205], s[76:77] op_sel_hi:[1,0]
    v_pk_mul_f32 v[206:207], v[206:207], s[76:77] op_sel_hi:[1,0]
    v_pk_mul_f32 v[220:221], v[220:221], s[76:77] op_sel_hi:[1,0]
    v_pk_mul_f32 v[222:223], v[222:223], s[76:77] op_sel_hi:[1,0]
    v_exp_f32 v204, v204
    v_exp_f32 v205, v205
    v_exp_f32 v206, v206
    v_exp_f32 v207, v207
    buffer_load_dwordx4 a[96:99], v3, s[44:47], s85 offen offset:0 sc1
    v_exp_f32 v220, v220
    v_exp_f32 v221, v221
    v_exp_f32 v222, v222
    v_exp_f32 v223, v223
    v_pk_add_f32 v[204:205], v[204:205], 1.0 op_sel_hi:[1,0]
    v_pk_add_f32 v[206:207], v[206:207], 1.0 op_sel_hi:[1,0]
    v_pk_add_f32 v[220:221], v[220:221], 1.0 op_sel_hi:[1,0]
    v_pk_add_f32 v[222:223], v[222:223], 1.0 op_sel_hi:[1,0]
    v_rcp_f32 v204, v204
    v_rcp_f32 v205, v205
    v_rcp_f32 v206, v206
    v_rcp_f32 v207, v207
    v_rcp_f32 v220, v220
    v_rcp_f32 v221, v221
    v_rcp_f32 v222, v222
    buffer_load_dwordx4 a[100:103], v3, s[44:47], s85 offen offset:1024 sc1
    v_rcp_f32 v223, v223
    v_pk_mul_f32 v[204:205], v[204:205], v[236:237]
    v_pk_mul_f32 v[206:207], v[206:207], v[238:239]
    v_pk_mul_f32 v[220:221], v[220:221], v[252:253]
    v_pk_mul_f32 v[222:223], v[222:223], v[254:255]
    v_cvt_pk_bf16_f32 v236, v204, v205
    v_cvt_pk_bf16_f32 v237, v206, v207
    v_cvt_pk_bf16_f32 v238, v220, v221
    v_cvt_pk_bf16_f32 v239, v222, v223
    buffer_store_dwordx4 v[224:227], v3, s[44:47], s78 offen offset:0 sc1
    buffer_store_dwordx4 v[228:231], v4, s[44:47], s78 offen offset:0 sc1
    buffer_store_dwordx4 v[232:235], v5, s[44:47], s78 offen offset:0 sc1
    buffer_store_dwordx4 v[236:239], v6, s[44:47], s78 offen offset:0 sc1
    ds_read_b64_tr_b16 a[192:193], v9 offset:4096
    ds_read_b64_tr_b16 a[194:195], v9 offset:24576
    ds_read_b64_tr_b16 a[196:197], v9 offset:5120
    ds_read_b64_tr_b16 a[198:199], v9 offset:25600
    ds_read_b64_tr_b16 a[200:201], v10 offset:4096
    ds_read_b64_tr_b16 a[202:203], v10 offset:24576
    ds_read_b64_tr_b16 a[204:205], v10 offset:5120
    ds_read_b64_tr_b16 a[206:207], v10 offset:25600
    s_waitcnt vmcnt(18) lgkmcnt(4)
    v_mfma_f32_16x16x32_bf16 v[64:67], a[192:195], a[160:163], 0
    ds_read_b64_tr_b16 a[208:209], v9 offset:4608
    v_mul_f32 v32, s76, v32
    v_mfma_f32_16x16x32_bf16 v[64:67], a[196:199], a[164:167], v[64:67]
    v_exp_f32 v32, v32
    v_mfma_f32_16x16x32_bf16 v[68:71], a[196:199], a[172:175], 0
    ds_read_b64_tr_b16 a[210:211], v9 offset:25088
    v_mul_f32 v33, s76, v33
    v_mfma_f32_16x16x32_bf16 v[68:71], a[192:195], a[168:171], v[68:71]
    buffer_load_dwordx4 a[104:107], v4, s[44:47], s85 offen offset:0 sc1
    v_mul_f32 v34, s76, v34
    v_mfma_f32_16x16x32_bf16 v[72:75], a[192:195], a[176:179], 0
    ds_read_b64_tr_b16 a[212:213], v9 offset:5632
    v_mul_f32 v35, s76, v35
    v_mfma_f32_16x16x32_bf16 v[72:75], a[196:199], a[180:183], v[72:75]
    v_exp_f32 v33, v33
    v_mfma_f32_16x16x32_bf16 v[76:79], a[196:199], a[188:191], 0
    ds_read_b64_tr_b16 a[214:215], v9 offset:26112
    v_mul_f32 v48, s76, v48
    v_mfma_f32_16x16x32_bf16 v[76:79], a[192:195], a[184:187], v[76:79]
    s_waitcnt vmcnt(10)
    s_add_u32 s74, s65, 0
    s_mov_b64 exec, 1
    buffer_store_dword v21, off, s[52:55], s74 sc1
    s_mov_b64 exec, -1
    s_waitcnt vmcnt(37) lgkmcnt(4)
    s_barrier
    v_mfma_f32_16x16x32_bf16 v[92:95], a[200:203], a[184:187], 0
    ds_read_b64_tr_b16 a[216:217], v10 offset:4608
    v_mul_f32 v49, s76, v49
    v_mfma_f32_16x16x32_bf16 v[92:95], a[204:207], a[188:191], v[92:95]
    buffer_load_dwordx4 a[108:111], v4, s[44:47], s85 offen offset:1024 sc1
    v_mul_f32 v50, s76, v50
    v_mfma_f32_16x16x32_bf16 v[88:91], a[204:207], a[180:183], 0
    ds_read_b64_tr_b16 a[218:219], v10 offset:25088
    v_mul_f32 v51, s76, v51
    v_mfma_f32_16x16x32_bf16 v[88:91], a[200:203], a[176:179], v[88:91]
    v_exp_f32 v34, v34
    v_mfma_f32_16x16x32_bf16 v[84:87], a[200:203], a[168:171], 0
    ds_read_b64_tr_b16 a[220:221], v10 offset:5632
    v_add_f32 v32, 1.0, v32
    v_mfma_f32_16x16x32_bf16 v[84:87], a[204:207], a[172:175], v[84:87]
    buffer_load_dwordx4 a[112:115], v5, s[44:47], s85 offen offset:0 sc1
    v_add_f32 v33, 1.0, v33
    v_mfma_f32_16x16x32_bf16 v[80:83], a[204:207], a[164:167], 0
    ds_read_b64_tr_b16 a[222:223], v10 offset:26112
    v_accvgpr_read_b32 v128, a32
    v_mfma_f32_16x16x32_bf16 v[80:83], a[200:203], a[160:163], v[80:83]
    v_accvgpr_read_b32 v129, a33
    s_waitcnt lgkmcnt(4)
    v_mfma_f32_16x16x32_bf16 v[96:99], a[208:211], a[160:163], 0
    ds_read_b64_tr_b16 a[192:193], v9 offset:6144
    v_accvgpr_read_b32 v130, a34
    v_mfma_f32_16x16x32_bf16 v[96:99], a[212:215], a[164:167], v[96:99]
    buffer_load_dwordx4 a[116:119], v5, s[44:47], s85 offen offset:1024 sc1
    v_accvgpr_read_b32 v131, a35
    v_mfma_f32_16x16x32_bf16 v[100:103], a[212:215], a[172:175], 0
    ds_read_b64_tr_b16 a[194:195], v9 offset:26624
    v_accvgpr_read_b32 v132, a48
    v_mfma_f32_16x16x32_bf16 v[100:103], a[208:211], a[168:171], v[100:103]
    v_exp_f32 v35, v35
    v_mfma_f32_16x16x32_bf16 v[104:107], a[208:211], a[176:179], 0
    ds_read_b64_tr_b16 a[196:197], v9 offset:7168
    v_add_f32 v34, 1.0, v34
    v_mfma_f32_16x16x32_bf16 v[104:107], a[212:215], a[180:183], v[104:107]
    buffer_load_dwordx4 a[120:123], v6, s[44:47], s85 offen offset:0 sc1
    v_add_f32 v35, 1.0, v35
    v_mfma_f32_16x16x32_bf16 v[108:111], a[212:215], a[188:191], 0
    ds_read_b64_tr_b16 a[198:199], v9 offset:27648
    v_accvgpr_read_b32 v133, a49
    v_mfma_f32_16x16x32_bf16 v[108:111], a[208:211], a[184:187], v[108:111]
    v_accvgpr_read_b32 v134, a50
    s_waitcnt lgkmcnt(4)
    v_mfma_f32_16x16x32_bf16 v[124:127], a[216:219], a[184:187], 0
    ds_read_b64_tr_b16 a[200:201], v10 offset:6144
    v_accvgpr_read_b32 v135, a51
    v_mfma_f32_16x16x32_bf16 v[124:127], a[220:223], a[188:191], v[124:127]
    buffer_load_dwordx4 a[124:127], v6, s[44:47], s85 offen offset:1024 sc1
    v_mul_f32 v36, s76, v36
    v_mfma_f32_16x16x32_bf16 v[120:123], a[220:223], a[180:183], 0
    ds_read_b64_tr_b16 a[202:203], v10 offset:26624
    v_mul_f32 v37, s76, v37
    v_mfma_f32_16x16x32_bf16 v[120:123], a[216:219], a[176:179], v[120:123]
    v_exp_f32 v48, v48
    v_mfma_f32_16x16x32_bf16 v[116:119], a[216:219], a[168:171], 0
    ds_read_b64_tr_b16 a[204:205], v10 offset:7168
    s_add_u32 m0, s19, 0
    v_mfma_f32_16x16x32_bf16 v[116:119], a[220:223], a[172:175], v[116:119]
    s_lshl_b32 s11, s80, 4
    v_mul_f32 v38, s76, v38
    v_mfma_f32_16x16x32_bf16 v[112:115], a[220:223], a[164:167], 0
    ds_read_b64_tr_b16 a[206:207], v10 offset:27648
    v_mul_f32 v39, s76, v39
    v_mfma_f32_16x16x32_bf16 v[112:115], a[216:219], a[160:163], v[112:115]
    v_mul_f32 v52, s76, v52
    s_waitcnt lgkmcnt(4)
    v_mfma_f32_16x16x32_bf16 v[144:147], a[192:195], a[160:163], 0
    ds_read_b64_tr_b16 a[208:209], v9 offset:6656
    v_mul_f32 v53, s76, v53
    v_mfma_f32_16x16x32_bf16 v[144:147], a[196:199], a[164:167], v[144:147]
    buffer_load_dwordx4 v17, s[56:59], s11 offen offset:0 lds
    v_mul_f32 v54, s76, v54
    v_mfma_f32_16x16x32_bf16 v[148:151], a[196:199], a[172:175], 0
    ds_read_b64_tr_b16 a[210:211], v9 offset:27136
    v_mul_f32 v55, s76, v55
    v_mfma_f32_16x16x32_bf16 v[148:151], a[192:195], a[168:171], v[148:151]
    v_exp_f32 v49, v49
    v_mfma_f32_16x16x32_bf16 v[152:155], a[192:195], a[176:179], 0
    ds_read_b64_tr_b16 a[212:213], v9 offset:7680
    v_add_f32 v48, 1.0, v48
    v_mfma_f32_16x16x32_bf16 v[152:155], a[196:199], a[180:183], v[152:155]
    buffer_load_dwordx4 v18, s[56:59], s11 offen offset:1024 lds
    v_add_f32 v49, 1.0, v49
    v_mfma_f32_16x16x32_bf16 v[156:159], a[196:199], a[188:191], 0
    ds_read_b64_tr_b16 a[214:215], v9 offset:28160
    v_accvgpr_read_b32 v136, a36
    v_mfma_f32_16x16x32_bf16 v[156:159], a[192:195], a[184:187], v[156:159]
    v_accvgpr_read_b32 v137, a37
    s_waitcnt lgkmcnt(4)
    v_mfma_f32_16x16x32_bf16 v[188:191], a[200:203], a[184:187], 0
    ds_read_b64_tr_b16 a[216:217], v10 offset:6656
    v_accvgpr_read_b32 v138, a38
    v_mfma_f32_16x16x32_bf16 v[188:191], a[204:207], a[188:191], v[188:191]
    buffer_load_dwordx4 v19, s[56:59], s11 offen offset:2048 lds
    v_accvgpr_read_b32 v139, a39
    v_mfma_f32_16x16x32_bf16 v[184:187], a[204:207], a[180:183], 0
    ds_read_b64_tr_b16 a[218:219], v10 offset:27136
    v_accvgpr_read_b32 v140, a52
    v_mfma_f32_16x16x32_bf16 v[184:187], a[200:203], a[176:179], v[184:187]
    v_exp_f32 v50, v50
    v_mfma_f32_16x16x32_bf16 v[180:183], a[200:203], a[168:171], 0
    ds_read_b64_tr_b16 a[220:221], v10 offset:7680
    v_accvgpr_read_b32 v141, a53
    v_mfma_f32_16x16x32_bf16 v[180:183], a[204:207], a[172:175], v[180:183]
    buffer_load_dwordx4 v20, s[56:59], s11 offen offset:3072 lds
    v_accvgpr_read_b32 v142, a54
    v_mfma_f32_16x16x32_bf16 v[176:179], a[204:207], a[164:167], 0
    ds_read_b64_tr_b16 a[222:223], v10 offset:28160
    v_accvgpr_read_b32 v143, a55
    v_mfma_f32_16x16x32_bf16 v[176:179], a[200:203], a[160:163], v[176:179]
    v_exp_f32 v51, v51
    v_and_b32 v16, 3, v1
    v_lshlrev_b32 v16, 2, v16
    buffer_load_dword v16, v16, s[52:55], s73 offen offset:0 sc1
    s_waitcnt lgkmcnt(4)
    v_mfma_f32_16x16x32_bf16 v[208:211], a[208:211], a[160:163], 0
    ds_read_b64_tr_b16 a[192:193], v11 offset:4096
    s_add_u32 m0, s19, 4096
    v_mfma_f32_16x16x32_bf16 v[208:211], a[212:215], a[164:167], v[208:211]
    s_lshl_b32 s11, s82, 4
    v_add_f32 v50, 1.0, v50
    v_mfma_f32_16x16x32_bf16 v[212:215], a[212:215], a[172:175], 0
    ds_read_b64_tr_b16 a[194:195], v11 offset:24576
    v_add_f32 v51, 1.0, v51
    v_mfma_f32_16x16x32_bf16 v[212:215], a[208:211], a[168:171], v[212:215]
    buffer_load_dwordx4 v17, s[56:59], s11 offen offset:0 lds
    v_mul_f32 v40, s76, v40
    v_mfma_f32_16x16x32_bf16 v[216:219], a[208:211], a[176:179], 0
    ds_read_b64_tr_b16 a[196:197], v11 offset:5120
    v_mul_f32 v41, s76, v41
    v_mfma_f32_16x16x32_bf16 v[216:219], a[212:215], a[180:183], v[216:219]
    v_rcp_f32 v32, v32
    v_mfma_f32_16x16x32_bf16 v[220:223], a[212:215], a[188:191], 0
    ds_read_b64_tr_b16 a[198:199], v11 offset:25600
    v_mul_f32 v42, s76, v42
    v_mfma_f32_16x16x32_bf16 v[220:223], a[208:211], a[184:187], v[220:223]
    v_mul_f32 v43, s76, v43
    s_waitcnt lgkmcnt(4)
    v_mfma_f32_16x16x32_bf16 v[252:255], a[216:219], a[184:187], 0
    ds_read_b64_tr_b16 a[200:201], v12 offset:4096
    v_mul_f32 v56, s76, v56
    v_mfma_f32_16x16x32_bf16 v[252:255], a[220:223], a[188:191], v[252:255]
    buffer_load_dwordx4 v18, s[56:59], s11 offen offset:1024 lds
    v_mul_f32 v57, s76, v57
    v_mfma_f32_16x16x32_bf16 v[248:251], a[220:223], a[180:183], 0
    ds_read_b64_tr_b16 a[202:203], v12 offset:24576
    v_mul_f32 v58, s76, v58
    v_mfma_f32_16x16x32_bf16 v[248:251], a[216:219], a[176:179], v[248:251]
    v_rcp_f32 v33, v33
    v_mfma_f32_16x16x32_bf16 v[244:247], a[216:219], a[168:171], 0
    ds_read_b64_tr_b16 a[204:205], v12 offset:5120
    v_mul_f32 v32, v32, v128
    v_mfma_f32_16x16x32_bf16 v[244:247], a[220:223], a[172:175], v[244:247]
    buffer_load_dwordx4 v19, s[56:59], s11 offen offset:2048 lds
    v_mul_f32 v33, v33, v129
    v_mfma_f32_16x16x32_bf16 v[240:243], a[220:223], a[164:167], 0
    ds_read_b64_tr_b16 a[206:207], v12 offset:25600
    v_cvt_pk_bf16_f32 v32, v32, v33
    v_mfma_f32_16x16x32_bf16 v[240:243], a[216:219], a[160:163], v[240:243]
    v_mul_f32 v59, s76, v59
    s_waitcnt vmcnt(21) lgkmcnt(4)
    v_mfma_f32_16x16x32_bf16 v[64:67], a[192:195], a[128:131], v[64:67]
    ds_read_b64_tr_b16 a[208:209], v11 offset:4608
    v_rcp_f32 v34, v34
    v_mfma_f32_16x16x32_bf16 v[64:67], a[196:199], a[132:135], v[64:67]
    buffer_load_dwordx4 v20, s[56:59], s11 offen offset:3072 lds
    v_rcp_f32 v35, v35
    v_mfma_f32_16x16x32_bf16 v[68:71], a[196:199], a[140:143], v[68:71]
    ds_read_b64_tr_b16 a[210:211], v11 offset:25088
    v_mul_f32 v34, v34, v130
    v_mfma_f32_16x16x32_bf16 v[68:71], a[192:195], a[136:139], v[68:71]
    v_rcp_f32 v48, v48
    v_mfma_f32_16x16x32_bf16 v[72:75], a[192:195], a[144:147], v[72:75]
    ds_read_b64_tr_b16 a[212:213], v11 offset:5632
    v_mul_f32 v35, v35, v131
    v_mfma_f32_16x16x32_bf16 v[72:75], a[196:199], a[148:151], v[72:75]
    buffer_load_dwordx4 a[160:163], v3, s[44:47], s87 offen offset:0 sc1
    v_cvt_pk_bf16_f32 v33, v34, v35
    v_mfma_f32_16x16x32_bf16 v[76:79], a[196:199], a[156:159], v[76:79]
    ds_read_b64_tr_b16 a[214:215], v11 offset:26112
    v_rcp_f32 v49, v49
    v_mfma_f32_16x16x32_bf16 v[76:79], a[192:195], a[152:155], v[76:79]
    s_waitcnt vmcnt(48) lgkmcnt(4)
    s_barrier
    v_mfma_f32_16x16x32_bf16 v[92:95], a[200:203], a[152:155], v[92:95]
    ds_read_b64_tr_b16 a[216:217], v12 offset:4608
    v_mul_f32 v48, v48, v132
    v_mfma_f32_16x16x32_bf16 v[92:95], a[204:207], a[156:159], v[92:95]
    buffer_load_dwordx4 a[164:167], v3, s[44:47], s87 offen offset:1024 sc1
    v_mul_f32 v49, v49, v133
    v_mfma_f32_16x16x32_bf16 v[88:91], a[204:207], a[148:151], v[88:91]
    ds_read_b64_tr_b16 a[218:219], v12 offset:25088
    v_cvt_pk_bf16_f32 v34, v48, v49
    v_mfma_f32_16x16x32_bf16 v[88:91], a[200:203], a[144:147], v[88:91]
    v_rcp_f32 v50, v50
    v_mfma_f32_16x16x32_bf16 v[84:87], a[200:203], a[136:139], v[84:87]
    ds_read_b64_tr_b16 a[220:221], v12 offset:5632
    v_rcp_f32 v51, v51
    v_mfma_f32_16x16x32_bf16 v[84:87], a[204:207], a[140:143], v[84:87]
    buffer_load_dwordx4 a[168:171], v4, s[44:47], s87 offen offset:0 sc1
    v_mul_f32 v50, v50, v134
    v_mfma_f32_16x16x32_bf16 v[80:83], a[204:207], a[132:135], v[80:83]
    ds_read_b64_tr_b16 a[222:223], v12 offset:26112
    v_mul_f32 v51, v51, v135
    v_mfma_f32_16x16x32_bf16 v[80:83], a[200:203], a[128:131], v[80:83]
    v_cvt_pk_bf16_f32 v35, v50, v51
    s_waitcnt vmcnt(19)
    s_add_u32 s74, s66, 57408
    s_mov_b64 exec, 1
    buffer_store_dword v21, off, s[52:55], s74 sc1
    s_mov_b64 exec, -1
    s_waitcnt lgkmcnt(4)
    v_mfma_f32_16x16x32_bf16 v[96:99], a[208:211], a[128:131], v[96:99]
    ds_read_b64_tr_b16 a[192:193], v11 offset:6144
    v_exp_f32 v36, v36
    v_mfma_f32_16x16x32_bf16 v[96:99], a[212:215], a[132:135], v[96:99]
    buffer_load_dwordx4 a[172:175], v4, s[44:47], s87 offen offset:1024 sc1
    v_exp_f32 v37, v37
    v_mfma_f32_16x16x32_bf16 v[100:103], a[212:215], a[140:143], v[100:103]
    ds_read_b64_tr_b16 a[194:195], v11 offset:26624
    v_add_f32 v36, 1.0, v36
    v_mfma_f32_16x16x32_bf16 v[100:103], a[208:211], a[136:139], v[100:103]
    buffer_store_dwordx4 v[32:35], v3, s[44:47], s88 offen offset:0 sc1
    v_mfma_f32_16x16x32_bf16 v[104:107], a[208:211], a[144:147], v[104:107]
    ds_read_b64_tr_b16 a[196:197], v11 offset:7168
    v_add_f32 v37, 1.0, v37
    v_mfma_f32_16x16x32_bf16 v[104:107], a[212:215], a[148:151], v[104:107]
    buffer_load_dwordx4 a[176:179], v5, s[44:47], s87 offen offset:0 sc1
    v_accvgpr_read_b32 v160, a40
    v_mfma_f32_16x16x32_bf16 v[108:111], a[212:215], a[156:159], v[108:111]
    ds_read_b64_tr_b16 a[198:199], v11 offset:27648
    v_accvgpr_read_b32 v161, a41
    v_mfma_f32_16x16x32_bf16 v[108:111], a[208:211], a[152:155], v[108:111]
    v_accvgpr_read_b32 v162, a42
    s_waitcnt lgkmcnt(4)
    v_mfma_f32_16x16x32_bf16 v[124:127], a[216:219], a[152:155], v[124:127]
    ds_read_b64_tr_b16 a[200:201], v12 offset:6144
    v_accvgpr_read_b32 v163, a43
    v_mfma_f32_16x16x32_bf16 v[124:127], a[220:223], a[156:159], v[124:127]
    buffer_load_dwordx4 a[180:183], v5, s[44:47], s87 offen offset:1024 sc1
    v_accvgpr_read_b32 v164, a56
    v_mfma_f32_16x16x32_bf16 v[120:123], a[220:223], a[148:151], v[120:123]
    ds_read_b64_tr_b16 a[202:203], v12 offset:26624
    v_accvgpr_read_b32 v165, a57
    v_mfma_f32_16x16x32_bf16 v[120:123], a[216:219], a[144:147], v[120:123]
    v_exp_f32 v38, v38
    v_mfma_f32_16x16x32_bf16 v[116:119], a[216:219], a[136:139], v[116:119]
    ds_read_b64_tr_b16 a[204:205], v12 offset:7168
    v_accvgpr_read_b32 v166, a58
    v_mfma_f32_16x16x32_bf16 v[116:119], a[220:223], a[140:143], v[116:119]
    buffer_load_dwordx4 a[184:187], v6, s[44:47], s87 offen offset:0 sc1
    v_accvgpr_read_b32 v167, a59
    v_mfma_f32_16x16x32_bf16 v[112:115], a[220:223], a[132:135], v[112:115]
    ds_read_b64_tr_b16 a[206:207], v12 offset:27648
    v_exp_f32 v39, v39
    v_mfma_f32_16x16x32_bf16 v[112:115], a[216:219], a[128:131], v[112:115]
    v_add_f32 v38, 1.0, v38
    s_waitcnt lgkmcnt(4)
    v_mfma_f32_16x16x32_bf16 v[144:147], a[192:195], a[128:131], v[144:147]
    ds_read_b64_tr_b16 a[208:209], v11 offset:6656
    v_add_f32 v39, 1.0, v39
    v_mfma_f32_16x16x32_bf16 v[144:147], a[196:199], a[132:135], v[144:147]
    buffer_load_dwordx4 a[188:191], v6, s[44:47], s87 offen offset:1024 sc1
    v_exp_f32 v52, v52
    v_mfma_f32_16x16x32_bf16 v[148:151], a[196:199], a[140:143], v[148:151]
    ds_read_b64_tr_b16 a[210:211], v11 offset:27136
    v_exp_f32 v53, v53
    v_mfma_f32_16x16x32_bf16 v[148:151], a[192:195], a[136:139], v[148:151]
    v_exp_f32 v54, v54
    v_mfma_f32_16x16x32_bf16 v[152:155], a[192:195], a[144:147], v[152:155]
    ds_read_b64_tr_b16 a[212:213], v11 offset:7680
    s_add_u32 m0, s19, 40960
    v_mfma_f32_16x16x32_bf16 v[152:155], a[196:199], a[148:151], v[152:155]
    s_lshl_b32 s11, s84, 4
    v_add_f32 v52, 1.0, v52
    v_mfma_f32_16x16x32_bf16 v[156:159], a[196:199], a[156:159], v[156:159]
    ds_read_b64_tr_b16 a[214:215], v11 offset:28160
    v_add_f32 v53, 1.0, v53
    v_mfma_f32_16x16x32_bf16 v[156:159], a[192:195], a[152:155], v[156:159]
    v_exp_f32 v55, v55
    s_waitcnt lgkmcnt(4)
    v_mfma_f32_16x16x32_bf16 v[188:191], a[200:203], a[152:155], v[188:191]
    ds_read_b64_tr_b16 a[216:217], v12 offset:6656
    v_add_f32 v54, 1.0, v54
    v_mfma_f32_16x16x32_bf16 v[188:191], a[204:207], a[156:159], v[188:191]
    buffer_load_dwordx4 v17, s[56:59], s11 offen offset:0 lds
    v_add_f32 v55, 1.0, v55
    v_mfma_f32_16x16x32_bf16 v[184:187], a[204:207], a[148:151], v[184:187]
    ds_read_b64_tr_b16 a[218:219], v12 offset:27136
    v_mul_f32 v44, s76, v44
    v_mfma_f32_16x16x32_bf16 v[184:187], a[200:203], a[144:147], v[184:187]
    v_rcp_f32 v36, v36
    v_mfma_f32_16x16x32_bf16 v[180:183], a[200:203], a[136:139], v[180:183]
    ds_read_b64_tr_b16 a[220:221], v12 offset:7680
    v_mul_f32 v45, s76, v45
    v_mfma_f32_16x16x32_bf16 v[180:183], a[204:207], a[140:143], v[180:183]
    buffer_load_dwordx4 v18, s[56:59], s11 offen offset:1024 lds
    v_mul_f32 v46, s76, v46
    v_mfma_f32_16x16x32_bf16 v[176:179], a[204:207], a[132:135], v[176:179]
    ds_read_b64_tr_b16 a[222:223], v12 offset:28160
    v_mul_f32 v47, s76, v47
    v_mfma_f32_16x16x32_bf16 v[176:179], a[200:203], a[128:131], v[176:179]
    v_mul_f32 v60, s76, v60
    s_waitcnt vmcnt(16)
    v_cmp_ne_u32 vcc, s18, v16
    s_cbranch_vccnz L_pl2
L_pl2_b:
    s_waitcnt lgkmcnt(4)
    v_mfma_f32_16x16x32_bf16 v[208:211], a[208:211], a[128:131], v[208:211]
    ds_read_b64_tr_b16 a[192:193], v13 offset:4096
    v_mul_f32 v61, s76, v61
    v_mfma_f32_16x16x32_bf16 v[208:211], a[212:215], a[132:135], v[208:211]
    buffer_load_dwordx4 v19, s[56:59], s11 offen offset:2048 lds
    v_mul_f32 v62, s76, v62
    v_mfma_f32_16x16x32_bf16 v[212:215], a[212:215], a[140:143], v[212:215]
    ds_read_b64_tr_b16 a[194:195], v13 offset:24576
    v_mul_f32 v63, s76, v63
    v_mfma_f32_16x16x32_bf16 v[212:215], a[208:211], a[136:139], v[212:215]
    v_rcp_f32 v37, v37
    v_mfma_f32_16x16x32_bf16 v[216:219], a[208:211], a[144:147], v[216:219]
    ds_read_b64_tr_b16 a[196:197], v13 offset:5120
    v_mul_f32 v36, v36, v136
    v_mfma_f32_16x16x32_bf16 v[216:219], a[212:215], a[148:151], v[216:219]
    buffer_load_dwordx4 v20, s[56:59], s11 offen offset:3072 lds
    v_mul_f32 v37, v37, v137
    v_mfma_f32_16x16x32_bf16 v[220:223], a[212:215], a[156:159], v[220:223]
    ds_read_b64_tr_b16 a[198:199], v13 offset:25600
    v_cvt_pk_bf16_f32 v36, v36, v37
    v_mfma_f32_16x16x32_bf16 v[220:223], a[208:211], a[152:155], v[220:223]
    v_rcp_f32 v38, v38
    s_waitcnt lgkmcnt(4)
    v_mfma_f32_16x16x32_bf16 v[252:255], a[216:219], a[152:155], v[252:255]
    ds_read_b64_tr_b16 a[200:201], v14 offset:4096
    s_add_u32 m0, s19, 81920
    v_mfma_f32_16x16x32_bf16 v[252:255], a[220:223], a[156:159], v[252:255]
    s_lshl_b32 s11, s86, 4
    v_rcp_f32 v39, v39
    v_mfma_f32_16x16x32_bf16 v[248:251], a[220:223], a[148:151], v[248:251]
    ds_read_b64_tr_b16 a[202:203], v14 offset:24576
    v_mul_f32 v38, v38, v138
    v_mfma_f32_16x16x32_bf16 v[248:251], a[216:219], a[144:147], v[248:251]
    buffer_load_dwordx4 v17, s[56:59], s11 offen offset:0 lds
    v_mul_f32 v39, v39, v139
    v_mfma_f32_16x16x32_bf16 v[244:247], a[216:219], a[136:139], v[244:247]
    ds_read_b64_tr_b16 a[204:205], v14 offset:5120
    v_cvt_pk_bf16_f32 v37, v38, v39
    v_mfma_f32_16x16x32_bf16 v[244:247], a[220:223], a[140:143], v[244:247]
    v_rcp_f32 v52, v52
    v_mfma_f32_16x16x32_bf16 v[240:243], a[220:223], a[132:135], v[240:243]
    ds_read_b64_tr_b16 a[206:207], v14 offset:25600
    v_rcp_f32 v53, v53
    v_mfma_f32_16x16x32_bf16 v[240:243], a[216:219], a[128:131], v[240:243]
    v_mul_f32 v52, v52, v140
    s_waitcnt vmcnt(24) lgkmcnt(4)
    v_mfma_f32_16x16x32_bf16 v[64:67], a[192:195], a[96:99], v[64:67]
    ds_read_b64_tr_b16 a[208:209], v13 offset:4608
    v_mul_f32 v53, v53, v141
    v_mfma_f32_16x16x32_bf16 v[64:67], a[196:199], a[100:103], v[64:67]
    buffer_load_dwordx4 v18, s[56:59], s11 offen offset:1024 lds
    v_cvt_pk_bf16_f32 v38, v52, v53
    v_mfma_f32_16x16x32_bf16 v[68:71], a[196:199], a[108:111], v[68:71]
    ds_read_b64_tr_b16 a[210:211], v13 offset:25088
    v_rcp_f32 v54, v54
    v_mfma_f32_16x16x32_bf16 v[68:71], a[192:195], a[104:107], v[68:71]
    v_rcp_f32 v55, v55
    v_mfma_f32_16x16x32_bf16 v[72:75], a[192:195], a[112:115], v[72:75]
    ds_read_b64_tr_b16 a[212:213], v13 offset:5632
    v_mul_f32 v54, v54, v142
    v_mfma_f32_16x16x32_bf16 v[72:75], a[196:199], a[116:119], v[72:75]
    buffer_load_dwordx4 v19, s[56:59], s11 offen offset:2048 lds
    v_mul_f32 v55, v55, v143
    v_mfma_f32_16x16x32_bf16 v[76:79], a[196:199], a[124:127], v[76:79]
    ds_read_b64_tr_b16 a[214:215], v13 offset:26112
    v_cvt_pk_bf16_f32 v39, v54, v55
    v_mfma_f32_16x16x32_bf16 v[76:79], a[192:195], a[120:123], v[76:79]
    s_waitcnt vmcnt(59) lgkmcnt(4)
    s_barrier
    v_mfma_f32_16x16x32_bf16 v[92:95], a[200:203], a[120:123], v[92:95]
    ds_read_b64_tr_b16 a[216:217], v14 offset:4608
    v_exp_f32 v40, v40
    v_mfma_f32_16x16x32_bf16 v[92:95], a[204:207], a[124:127], v[92:95]
    buffer_load_dwordx4 v20, s[56:59], s11 offen offset:3072 lds
    v_exp_f32 v41, v41
    v_mfma_f32_16x16x32_bf16 v[88:91], a[204:207], a[116:119], v[88:91]
    ds_read_b64_tr_b16 a[218:219], v14 offset:25088
    v_add_f32 v40, 1.0, v40
    v_mfma_f32_16x16x32_bf16 v[88:91], a[200:203], a[112:115], v[88:91]
    buffer_store_dwordx4 v[36:39], v4, s[44:47], s88 offen offset:0 sc1
    v_mfma_f32_16x16x32_bf16 v[84:87], a[200:203], a[104:107], v[84:87]
    ds_read_b64_tr_b16 a[220:221], v14 offset:5632
    v_add_f32 v41, 1.0, v41
    v_mfma_f32_16x16x32_bf16 v[84:87], a[204:207], a[108:111], v[84:87]
    buffer_load_dwordx4 a[128:131], v3, s[44:47], s80 offen offset:0 sc1
    v_accvgpr_read_b32 v168, a44
    v_mfma_f32_16x16x32_bf16 v[80:83], a[204:207], a[100:103], v[80:83]
    ds_read_b64_tr_b16 a[222:223], v14 offset:26112
    v_accvgpr_read_b32 v169, a45
    v_mfma_f32_16x16x32_bf16 v[80:83], a[200:203], a[96:99], v[80:83]
    v_accvgpr_read_b32 v170, a46
    s_waitcnt lgkmcnt(4)
    v_mfma_f32_16x16x32_bf16 v[96:99], a[208:211], a[96:99], v[96:99]
    ds_read_b64_tr_b16 a[192:193], v13 offset:6144
    v_accvgpr_read_b32 v171, a47
    v_mfma_f32_16x16x32_bf16 v[96:99], a[212:215], a[100:103], v[96:99]
    buffer_load_dwordx4 a[132:135], v3, s[44:47], s80 offen offset:1024 sc1
    v_accvgpr_read_b32 v172, a60
    v_mfma_f32_16x16x32_bf16 v[100:103], a[212:215], a[108:111], v[100:103]
    ds_read_b64_tr_b16 a[194:195], v13 offset:26624
    v_accvgpr_read_b32 v173, a61
    v_mfma_f32_16x16x32_bf16 v[100:103], a[208:211], a[104:107], v[100:103]
    v_exp_f32 v42, v42
    v_mfma_f32_16x16x32_bf16 v[104:107], a[208:211], a[112:115], v[104:107]
    ds_read_b64_tr_b16 a[196:197], v13 offset:7168
    v_accvgpr_read_b32 v174, a62
    v_mfma_f32_16x16x32_bf16 v[104:107], a[212:215], a[116:119], v[104:107]
    buffer_load_dwordx4 a[136:139], v4, s[44:47], s80 offen offset:0 sc1
    v_accvgpr_read_b32 v175, a63
    v_mfma_f32_16x16x32_bf16 v[108:111], a[212:215], a[124:127], v[108:111]
    ds_read_b64_tr_b16 a[198:199], v13 offset:27648
    v_exp_f32 v43, v43
    v_mfma_f32_16x16x32_bf16 v[108:111], a[208:211], a[120:123], v[108:111]
    v_add_f32 v42, 1.0, v42
    s_waitcnt lgkmcnt(4)
    v_mfma_f32_16x16x32_bf16 v[124:127], a[216:219], a[120:123], v[124:127]
    ds_read_b64_tr_b16 a[200:201], v14 offset:6144
    v_add_f32 v43, 1.0, v43
    v_mfma_f32_16x16x32_bf16 v[124:127], a[220:223], a[124:127], v[124:127]
    buffer_load_dwordx4 a[140:143], v4, s[44:47], s80 offen offset:1024 sc1
    v_exp_f32 v56, v56
    v_mfma_f32_16x16x32_bf16 v[120:123], a[220:223], a[116:119], v[120:123]
    ds_read_b64_tr_b16 a[202:203], v14 offset:26624
    v_exp_f32 v57, v57
    v_mfma_f32_16x16x32_bf16 v[120:123], a[216:219], a[112:115], v[120:123]
    v_exp_f32 v58, v58
    v_mfma_f32_16x16x32_bf16 v[116:119], a[216:219], a[104:107], v[116:119]
    ds_read_b64_tr_b16 a[204:205], v14 offset:7168
    v_add_f32 v56, 1.0, v56
    v_mfma_f32_16x16x32_bf16 v[116:119], a[220:223], a[108:111], v[116:119]
    buffer_load_dwordx4 a[144:147], v5, s[44:47], s80 offen offset:0 sc1
    v_add_f32 v57, 1.0, v57
    v_mfma_f32_16x16x32_bf16 v[112:115], a[220:223], a[100:103], v[112:115]
    ds_read_b64_tr_b16 a[206:207], v14 offset:27648
    v_exp_f32 v59, v59
    v_mfma_f32_16x16x32_bf16 v[112:115], a[216:219], a[96:99], v[112:115]
    v_add_f32 v58, 1.0, v58
    s_waitcnt lgkmcnt(4)
    v_mfma_f32_16x16x32_bf16 v[144:147], a[192:195], a[96:99], v[144:147]
    ds_read_b64_tr_b16 a[208:209], v13 offset:6656
    v_add_f32 v59, 1.0, v59
    v_mfma_f32_16x16x32_bf16 v[144:147], a[196:199], a[100:103], v[144:147]
    buffer_load_dwordx4 a[148:151], v5, s[44:47], s80 offen offset:1024 sc1
    v_rcp_f32 v40, v40
    v_mfma_f32_16x16x32_bf16 v[148:151], a[196:199], a[108:111], v[148:151]
    ds_read_b64_tr_b16 a[210:211], v13 offset:27136
    v_rcp_f32 v41, v41
    v_mfma_f32_16x16x32_bf16 v[148:151], a[192:195], a[104:107], v[148:151]
    v_rcp_f32 v42, v42
    v_mfma_f32_16x16x32_bf16 v[152:155], a[192:195], a[112:115], v[152:155]
    ds_read_b64_tr_b16 a[212:213], v13 offset:7680
    v_mul_f32 v40, v40, v160
    v_mfma_f32_16x16x32_bf16 v[152:155], a[196:199], a[116:119], v[152:155]
    buffer_load_dwordx4 a[152:155], v6, s[44:47], s80 offen offset:0 sc1
    v_mul_f32 v41, v41, v161
    v_mfma_f32_16x16x32_bf16 v[156:159], a[196:199], a[124:127], v[156:159]
    ds_read_b64_tr_b16 a[214:215], v13 offset:28160
    v_cvt_pk_bf16_f32 v40, v40, v41
    v_mfma_f32_16x16x32_bf16 v[156:159], a[192:195], a[120:123], v[156:159]
    v_rcp_f32 v43, v43
    s_waitcnt lgkmcnt(4)
    v_mfma_f32_16x16x32_bf16 v[188:191], a[200:203], a[120:123], v[188:191]
    ds_read_b64_tr_b16 a[216:217], v14 offset:6656
    v_mul_f32 v42, v42, v162
    v_mfma_f32_16x16x32_bf16 v[188:191], a[204:207], a[124:127], v[188:191]
    buffer_load_dwordx4 a[156:159], v6, s[44:47], s80 offen offset:1024 sc1
    v_mul_f32 v43, v43, v163
    v_mfma_f32_16x16x32_bf16 v[184:187], a[204:207], a[116:119], v[184:187]
    ds_read_b64_tr_b16 a[218:219], v14 offset:27136
    v_cvt_pk_bf16_f32 v41, v42, v43
    v_mfma_f32_16x16x32_bf16 v[184:187], a[200:203], a[112:115], v[184:187]
    v_rcp_f32 v56, v56
    v_mfma_f32_16x16x32_bf16 v[180:183], a[200:203], a[104:107], v[180:183]
    ds_read_b64_tr_b16 a[220:221], v14 offset:7680
    s_add_u32 m0, s19, 122880
    v_mfma_f32_16x16x32_bf16 v[180:183], a[204:207], a[108:111], v[180:183]
    s_lshl_b32 s11, s92, 4
    v_rcp_f32 v57, v57
    v_mfma_f32_16x16x32_bf16 v[176:179], a[204:207], a[100:103], v[176:179]
    ds_read_b64_tr_b16 a[222:223], v14 offset:28160
    v_mul_f32 v56, v56, v164
    v_mfma_f32_16x16x32_bf16 v[176:179], a[200:203], a[96:99], v[176:179]
    v_mul_f32 v57, v57, v165
    s_waitcnt lgkmcnt(4)
    v_mfma_f32_16x16x32_bf16 v[208:211], a[208:211], a[96:99], v[208:211]
    ds_read_b64_tr_b16 a[192:193], v7 offset:8192
    v_cvt_pk_bf16_f32 v42, v56, v57
    v_mfma_f32_16x16x32_bf16 v[208:211], a[212:215], a[100:103], v[208:211]
    buffer_load_dwordx4 v17, s[56:59], s11 offen offset:0 lds
    v_rcp_f32 v58, v58
    v_mfma_f32_16x16x32_bf16 v[212:215], a[212:215], a[108:111], v[212:215]
    ds_read_b64_tr_b16 a[194:195], v7 offset:28672
    v_rcp_f32 v59, v59
    v_mfma_f32_16x16x32_bf16 v[212:215], a[208:211], a[104:107], v[212:215]
    v_exp_f32 v44, v44
    v_mfma_f32_16x16x32_bf16 v[216:219], a[208:211], a[112:115], v[216:219]
    ds_read_b64_tr_b16 a[196:197], v7 offset:9216
    v_mul_f32 v58, v58, v166
    v_mfma_f32_16x16x32_bf16 v[216:219], a[212:215], a[116:119], v[216:219]
    buffer_load_dwordx4 v18, s[56:59], s11 offen offset:1024 lds
    v_mul_f32 v59, v59, v167
    v_mfma_f32_16x16x32_bf16 v[220:223], a[212:215], a[124:127], v[220:223]
    ds_read_b64_tr_b16 a[198:199], v7 offset:29696
    v_cvt_pk_bf16_f32 v43, v58, v59
    v_mfma_f32_16x16x32_bf16 v[220:223], a[208:211], a[120:123], v[220:223]
    v_exp_f32 v45, v45
    s_waitcnt lgkmcnt(4)
    v_mfma_f32_16x16x32_bf16 v[252:255], a[216:219], a[120:123], v[252:255]
    ds_read_b64_tr_b16 a[200:201], v8 offset:8192
    v_add_f32 v44, 1.0, v44
    v_mfma_f32_16x16x32_bf16 v[252:255], a[220:223], a[124:127], v[252:255]
    buffer_load_dwordx4 v19, s[56:59], s11 offen offset:2048 lds
    v_add_f32 v45, 1.0, v45
    v_mfma_f32_16x16x32_bf16 v[248:251], a[220:223], a[116:119], v[248:251]
    ds_read_b64_tr_b16 a[202:203], v8 offset:28672
    v_exp_f32 v46, v46
    v_mfma_f32_16x16x32_bf16 v[248:251], a[216:219], a[112:115], v[248:251]
    buffer_store_dwordx4 v[40:43], v5, s[44:47], s88 offen offset:0 sc1
    v_mfma_f32_16x16x32_bf16 v[244:247], a[216:219], a[104:107], v[244:247]
    ds_read_b64_tr_b16 a[204:205], v8 offset:9216
    v_exp_f32 v47, v47
    v_mfma_f32_16x16x32_bf16 v[244:247], a[220:223], a[108:111], v[244:247]
    buffer_load_dwordx4 v20, s[56:59], s11 offen offset:3072 lds
    v_add_f32 v46, 1.0, v46
    v_mfma_f32_16x16x32_bf16 v[240:243], a[220:223], a[100:103], v[240:243]
    ds_read_b64_tr_b16 a[206:207], v8 offset:29696
    v_add_f32 v47, 1.0, v47
    v_mfma_f32_16x16x32_bf16 v[240:243], a[216:219], a[96:99], v[240:243]
    v_exp_f32 v60, v60
    v_and_b32 v16, 3, v1
    v_lshlrev_b32 v16, 2, v16
    buffer_load_dword v16, v16, s[52:55], s73 offen offset:64 sc1
    s_waitcnt vmcnt(23) lgkmcnt(4)
    v_mfma_f32_16x16x32_bf16 v[64:67], a[192:195], a[160:163], v[64:67]
    ds_read_b64_tr_b16 a[208:209], v7 offset:8704
    v_exp_f32 v61, v61
    v_mfma_f32_16x16x32_bf16 v[64:67], a[196:199], a[164:167], v[64:67]
    buffer_load_dwordx4 a[96:99], v3, s[44:47], s82 offen offset:0 sc1
    v_add_f32 v60, 1.0, v60
    v_mfma_f32_16x16x32_bf16 v[68:71], a[196:199], a[172:175], v[68:71]
    ds_read_b64_tr_b16 a[210:211], v7 offset:29184
    v_add_f32 v61, 1.0, v61
    v_mfma_f32_16x16x32_bf16 v[68:71], a[192:195], a[168:171], v[68:71]
    v_exp_f32 v62, v62
    v_mfma_f32_16x16x32_bf16 v[72:75], a[192:195], a[176:179], v[72:75]
    ds_read_b64_tr_b16 a[212:213], v7 offset:9728
    v_exp_f32 v63, v63
    v_mfma_f32_16x16x32_bf16 v[72:75], a[196:199], a[180:183], v[72:75]
    buffer_load_dwordx4 a[100:103], v3, s[44:47], s82 offen offset:1024 sc1
    v_add_f32 v62, 1.0, v62
    v_mfma_f32_16x16x32_bf16 v[76:79], a[196:199], a[188:191], v[76:79]
    ds_read_b64_tr_b16 a[214:215], v7 offset:30208
    v_add_f32 v63, 1.0, v63
    v_mfma_f32_16x16x32_bf16 v[76:79], a[192:195], a[184:187], v[76:79]
    s_waitcnt vmcnt(40) lgkmcnt(4)
    s_barrier
    v_mfma_f32_16x16x32_bf16 v[92:95], a[200:203], a[184:187], v[92:95]
    ds_read_b64_tr_b16 a[216:217], v8 offset:8704
    v_rcp_f32 v44, v44
    v_mfma_f32_16x16x32_bf16 v[92:95], a[204:207], a[188:191], v[92:95]
    buffer_load_dwordx4 a[104:107], v4, s[44:47], s82 offen offset:0 sc1
    v_rcp_f32 v45, v45
    v_mfma_f32_16x16x32_bf16 v[88:91], a[204:207], a[180:183], v[88:91]
    ds_read_b64_tr_b16 a[218:219], v8 offset:29184
    v_mul_f32 v44, v44, v168
    v_mfma_f32_16x16x32_bf16 v[88:91], a[200:203], a[176:179], v[88:91]
    v_rcp_f32 v46, v46
    v_mfma_f32_16x16x32_bf16 v[84:87], a[200:203], a[168:171], v[84:87]
    ds_read_b64_tr_b16 a[220:221], v8 offset:9728
    v_mul_f32 v45, v45, v169
    v_mfma_f32_16x16x32_bf16 v[84:87], a[204:207], a[172:175], v[84:87]
    buffer_load_dwordx4 a[108:111], v4, s[44:47], s82 offen offset:1024 sc1
    v_cvt_pk_bf16_f32 v44, v44, v45
    v_mfma_f32_16x16x32_bf16 v[80:83], a[204:207], a[164:167], v[80:83]
    ds_read_b64_tr_b16 a[222:223], v8 offset:30208
    v_rcp_f32 v47, v47
    v_mfma_f32_16x16x32_bf16 v[80:83], a[200:203], a[160:163], v[80:83]
    v_mul_f32 v46, v46, v170
    s_waitcnt lgkmcnt(4)
    v_mfma_f32_16x16x32_bf16 v[96:99], a[208:211], a[160:163], v[96:99]
    ds_read_b64_tr_b16 a[192:193], v9 offset:8192
    v_mul_f32 v47, v47, v171
    v_mfma_f32_16x16x32_bf16 v[96:99], a[212:215], a[164:167], v[96:99]
    buffer_load_dwordx4 a[112:115], v5, s[44:47], s82 offen offset:0 sc1
    v_cvt_pk_bf16_f32 v45, v46, v47
    v_mfma_f32_16x16x32_bf16 v[100:103], a[212:215], a[172:175], v[100:103]
    ds_read_b64_tr_b16 a[194:195], v9 offset:28672
    v_rcp_f32 v60, v60
    v_mfma_f32_16x16x32_bf16 v[100:103], a[208:211], a[168:171], v[100:103]
    v_rcp_f32 v61, v61
    v_mfma_f32_16x16x32_bf16 v[104:107], a[208:211], a[176:179], v[104:107]
    ds_read_b64_tr_b16 a[196:197], v9 offset:9216
    v_mul_f32 v60, v60, v172
    v_mfma_f32_16x16x32_bf16 v[104:107], a[212:215], a[180:183], v[104:107]
    buffer_load_dwordx4 a[116:119], v5, s[44:47], s82 offen offset:1024 sc1
    v_mul_f32 v61, v61, v173
    v_mfma_f32_16x16x32_bf16 v[108:111], a[212:215], a[188:191], v[108:111]
    ds_read_b64_tr_b16 a[198:199], v9 offset:29696
    v_cvt_pk_bf16_f32 v46, v60, v61
    v_mfma_f32_16x16x32_bf16 v[108:111], a[208:211], a[184:187], v[108:111]
    v_rcp_f32 v62, v62
    s_waitcnt lgkmcnt(4)
    v_mfma_f32_16x16x32_bf16 v[124:127], a[216:219], a[184:187], v[124:127]
    ds_read_b64_tr_b16 a[200:201], v10 offset:8192
    v_rcp_f32 v63, v63
    v_mfma_f32_16x16x32_bf16 v[124:127], a[220:223], a[188:191], v[124:127]
    buffer_load_dwordx4 a[120:123], v6, s[44:47], s82 offen offset:0 sc1
    v_mul_f32 v62, v62, v174
    v_mfma_f32_16x16x32_bf16 v[120:123], a[220:223], a[180:183], v[120:123]
    ds_read_b64_tr_b16 a[202:203], v10 offset:28672
    v_mul_f32 v63, v63, v175
    v_mfma_f32_16x16x32_bf16 v[120:123], a[216:219], a[176:179], v[120:123]
    v_cvt_pk_bf16_f32 v47, v62, v63
    v_mfma_f32_16x16x32_bf16 v[116:119], a[216:219], a[168:171], v[116:119]
    ds_read_b64_tr_b16 a[204:205], v10 offset:9216
    v_mfma_f32_16x16x32_bf16 v[116:119], a[220:223], a[172:175], v[116:119]
    buffer_load_dwordx4 a[124:127], v6, s[44:47], s82 offen offset:1024 sc1
    v_mfma_f32_16x16x32_bf16 v[112:115], a[220:223], a[164:167], v[112:115]
    ds_read_b64_tr_b16 a[206:207], v10 offset:29696
    v_mfma_f32_16x16x32_bf16 v[112:115], a[216:219], a[160:163], v[112:115]
    s_waitcnt lgkmcnt(4)
    v_mfma_f32_16x16x32_bf16 v[144:147], a[192:195], a[160:163], v[144:147]
    ds_read_b64_tr_b16 a[208:209], v9 offset:8704
    s_add_u32 m0, s19, 45056
    v_mfma_f32_16x16x32_bf16 v[144:147], a[196:199], a[164:167], v[144:147]
    s_lshl_b32 s11, s93, 4
    v_mfma_f32_16x16x32_bf16 v[148:151], a[196:199], a[172:175], v[148:151]
    ds_read_b64_tr_b16 a[210:211], v9 offset:29184
    v_mfma_f32_16x16x32_bf16 v[148:151], a[192:195], a[168:171], v[148:151]
    buffer_load_dwordx4 v17, s[56:59], s11 offen offset:0 lds
    v_mfma_f32_16x16x32_bf16 v[152:155], a[192:195], a[176:179], v[152:155]
    ds_read_b64_tr_b16 a[212:213], v9 offset:9728
    v_mfma_f32_16x16x32_bf16 v[152:155], a[196:199], a[180:183], v[152:155]
    buffer_store_dwordx4 v[44:47], v6, s[44:47], s88 offen offset:0 sc1
    v_mfma_f32_16x16x32_bf16 v[156:159], a[196:199], a[188:191], v[156:159]
    ds_read_b64_tr_b16 a[214:215], v9 offset:30208
    v_accvgpr_read_b32 v128, a0
    v_mfma_f32_16x16x32_bf16 v[156:159], a[192:195], a[184:187], v[156:159]
    v_accvgpr_read_b32 v129, a1
    s_waitcnt lgkmcnt(4)
    v_mfma_f32_16x16x32_bf16 v[188:191], a[200:203], a[184:187], v[188:191]
    ds_read_b64_tr_b16 a[216:217], v10 offset:8704
    v_accvgpr_read_b32 v130, a2
    v_mfma_f32_16x16x32_bf16 v[188:191], a[204:207], a[188:191], v[188:191]
    buffer_load_dwordx4 v18, s[56:59], s11 offen offset:1024 lds
    v_accvgpr_read_b32 v131, a3
    v_mfma_f32_16x16x32_bf16 v[184:187], a[204:207], a[180:183], v[184:187]
    ds_read_b64_tr_b16 a[218:219], v10 offset:29184
    v_accvgpr_read_b32 v132, a16
    v_mfma_f32_16x16x32_bf16 v[184:187], a[200:203], a[176:179], v[184:187]
    v_accvgpr_read_b32 v133, a17
    v_accvgpr_read_b32 v134, a18
    v_mfma_f32_16x16x32_bf16 v[180:183], a[200:203], a[168:171], v[180:183]
    ds_read_b64_tr_b16 a[220:221], v10 offset:9728
    v_accvgpr_read_b32 v135, a19
    v_mfma_f32_16x16x32_bf16 v[180:183], a[204:207], a[172:175], v[180:183]
    buffer_load_dwordx4 v19, s[56:59], s11 offen offset:2048 lds
    v_mul_f32 v128, s76, v128
    v_mfma_f32_16x16x32_bf16 v[176:179], a[204:207], a[164:167], v[176:179]
    ds_read_b64_tr_b16 a[222:223], v10 offset:30208
    v_mul_f32 v129, s76, v129
    v_mfma_f32_16x16x32_bf16 v[176:179], a[200:203], a[160:163], v[176:179]
    v_mul_f32 v130, s76, v130
    s_waitcnt lgkmcnt(4)
    v_mfma_f32_16x16x32_bf16 v[208:211], a[208:211], a[160:163], v[208:211]
    ds_read_b64_tr_b16 a[192:193], v7 offset:0
    v_mul_f32 v131, s76, v131
    v_mfma_f32_16x16x32_bf16 v[208:211], a[212:215], a[164:167], v[208:211]
    buffer_load_dwordx4 v20, s[56:59], s11 offen offset:3072 lds
    v_mul_f32 v132, s76, v132
    v_mfma_f32_16x16x32_bf16 v[212:215], a[212:215], a[172:175], v[212:215]
    ds_read_b64_tr_b16 a[194:195], v7 offset:20480
    v_mul_f32 v133, s76, v133
    v_mfma_f32_16x16x32_bf16 v[212:215], a[208:211], a[168:171], v[212:215]
    v_exp_f32 v128, v128
    v_mfma_f32_16x16x32_bf16 v[216:219], a[208:211], a[176:179], v[216:219]
    ds_read_b64_tr_b16 a[196:197], v7 offset:1024
    v_mul_f32 v134, s76, v134
    v_mfma_f32_16x16x32_bf16 v[216:219], a[212:215], a[180:183], v[216:219]
    buffer_load_dwordx4 a[32:35], v3, s[44:47], s84 offen offset:0 sc1
    v_mul_f32 v135, s76, v135
    v_mfma_f32_16x16x32_bf16 v[220:223], a[212:215], a[188:191], v[220:223]
    ds_read_b64_tr_b16 a[198:199], v7 offset:21504
    v_accvgpr_read_b32 v136, a64
    v_mfma_f32_16x16x32_bf16 v[220:223], a[208:211], a[184:187], v[220:223]
    v_accvgpr_read_b32 v137, a65
    s_waitcnt lgkmcnt(4)
    v_mfma_f32_16x16x32_bf16 v[252:255], a[216:219], a[184:187], v[252:255]
    ds_read_b64_tr_b16 a[200:201], v8 offset:0
    v_accvgpr_read_b32 v138, a66
    v_mfma_f32_16x16x32_bf16 v[252:255], a[220:223], a[188:191], v[252:255]
    buffer_load_dwordx4 a[36:39], v3, s[44:47], s84 offen offset:1024 sc1
    v_accvgpr_read_b32 v139, a67
    v_mfma_f32_16x16x32_bf16 v[248:251], a[220:223], a[180:183], v[248:251]
    ds_read_b64_tr_b16 a[202:203], v8 offset:20480
    v_accvgpr_read_b32 v140, a80
    v_mfma_f32_16x16x32_bf16 v[248:251], a[216:219], a[176:179], v[248:251]
    v_exp_f32 v129, v129
    v_mfma_f32_16x16x32_bf16 v[244:247], a[216:219], a[168:171], v[244:247]
    ds_read_b64_tr_b16 a[204:205], v8 offset:1024
    v_add_f32 v128, 1.0, v128
    v_mfma_f32_16x16x32_bf16 v[244:247], a[220:223], a[172:175], v[244:247]
    buffer_load_dwordx4 a[40:43], v4, s[44:47], s84 offen offset:0 sc1
    v_add_f32 v129, 1.0, v129
    v_mfma_f32_16x16x32_bf16 v[240:243], a[220:223], a[164:167], v[240:243]
    ds_read_b64_tr_b16 a[206:207], v8 offset:21504
    v_accvgpr_read_b32 v141, a81
    v_mfma_f32_16x16x32_bf16 v[240:243], a[216:219], a[160:163], v[240:243]
    v_accvgpr_read_b32 v142, a82
    s_waitcnt vmcnt(16)
    v_cmp_ne_u32 vcc, s18, v16
    s_cbranch_vccnz L_pl3
L_pl3_b:
    s_waitcnt vmcnt(22) lgkmcnt(4)
    v_mfma_f32_16x16x32_bf16 v[64:67], a[192:195], a[128:131], v[64:67]
    ds_read_b64_tr_b16 a[208:209], v7 offset:512
    v_accvgpr_read_b32 v143, a83
    v_mfma_f32_16x16x32_bf16 v[64:67], a[196:199], a[132:135], v[64:67]
    buffer_load_dwordx4 a[44:47], v4, s[44:47], s84 offen offset:1024 sc1
    v_accvgpr_read_b32 v160, a4
    v_mfma_f32_16x16x32_bf16 v[68:71], a[196:199], a[140:143], v[68:71]
    ds_read_b64_tr_b16 a[210:211], v7 offset:20992
    v_accvgpr_read_b32 v161, a5
    v_mfma_f32_16x16x32_bf16 v[68:71], a[192:195], a[136:139], v[68:71]
    v_exp_f32 v130, v130
    v_mfma_f32_16x16x32_bf16 v[72:75], a[192:195], a[144:147], v[72:75]
    ds_read_b64_tr_b16 a[212:213], v7 offset:1536
    v_accvgpr_read_b32 v162, a6
    v_mfma_f32_16x16x32_bf16 v[72:75], a[196:199], a[148:151], v[72:75]
    buffer_load_dwordx4 a[48:51], v5, s[44:47], s84 offen offset:0 sc1
    v_accvgpr_read_b32 v163, a7
    v_mfma_f32_16x16x32_bf16 v[76:79], a[196:199], a[156:159], v[76:79]
    ds_read_b64_tr_b16 a[214:215], v7 offset:22016
    v_accvgpr_read_b32 v164, a20
    v_mfma_f32_16x16x32_bf16 v[76:79], a[192:195], a[152:155], v[76:79]
    s_waitcnt vmcnt(51) lgkmcnt(4)
    s_barrier
    v_mfma_f32_16x16x32_bf16 v[92:95], a[200:203], a[152:155], v[92:95]
    ds_read_b64_tr_b16 a[216:217], v8 offset:512
    v_accvgpr_read_b32 v165, a21
    v_mfma_f32_16x16x32_bf16 v[92:95], a[204:207], a[156:159], v[92:95]
    buffer_load_dwordx4 a[52:55], v5, s[44:47], s84 offen offset:1024 sc1
    v_accvgpr_read_b32 v166, a22
    v_mfma_f32_16x16x32_bf16 v[88:91], a[204:207], a[148:151], v[88:91]
    ds_read_b64_tr_b16 a[218:219], v8 offset:20992
    v_accvgpr_read_b32 v167, a23
    v_mfma_f32_16x16x32_bf16 v[88:91], a[200:203], a[144:147], v[88:91]
    v_exp_f32 v131, v131
    v_mfma_f32_16x16x32_bf16 v[84:87], a[200:203], a[136:139], v[84:87]
    ds_read_b64_tr_b16 a[220:221], v8 offset:1536
    v_add_f32 v130, 1.0, v130
    v_mfma_f32_16x16x32_bf16 v[84:87], a[204:207], a[140:143], v[84:87]
    buffer_load_dwordx4 a[56:59], v6, s[44:47], s84 offen offset:0 sc1
    v_add_f32 v131, 1.0, v131
    v_mfma_f32_16x16x32_bf16 v[80:83], a[204:207], a[132:135], v[80:83]
    ds_read_b64_tr_b16 a[222:223], v8 offset:22016
    v_mul_f32 v160, s76, v160
    v_mfma_f32_16x16x32_bf16 v[80:83], a[200:203], a[128:131], v[80:83]
    v_mul_f32 v161, s76, v161
    s_waitcnt lgkmcnt(4)
    v_mfma_f32_16x16x32_bf16 v[96:99], a[208:211], a[128:131], v[96:99]
    ds_read_b64_tr_b16 a[192:193], v7 offset:2048
    v_mul_f32 v162, s76, v162
    v_mfma_f32_16x16x32_bf16 v[96:99], a[212:215], a[132:135], v[96:99]
    buffer_load_dwordx4 a[60:63], v6, s[44:47], s84 offen offset:1024 sc1
    v_mul_f32 v163, s76, v163
    v_mfma_f32_16x16x32_bf16 v[100:103], a[212:215], a[140:143], v[100:103]
    ds_read_b64_tr_b16 a[194:195], v7 offset:22528
    v_mul_f32 v164, s76, v164
    v_mfma_f32_16x16x32_bf16 v[100:103], a[208:211], a[136:139], v[100:103]
    v_exp_f32 v132, v132
    v_mfma_f32_16x16x32_bf16 v[104:107], a[208:211], a[144:147], v[104:107]
    ds_read_b64_tr_b16 a[196:197], v7 offset:3072
    v_mul_f32 v165, s76, v165
    v_mfma_f32_16x16x32_bf16 v[104:107], a[212:215], a[148:151], v[104:107]
    buffer_load_dwordx4 a[160:163], v3, s[44:47], s86 offen offset:0 sc1
    v_mul_f32 v166, s76, v166
    v_mfma_f32_16x16x32_bf16 v[108:111], a[212:215], a[156:159], v[108:111]
    ds_read_b64_tr_b16 a[198:199], v7 offset:23552
    v_mul_f32 v167, s76, v167
    v_mfma_f32_16x16x32_bf16 v[108:111], a[208:211], a[152:155], v[108:111]
    v_accvgpr_read_b32 v168, a68
    s_waitcnt lgkmcnt(4)
    v_mfma_f32_16x16x32_bf16 v[124:127], a[216:219], a[152:155], v[124:127]
    ds_read_b64_tr_b16 a[200:201], v8 offset:2048
    v_accvgpr_read_b32 v169, a69
    v_mfma_f32_16x16x32_bf16 v[124:127], a[220:223], a[156:159], v[124:127]
    buffer_load_dwordx4 a[164:167], v3, s[44:47], s86 offen offset:1024 sc1
    v_accvgpr_read_b32 v170, a70
    v_mfma_f32_16x16x32_bf16 v[120:123], a[220:223], a[148:151], v[120:123]
    ds_read_b64_tr_b16 a[202:203], v8 offset:22528
    v_accvgpr_read_b32 v171, a71
    v_mfma_f32_16x16x32_bf16 v[120:123], a[216:219], a[144:147], v[120:123]
    v_exp_f32 v133, v133
    v_mfma_f32_16x16x32_bf16 v[116:119], a[216:219], a[136:139], v[116:119]
    ds_read_b64_tr_b16 a[204:205], v8 offset:3072
    v_add_f32 v132, 1.0, v132
    v_mfma_f32_16x16x32_bf16 v[116:119], a[220:223], a[140:143], v[116:119]
    buffer_load_dwordx4 a[168:171], v4, s[44:47], s86 offen offset:0 sc1
    v_add_f32 v133, 1.0, v133
    v_mfma_f32_16x16x32_bf16 v[112:115], a[220:223], a[132:135], v[112:115]
    ds_read_b64_tr_b16 a[206:207], v8 offset:23552
    v_accvgpr_read_b32 v172, a84
    v_mfma_f32_16x16x32_bf16 v[112:115], a[216:219], a[128:131], v[112:115]
    v_accvgpr_read_b32 v173, a85
    v_exp_f32 v134, v134
    v_exp_f32 v135, v135
    s_nop 0
    v_pk_add_f32 v[134:135], v[134:135], 1.0 op_sel_hi:[1,0]
    v_rcp_f32 v128, v128
    v_rcp_f32 v129, v129
    v_rcp_f32 v130, v130
    v_rcp_f32 v131, v131
    v_rcp_f32 v132, v132
    v_rcp_f32 v133, v133
    v_rcp_f32 v134, v134
    v_rcp_f32 v135, v135
    v_pk_mul_f32 v[128:129], v[128:129], v[136:137]
    v_pk_mul_f32 v[130:131], v[130:131], v[138:139]
    v_pk_mul_f32 v[132:133], v[132:133], v[140:141]
    v_pk_mul_f32 v[134:135], v[134:135], v[142:143]
    v_cvt_pk_bf16_f32 v48, v128, v129
    buffer_load_dwordx4 a[172:175], v4, s[44:47], s86 offen offset:1024 sc1
    v_cvt_pk_bf16_f32 v49, v130, v131
    v_cvt_pk_bf16_f32 v50, v132, v133
    v_cvt_pk_bf16_f32 v51, v134, v135
    buffer_store_dwordx4 v[48:51], v3, s[44:47], s88 offen offset:1024 sc1
    v_exp_f32 v160, v160
    v_exp_f32 v161, v161
    v_exp_f32 v162, v162
    v_exp_f32 v163, v163
    v_exp_f32 v164, v164
    v_exp_f32 v165, v165
    v_exp_f32 v166, v166
    v_exp_f32 v167, v167
    v_pk_add_f32 v[160:161], v[160:161], 1.0 op_sel_hi:[1,0]
    v_pk_add_f32 v[162:163], v[162:163], 1.0 op_sel_hi:[1,0]
    v_pk_add_f32 v[164:165], v[164:165], 1.0 op_sel_hi:[1,0]
    v_pk_add_f32 v[166:167], v[166:167], 1.0 op_sel_hi:[1,0]
    v_rcp_f32 v160, v160
    buffer_load_dwordx4 a[176:179], v5, s[44:47], s86 offen offset:0 sc1
    v_rcp_f32 v161, v161
    v_rcp_f32 v162, v162
    v_rcp_f32 v163, v163
    v_rcp_f32 v164, v164
    v_rcp_f32 v165, v165
    v_rcp_f32 v166, v166
    v_rcp_f32 v167, v167
    v_accvgpr_read_b32 v174, a86
    v_accvgpr_read_b32 v175, a87
    v_pk_mul_f32 v[160:161], v[160:161], v[168:169]
    v_pk_mul_f32 v[162:163], v[162:163], v[170:171]
    v_pk_mul_f32 v[164:165], v[164:165], v[172:173]
    v_pk_mul_f32 v[166:167], v[166:167], v[174:175]
    v_cvt_pk_bf16_f32 v52, v160, v161
    v_cvt_pk_bf16_f32 v53, v162, v163
    v_cvt_pk_bf16_f32 v54, v164, v165
    v_cvt_pk_bf16_f32 v55, v166, v167
    buffer_store_dwordx4 v[52:55], v4, s[44:47], s88 offen offset:1024 sc1
    buffer_load_dwordx4 a[180:183], v5, s[44:47], s86 offen offset:1024 sc1
    v_accvgpr_read_b32 v192, a8
    v_accvgpr_read_b32 v193, a9
    v_accvgpr_read_b32 v194, a10
    v_accvgpr_read_b32 v195, a11
    v_accvgpr_read_b32 v196, a24
    v_accvgpr_read_b32 v197, a25
    v_accvgpr_read_b32 v198, a26
    v_accvgpr_read_b32 v199, a27
    v_pk_mul_f32 v[192:193], v[192:193], s[76:77] op_sel_hi:[1,0]
    v_pk_mul_f32 v[194:195], v[194:195], s[76:77] op_sel_hi:[1,0]
    v_pk_mul_f32 v[196:197], v[196:197], s[76:77] op_sel_hi:[1,0]
    v_pk_mul_f32 v[198:199], v[198:199], s[76:77] op_sel_hi:[1,0]
    v_exp_f32 v192, v192
    v_exp_f32 v193, v193
    v_exp_f32 v194, v194
    v_exp_f32 v195, v195
    v_exp_f32 v196, v196
    v_exp_f32 v197, v197
    v_exp_f32 v198, v198
    buffer_load_dwordx4 a[184:187], v6, s[44:47], s86 offen offset:0 sc1
    v_exp_f32 v199, v199
    v_pk_add_f32 v[192:193], v[192:193], 1.0 op_sel_hi:[1,0]
    v_pk_add_f32 v[194:195], v[194:195], 1.0 op_sel_hi:[1,0]
    v_pk_add_f32 v[196:197], v[196:197], 1.0 op_sel_hi:[1,0]
    v_pk_add_f32 v[198:199], v[198:199], 1.0 op_sel_hi:[1,0]
    v_rcp_f32 v192, v192
    v_rcp_f32 v193, v193
    v_rcp_f32 v194, v194
    v_rcp_f32 v195, v195
    v_rcp_f32 v196, v196
    v_rcp_f32 v197, v197
    v_rcp_f32 v198, v198
    v_rcp_f32 v199, v199
    v_accvgpr_read_b32 v200, a72
    v_accvgpr_read_b32 v201, a73
    v_accvgpr_read_b32 v202, a74
    v_accvgpr_read_b32 v203, a75
    buffer_load_dwordx4 a[188:191], v6, s[44:47], s86 offen offset:1024 sc1
    v_accvgpr_read_b32 v204, a88
    v_accvgpr_read_b32 v205, a89
    v_accvgpr_read_b32 v206, a90
    v_accvgpr_read_b32 v207, a91
    v_pk_mul_f32 v[192:193], v[192:193], v[200:201]
    v_pk_mul_f32 v[194:195], v[194:195], v[202:203]
    v_pk_mul_f32 v[196:197], v[196:197], v[204:205]
    v_pk_mul_f32 v[198:199], v[198:199], v[206:207]
    v_cvt_pk_bf16_f32 v56, v192, v193
    v_cvt_pk_bf16_f32 v57, v194, v195
    v_cvt_pk_bf16_f32 v58, v196, v197
    v_cvt_pk_bf16_f32 v59, v198, v199
    buffer_store_dwordx4 v[56:59], v5, s[44:47], s88 offen offset:1024 sc1
    v_accvgpr_read_b32 v224, a12
    v_accvgpr_read_b32 v225, a13
    v_accvgpr_read_b32 v226, a14
    v_accvgpr_read_b32 v227, a15
    v_accvgpr_read_b32 v228, a28
    v_accvgpr_read_b32 v229, a29
    v_accvgpr_read_b32 v230, a30
    v_accvgpr_read_b32 v231, a31
    v_pk_mul_f32 v[224:225], v[224:225], s[76:77] op_sel_hi:[1,0]
    v_pk_mul_f32 v[226:227], v[226:227], s[76:77] op_sel_hi:[1,0]
    v_pk_mul_f32 v[228:229], v[228:229], s[76:77] op_sel_hi:[1,0]
    v_pk_mul_f32 v[230:231], v[230:231], s[76:77] op_sel_hi:[1,0]
    s_add_u32 m0, s19, 86016
    s_lshl_b32 s11, s88, 4
    buffer_load_dwordx4 v17, s[56:59], s11 offen offset:0 lds
    v_exp_f32 v224, v224
    v_exp_f32 v225, v225
    v_exp_f32 v226, v226
    v_exp_f32 v227, v227
    v_exp_f32 v228, v228
    v_exp_f32 v229, v229
    v_exp_f32 v230, v230
    v_exp_f32 v231, v231
    v_pk_add_f32 v[224:225], v[224:225], 1.0 op_sel_hi:[1,0]
    v_pk_add_f32 v[226:227], v[226:227], 1.0 op_sel_hi:[1,0]
    v_pk_add_f32 v[228:229], v[228:229], 1.0 op_sel_hi:[1,0]
    v_pk_add_f32 v[230:231], v[230:231], 1.0 op_sel_hi:[1,0]
    v_rcp_f32 v224, v224
    v_rcp_f32 v225, v225
    v_rcp_f32 v226, v226
    buffer_load_dwordx4 v18, s[56:59], s11 offen offset:1024 lds
    v_rcp_f32 v227, v227
    v_rcp_f32 v228, v228
    v_rcp_f32 v229, v229
    v_rcp_f32 v230, v230
    v_rcp_f32 v231, v231
    v_accvgpr_read_b32 v232, a76
    v_accvgpr_read_b32 v233, a77
    v_accvgpr_read_b32 v234, a78
    v_accvgpr_read_b32 v235, a79
    v_accvgpr_read_b32 v236, a92
    v_accvgpr_read_b32 v237, a93
    v_accvgpr_read_b32 v238, a94
    v_accvgpr_read_b32 v239, a95
    v_pk_mul_f32 v[224:225], v[224:225], v[232:233]
    v_pk_mul_f32 v[226:227], v[226:227], v[234:235]
    v_pk_mul_f32 v[228:229], v[228:229], v[236:237]
    v_pk_mul_f32 v[230:231], v[230:231], v[238:239]
    v_cvt_pk_bf16_f32 v60, v224, v225
    v_cvt_pk_bf16_f32 v61, v226, v227
    v_cvt_pk_bf16_f32 v62, v228, v229
    v_cvt_pk_bf16_f32 v63, v230, v231
    buffer_load_dwordx4 v19, s[56:59], s11 offen offset:2048 lds
    buffer_store_dwordx4 v[60:63], v6, s[44:47], s88 offen offset:1024 sc1
    s_waitcnt lgkmcnt(4)
    v_mfma_f32_16x16x32_bf16 v[144:147], a[192:195], a[128:131], v[144:147]
    ds_read_b64_tr_b16 a[208:209], v7 offset:2560
    v_mfma_f32_16x16x32_bf16 v[144:147], a[196:199], a[132:135], v[144:147]
    v_mfma_f32_16x16x32_bf16 v[148:151], a[196:199], a[140:143], v[148:151]
    ds_read_b64_tr_b16 a[210:211], v7 offset:23040
    v_mfma_f32_16x16x32_bf16 v[148:151], a[192:195], a[136:139], v[148:151]
    buffer_load_dwordx4 v20, s[56:59], s11 offen offset:3072 lds
    v_mfma_f32_16x16x32_bf16 v[152:155], a[192:195], a[144:147], v[152:155]
    ds_read_b64_tr_b16 a[212:213], v7 offset:3584
    v_mfma_f32_16x16x32_bf16 v[152:155], a[196:199], a[148:151], v[152:155]
    v_mfma_f32_16x16x32_bf16 v[156:159], a[196:199], a[156:159], v[156:159]
    ds_read_b64_tr_b16 a[214:215], v7 offset:24064
    v_mfma_f32_16x16x32_bf16 v[156:159], a[192:195], a[152:155], v[156:159]
    s_waitcnt lgkmcnt(4)
    v_mfma_f32_16x16x32_bf16 v[188:191], a[200:203], a[152:155], v[188:191]
    ds_read_b64_tr_b16 a[216:217], v8 offset:2560
    v_mfma_f32_16x16x32_bf16 v[188:191], a[204:207], a[156:159], v[188:191]
    buffer_load_dwordx4 a[0:3], v3, s[44:47], s92 offen offset:0 sc1
    v_mfma_f32_16x16x32_bf16 v[184:187], a[204:207], a[148:151], v[184:187]
    ds_read_b64_tr_b16 a[218:219], v8 offset:23040
    v_mfma_f32_16x16x32_bf16 v[184:187], a[200:203], a[144:147], v[184:187]
    v_mfma_f32_16x16x32_bf16 v[180:183], a[200:203], a[136:139], v[180:183]
    ds_read_b64_tr_b16 a[220:221], v8 offset:3584
    v_mfma_f32_16x16x32_bf16 v[180:183], a[204:207], a[140:143], v[180:183]
    buffer_load_dwordx4 a[4:7], v3, s[44:47], s92 offen offset:1024 sc1
    v_mfma_f32_16x16x32_bf16 v[176:179], a[204:207], a[132:135], v[176:179]
    ds_read_b64_tr_b16 a[222:223], v8 offset:24064
    v_mfma_f32_16x16x32_bf16 v[176:179], a[200:203], a[128:131], v[176:179]
    s_waitcnt lgkmcnt(4)
    v_mfma_f32_16x16x32_bf16 v[208:211], a[208:211], a[128:131], v[208:211]
    ds_read_b64_tr_b16 a[192:193], v7 offset:4096
    v_mfma_f32_16x16x32_bf16 v[208:211], a[212:215], a[132:135], v[208:211]
    buffer_load_dwordx4 a[8:11], v4, s[44:47], s92 offen offset:0 sc1
    v_mfma_f32_16x16x32_bf16 v[212:215], a[212:215], a[140:143], v[212:215]
    ds_read_b64_tr_b16 a[194:195], v7 offset:24576
    v_mfma_f32_16x16x32_bf16 v[212:215], a[208:211], a[136:139], v[212:215]
    v_mfma_f32_16x16x32_bf16 v[216:219], a[208:211], a[144:147], v[216:219]
    ds_read_b64_tr_b16 a[196:197], v7 offset:5120
    v_mfma_f32_16x16x32_bf16 v[216:219], a[212:215], a[148:151], v[216:219]
    buffer_load_dwordx4 a[12:15], v4, s[44:47], s92 offen offset:1024 sc1
    v_mfma_f32_16x16x32_bf16 v[220:223], a[212:215], a[156:159], v[220:223]
    ds_read_b64_tr_b16 a[198:199], v7 offset:25600
    v_mfma_f32_16x16x32_bf16 v[220:223], a[208:211], a[152:155], v[220:223]
    s_waitcnt lgkmcnt(4)
    v_mfma_f32_16x16x32_bf16 v[252:255], a[216:219], a[152:155], v[252:255]
    ds_read_b64_tr_b16 a[200:201], v8 offset:4096
    v_mfma_f32_16x16x32_bf16 v[252:255], a[220:223], a[156:159], v[252:255]
    buffer_load_dwordx4 a[16:19], v5, s[44:47], s92 offen offset:0 sc1
    v_mfma_f32_16x16x32_bf16 v[248:251], a[220:223], a[148:151], v[248:251]
    ds_read_b64_tr_b16 a[202:203], v8 offset:24576
    v_mfma_f32_16x16x32_bf16 v[248:251], a[216:219], a[144:147], v[248:251]
    v_mfma_f32_16x16x32_bf16 v[244:247], a[216:219], a[136:139], v[244:247]
    ds_read_b64_tr_b16 a[204:205], v8 offset:5120
    v_mfma_f32_16x16x32_bf16 v[244:247], a[220:223], a[140:143], v[244:247]
    buffer_load_dwordx4 a[20:23], v5, s[44:47], s92 offen offset:1024 sc1
    v_mfma_f32_16x16x32_bf16 v[240:243], a[220:223], a[132:135], v[240:243]
    ds_read_b64_tr_b16 a[206:207], v8 offset:25600
    v_mfma_f32_16x16x32_bf16 v[240:243], a[216:219], a[128:131], v[240:243]
    s_waitcnt vmcnt(35) lgkmcnt(4)
    v_mfma_f32_16x16x32_bf16 v[64:67], a[192:195], a[96:99], v[64:67]
    ds_read_b64_tr_b16 a[208:209], v7 offset:4608
    v_mfma_f32_16x16x32_bf16 v[64:67], a[196:199], a[100:103], v[64:67]
    buffer_load_dwordx4 a[24:27], v6, s[44:47], s92 offen offset:0 sc1
    v_mfma_f32_16x16x32_bf16 v[68:71], a[196:199], a[108:111], v[68:71]
    ds_read_b64_tr_b16 a[210:211], v7 offset:25088
    v_mfma_f32_16x16x32_bf16 v[68:71], a[192:195], a[104:107], v[68:71]
    v_mfma_f32_16x16x32_bf16 v[72:75], a[192:195], a[112:115], v[72:75]
    ds_read_b64_tr_b16 a[212:213], v7 offset:5632
    v_mfma_f32_16x16x32_bf16 v[72:75], a[196:199], a[116:119], v[72:75]
    buffer_load_dwordx4 a[28:31], v6, s[44:47], s92 offen offset:1024 sc1
    v_mfma_f32_16x16x32_bf16 v[76:79], a[196:199], a[124:127], v[76:79]
    ds_read_b64_tr_b16 a[214:215], v7 offset:26112
    v_mfma_f32_16x16x32_bf16 v[76:79], a[192:195], a[120:123], v[76:79]
    s_waitcnt vmcnt(63) lgkmcnt(4)
    s_barrier
    v_mfma_f32_16x16x32_bf16 v[92:95], a[200:203], a[120:123], v[92:95]
    ds_read_b64_tr_b16 a[216:217], v8 offset:4608
    v_mfma_f32_16x16x32_bf16 v[92:95], a[204:207], a[124:127], v[92:95]
    buffer_load_dwordx4 a[128:131], v3, s[44:47], s93 offen offset:0 sc1
    v_mfma_f32_16x16x32_bf16 v[88:91], a[204:207], a[116:119], v[88:91]
    ds_read_b64_tr_b16 a[218:219], v8 offset:25088
    v_mfma_f32_16x16x32_bf16 v[88:91], a[200:203], a[112:115], v[88:91]
    v_mfma_f32_16x16x32_bf16 v[84:87], a[200:203], a[104:107], v[84:87]
    ds_read_b64_tr_b16 a[220:221], v8 offset:5632
    v_mfma_f32_16x16x32_bf16 v[84:87], a[204:207], a[108:111], v[84:87]
    buffer_load_dwordx4 a[132:135], v3, s[44:47], s93 offen offset:1024 sc1
    v_mfma_f32_16x16x32_bf16 v[80:83], a[204:207], a[100:103], v[80:83]
    ds_read_b64_tr_b16 a[222:223], v8 offset:26112
    v_mfma_f32_16x16x32_bf16 v[80:83], a[200:203], a[96:99], v[80:83]
    s_waitcnt lgkmcnt(4)
    v_mfma_f32_16x16x32_bf16 v[96:99], a[208:211], a[96:99], v[96:99]
    ds_read_b64_tr_b16 a[192:193], v7 offset:6144
    v_mfma_f32_16x16x32_bf16 v[96:99], a[212:215], a[100:103], v[96:99]
    buffer_load_dwordx4 a[136:139], v4, s[44:47], s93 offen offset:0 sc1
    v_mfma_f32_16x16x32_bf16 v[100:103], a[212:215], a[108:111], v[100:103]
    ds_read_b64_tr_b16 a[194:195], v7 offset:26624
    v_mfma_f32_16x16x32_bf16 v[100:103], a[208:211], a[104:107], v[100:103]
    v_mfma_f32_16x16x32_bf16 v[104:107], a[208:211], a[112:115], v[104:107]
    ds_read_b64_tr_b16 a[196:197], v7 offset:7168
    v_mfma_f32_16x16x32_bf16 v[104:107], a[212:215], a[116:119], v[104:107]
    buffer_load_dwordx4 a[140:143], v4, s[44:47], s93 offen offset:1024 sc1
    v_mfma_f32_16x16x32_bf16 v[108:111], a[212:215], a[124:127], v[108:111]
    ds_read_b64_tr_b16 a[198:199], v7 offset:27648
    v_mfma_f32_16x16x32_bf16 v[108:111], a[208:211], a[120:123], v[108:111]
    s_waitcnt vmcnt(13)
    s_add_u32 s74, s66, 4160
    s_mov_b64 exec, 1
    buffer_store_dword v21, off, s[52:55], s74 sc1
    s_mov_b64 exec, -1
    s_waitcnt lgkmcnt(4)
    v_mfma_f32_16x16x32_bf16 v[124:127], a[216:219], a[120:123], v[124:127]
    ds_read_b64_tr_b16 a[200:201], v8 offset:6144
    v_mfma_f32_16x16x32_bf16 v[124:127], a[220:223], a[124:127], v[124:127]
    buffer_load_dwordx4 a[144:147], v5, s[44:47], s93 offen offset:0 sc1
    v_mfma_f32_16x16x32_bf16 v[120:123], a[220:223], a[116:119], v[120:123]
    ds_read_b64_tr_b16 a[202:203], v8 offset:26624
    v_mfma_f32_16x16x32_bf16 v[120:123], a[216:219], a[112:115], v[120:123]
    v_mfma_f32_16x16x32_bf16 v[116:119], a[216:219], a[104:107], v[116:119]
    ds_read_b64_tr_b16 a[204:205], v8 offset:7168
    v_mfma_f32_16x16x32_bf16 v[116:119], a[220:223], a[108:111], v[116:119]
    buffer_load_dwordx4 a[148:151], v5, s[44:47], s93 offen offset:1024 sc1
    v_mfma_f32_16x16x32_bf16 v[112:115], a[220:223], a[100:103], v[112:115]
    ds_read_b64_tr_b16 a[206:207], v8 offset:27648
    v_mfma_f32_16x16x32_bf16 v[112:115], a[216:219], a[96:99], v[112:115]
    s_waitcnt lgkmcnt(4)
    v_mfma_f32_16x16x32_bf16 v[144:147], a[192:195], a[96:99], v[144:147]
    ds_read_b64_tr_b16 a[208:209], v7 offset:6656
    v_mfma_f32_16x16x32_bf16 v[144:147], a[196:199], a[100:103], v[144:147]
    buffer_load_dwordx4 a[152:155], v6, s[44:47], s93 offen offset:0 sc1
    v_mfma_f32_16x16x32_bf16 v[148:151], a[196:199], a[108:111], v[148:151]
    ds_read_b64_tr_b16 a[210:211], v7 offset:27136
    v_mfma_f32_16x16x32_bf16 v[148:151], a[192:195], a[104:107], v[148:151]
    v_mfma_f32_16x16x32_bf16 v[152:155], a[192:195], a[112:115], v[152:155]
    ds_read_b64_tr_b16 a[212:213], v7 offset:7680
    v_mfma_f32_16x16x32_bf16 v[152:155], a[196:199], a[116:119], v[152:155]
    buffer_load_dwordx4 a[156:159], v6, s[44:47], s93 offen offset:1024 sc1
    v_mfma_f32_16x16x32_bf16 v[156:159], a[196:199], a[124:127], v[156:159]
    ds_read_b64_tr_b16 a[214:215], v7 offset:28160
    v_mfma_f32_16x16x32_bf16 v[156:159], a[192:195], a[120:123], v[156:159]
    s_waitcnt lgkmcnt(4)
    v_mfma_f32_16x16x32_bf16 v[188:191], a[200:203], a[120:123], v[188:191]
    ds_read_b64_tr_b16 a[216:217], v8 offset:6656
    s_add_u32 m0, s19, 126976
    v_mfma_f32_16x16x32_bf16 v[188:191], a[204:207], a[124:127], v[188:191]
    s_lshl_b32 s11, s89, 4
    v_mfma_f32_16x16x32_bf16 v[184:187], a[204:207], a[116:119], v[184:187]
    ds_read_b64_tr_b16 a[218:219], v8 offset:27136
    v_mfma_f32_16x16x32_bf16 v[184:187], a[200:203], a[112:115], v[184:187]
    buffer_load_dwordx4 v17, s[56:59], s11 offen offset:0 lds
    v_mfma_f32_16x16x32_bf16 v[180:183], a[200:203], a[104:107], v[180:183]
    ds_read_b64_tr_b16 a[220:221], v8 offset:7680
    v_mfma_f32_16x16x32_bf16 v[180:183], a[204:207], a[108:111], v[180:183]
    v_mfma_f32_16x16x32_bf16 v[176:179], a[204:207], a[100:103], v[176:179]
    ds_read_b64_tr_b16 a[222:223], v8 offset:28160
    v_mfma_f32_16x16x32_bf16 v[176:179], a[200:203], a[96:99], v[176:179]
    s_waitcnt lgkmcnt(4)
    v_mfma_f32_16x16x32_bf16 v[208:211], a[208:211], a[96:99], v[208:211]
    ds_read_b64_tr_b16 a[192:193], v9 offset:0
    v_mfma_f32_16x16x32_bf16 v[208:211], a[212:215], a[100:103], v[208:211]
    buffer_load_dwordx4 v18, s[56:59], s11 offen offset:1024 lds
    v_mfma_f32_16x16x32_bf16 v[212:215], a[212:215], a[108:111], v[212:215]
    ds_read_b64_tr_b16 a[194:195], v9 offset:20480
    v_mfma_f32_16x16x32_bf16 v[212:215], a[208:211], a[104:107], v[212:215]
    v_mfma_f32_16x16x32_bf16 v[216:219], a[208:211], a[112:115], v[216:219]
    ds_read_b64_tr_b16 a[196:197], v9 offset:1024
    v_mfma_f32_16x16x32_bf16 v[216:219], a[212:215], a[116:119], v[216:219]
    buffer_load_dwordx4 v19, s[56:59], s11 offen offset:2048 lds
    v_mfma_f32_16x16x32_bf16 v[220:223], a[212:215], a[124:127], v[220:223]
    ds_read_b64_tr_b16 a[198:199], v9 offset:21504
    v_mfma_f32_16x16x32_bf16 v[220:223], a[208:211], a[120:123], v[220:223]
    s_waitcnt lgkmcnt(4)
    v_mfma_f32_16x16x32_bf16 v[252:255], a[216:219], a[120:123], v[252:255]
    ds_read_b64_tr_b16 a[200:201], v10 offset:0
    v_mfma_f32_16x16x32_bf16 v[252:255], a[220:223], a[124:127], v[252:255]
    buffer_load_dwordx4 v20, s[56:59], s11 offen offset:3072 lds
    v_mfma_f32_16x16x32_bf16 v[248:251], a[220:223], a[116:119], v[248:251]
    ds_read_b64_tr_b16 a[202:203], v10 offset:20480
    v_mfma_f32_16x16x32_bf16 v[248:251], a[216:219], a[112:115], v[248:251]
    v_mfma_f32_16x16x32_bf16 v[244:247], a[216:219], a[104:107], v[244:247]
    ds_read_b64_tr_b16 a[204:205], v10 offset:1024
    s_add_u32 m0, s19, 0
    v_mfma_f32_16x16x32_bf16 v[244:247], a[220:223], a[108:111], v[244:247]
    s_lshl_b32 s11, s90, 4
    v_mfma_f32_16x16x32_bf16 v[240:243], a[220:223], a[100:103], v[240:243]
    ds_read_b64_tr_b16 a[206:207], v10 offset:21504
    v_mfma_f32_16x16x32_bf16 v[240:243], a[216:219], a[96:99], v[240:243]
    s_waitcnt vmcnt(37) lgkmcnt(4)
    v_mfma_f32_16x16x32_bf16 v[64:67], a[192:195], a[32:35], v[64:67]
    ds_read_b64_tr_b16 a[208:209], v9 offset:512
    v_mfma_f32_16x16x32_bf16 v[64:67], a[196:199], a[36:39], v[64:67]
    buffer_load_dwordx4 v17, s[56:59], s11 offen offset:0 lds
    v_mfma_f32_16x16x32_bf16 v[68:71], a[196:199], a[44:47], v[68:71]
    ds_read_b64_tr_b16 a[210:211], v9 offset:20992
    v_mfma_f32_16x16x32_bf16 v[68:71], a[192:195], a[40:43], v[68:71]
    v_mfma_f32_16x16x32_bf16 v[72:75], a[192:195], a[48:51], v[72:75]
    ds_read_b64_tr_b16 a[212:213], v9 offset:1536
    v_mfma_f32_16x16x32_bf16 v[72:75], a[196:199], a[52:55], v[72:75]
    buffer_load_dwordx4 v18, s[56:59], s11 offen offset:1024 lds
    v_mfma_f32_16x16x32_bf16 v[76:79], a[196:199], a[60:63], v[76:79]
    ds_read_b64_tr_b16 a[214:215], v9 offset:22016
    v_mfma_f32_16x16x32_bf16 v[76:79], a[192:195], a[56:59], v[76:79]
    s_waitcnt vmcnt(63) lgkmcnt(4)
    s_barrier
    v_mfma_f32_16x16x32_bf16 v[92:95], a[200:203], a[56:59], v[92:95]
    ds_read_b64_tr_b16 a[216:217], v10 offset:512
    v_mfma_f32_16x16x32_bf16 v[92:95], a[204:207], a[60:63], v[92:95]
    buffer_load_dwordx4 v19, s[56:59], s11 offen offset:2048 lds
    v_mfma_f32_16x16x32_bf16 v[88:91], a[204:207], a[52:55], v[88:91]
    ds_read_b64_tr_b16 a[218:219], v10 offset:20992
    v_mfma_f32_16x16x32_bf16 v[88:91], a[200:203], a[48:51], v[88:91]
    v_mfma_f32_16x16x32_bf16 v[84:87], a[200:203], a[40:43], v[84:87]
    ds_read_b64_tr_b16 a[220:221], v10 offset:1536
    v_mfma_f32_16x16x32_bf16 v[84:87], a[204:207], a[44:47], v[84:87]
    buffer_load_dwordx4 v20, s[56:59], s11 offen offset:3072 lds
    v_mfma_f32_16x16x32_bf16 v[80:83], a[204:207], a[36:39], v[80:83]
    ds_read_b64_tr_b16 a[222:223], v10 offset:22016
    v_mfma_f32_16x16x32_bf16 v[80:83], a[200:203], a[32:35], v[80:83]
    s_waitcnt lgkmcnt(4)
    v_mfma_f32_16x16x32_bf16 v[96:99], a[208:211], a[32:35], v[96:99]
    ds_read_b64_tr_b16 a[192:193], v9 offset:2048
    s_add_u32 m0, s19, 4096
    v_mfma_f32_16x16x32_bf16 v[96:99], a[212:215], a[36:39], v[96:99]
    s_lshl_b32 s11, s91, 4
    v_mfma_f32_16x16x32_bf16 v[100:103], a[212:215], a[44:47], v[100:103]
    ds_read_b64_tr_b16 a[194:195], v9 offset:22528
    v_mfma_f32_16x16x32_bf16 v[100:103], a[208:211], a[40:43], v[100:103]
    buffer_load_dwordx4 v17, s[56:59], s11 offen offset:0 lds
    v_mfma_f32_16x16x32_bf16 v[104:107], a[208:211], a[48:51], v[104:107]
    ds_read_b64_tr_b16 a[196:197], v9 offset:3072
    v_mfma_f32_16x16x32_bf16 v[104:107], a[212:215], a[52:55], v[104:107]
    v_mfma_f32_16x16x32_bf16 v[108:111], a[212:215], a[60:63], v[108:111]
    ds_read_b64_tr_b16 a[198:199], v9 offset:23552
    v_mfma_f32_16x16x32_bf16 v[108:111], a[208:211], a[56:59], v[108:111]
    s_waitcnt lgkmcnt(4)
    v_mfma_f32_16x16x32_bf16 v[124:127], a[216:219], a[56:59], v[124:127]
    ds_read_b64_tr_b16 a[200:201], v10 offset:2048
    v_mfma_f32_16x16x32_bf16 v[124:127], a[220:223], a[60:63], v[124:127]
    buffer_load_dwordx4 v18, s[56:59], s11 offen offset:1024 lds
    v_mfma_f32_16x16x32_bf16 v[120:123], a[220:223], a[52:55], v[120:123]
    ds_read_b64_tr_b16 a[202:203], v10 offset:22528
    v_mfma_f32_16x16x32_bf16 v[120:123], a[216:219], a[48:51], v[120:123]
    v_mfma_f32_16x16x32_bf16 v[116:119], a[216:219], a[40:43], v[116:119]
    ds_read_b64_tr_b16 a[204:205], v10 offset:3072
    v_mfma_f32_16x16x32_bf16 v[116:119], a[220:223], a[44:47], v[116:119]
    buffer_load_dwordx4 v19, s[56:59], s11 offen offset:2048 lds
    v_mfma_f32_16x16x32_bf16 v[112:115], a[220:223], a[36:39], v[112:115]
    ds_read_b64_tr_b16 a[206:207], v10 offset:23552
    v_mfma_f32_16x16x32_bf16 v[112:115], a[216:219], a[32:35], v[112:115]
    s_waitcnt lgkmcnt(4)
    v_mfma_f32_16x16x32_bf16 v[144:147], a[192:195], a[32:35], v[144:147]
    ds_read_b64_tr_b16 a[208:209], v9 offset:2560
    v_mfma_f32_16x16x32_bf16 v[144:147], a[196:199], a[36:39], v[144:147]
    buffer_load_dwordx4 v20, s[56:59], s11 offen offset:3072 lds
    v_mfma_f32_16x16x32_bf16 v[148:151], a[196:199], a[44:47], v[148:151]
    ds_read_b64_tr_b16 a[210:211], v9 offset:23040
    v_mfma_f32_16x16x32_bf16 v[148:151], a[192:195], a[40:43], v[148:151]
    v_mfma_f32_16x16x32_bf16 v[152:155], a[192:195], a[48:51], v[152:155]
    ds_read_b64_tr_b16 a[212:213], v9 offset:3584
    v_mfma_f32_16x16x32_bf16 v[152:155], a[196:199], a[52:55], v[152:155]
    v_mfma_f32_16x16x32_bf16 v[156:159], a[196:199], a[60:63], v[156:159]
    ds_read_b64_tr_b16 a[214:215], v9 offset:24064
    v_mfma_f32_16x16x32_bf16 v[156:159], a[192:195], a[56:59], v[156:159]
    s_waitcnt lgkmcnt(4)
    v_mfma_f32_16x16x32_bf16 v[188:191], a[200:203], a[56:59], v[188:191]
    ds_read_b64_tr_b16 a[216:217], v10 offset:2560
    v_mfma_f32_16x16x32_bf16 v[188:191], a[204:207], a[60:63], v[188:191]
    v_mfma_f32_16x16x32_bf16 v[184:187], a[204:207], a[52:55], v[184:187]
    ds_read_b64_tr_b16 a[218:219], v10 offset:23040
    v_mfma_f32_16x16x32_bf16 v[184:187], a[200:203], a[48:51], v[184:187]
    v_mfma_f32_16x16x32_bf16 v[180:183], a[200:203], a[40:43], v[180:183]
    ds_read_b64_tr_b16 a[220:221], v10 offset:3584
    v_mfma_f32_16x16x32_bf16 v[180:183], a[204:207], a[44:47], v[180:183]
    v_mfma_f32_16x16x32_bf16 v[176:179], a[204:207], a[36:39], v[176:179]
    ds_read_b64_tr_b16 a[222:223], v10 offset:24064
    v_mfma_f32_16x16x32_bf16 v[176:179], a[200:203], a[32:35], v[176:179]
    s_waitcnt lgkmcnt(4)
    v_mfma_f32_16x16x32_bf16 v[208:211], a[208:211], a[32:35], v[208:211]
    ds_read_b64_tr_b16 a[192:193], v11 offset:0
    v_mfma_f32_16x16x32_bf16 v[208:211], a[212:215], a[36:39], v[208:211]
    v_mfma_f32_16x16x32_bf16 v[212:215], a[212:215], a[44:47], v[212:215]
    ds_read_b64_tr_b16 a[194:195], v11 offset:20480
    v_mfma_f32_16x16x32_bf16 v[212:215], a[208:211], a[40:43], v[212:215]
    v_mfma_f32_16x16x32_bf16 v[216:219], a[208:211], a[48:51], v[216:219]
    ds_read_b64_tr_b16 a[196:197], v11 offset:1024
    v_mfma_f32_16x16x32_bf16 v[216:219], a[212:215], a[52:55], v[216:219]
    v_mfma_f32_16x16x32_bf16 v[220:223], a[212:215], a[60:63], v[220:223]
    ds_read_b64_tr_b16 a[198:199], v11 offset:21504
    v_mfma_f32_16x16x32_bf16 v[220:223], a[208:211], a[56:59], v[220:223]
    s_waitcnt lgkmcnt(4)
    v_mfma_f32_16x16x32_bf16 v[252:255], a[216:219], a[56:59], v[252:255]
    ds_read_b64_tr_b16 a[200:201], v12 offset:0
    v_mfma_f32_16x16x32_bf16 v[252:255], a[220:223], a[60:63], v[252:255]
    v_mfma_f32_16x16x32_bf16 v[248:251], a[220:223], a[52:55], v[248:251]
    ds_read_b64_tr_b16 a[202:203], v12 offset:20480
    v_mfma_f32_16x16x32_bf16 v[248:251], a[216:219], a[48:51], v[248:251]
    v_mfma_f32_16x16x32_bf16 v[244:247], a[216:219], a[40:43], v[244:247]
    ds_read_b64_tr_b16 a[204:205], v12 offset:1024
    v_mfma_f32_16x16x32_bf16 v[244:247], a[220:223], a[44:47], v[244:247]
    v_mfma_f32_16x16x32_bf16 v[240:243], a[220:223], a[36:39], v[240:243]
    ds_read_b64_tr_b16 a[206:207], v12 offset:21504
    v_mfma_f32_16x16x32_bf16 v[240:243], a[216:219], a[32:35], v[240:243]
    s_waitcnt vmcnt(35) lgkmcnt(4)
    v_mfma_f32_16x16x32_bf16 v[64:67], a[192:195], a[160:163], v[64:67]
    ds_read_b64_tr_b16 a[208:209], v11 offset:512
    v_mfma_f32_16x16x32_bf16 v[64:67], a[196:199], a[164:167], v[64:67]
    v_mfma_f32_16x16x32_bf16 v[68:71], a[196:199], a[172:175], v[68:71]
    ds_read_b64_tr_b16 a[210:211], v11 offset:20992
    v_mfma_f32_16x16x32_bf16 v[68:71], a[192:195], a[168:171], v[68:71]
    v_mfma_f32_16x16x32_bf16 v[72:75], a[192:195], a[176:179], v[72:75]
    ds_read_b64_tr_b16 a[212:213], v11 offset:1536
    v_mfma_f32_16x16x32_bf16 v[72:75], a[196:199], a[180:183], v[72:75]
    v_mfma_f32_16x16x32_bf16 v[76:79], a[196:199], a[188:191], v[76:79]
    ds_read_b64_tr_b16 a[214:215], v11 offset:22016
    v_mfma_f32_16x16x32_bf16 v[76:79], a[192:195], a[184:187], v[76:79]
    s_waitcnt vmcnt(63) lgkmcnt(4)
    s_barrier
    v_mfma_f32_16x16x32_bf16 v[92:95], a[200:203], a[184:187], v[92:95]
    ds_read_b64_tr_b16 a[216:217], v12 offset:512
    s_add_u32 m0, s19, 40960
    v_mfma_f32_16x16x32_bf16 v[92:95], a[204:207], a[188:191], v[92:95]
    s_mov_b32 s11, 0
    v_mfma_f32_16x16x32_bf16 v[88:91], a[204:207], a[180:183], v[88:91]
    ds_read_b64_tr_b16 a[218:219], v12 offset:20992
    v_mfma_f32_16x16x32_bf16 v[88:91], a[200:203], a[176:179], v[88:91]
    buffer_load_dwordx4 v17, s[36:39], s11 offen offset:0 lds
    v_mfma_f32_16x16x32_bf16 v[84:87], a[200:203], a[168:171], v[84:87]
    ds_read_b64_tr_b16 a[220:221], v12 offset:1536
    v_mfma_f32_16x16x32_bf16 v[84:87], a[204:207], a[172:175], v[84:87]
    v_mfma_f32_16x16x32_bf16 v[80:83], a[204:207], a[164:167], v[80:83]
    ds_read_b64_tr_b16 a[222:223], v12 offset:22016
    v_mfma_f32_16x16x32_bf16 v[80:83], a[200:203], a[160:163], v[80:83]
    v_bfe_u32 v30, v1, 4, 1
    v_lshrrev_b32 v15, 5, v1
    v_lshlrev_b32 v30, 5, v30
    v_lshl_add_u32 v30, v15, 4, v30
    v_and_b32 v15, 15, v1
    v_lshl_add_u32 v30, v15, 11, v30
    s_waitcnt lgkmcnt(4)
    v_mfma_f32_16x16x32_bf16 v[96:99], a[208:211], a[160:163], v[96:99]
    ds_read_b64_tr_b16 a[192:193], v11 offset:2048
    v_mfma_f32_16x16x32_bf16 v[96:99], a[212:215], a[164:167], v[96:99]
    buffer_load_dwordx4 v18, s[36:39], s11 offen offset:1024 lds
    v_mfma_f32_16x16x32_bf16 v[100:103], a[212:215], a[172:175], v[100:103]
    ds_read_b64_tr_b16 a[194:195], v11 offset:22528
    v_mfma_f32_16x16x32_bf16 v[100:103], a[208:211], a[168:171], v[100:103]
    v_mfma_f32_16x16x32_bf16 v[104:107], a[208:211], a[176:179], v[104:107]
    ds_read_b64_tr_b16 a[196:197], v11 offset:3072
    v_mfma_f32_16x16x32_bf16 v[104:107], a[212:215], a[180:183], v[104:107]
    buffer_load_dwordx4 v19, s[36:39], s11 offen offset:2048 lds
    v_mfma_f32_16x16x32_bf16 v[108:111], a[212:215], a[188:191], v[108:111]
    ds_read_b64_tr_b16 a[198:199], v11 offset:23552
    v_mfma_f32_16x16x32_bf16 v[108:111], a[208:211], a[184:187], v[108:111]
    s_waitcnt lgkmcnt(4)
    v_mfma_f32_16x16x32_bf16 v[124:127], a[216:219], a[184:187], v[124:127]
    ds_read_b64_tr_b16 a[200:201], v12 offset:2048
    v_mfma_f32_16x16x32_bf16 v[124:127], a[220:223], a[188:191], v[124:127]
    buffer_load_dwordx4 v20, s[36:39], s11 offen offset:3072 lds
    v_mfma_f32_16x16x32_bf16 v[120:123], a[220:223], a[180:183], v[120:123]
    ds_read_b64_tr_b16 a[202:203], v12 offset:22528
    v_mfma_f32_16x16x32_bf16 v[120:123], a[216:219], a[176:179], v[120:123]
    v_mfma_f32_16x16x32_bf16 v[116:119], a[216:219], a[168:171], v[116:119]
    ds_read_b64_tr_b16 a[204:205], v12 offset:3072
    v_mfma_f32_16x16x32_bf16 v[116:119], a[220:223], a[172:175], v[116:119]
    buffer_load_dwordx4 v[224:227], v30, s[28:31], 0 offen offset:0 sc1
    v_mfma_f32_16x16x32_bf16 v[112:115], a[220:223], a[164:167], v[112:115]
    ds_read_b64_tr_b16 a[206:207], v12 offset:23552
    v_mfma_f32_16x16x32_bf16 v[112:115], a[216:219], a[160:163], v[112:115]
    s_waitcnt vmcnt(63)
    v_and_b32 v0, 3, v1
    v_lshlrev_b32 v0, 2, v0
    buffer_load_dword v0, v0, s[52:55], s67 offen offset:64 sc1
    s_waitcnt lgkmcnt(4)
    v_mfma_f32_16x16x32_bf16 v[144:147], a[192:195], a[160:163], v[144:147]
    ds_read_b64_tr_b16 a[208:209], v11 offset:2560
    v_mfma_f32_16x16x32_bf16 v[144:147], a[196:199], a[164:167], v[144:147]
    buffer_load_dwordx4 v[228:231], v30, s[28:31], 0 offen offset:64 sc1
    v_mfma_f32_16x16x32_bf16 v[148:151], a[196:199], a[172:175], v[148:151]
    ds_read_b64_tr_b16 a[210:211], v11 offset:23040
    v_mfma_f32_16x16x32_bf16 v[148:151], a[192:195], a[168:171], v[148:151]
    v_mfma_f32_16x16x32_bf16 v[152:155], a[192:195], a[176:179], v[152:155]
    ds_read_b64_tr_b16 a[212:213], v11 offset:3584
    v_mfma_f32_16x16x32_bf16 v[152:155], a[196:199], a[180:183], v[152:155]
    buffer_load_dwordx4 v[232:235], v30, s[28:31], 0 offen offset:128 sc1
    v_mfma_f32_16x16x32_bf16 v[156:159], a[196:199], a[188:191], v[156:159]
    ds_read_b64_tr_b16 a[214:215], v11 offset:24064
    v_mfma_f32_16x16x32_bf16 v[156:159], a[192:195], a[184:187], v[156:159]
    s_waitcnt lgkmcnt(4)
    v_mfma_f32_16x16x32_bf16 v[188:191], a[200:203], a[184:187], v[188:191]
    ds_read_b64_tr_b16 a[216:217], v12 offset:2560
    v_mfma_f32_16x16x32_bf16 v[188:191], a[204:207], a[188:191], v[188:191]
    buffer_load_dwordx4 v[236:239], v30, s[28:31], 0 offen offset:192 sc1
    v_mfma_f32_16x16x32_bf16 v[184:187], a[204:207], a[180:183], v[184:187]
    ds_read_b64_tr_b16 a[218:219], v12 offset:23040
    v_mfma_f32_16x16x32_bf16 v[184:187], a[200:203], a[176:179], v[184:187]
    v_mfma_f32_16x16x32_bf16 v[180:183], a[200:203], a[168:171], v[180:183]
    ds_read_b64_tr_b16 a[220:221], v12 offset:3584
    v_mfma_f32_16x16x32_bf16 v[180:183], a[204:207], a[172:175], v[180:183]
    v_mfma_f32_16x16x32_bf16 v[176:179], a[204:207], a[164:167], v[176:179]
    ds_read_b64_tr_b16 a[222:223], v12 offset:24064
    v_mfma_f32_16x16x32_bf16 v[176:179], a[200:203], a[160:163], v[176:179]
    s_waitcnt lgkmcnt(4)
    v_mfma_f32_16x16x32_bf16 v[208:211], a[208:211], a[160:163], v[208:211]
    ds_read_b64_tr_b16 a[192:193], v13 offset:0
    v_mfma_f32_16x16x32_bf16 v[208:211], a[212:215], a[164:167], v[208:211]
    v_mfma_f32_16x16x32_bf16 v[212:215], a[212:215], a[172:175], v[212:215]
    ds_read_b64_tr_b16 a[194:195], v13 offset:20480
    v_mfma_f32_16x16x32_bf16 v[212:215], a[208:211], a[168:171], v[212:215]
    v_mfma_f32_16x16x32_bf16 v[216:219], a[208:211], a[176:179], v[216:219]
    ds_read_b64_tr_b16 a[196:197], v13 offset:1024
    v_mfma_f32_16x16x32_bf16 v[216:219], a[212:215], a[180:183], v[216:219]
    v_mfma_f32_16x16x32_bf16 v[220:223], a[212:215], a[188:191], v[220:223]
    ds_read_b64_tr_b16 a[198:199], v13 offset:21504
    v_mfma_f32_16x16x32_bf16 v[220:223], a[208:211], a[184:187], v[220:223]
    s_waitcnt lgkmcnt(4)
    v_mfma_f32_16x16x32_bf16 v[252:255], a[216:219], a[184:187], v[252:255]
    ds_read_b64_tr_b16 a[200:201], v14 offset:0
    v_mfma_f32_16x16x32_bf16 v[252:255], a[220:223], a[188:191], v[252:255]
    v_mfma_f32_16x16x32_bf16 v[248:251], a[220:223], a[180:183], v[248:251]
    ds_read_b64_tr_b16 a[202:203], v14 offset:20480
    v_mfma_f32_16x16x32_bf16 v[248:251], a[216:219], a[176:179], v[248:251]
    v_mfma_f32_16x16x32_bf16 v[244:247], a[216:219], a[168:171], v[244:247]
    ds_read_b64_tr_b16 a[204:205], v14 offset:1024
    v_mfma_f32_16x16x32_bf16 v[244:247], a[220:223], a[172:175], v[244:247]
    v_mfma_f32_16x16x32_bf16 v[240:243], a[220:223], a[164:167], v[240:243]
    ds_read_b64_tr_b16 a[206:207], v14 offset:21504
    v_mfma_f32_16x16x32_bf16 v[240:243], a[216:219], a[160:163], v[240:243]
    s_waitcnt vmcnt(30) lgkmcnt(4)
    v_mfma_f32_16x16x32_bf16 v[64:67], a[192:195], a[0:3], v[64:67]
    ds_read_b64_tr_b16 a[208:209], v13 offset:512
    v_mfma_f32_16x16x32_bf16 v[64:67], a[196:199], a[4:7], v[64:67]
    v_mfma_f32_16x16x32_bf16 v[68:71], a[196:199], a[12:15], v[68:71]
    ds_read_b64_tr_b16 a[210:211], v13 offset:20992
    v_mfma_f32_16x16x32_bf16 v[68:71], a[192:195], a[8:11], v[68:71]
    v_mfma_f32_16x16x32_bf16 v[72:75], a[192:195], a[16:19], v[72:75]
    ds_read_b64_tr_b16 a[212:213], v13 offset:1536
    v_mfma_f32_16x16x32_bf16 v[72:75], a[196:199], a[20:23], v[72:75]
    v_mfma_f32_16x16x32_bf16 v[76:79], a[196:199], a[28:31], v[76:79]
    ds_read_b64_tr_b16 a[214:215], v13 offset:22016
    v_mfma_f32_16x16x32_bf16 v[76:79], a[192:195], a[24:27], v[76:79]
    s_waitcnt vmcnt(62) lgkmcnt(4)
    s_barrier
    v_mfma_f32_16x16x32_bf16 v[92:95], a[200:203], a[24:27], v[92:95]
    ds_read_b64_tr_b16 a[216:217], v14 offset:512
    s_add_u32 m0, s19, 81920
    v_mfma_f32_16x16x32_bf16 v[92:95], a[204:207], a[28:31], v[92:95]
    s_mov_b32 s11, 131072
    v_mfma_f32_16x16x32_bf16 v[88:91], a[204:207], a[20:23], v[88:91]
    ds_read_b64_tr_b16 a[218:219], v14 offset:20992
    v_mfma_f32_16x16x32_bf16 v[88:91], a[200:203], a[16:19], v[88:91]
    buffer_load_dwordx4 v17, s[36:39], s11 offen offset:0 lds
    v_mfma_f32_16x16x32_bf16 v[84:87], a[200:203], a[8:11], v[84:87]
    ds_read_b64_tr_b16 a[220:221], v14 offset:1536
    v_mfma_f32_16x16x32_bf16 v[84:87], a[204:207], a[12:15], v[84:87]
    v_mfma_f32_16x16x32_bf16 v[80:83], a[204:207], a[4:7], v[80:83]
    ds_read_b64_tr_b16 a[222:223], v14 offset:22016
    v_mfma_f32_16x16x32_bf16 v[80:83], a[200:203], a[0:3], v[80:83]
    s_waitcnt vmcnt(4)
    v_cmp_ne_u32 vcc, s18, v0
    s_cbranch_vccnz L_pl4
L_pl4_b:
    s_waitcnt lgkmcnt(4)
    v_mfma_f32_16x16x32_bf16 v[96:99], a[208:211], a[0:3], v[96:99]
    ds_read_b64_tr_b16 a[192:193], v13 offset:2048
    v_mfma_f32_16x16x32_bf16 v[96:99], a[212:215], a[4:7], v[96:99]
    buffer_load_dwordx4 v18, s[36:39], s11 offen offset:1024 lds
    v_mfma_f32_16x16x32_bf16 v[100:103], a[212:215], a[12:15], v[100:103]
    ds_read_b64_tr_b16 a[194:195], v13 offset:22528
    v_mfma_f32_16x16x32_bf16 v[100:103], a[208:211], a[8:11], v[100:103]
    v_mfma_f32_16x16x32_bf16 v[104:107], a[208:211], a[16:19], v[104:107]
    ds_read_b64_tr_b16 a[196:197], v13 offset:3072
    v_mfma_f32_16x16x32_bf16 v[104:107], a[212:215], a[20:23], v[104:107]
    buffer_load_dwordx4 v19, s[36:39], s11 offen offset:2048 lds
    v_mfma_f32_16x16x32_bf16 v[108:111], a[212:215], a[28:31], v[108:111]
    ds_read_b64_tr_b16 a[198:199], v13 offset:23552
    v_mfma_f32_16x16x32_bf16 v[108:111], a[208:211], a[24:27], v[108:111]
    s_waitcnt lgkmcnt(4)
    v_mfma_f32_16x16x32_bf16 v[124:127], a[216:219], a[24:27], v[124:127]
    ds_read_b64_tr_b16 a[200:201], v14 offset:2048
    v_mfma_f32_16x16x32_bf16 v[124:127], a[220:223], a[28:31], v[124:127]
    buffer_load_dwordx4 v20, s[36:39], s11 offen offset:3072 lds
    v_mfma_f32_16x16x32_bf16 v[120:123], a[220:223], a[20:23], v[120:123]
    ds_read_b64_tr_b16 a[202:203], v14 offset:22528
    v_mfma_f32_16x16x32_bf16 v[120:123], a[216:219], a[16:19], v[120:123]
    v_mfma_f32_16x16x32_bf16 v[116:119], a[216:219], a[8:11], v[116:119]
    ds_read_b64_tr_b16 a[204:205], v14 offset:3072
    v_mfma_f32_16x16x32_bf16 v[116:119], a[220:223], a[12:15], v[116:119]
    buffer_load_dwordx4 a[96:99], v3, s[44:47], s89 offen offset:0 sc1
    v_mfma_f32_16x16x32_bf16 v[112:115], a[220:223], a[4:7], v[112:115]
    ds_read_b64_tr_b16 a[206:207], v14 offset:23552
    v_mfma_f32_16x16x32_bf16 v[112:115], a[216:219], a[0:3], v[112:115]
    s_waitcnt lgkmcnt(4)
    v_mfma_f32_16x16x32_bf16 v[144:147], a[192:195], a[0:3], v[144:147]
    ds_read_b64_tr_b16 a[208:209], v13 offset:2560
    v_mfma_f32_16x16x32_bf16 v[144:147], a[196:199], a[4:7], v[144:147]
    buffer_load_dwordx4 a[100:103], v3, s[44:47], s89 offen offset:1024 sc1
    v_mfma_f32_16x16x32_bf16 v[148:151], a[196:199], a[12:15], v[148:151]
    ds_read_b64_tr_b16 a[210:211], v13 offset:23040
    v_mfma_f32_16x16x32_bf16 v[148:151], a[192:195], a[8:11], v[148:151]
    v_mfma_f32_16x16x32_bf16 v[152:155], a[192:195], a[16:19], v[152:155]
    ds_read_b64_tr_b16 a[212:213], v13 offset:3584
    v_mfma_f32_16x16x32_bf16 v[152:155], a[196:199], a[20:23], v[152:155]
    buffer_load_dwordx4 a[104:107], v4, s[44:47], s89 offen offset:0 sc1
    v_mfma_f32_16x16x32_bf16 v[156:159], a[196:199], a[28:31], v[156:159]
    ds_read_b64_tr_b16 a[214:215], v13 offset:24064
    v_mfma_f32_16x16x32_bf16 v[156:159], a[192:195], a[24:27], v[156:159]
    s_waitcnt lgkmcnt(4)
    v_mfma_f32_16x16x32_bf16 v[188:191], a[200:203], a[24:27], v[188:191]
    ds_read_b64_tr_b16 a[216:217], v14 offset:2560
    v_mfma_f32_16x16x32_bf16 v[188:191], a[204:207], a[28:31], v[188:191]
    buffer_load_dwordx4 a[108:111], v4, s[44:47], s89 offen offset:1024 sc1
    v_mfma_f32_16x16x32_bf16 v[184:187], a[204:207], a[20:23], v[184:187]
    ds_read_b64_tr_b16 a[218:219], v14 offset:23040
    v_mfma_f32_16x16x32_bf16 v[184:187], a[200:203], a[16:19], v[184:187]
    v_mfma_f32_16x16x32_bf16 v[180:183], a[200:203], a[8:11], v[180:183]
    ds_read_b64_tr_b16 a[220:221], v14 offset:3584
    v_mfma_f32_16x16x32_bf16 v[180:183], a[204:207], a[12:15], v[180:183]
    buffer_load_dwordx4 a[112:115], v5, s[44:47], s89 offen offset:0 sc1
    v_mfma_f32_16x16x32_bf16 v[176:179], a[204:207], a[4:7], v[176:179]
    ds_read_b64_tr_b16 a[222:223], v14 offset:24064
    v_mfma_f32_16x16x32_bf16 v[176:179], a[200:203], a[0:3], v[176:179]
    s_waitcnt lgkmcnt(4)
    v_mfma_f32_16x16x32_bf16 v[208:211], a[208:211], a[0:3], v[208:211]
    ds_read_b64_tr_b16 a[192:193], v9 offset:4096
    v_mfma_f32_16x16x32_bf16 v[208:211], a[212:215], a[4:7], v[208:211]
    buffer_load_dwordx4 a[116:119], v5, s[44:47], s89 offen offset:1024 sc1
    v_mfma_f32_16x16x32_bf16 v[212:215], a[212:215], a[12:15], v[212:215]
    ds_read_b64_tr_b16 a[194:195], v9 offset:24576
    v_mfma_f32_16x16x32_bf16 v[212:215], a[208:211], a[8:11], v[212:215]
    v_mfma_f32_16x16x32_bf16 v[216:219], a[208:211], a[16:19], v[216:219]
    ds_read_b64_tr_b16 a[196:197], v9 offset:5120
    v_mfma_f32_16x16x32_bf16 v[216:219], a[212:215], a[20:23], v[216:219]
    buffer_load_dwordx4 a[120:123], v6, s[44:47], s89 offen offset:0 sc1
    v_mfma_f32_16x16x32_bf16 v[220:223], a[212:215], a[28:31], v[220:223]
    ds_read_b64_tr_b16 a[198:199], v9 offset:25600
    v_mfma_f32_16x16x32_bf16 v[220:223], a[208:211], a[24:27], v[220:223]
    s_waitcnt lgkmcnt(4)
    v_mfma_f32_16x16x32_bf16 v[252:255], a[216:219], a[24:27], v[252:255]
    ds_read_b64_tr_b16 a[200:201], v10 offset:4096
    v_mfma_f32_16x16x32_bf16 v[252:255], a[220:223], a[28:31], v[252:255]
    buffer_load_dwordx4 a[124:127], v6, s[44:47], s89 offen offset:1024 sc1
    v_mfma_f32_16x16x32_bf16 v[248:251], a[220:223], a[20:23], v[248:251]
    ds_read_b64_tr_b16 a[202:203], v10 offset:24576
    v_mfma_f32_16x16x32_bf16 v[248:251], a[216:219], a[16:19], v[248:251]
    v_mfma_f32_16x16x32_bf16 v[244:247], a[216:219], a[8:11], v[244:247]
    ds_read_b64_tr_b16 a[204:205], v10 offset:5120
    s_add_u32 m0, s19, 8192
    v_mfma_f32_16x16x32_bf16 v[244:247], a[220:223], a[12:15], v[244:247]
    s_mov_b32 s11, 262144
    v_mfma_f32_16x16x32_bf16 v[240:243], a[220:223], a[4:7], v[240:243]
    ds_read_b64_tr_b16 a[206:207], v10 offset:25600
    v_mfma_f32_16x16x32_bf16 v[240:243], a[216:219], a[0:3], v[240:243]
    s_getpc_b64 s[94:95]
L_ct5973:
    s_lshr_b32 s74, s2, 4
    s_lshl_b32 s74, s74, 2
    s_add_u32 s74, s74, s3
    s_mul_i32 s74, s74, 256
    v_min_u32 v22, 1, v1
    v_lshl_add_u32 v22, v22, 7, s74
    v_add_u32 v22, L_P2_d-L_ct5973, v22
    v_min_u32 v22, L_end-L_ct5973-4, v22
    v_mov_b32 v23, s95
    v_add_co_u32 v22, vcc, s94, v22
    s_nop 1
    v_addc_co_u32 v23, vcc, 0, v23, vcc
    global_load_dword v0, v[22:23], off
    s_waitcnt vmcnt(34) lgkmcnt(4)
    v_mfma_f32_16x16x32_bf16 v[64:67], a[192:195], a[128:131], v[64:67]
    ds_read_b64_tr_b16 a[208:209], v9 offset:4608
    v_mfma_f32_16x16x32_bf16 v[64:67], a[196:199], a[132:135], v[64:67]
    buffer_load_dwordx4 v17, s[36:39], s11 offen offset:0 lds
    v_mfma_f32_16x16x32_bf16 v[68:71], a[196:199], a[140:143], v[68:71]
    ds_read_b64_tr_b16 a[210:211], v9 offset:25088
    v_mfma_f32_16x16x32_bf16 v[68:71], a[192:195], a[136:139], v[68:71]
    v_mfma_f32_16x16x32_bf16 v[72:75], a[192:195], a[144:147], v[72:75]
    ds_read_b64_tr_b16 a[212:213], v9 offset:5632
    v_mfma_f32_16x16x32_bf16 v[72:75], a[196:199], a[148:151], v[72:75]
    buffer_load_dwordx4 v18, s[36:39], s11 offen offset:1024 lds
    v_mfma_f32_16x16x32_bf16 v[76:79], a[196:199], a[156:159], v[76:79]
    ds_read_b64_tr_b16 a[214:215], v9 offset:26112
    v_mfma_f32_16x16x32_bf16 v[76:79], a[192:195], a[152:155], v[76:79]
    s_waitcnt vmcnt(53) lgkmcnt(4)
    s_barrier
    v_mfma_f32_16x16x32_bf16 v[92:95], a[200:203], a[152:155], v[92:95]
    ds_read_b64_tr_b16 a[216:217], v10 offset:4608
    s_add_u32 m0, s19, 47104
    v_mfma_f32_16x16x32_bf16 v[92:95], a[204:207], a[156:159], v[92:95]
    buffer_load_dwordx4 v19, s[36:39], s11 offen offset:2048 lds
    v_mfma_f32_16x16x32_bf16 v[88:91], a[204:207], a[148:151], v[88:91]
    ds_read_b64_tr_b16 a[218:219], v10 offset:25088
    v_mfma_f32_16x16x32_bf16 v[88:91], a[200:203], a[144:147], v[88:91]
    v_mfma_f32_16x16x32_bf16 v[84:87], a[200:203], a[136:139], v[84:87]
    ds_read_b64_tr_b16 a[220:221], v10 offset:5632
    v_mfma_f32_16x16x32_bf16 v[84:87], a[204:207], a[140:143], v[84:87]
    buffer_load_dwordx4 v20, s[36:39], s11 offen offset:3072 lds
    v_mfma_f32_16x16x32_bf16 v[80:83], a[204:207], a[132:135], v[80:83]
    ds_read_b64_tr_b16 a[222:223], v10 offset:26112
    v_mfma_f32_16x16x32_bf16 v[80:83], a[200:203], a[128:131], v[80:83]
    s_waitcnt lgkmcnt(4)
    v_mfma_f32_16x16x32_bf16 v[96:99], a[208:211], a[128:131], v[96:99]
    ds_read_b64_tr_b16 a[192:193], v9 offset:6144
    s_add_u32 m0, s19, 122880
    v_mfma_f32_16x16x32_bf16 v[96:99], a[212:215], a[132:135], v[96:99]
    s_mov_b32 s11, 393216
    v_mfma_f32_16x16x32_bf16 v[100:103], a[212:215], a[140:143], v[100:103]
    ds_read_b64_tr_b16 a[194:195], v9 offset:26624
    v_mfma_f32_16x16x32_bf16 v[100:103], a[208:211], a[136:139], v[100:103]
    buffer_load_dwordx4 v17, s[36:39], s11 offen offset:0 lds
    v_mfma_f32_16x16x32_bf16 v[104:107], a[208:211], a[144:147], v[104:107]
    ds_read_b64_tr_b16 a[196:197], v9 offset:7168
    v_mfma_f32_16x16x32_bf16 v[104:107], a[212:215], a[148:151], v[104:107]
    v_mfma_f32_16x16x32_bf16 v[108:111], a[212:215], a[156:159], v[108:111]
    ds_read_b64_tr_b16 a[198:199], v9 offset:27648
    v_mfma_f32_16x16x32_bf16 v[108:111], a[208:211], a[152:155], v[108:111]
    s_waitcnt lgkmcnt(4)
    v_mfma_f32_16x16x32_bf16 v[124:127], a[216:219], a[152:155], v[124:127]
    ds_read_b64_tr_b16 a[200:201], v10 offset:6144
    v_mfma_f32_16x16x32_bf16 v[124:127], a[220:223], a[156:159], v[124:127]
    buffer_load_dwordx4 v18, s[36:39], s11 offen offset:1024 lds
    v_mfma_f32_16x16x32_bf16 v[120:123], a[220:223], a[148:151], v[120:123]
    ds_read_b64_tr_b16 a[202:203], v10 offset:26624
    v_mfma_f32_16x16x32_bf16 v[120:123], a[216:219], a[144:147], v[120:123]
    v_mfma_f32_16x16x32_bf16 v[116:119], a[216:219], a[136:139], v[116:119]
    ds_read_b64_tr_b16 a[204:205], v10 offset:7168
    v_mfma_f32_16x16x32_bf16 v[116:119], a[220:223], a[140:143], v[116:119]
    buffer_load_dwordx4 v19, s[36:39], s11 offen offset:2048 lds
    v_mfma_f32_16x16x32_bf16 v[112:115], a[220:223], a[132:135], v[112:115]
    ds_read_b64_tr_b16 a[206:207], v10 offset:27648
    v_mfma_f32_16x16x32_bf16 v[112:115], a[216:219], a[128:131], v[112:115]
    s_waitcnt lgkmcnt(4)
    v_mfma_f32_16x16x32_bf16 v[144:147], a[192:195], a[128:131], v[144:147]
    ds_read_b64_tr_b16 a[208:209], v9 offset:6656
    v_mfma_f32_16x16x32_bf16 v[144:147], a[196:199], a[132:135], v[144:147]
    buffer_load_dwordx4 v20, s[36:39], s11 offen offset:3072 lds
    v_mfma_f32_16x16x32_bf16 v[148:151], a[196:199], a[140:143], v[148:151]
    ds_read_b64_tr_b16 a[210:211], v9 offset:27136
    v_mfma_f32_16x16x32_bf16 v[148:151], a[192:195], a[136:139], v[148:151]
    v_mfma_f32_16x16x32_bf16 v[152:155], a[192:195], a[144:147], v[152:155]
    ds_read_b64_tr_b16 a[212:213], v9 offset:7680
    s_add_u32 m0, s19, 90112
    v_mfma_f32_16x16x32_bf16 v[152:155], a[196:199], a[148:151], v[152:155]
    s_mov_b32 s11, 524288
    v_mfma_f32_16x16x32_bf16 v[156:159], a[196:199], a[156:159], v[156:159]
    ds_read_b64_tr_b16 a[214:215], v9 offset:28160
    v_mfma_f32_16x16x32_bf16 v[156:159], a[192:195], a[152:155], v[156:159]
    s_waitcnt lgkmcnt(4)
    v_mfma_f32_16x16x32_bf16 v[188:191], a[200:203], a[152:155], v[188:191]
    ds_read_b64_tr_b16 a[216:217], v10 offset:6656
    v_mfma_f32_16x16x32_bf16 v[188:191], a[204:207], a[156:159], v[188:191]
    buffer_load_dwordx4 v17, s[36:39], s11 offen offset:0 lds
    v_mfma_f32_16x16x32_bf16 v[184:187], a[204:207], a[148:151], v[184:187]
    ds_read_b64_tr_b16 a[218:219], v10 offset:27136
    v_mfma_f32_16x16x32_bf16 v[184:187], a[200:203], a[144:147], v[184:187]
    v_mfma_f32_16x16x32_bf16 v[180:183], a[200:203], a[136:139], v[180:183]
    ds_read_b64_tr_b16 a[220:221], v10 offset:7680
    v_mfma_f32_16x16x32_bf16 v[180:183], a[204:207], a[140:143], v[180:183]
    buffer_load_dwordx4 v18, s[36:39], s11 offen offset:1024 lds
    v_mfma_f32_16x16x32_bf16 v[176:179], a[204:207], a[132:135], v[176:179]
    ds_read_b64_tr_b16 a[222:223], v10 offset:28160
    v_mfma_f32_16x16x32_bf16 v[176:179], a[200:203], a[128:131], v[176:179]
    s_waitcnt lgkmcnt(4)
    v_mfma_f32_16x16x32_bf16 v[208:211], a[208:211], a[128:131], v[208:211]
    ds_read_b64_tr_b16 a[192:193], v11 offset:4096
    s_add_u32 m0, s19, 129024
    v_mfma_f32_16x16x32_bf16 v[208:211], a[212:215], a[132:135], v[208:211]
    buffer_load_dwordx4 v19, s[36:39], s11 offen offset:2048 lds
    v_mfma_f32_16x16x32_bf16 v[212:215], a[212:215], a[140:143], v[212:215]
    ds_read_b64_tr_b16 a[194:195], v11 offset:24576
    v_mfma_f32_16x16x32_bf16 v[212:215], a[208:211], a[136:139], v[212:215]
    v_mfma_f32_16x16x32_bf16 v[216:219], a[208:211], a[144:147], v[216:219]
    ds_read_b64_tr_b16 a[196:197], v11 offset:5120
    v_mfma_f32_16x16x32_bf16 v[216:219], a[212:215], a[148:151], v[216:219]
    buffer_load_dwordx4 v20, s[36:39], s11 offen offset:3072 lds
    v_mfma_f32_16x16x32_bf16 v[220:223], a[212:215], a[156:159], v[220:223]
    ds_read_b64_tr_b16 a[198:199], v11 offset:25600
    v_mfma_f32_16x16x32_bf16 v[220:223], a[208:211], a[152:155], v[220:223]
    s_waitcnt lgkmcnt(4)
    v_mfma_f32_16x16x32_bf16 v[252:255], a[216:219], a[152:155], v[252:255]
    ds_read_b64_tr_b16 a[200:201], v12 offset:4096
    v_mfma_f32_16x16x32_bf16 v[252:255], a[220:223], a[156:159], v[252:255]
    v_mfma_f32_16x16x32_bf16 v[248:251], a[220:223], a[148:151], v[248:251]
    ds_read_b64_tr_b16 a[202:203], v12 offset:24576
    v_mfma_f32_16x16x32_bf16 v[248:251], a[216:219], a[144:147], v[248:251]
    v_mfma_f32_16x16x32_bf16 v[244:247], a[216:219], a[136:139], v[244:247]
    ds_read_b64_tr_b16 a[204:205], v12 offset:5120
    v_mfma_f32_16x16x32_bf16 v[244:247], a[220:223], a[140:143], v[244:247]
    v_mfma_f32_16x16x32_bf16 v[240:243], a[220:223], a[132:135], v[240:243]
    ds_read_b64_tr_b16 a[206:207], v12 offset:25600
    v_mfma_f32_16x16x32_bf16 v[240:243], a[216:219], a[128:131], v[240:243]
    v_and_b32 v16, 15, v1
    v_lshlrev_b32 v16, 2, v16
    buffer_load_dword v16, v16, s[52:55], s64 offen offset:0 sc1
    s_waitcnt lgkmcnt(4)
    v_mfma_f32_16x16x32_bf16 v[64:67], a[192:195], v[32:35], v[64:67]
    ds_read_b64_tr_b16 a[208:209], v11 offset:4608
    v_mfma_f32_16x16x32_bf16 v[64:67], a[196:199], v[48:51], v[64:67]
    buffer_load_dwordx4 a[128:131], v3, s[44:47], s90 offen offset:0 sc1
    v_mfma_f32_16x16x32_bf16 v[68:71], a[196:199], v[52:55], v[68:71]
    ds_read_b64_tr_b16 a[210:211], v11 offset:25088
    v_mfma_f32_16x16x32_bf16 v[68:71], a[192:195], v[36:39], v[68:71]
    v_mfma_f32_16x16x32_bf16 v[72:75], a[192:195], v[40:43], v[72:75]
    ds_read_b64_tr_b16 a[212:213], v11 offset:5632
    v_mfma_f32_16x16x32_bf16 v[72:75], a[196:199], v[56:59], v[72:75]
    buffer_load_dwordx4 a[132:135], v3, s[44:47], s90 offen offset:1024 sc1
    v_mfma_f32_16x16x32_bf16 v[76:79], a[196:199], v[60:63], v[76:79]
    ds_read_b64_tr_b16 a[214:215], v11 offset:26112
    v_mfma_f32_16x16x32_bf16 v[76:79], a[192:195], v[44:47], v[76:79]
    s_waitcnt vmcnt(45) lgkmcnt(4)
    s_barrier
    v_mfma_f32_16x16x32_bf16 v[92:95], a[200:203], v[44:47], v[92:95]
    ds_read_b64_tr_b16 a[216:217], v12 offset:4608
    v_mfma_f32_16x16x32_bf16 v[92:95], a[204:207], v[60:63], v[92:95]
    buffer_load_dwordx4 a[136:139], v4, s[44:47], s90 offen offset:0 sc1
    v_mfma_f32_16x16x32_bf16 v[88:91], a[204:207], v[56:59], v[88:91]
    ds_read_b64_tr_b16 a[218:219], v12 offset:25088
    v_mfma_f32_16x16x32_bf16 v[88:91], a[200:203], v[40:43], v[88:91]
    v_mfma_f32_16x16x32_bf16 v[84:87], a[200:203], v[36:39], v[84:87]
    ds_read_b64_tr_b16 a[220:221], v12 offset:5632
    v_mfma_f32_16x16x32_bf16 v[84:87], a[204:207], v[52:55], v[84:87]
    buffer_load_dwordx4 a[140:143], v4, s[44:47], s90 offen offset:1024 sc1
    v_mfma_f32_16x16x32_bf16 v[80:83], a[204:207], v[48:51], v[80:83]
    ds_read_b64_tr_b16 a[222:223], v12 offset:26112
    v_mfma_f32_16x16x32_bf16 v[80:83], a[200:203], v[32:35], v[80:83]
    s_waitcnt lgkmcnt(4)
    v_mfma_f32_16x16x32_bf16 v[96:99], a[208:211], v[32:35], v[96:99]
    ds_read_b64_tr_b16 a[192:193], v11 offset:6144
    v_mfma_f32_16x16x32_bf16 v[96:99], a[212:215], v[48:51], v[96:99]
    buffer_load_dwordx4 a[144:147], v5, s[44:47], s90 offen offset:0 sc1
    v_mfma_f32_16x16x32_bf16 v[100:103], a[212:215], v[52:55], v[100:103]
    ds_read_b64_tr_b16 a[194:195], v11 offset:26624
    v_mfma_f32_16x16x32_bf16 v[100:103], a[208:211], v[36:39], v[100:103]
    v_mfma_f32_16x16x32_bf16 v[104:107], a[208:211], v[40:43], v[104:107]
    ds_read_b64_tr_b16 a[196:197], v11 offset:7168
    v_mfma_f32_16x16x32_bf16 v[104:107], a[212:215], v[56:59], v[104:107]
    buffer_load_dwordx4 a[148:151], v5, s[44:47], s90 offen offset:1024 sc1
    v_mfma_f32_16x16x32_bf16 v[108:111], a[212:215], v[60:63], v[108:111]
    ds_read_b64_tr_b16 a[198:199], v11 offset:27648
    v_mfma_f32_16x16x32_bf16 v[108:111], a[208:211], v[44:47], v[108:111]
    s_waitcnt lgkmcnt(4)
    v_mfma_f32_16x16x32_bf16 v[124:127], a[216:219], v[44:47], v[124:127]
    ds_read_b64_tr_b16 a[200:201], v12 offset:6144
    v_mfma_f32_16x16x32_bf16 v[124:127], a[220:223], v[60:63], v[124:127]
    buffer_load_dwordx4 a[152:155], v6, s[44:47], s90 offen offset:0 sc1
    v_mfma_f32_16x16x32_bf16 v[120:123], a[220:223], v[56:59], v[120:123]
    ds_read_b64_tr_b16 a[202:203], v12 offset:26624
    v_mfma_f32_16x16x32_bf16 v[120:123], a[216:219], v[40:43], v[120:123]
    v_mfma_f32_16x16x32_bf16 v[116:119], a[216:219], v[36:39], v[116:119]
    ds_read_b64_tr_b16 a[204:205], v12 offset:7168
    v_mfma_f32_16x16x32_bf16 v[116:119], a[220:223], v[52:55], v[116:119]
    buffer_load_dwordx4 a[156:159], v6, s[44:47], s90 offen offset:1024 sc1
    v_mfma_f32_16x16x32_bf16 v[112:115], a[220:223], v[48:51], v[112:115]
    ds_read_b64_tr_b16 a[206:207], v12 offset:27648
    v_mfma_f32_16x16x32_bf16 v[112:115], a[216:219], v[32:35], v[112:115]
    s_waitcnt lgkmcnt(4)
    v_mfma_f32_16x16x32_bf16 v[144:147], a[192:195], v[32:35], v[144:147]
    ds_read_b64_tr_b16 a[208:209], v11 offset:6656
    v_mfma_f32_16x16x32_bf16 v[144:147], a[196:199], v[48:51], v[144:147]
    buffer_load_dwordx4 a[160:163], v3, s[44:47], s91 offen offset:0 sc1
    v_mfma_f32_16x16x32_bf16 v[148:151], a[196:199], v[52:55], v[148:151]
    ds_read_b64_tr_b16 a[210:211], v11 offset:27136
    v_mfma_f32_16x16x32_bf16 v[148:151], a[192:195], v[36:39], v[148:151]
    v_mfma_f32_16x16x32_bf16 v[152:155], a[192:195], v[40:43], v[152:155]
    ds_read_b64_tr_b16 a[212:213], v11 offset:7680
    v_mfma_f32_16x16x32_bf16 v[152:155], a[196:199], v[56:59], v[152:155]
    buffer_load_dwordx4 a[164:167], v3, s[44:47], s91 offen offset:1024 sc1
    v_mfma_f32_16x16x32_bf16 v[156:159], a[196:199], v[60:63], v[156:159]
    ds_read_b64_tr_b16 a[214:215], v11 offset:28160
    v_mfma_f32_16x16x32_bf16 v[156:159], a[192:195], v[44:47], v[156:159]
    s_waitcnt lgkmcnt(4)
    v_mfma_f32_16x16x32_bf16 v[188:191], a[200:203], v[44:47], v[188:191]
    ds_read_b64_tr_b16 a[216:217], v12 offset:6656
    v_mfma_f32_16x16x32_bf16 v[188:191], a[204:207], v[60:63], v[188:191]
    buffer_load_dwordx4 a[168:171], v4, s[44:47], s91 offen offset:0 sc1
    v_mfma_f32_16x16x32_bf16 v[184:187], a[204:207], v[56:59], v[184:187]
    ds_read_b64_tr_b16 a[218:219], v12 offset:27136
    v_mfma_f32_16x16x32_bf16 v[184:187], a[200:203], v[40:43], v[184:187]
    v_mfma_f32_16x16x32_bf16 v[180:183], a[200:203], v[36:39], v[180:183]
    ds_read_b64_tr_b16 a[220:221], v12 offset:7680
    v_mfma_f32_16x16x32_bf16 v[180:183], a[204:207], v[52:55], v[180:183]
    buffer_load_dwordx4 a[172:175], v4, s[44:47], s91 offen offset:1024 sc1
    v_mfma_f32_16x16x32_bf16 v[176:179], a[204:207], v[48:51], v[176:179]
    ds_read_b64_tr_b16 a[222:223], v12 offset:28160
    v_mfma_f32_16x16x32_bf16 v[176:179], a[200:203], v[32:35], v[176:179]
    s_waitcnt lgkmcnt(4)
    v_mfma_f32_16x16x32_bf16 v[208:211], a[208:211], v[32:35], v[208:211]
    ds_read_b64_tr_b16 a[192:193], v13 offset:4096
    v_mfma_f32_16x16x32_bf16 v[208:211], a[212:215], v[48:51], v[208:211]
    buffer_load_dwordx4 a[176:179], v5, s[44:47], s91 offen offset:0 sc1
    v_mfma_f32_16x16x32_bf16 v[212:215], a[212:215], v[52:55], v[212:215]
    ds_read_b64_tr_b16 a[194:195], v13 offset:24576
    v_mfma_f32_16x16x32_bf16 v[212:215], a[208:211], v[36:39], v[212:215]
    v_mfma_f32_16x16x32_bf16 v[216:219], a[208:211], v[40:43], v[216:219]
    ds_read_b64_tr_b16 a[196:197], v13 offset:5120
    v_mfma_f32_16x16x32_bf16 v[216:219], a[212:215], v[56:59], v[216:219]
    buffer_load_dwordx4 a[180:183], v5, s[44:47], s91 offen offset:1024 sc1
    v_mfma_f32_16x16x32_bf16 v[220:223], a[212:215], v[60:63], v[220:223]
    ds_read_b64_tr_b16 a[198:199], v13 offset:25600
    v_mfma_f32_16x16x32_bf16 v[220:223], a[208:211], v[44:47], v[220:223]
    s_waitcnt lgkmcnt(4)
    v_mfma_f32_16x16x32_bf16 v[252:255], a[216:219], v[44:47], v[252:255]
    ds_read_b64_tr_b16 a[200:201], v14 offset:4096
    v_mfma_f32_16x16x32_bf16 v[252:255], a[220:223], v[60:63], v[252:255]
    buffer_load_dwordx4 a[184:187], v6, s[44:47], s91 offen offset:0 sc1
    v_mfma_f32_16x16x32_bf16 v[248:251], a[220:223], v[56:59], v[248:251]
    ds_read_b64_tr_b16 a[202:203], v14 offset:24576
    v_mfma_f32_16x16x32_bf16 v[248:251], a[216:219], v[40:43], v[248:251]
    v_mfma_f32_16x16x32_bf16 v[244:247], a[216:219], v[36:39], v[244:247]
    ds_read_b64_tr_b16 a[204:205], v14 offset:5120
    v_mfma_f32_16x16x32_bf16 v[244:247], a[220:223], v[52:55], v[244:247]
    buffer_load_dwordx4 a[188:191], v6, s[44:47], s91 offen offset:1024 sc1
    v_mfma_f32_16x16x32_bf16 v[240:243], a[220:223], v[48:51], v[240:243]
    ds_read_b64_tr_b16 a[206:207], v14 offset:25600
    v_mfma_f32_16x16x32_bf16 v[240:243], a[216:219], v[32:35], v[240:243]
L_P2_d:
    s_waitcnt vmcnt(16)
    v_cmp_ne_u32 vcc, s18, v16
    s_cbranch_vccnz L_pl10_d
L_pl10_b_d:
    s_waitcnt vmcnt(16) lgkmcnt(4)
    v_mfma_f32_16x16x32_bf16 v[64:67], a[192:195], a[96:99], v[64:67]
    ds_read_b64_tr_b16 a[208:209], v13 offset:4608
    v_mfma_f32_16x16x32_bf16 v[64:67], a[196:199], a[100:103], v[64:67]
    v_mfma_f32_16x16x32_bf16 v[68:71], a[196:199], a[108:111], v[68:71]
    ds_read_b64_tr_b16 a[210:211], v13 offset:25088
    s_mov_b32 s10, 458752
    v_mfma_f32_16x16x32_bf16 v[68:71], a[192:195], a[104:107], v[68:71]
    buffer_load_dwordx4 a[32:35], v3, s[44:47], s10 offen offset:0 sc1
    v_mfma_f32_16x16x32_bf16 v[72:75], a[192:195], a[112:115], v[72:75]
    ds_read_b64_tr_b16 a[212:213], v13 offset:5632
    v_mfma_f32_16x16x32_bf16 v[72:75], a[196:199], a[116:119], v[72:75]
    v_mfma_f32_16x16x32_bf16 v[76:79], a[196:199], a[124:127], v[76:79]
    ds_read_b64_tr_b16 a[214:215], v13 offset:26112
    v_mfma_f32_16x16x32_bf16 v[76:79], a[192:195], a[120:123], v[76:79]
    s_waitcnt vmcnt(56) lgkmcnt(4)
    s_barrier
    v_mfma_f32_16x16x32_bf16 v[92:95], a[200:203], a[120:123], v[92:95]
    ds_read_b64_tr_b16 a[216:217], v14 offset:4608
    v_mfma_f32_16x16x32_bf16 v[92:95], a[204:207], a[124:127], v[92:95]
    buffer_load_dwordx4 a[36:39], v3, s[44:47], s10 offen offset:1024 sc1
    v_mfma_f32_16x16x32_bf16 v[88:91], a[204:207], a[116:119], v[88:91]
    ds_read_b64_tr_b16 a[218:219], v14 offset:25088
    v_mfma_f32_16x16x32_bf16 v[88:91], a[200:203], a[112:115], v[88:91]
    v_mfma_f32_16x16x32_bf16 v[84:87], a[200:203], a[104:107], v[84:87]
    ds_read_b64_tr_b16 a[220:221], v14 offset:5632
    s_mov_b32 s10, 466944
    v_mfma_f32_16x16x32_bf16 v[84:87], a[204:207], a[108:111], v[84:87]
    buffer_load_dwordx4 a[40:43], v3, s[44:47], s10 offen offset:0 sc1
    v_mfma_f32_16x16x32_bf16 v[80:83], a[204:207], a[100:103], v[80:83]
    ds_read_b64_tr_b16 a[222:223], v14 offset:26112
    v_mfma_f32_16x16x32_bf16 v[80:83], a[200:203], a[96:99], v[80:83]
    s_waitcnt lgkmcnt(4)
    v_mfma_f32_16x16x32_bf16 v[96:99], a[208:211], a[96:99], v[96:99]
    ds_read_b64_tr_b16 a[192:193], v13 offset:6144
    v_mfma_f32_16x16x32_bf16 v[96:99], a[212:215], a[100:103], v[96:99]
    buffer_load_dwordx4 a[44:47], v3, s[44:47], s10 offen offset:1024 sc1
    v_mfma_f32_16x16x32_bf16 v[100:103], a[212:215], a[108:111], v[100:103]
    ds_read_b64_tr_b16 a[194:195], v13 offset:26624
    v_mfma_f32_16x16x32_bf16 v[100:103], a[208:211], a[104:107], v[100:103]
    v_mfma_f32_16x16x32_bf16 v[104:107], a[208:211], a[112:115], v[104:107]
    ds_read_b64_tr_b16 a[196:197], v13 offset:7168
    s_mov_b32 s10, 475136
    v_mfma_f32_16x16x32_bf16 v[104:107], a[212:215], a[116:119], v[104:107]
    buffer_load_dwordx4 a[48:51], v3, s[44:47], s10 offen offset:0 sc1
    v_mfma_f32_16x16x32_bf16 v[108:111], a[212:215], a[124:127], v[108:111]
    ds_read_b64_tr_b16 a[198:199], v13 offset:27648
    v_mfma_f32_16x16x32_bf16 v[108:111], a[208:211], a[120:123], v[108:111]
    s_waitcnt lgkmcnt(4)
    v_mfma_f32_16x16x32_bf16 v[124:127], a[216:219], a[120:123], v[124:127]
    ds_read_b64_tr_b16 a[200:201], v14 offset:6144
    v_mfma_f32_16x16x32_bf16 v[124:127], a[220:223], a[124:127], v[124:127]
    buffer_load_dwordx4 a[52:55], v3, s[44:47], s10 offen offset:1024 sc1
    v_mfma_f32_16x16x32_bf16 v[120:123], a[220:223], a[116:119], v[120:123]
    ds_read_b64_tr_b16 a[202:203], v14 offset:26624
    v_mfma_f32_16x16x32_bf16 v[120:123], a[216:219], a[112:115], v[120:123]
    v_mfma_f32_16x16x32_bf16 v[116:119], a[216:219], a[104:107], v[116:119]
    ds_read_b64_tr_b16 a[204:205], v14 offset:7168
    s_mov_b32 s10, 483328
    v_mfma_f32_16x16x32_bf16 v[116:119], a[220:223], a[108:111], v[116:119]
    buffer_load_dwordx4 a[56:59], v3, s[44:47], s10 offen offset:0 sc1
    v_mfma_f32_16x16x32_bf16 v[112:115], a[220:223], a[100:103], v[112:115]
    ds_read_b64_tr_b16 a[206:207], v14 offset:27648
    v_mfma_f32_16x16x32_bf16 v[112:115], a[216:219], a[96:99], v[112:115]
    s_waitcnt lgkmcnt(4)
    v_mfma_f32_16x16x32_bf16 v[144:147], a[192:195], a[96:99], v[144:147]
    ds_read_b64_tr_b16 a[208:209], v13 offset:6656
    v_mfma_f32_16x16x32_bf16 v[144:147], a[196:199], a[100:103], v[144:147]
    buffer_load_dwordx4 a[60:63], v3, s[44:47], s10 offen offset:1024 sc1
    v_mfma_f32_16x16x32_bf16 v[148:151], a[196:199], a[108:111], v[148:151]
    ds_read_b64_tr_b16 a[210:211], v13 offset:27136
    v_mfma_f32_16x16x32_bf16 v[148:151], a[192:195], a[104:107], v[148:151]
    v_mfma_f32_16x16x32_bf16 v[152:155], a[192:195], a[112:115], v[152:155]
    ds_read_b64_tr_b16 a[212:213], v13 offset:7680
    s_mov_b32 s10, 491520
    v_mfma_f32_16x16x32_bf16 v[152:155], a[196:199], a[116:119], v[152:155]
    buffer_load_dwordx4 a[0:3], v3, s[44:47], s10 offen offset:0 sc1
    v_mfma_f32_16x16x32_bf16 v[156:159], a[196:199], a[124:127], v[156:159]
    ds_read_b64_tr_b16 a[214:215], v13 offset:28160
    v_mfma_f32_16x16x32_bf16 v[156:159], a[192:195], a[120:123], v[156:159]
    s_waitcnt lgkmcnt(4)
    v_mfma_f32_16x16x32_bf16 v[188:191], a[200:203], a[120:123], v[188:191]
    ds_read_b64_tr_b16 a[216:217], v14 offset:6656
    v_mfma_f32_16x16x32_bf16 v[188:191], a[204:207], a[124:127], v[188:191]
    buffer_load_dwordx4 a[4:7], v3, s[44:47], s10 offen offset:1024 sc1
    v_mfma_f32_16x16x32_bf16 v[184:187], a[204:207], a[116:119], v[184:187]
    ds_read_b64_tr_b16 a[218:219], v14 offset:27136
    v_mfma_f32_16x16x32_bf16 v[184:187], a[200:203], a[112:115], v[184:187]
    v_mfma_f32_16x16x32_bf16 v[180:183], a[200:203], a[104:107], v[180:183]
    ds_read_b64_tr_b16 a[220:221], v14 offset:7680
    s_mov_b32 s10, 499712
    v_mfma_f32_16x16x32_bf16 v[180:183], a[204:207], a[108:111], v[180:183]
    buffer_load_dwordx4 a[8:11], v3, s[44:47], s10 offen offset:0 sc1
    v_mfma_f32_16x16x32_bf16 v[176:179], a[204:207], a[100:103], v[176:179]
    ds_read_b64_tr_b16 a[222:223], v14 offset:28160
    v_mfma_f32_16x16x32_bf16 v[176:179], a[200:203], a[96:99], v[176:179]
    s_waitcnt lgkmcnt(4)
    v_mfma_f32_16x16x32_bf16 v[208:211], a[208:211], a[96:99], v[208:211]
    ds_read_b64_tr_b16 a[192:193], v7 offset:0
    v_mfma_f32_16x16x32_bf16 v[208:211], a[212:215], a[100:103], v[208:211]
    buffer_load_dwordx4 a[12:15], v3, s[44:47], s10 offen offset:1024 sc1
    v_mfma_f32_16x16x32_bf16 v[212:215], a[212:215], a[108:111], v[212:215]
    ds_read_b64_tr_b16 a[194:195], v7 offset:20480
    v_mfma_f32_16x16x32_bf16 v[212:215], a[208:211], a[104:107], v[212:215]
    v_mfma_f32_16x16x32_bf16 v[216:219], a[208:211], a[112:115], v[216:219]
    ds_read_b64_tr_b16 a[196:197], v7 offset:1024
    s_mov_b32 s10, 507904
    v_mfma_f32_16x16x32_bf16 v[216:219], a[212:215], a[116:119], v[216:219]
    buffer_load_dwordx4 a[16:19], v3, s[44:47], s10 offen offset:0 sc1
    v_mfma_f32_16x16x32_bf16 v[220:223], a[212:215], a[124:127], v[220:223]
    ds_read_b64_tr_b16 a[198:199], v7 offset:21504
    v_mfma_f32_16x16x32_bf16 v[220:223], a[208:211], a[120:123], v[220:223]
    s_waitcnt lgkmcnt(4)
    v_mfma_f32_16x16x32_bf16 v[252:255], a[216:219], a[120:123], v[252:255]
    ds_read_b64_tr_b16 a[200:201], v8 offset:0
    v_mfma_f32_16x16x32_bf16 v[252:255], a[220:223], a[124:127], v[252:255]
    buffer_load_dwordx4 a[20:23], v3, s[44:47], s10 offen offset:1024 sc1
    v_mfma_f32_16x16x32_bf16 v[248:251], a[220:223], a[116:119], v[248:251]
    ds_read_b64_tr_b16 a[202:203], v8 offset:20480
    v_mfma_f32_16x16x32_bf16 v[248:251], a[216:219], a[112:115], v[248:251]
    v_mfma_f32_16x16x32_bf16 v[244:247], a[216:219], a[104:107], v[244:247]
    ds_read_b64_tr_b16 a[204:205], v8 offset:1024
    s_mov_b32 s10, 516096
    v_mfma_f32_16x16x32_bf16 v[244:247], a[220:223], a[108:111], v[244:247]
    buffer_load_dwordx4 a[24:27], v3, s[44:47], s10 offen offset:0 sc1
    v_mfma_f32_16x16x32_bf16 v[240:243], a[220:223], a[100:103], v[240:243]
    ds_read_b64_tr_b16 a[206:207], v8 offset:21504
    v_mfma_f32_16x16x32_bf16 v[240:243], a[216:219], a[96:99], v[240:243]
    s_waitcnt vmcnt(23) lgkmcnt(4)
    v_mfma_f32_16x16x32_bf16 v[64:67], a[192:195], a[128:131], v[64:67]
    ds_read_b64_tr_b16 a[208:209], v7 offset:512
    v_mfma_f32_16x16x32_bf16 v[64:67], a[196:199], a[132:135], v[64:67]
    buffer_load_dwordx4 a[28:31], v3, s[44:47], s10 offen offset:1024 sc1
    v_mfma_f32_16x16x32_bf16 v[68:71], a[196:199], a[140:143], v[68:71]
    ds_read_b64_tr_b16 a[210:211], v7 offset:20992
    v_mfma_f32_16x16x32_bf16 v[68:71], a[192:195], a[136:139], v[68:71]
    v_mfma_f32_16x16x32_bf16 v[72:75], a[192:195], a[144:147], v[72:75]
    ds_read_b64_tr_b16 a[212:213], v7 offset:1536
    s_add_u32 m0, s19, 45056
    v_mfma_f32_16x16x32_bf16 v[72:75], a[196:199], a[148:151], v[72:75]
    s_mov_b32 s11, 655360
    v_mfma_f32_16x16x32_bf16 v[76:79], a[196:199], a[156:159], v[76:79]
    ds_read_b64_tr_b16 a[214:215], v7 offset:22016
    v_mfma_f32_16x16x32_bf16 v[76:79], a[192:195], a[152:155], v[76:79]
    s_waitcnt vmcnt(63) lgkmcnt(4)
    s_barrier
    v_mfma_f32_16x16x32_bf16 v[92:95], a[200:203], a[152:155], v[92:95]
    ds_read_b64_tr_b16 a[216:217], v8 offset:512
    v_mfma_f32_16x16x32_bf16 v[92:95], a[204:207], a[156:159], v[92:95]
    buffer_load_dwordx4 v17, s[36:39], s11 offen offset:0 lds
    v_mfma_f32_16x16x32_bf16 v[88:91], a[204:207], a[148:151], v[88:91]
    ds_read_b64_tr_b16 a[218:219], v8 offset:20992
    v_mfma_f32_16x16x32_bf16 v[88:91], a[200:203], a[144:147], v[88:91]
    v_mfma_f32_16x16x32_bf16 v[84:87], a[200:203], a[136:139], v[84:87]
    ds_read_b64_tr_b16 a[220:221], v8 offset:1536
    v_mfma_f32_16x16x32_bf16 v[84:87], a[204:207], a[140:143], v[84:87]
    buffer_load_dwordx4 v18, s[36:39], s11 offen offset:1024 lds
    v_mfma_f32_16x16x32_bf16 v[80:83], a[204:207], a[132:135], v[80:83]
    ds_read_b64_tr_b16 a[222:223], v8 offset:22016
    v_mfma_f32_16x16x32_bf16 v[80:83], a[200:203], a[128:131], v[80:83]
    s_waitcnt lgkmcnt(4)
    v_mfma_f32_16x16x32_bf16 v[96:99], a[208:211], a[128:131], v[96:99]
    ds_read_b64_tr_b16 a[192:193], v7 offset:2048
    ds_read_b64_tr_b16 a[224:225], v7 offset:6144
    v_mfma_f32_16x16x32_bf16 v[96:99], a[212:215], a[132:135], v[96:99]
    buffer_load_dwordx4 v19, s[36:39], s11 offen offset:2048 lds
    v_mfma_f32_16x16x32_bf16 v[100:103], a[212:215], a[140:143], v[100:103]
    ds_read_b64_tr_b16 a[194:195], v7 offset:22528
    ds_read_b64_tr_b16 a[226:227], v7 offset:26624
    v_mfma_f32_16x16x32_bf16 v[100:103], a[208:211], a[136:139], v[100:103]
    v_mfma_f32_16x16x32_bf16 v[104:107], a[208:211], a[144:147], v[104:107]
    ds_read_b64_tr_b16 a[196:197], v7 offset:3072
    ds_read_b64_tr_b16 a[228:229], v7 offset:7168
    v_mfma_f32_16x16x32_bf16 v[104:107], a[212:215], a[148:151], v[104:107]
    buffer_load_dwordx4 v20, s[36:39], s11 offen offset:3072 lds
    v_mfma_f32_16x16x32_bf16 v[108:111], a[212:215], a[156:159], v[108:111]
    ds_read_b64_tr_b16 a[198:199], v7 offset:23552
    ds_read_b64_tr_b16 a[230:231], v7 offset:27648
    v_mfma_f32_16x16x32_bf16 v[108:111], a[208:211], a[152:155], v[108:111]
    s_waitcnt lgkmcnt(8)
    v_mfma_f32_16x16x32_bf16 v[124:127], a[216:219], a[152:155], v[124:127]
    ds_read_b64_tr_b16 a[200:201], v8 offset:2048
    ds_read_b64_tr_b16 a[232:233], v8 offset:6144
    v_mfma_f32_16x16x32_bf16 v[124:127], a[220:223], a[156:159], v[124:127]
    s_add_u32 m0, s19, 86016
    s_mov_b32 s11, 786432
    v_mfma_f32_16x16x32_bf16 v[120:123], a[220:223], a[148:151], v[120:123]
    ds_read_b64_tr_b16 a[202:203], v8 offset:22528
    ds_read_b64_tr_b16 a[234:235], v8 offset:26624
    v_mfma_f32_16x16x32_bf16 v[120:123], a[216:219], a[144:147], v[120:123]
    buffer_load_dwordx4 v17, s[36:39], s11 offen offset:0 lds
    v_mfma_f32_16x16x32_bf16 v[116:119], a[216:219], a[136:139], v[116:119]
    ds_read_b64_tr_b16 a[204:205], v8 offset:3072
    ds_read_b64_tr_b16 a[236:237], v8 offset:7168
    v_mfma_f32_16x16x32_bf16 v[116:119], a[220:223], a[140:143], v[116:119]
    v_mfma_f32_16x16x32_bf16 v[112:115], a[220:223], a[132:135], v[112:115]
    ds_read_b64_tr_b16 a[206:207], v8 offset:23552
    ds_read_b64_tr_b16 a[238:239], v8 offset:27648
    v_mfma_f32_16x16x32_bf16 v[112:115], a[216:219], a[128:131], v[112:115]
    s_waitcnt lgkmcnt(9)
    v_mfma_f32_16x16x32_bf16 v[144:147], a[192:195], a[128:131], v[144:147]
    ds_read_b64_tr_b16 a[208:209], v7 offset:2560
    ds_read_b64_tr_b16 a[240:241], v7 offset:6656
    v_mfma_f32_16x16x32_bf16 v[144:147], a[196:199], a[132:135], v[144:147]
    buffer_load_dwordx4 v18, s[36:39], s11 offen offset:1024 lds
    v_mfma_f32_16x16x32_bf16 v[148:151], a[196:199], a[140:143], v[148:151]
    ds_read_b64_tr_b16 a[210:211], v7 offset:23040
    ds_read_b64_tr_b16 a[242:243], v7 offset:27136
    v_mfma_f32_16x16x32_bf16 v[148:151], a[192:195], a[136:139], v[148:151]
    v_mfma_f32_16x16x32_bf16 v[152:155], a[192:195], a[144:147], v[152:155]
    ds_read_b64_tr_b16 a[212:213], v7 offset:3584
    ds_read_b64_tr_b16 a[244:245], v7 offset:7680
    v_mfma_f32_16x16x32_bf16 v[152:155], a[196:199], a[148:151], v[152:155]
    buffer_load_dwordx4 v19, s[36:39], s11 offen offset:2048 lds
    v_mfma_f32_16x16x32_bf16 v[156:159], a[196:199], a[156:159], v[156:159]
    ds_read_b64_tr_b16 a[214:215], v7 offset:24064
    ds_read_b64_tr_b16 a[246:247], v7 offset:28160
    v_mfma_f32_16x16x32_bf16 v[156:159], a[192:195], a[152:155], v[156:159]
    s_waitcnt lgkmcnt(9)
    v_mfma_f32_16x16x32_bf16 v[188:191], a[200:203], a[152:155], v[188:191]
    ds_read_b64_tr_b16 a[216:217], v8 offset:2560
    ds_read_b64_tr_b16 a[248:249], v8 offset:6656
    v_mfma_f32_16x16x32_bf16 v[188:191], a[204:207], a[156:159], v[188:191]
    buffer_load_dwordx4 v20, s[36:39], s11 offen offset:3072 lds
    v_mfma_f32_16x16x32_bf16 v[184:187], a[204:207], a[148:151], v[184:187]
    ds_read_b64_tr_b16 a[218:219], v8 offset:23040
    ds_read_b64_tr_b16 a[250:251], v8 offset:27136
    v_mfma_f32_16x16x32_bf16 v[184:187], a[200:203], a[144:147], v[184:187]
    v_mfma_f32_16x16x32_bf16 v[180:183], a[200:203], a[136:139], v[180:183]
    ds_read_b64_tr_b16 a[220:221], v8 offset:3584
    ds_read_b64_tr_b16 a[252:253], v8 offset:7680
    v_mfma_f32_16x16x32_bf16 v[180:183], a[204:207], a[140:143], v[180:183]
    s_add_u32 m0, s19, 126976
    s_mov_b32 s11, 917504
    v_mfma_f32_16x16x32_bf16 v[176:179], a[204:207], a[132:135], v[176:179]
    ds_read_b64_tr_b16 a[222:223], v8 offset:24064
    ds_read_b64_tr_b16 a[254:255], v8 offset:28160
    v_mfma_f32_16x16x32_bf16 v[176:179], a[200:203], a[128:131], v[176:179]
    s_waitcnt lgkmcnt(9)
    v_mfma_f32_16x16x32_bf16 v[208:211], a[208:211], a[128:131], v[208:211]
    ds_read_b64_tr_b16 a[192:193], v7 offset:4096
    v_mfma_f32_16x16x32_bf16 v[208:211], a[212:215], a[132:135], v[208:211]
    buffer_load_dwordx4 v17, s[36:39], s11 offen offset:0 lds
    v_mfma_f32_16x16x32_bf16 v[212:215], a[212:215], a[140:143], v[212:215]
    ds_read_b64_tr_b16 a[194:195], v7 offset:24576
    v_mfma_f32_16x16x32_bf16 v[212:215], a[208:211], a[136:139], v[212:215]
    v_mfma_f32_16x16x32_bf16 v[216:219], a[208:211], a[144:147], v[216:219]
    ds_read_b64_tr_b16 a[196:197], v7 offset:5120
    v_mfma_f32_16x16x32_bf16 v[216:219], a[212:215], a[148:151], v[216:219]
    buffer_load_dwordx4 v18, s[36:39], s11 offen offset:1024 lds
    v_mfma_f32_16x16x32_bf16 v[220:223], a[212:215], a[156:159], v[220:223]
    ds_read_b64_tr_b16 a[198:199], v7 offset:25600
    v_mfma_f32_16x16x32_bf16 v[220:223], a[208:211], a[152:155], v[220:223]
    s_waitcnt lgkmcnt(5)
    v_mfma_f32_16x16x32_bf16 v[252:255], a[216:219], a[152:155], v[252:255]
    ds_read_b64_tr_b16 a[200:201], v8 offset:4096
    v_mfma_f32_16x16x32_bf16 v[252:255], a[220:223], a[156:159], v[252:255]
    buffer_load_dwordx4 v19, s[36:39], s11 offen offset:2048 lds
    v_mfma_f32_16x16x32_bf16 v[248:251], a[220:223], a[148:151], v[248:251]
    ds_read_b64_tr_b16 a[202:203], v8 offset:24576
    v_mfma_f32_16x16x32_bf16 v[248:251], a[216:219], a[144:147], v[248:251]
    v_mfma_f32_16x16x32_bf16 v[244:247], a[216:219], a[136:139], v[244:247]
    ds_read_b64_tr_b16 a[204:205], v8 offset:5120
    v_mfma_f32_16x16x32_bf16 v[244:247], a[220:223], a[140:143], v[244:247]
    buffer_load_dwordx4 v20, s[36:39], s11 offen offset:3072 lds
    v_mfma_f32_16x16x32_bf16 v[240:243], a[220:223], a[132:135], v[240:243]
    ds_read_b64_tr_b16 a[206:207], v8 offset:25600
    v_mfma_f32_16x16x32_bf16 v[240:243], a[216:219], a[128:131], v[240:243]
    s_waitcnt vmcnt(28) lgkmcnt(15)
    v_mfma_f32_16x16x32_bf16 v[156:159], a[224:227], a[184:187], v[156:159]
    ds_read_b64_tr_b16 a[208:209], v7 offset:4608
    ds_read_b64_tr_b16 a[210:211], v7 offset:25088
    v_mfma_f32_16x16x32_bf16 v[156:159], a[228:231], a[188:191], v[156:159]
    ds_read_b64_tr_b16 a[212:213], v7 offset:5632
    ds_read_b64_tr_b16 a[214:215], v7 offset:26112
    s_waitcnt vmcnt(45) lgkmcnt(15)
    s_barrier
    v_mfma_f32_16x16x32_bf16 v[188:191], a[232:235], a[184:187], v[188:191]
    ds_read_b64_tr_b16 a[216:217], v8 offset:4608
    ds_read_b64_tr_b16 a[218:219], v8 offset:25088
    v_mfma_f32_16x16x32_bf16 v[188:191], a[236:239], a[188:191], v[188:191]
    ds_read_b64_tr_b16 a[220:221], v8 offset:5632
    ds_read_b64_tr_b16 a[222:223], v8 offset:26112
    s_waitcnt lgkmcnt(15)
    v_mfma_f32_16x16x32_bf16 v[220:223], a[240:243], a[184:187], v[220:223]
    s_mov_b32 s10, 524288
    v_mfma_f32_16x16x32_bf16 v[220:223], a[244:247], a[188:191], v[220:223]
    buffer_load_dwordx4 a[96:99], v3, s[44:47], s10 offen offset:0 sc1
    s_waitcnt lgkmcnt(15)
    v_mfma_f32_16x16x32_bf16 v[252:255], a[248:251], a[184:187], v[252:255]
    v_mfma_f32_16x16x32_bf16 v[252:255], a[252:255], a[188:191], v[252:255]
    buffer_load_dwordx4 a[100:103], v3, s[44:47], s10 offen offset:1024 sc1
    s_waitcnt lgkmcnt(12)
    v_mfma_f32_16x16x32_bf16 v[76:79], a[192:195], a[184:187], v[76:79]
    s_mov_b32 s10, 532480
    v_mfma_f32_16x16x32_bf16 v[76:79], a[196:199], a[188:191], v[76:79]
    buffer_load_dwordx4 a[104:107], v3, s[44:47], s10 offen offset:0 sc1
    s_waitcnt lgkmcnt(8)
    v_mfma_f32_16x16x32_bf16 v[92:95], a[200:203], a[184:187], v[92:95]
    v_mfma_f32_16x16x32_bf16 v[92:95], a[204:207], a[188:191], v[92:95]
    buffer_load_dwordx4 a[108:111], v3, s[44:47], s10 offen offset:1024 sc1
    s_waitcnt lgkmcnt(4)
    v_mfma_f32_16x16x32_bf16 v[108:111], a[208:211], a[184:187], v[108:111]
    s_mov_b32 s10, 540672
    v_mfma_f32_16x16x32_bf16 v[108:111], a[212:215], a[188:191], v[108:111]
    buffer_load_dwordx4 a[112:115], v3, s[44:47], s10 offen offset:0 sc1
    s_waitcnt lgkmcnt(0)
    v_mfma_f32_16x16x32_bf16 v[124:127], a[216:219], a[184:187], v[124:127]
    v_mfma_f32_16x16x32_bf16 v[124:127], a[220:223], a[188:191], v[124:127]
    buffer_load_dwordx4 a[116:119], v3, s[44:47], s10 offen offset:1024 sc1
    v_cvt_pk_bf16_f32 v156, v156, v157
    s_mov_b32 s10, 548864
    buffer_load_dwordx4 a[120:123], v3, s[44:47], s10 offen offset:0 sc1
    buffer_load_dwordx4 a[124:127], v3, s[44:47], s10 offen offset:1024 sc1
    v_mfma_f32_16x16x32_bf16 v[152:155], a[224:227], a[176:179], v[152:155]
    v_cvt_pk_bf16_f32 v157, v158, v159
    v_cvt_pk_bf16_f32 v158, v188, v189
    v_mfma_f32_16x16x32_bf16 v[152:155], a[228:231], a[180:183], v[152:155]
    v_cvt_pk_bf16_f32 v159, v190, v191
    v_cvt_pk_bf16_f32 v220, v220, v221
    v_mfma_f32_16x16x32_bf16 v[184:187], a[232:235], a[176:179], v[184:187]
    buffer_store_dwordx4 v[156:159], v2, s[24:27], s42 offen offset:2048 sc1
    v_mfma_f32_16x16x32_bf16 v[184:187], a[236:239], a[180:183], v[184:187]
    v_cvt_pk_bf16_f32 v221, v222, v223
    v_cvt_pk_bf16_f32 v222, v252, v253
    v_mfma_f32_16x16x32_bf16 v[216:219], a[240:243], a[176:179], v[216:219]
    v_cvt_pk_bf16_f32 v223, v254, v255
    v_cvt_pk_bf16_f32 v76, v76, v77
    v_mfma_f32_16x16x32_bf16 v[216:219], a[244:247], a[180:183], v[216:219]
    v_cvt_pk_bf16_f32 v77, v78, v79
    v_cvt_pk_bf16_f32 v78, v92, v93
    v_mfma_f32_16x16x32_bf16 v[248:251], a[248:251], a[176:179], v[248:251]
    v_cvt_pk_bf16_f32 v79, v94, v95
    v_cvt_pk_bf16_f32 v108, v108, v109
    v_mfma_f32_16x16x32_bf16 v[248:251], a[252:255], a[180:183], v[248:251]
    v_cvt_pk_bf16_f32 v109, v110, v111
    v_cvt_pk_bf16_f32 v110, v124, v125
    v_mfma_f32_16x16x32_bf16 v[72:75], a[192:195], a[176:179], v[72:75]
    v_cvt_pk_bf16_f32 v111, v126, v127
    v_cvt_pk_bf16_f32 v152, v152, v153
    v_mfma_f32_16x16x32_bf16 v[72:75], a[196:199], a[180:183], v[72:75]
    v_cvt_pk_bf16_f32 v153, v154, v155
    v_cvt_pk_bf16_f32 v154, v184, v185
    v_mfma_f32_16x16x32_bf16 v[88:91], a[200:203], a[176:179], v[88:91]
    buffer_store_dwordx4 v[220:223], v2, s[24:27], s42 offen offset:3072 sc1
    v_mfma_f32_16x16x32_bf16 v[88:91], a[204:207], a[180:183], v[88:91]
    v_cvt_pk_bf16_f32 v155, v186, v187
    v_cvt_pk_bf16_f32 v216, v216, v217
    v_mfma_f32_16x16x32_bf16 v[104:107], a[208:211], a[176:179], v[104:107]
    v_cvt_pk_bf16_f32 v217, v218, v219
    v_cvt_pk_bf16_f32 v218, v248, v249
    v_mfma_f32_16x16x32_bf16 v[104:107], a[212:215], a[180:183], v[104:107]
    v_cvt_pk_bf16_f32 v219, v250, v251
    v_mfma_f32_16x16x32_bf16 v[120:123], a[216:219], a[176:179], v[120:123]
    v_cvt_pk_bf16_f32 v72, v72, v73
    v_cvt_pk_bf16_f32 v73, v74, v75
    v_mfma_f32_16x16x32_bf16 v[120:123], a[220:223], a[180:183], v[120:123]
    v_cvt_pk_bf16_f32 v74, v88, v89
    v_cvt_pk_bf16_f32 v75, v90, v91
    v_mfma_f32_16x16x32_bf16 v[148:151], a[224:227], a[168:171], v[148:151]
    v_mfma_f32_16x16x32_bf16 v[148:151], a[228:231], a[172:175], v[148:151]
    v_mfma_f32_16x16x32_bf16 v[180:183], a[232:235], a[168:171], v[180:183]
    buffer_store_dwordx4 v[76:79], v2, s[24:27], s42 offen offset:0 sc1
    v_mfma_f32_16x16x32_bf16 v[180:183], a[236:239], a[172:175], v[180:183]
    v_cvt_pk_bf16_f32 v104, v104, v105
    v_cvt_pk_bf16_f32 v105, v106, v107
    v_mfma_f32_16x16x32_bf16 v[212:215], a[240:243], a[168:171], v[212:215]
    v_cvt_pk_bf16_f32 v106, v120, v121
    v_cvt_pk_bf16_f32 v107, v122, v123
    v_mfma_f32_16x16x32_bf16 v[212:215], a[244:247], a[172:175], v[212:215]
    v_mfma_f32_16x16x32_bf16 v[244:247], a[248:251], a[168:171], v[244:247]
    v_cvt_pk_bf16_f32 v148, v148, v149
    v_cvt_pk_bf16_f32 v149, v150, v151
    v_mfma_f32_16x16x32_bf16 v[244:247], a[252:255], a[172:175], v[244:247]
    v_cvt_pk_bf16_f32 v150, v180, v181
    v_cvt_pk_bf16_f32 v151, v182, v183
    v_mfma_f32_16x16x32_bf16 v[68:71], a[192:195], a[168:171], v[68:71]
    v_mfma_f32_16x16x32_bf16 v[68:71], a[196:199], a[172:175], v[68:71]
    v_mfma_f32_16x16x32_bf16 v[84:87], a[200:203], a[168:171], v[84:87]
    buffer_store_dwordx4 v[108:111], v2, s[24:27], s42 offen offset:1024 sc1
    v_mfma_f32_16x16x32_bf16 v[84:87], a[204:207], a[172:175], v[84:87]
    v_cvt_pk_bf16_f32 v212, v212, v213
    v_cvt_pk_bf16_f32 v213, v214, v215
    v_mfma_f32_16x16x32_bf16 v[100:103], a[208:211], a[168:171], v[100:103]
    v_cvt_pk_bf16_f32 v214, v244, v245
    v_cvt_pk_bf16_f32 v215, v246, v247
    v_mfma_f32_16x16x32_bf16 v[100:103], a[212:215], a[172:175], v[100:103]
    v_mfma_f32_16x16x32_bf16 v[116:119], a[216:219], a[168:171], v[116:119]
    v_cvt_pk_bf16_f32 v68, v68, v69
    v_cvt_pk_bf16_f32 v69, v70, v71
    v_mfma_f32_16x16x32_bf16 v[116:119], a[220:223], a[172:175], v[116:119]
    v_cvt_pk_bf16_f32 v70, v84, v85
    v_cvt_pk_bf16_f32 v71, v86, v87
    v_mfma_f32_16x16x32_bf16 v[64:67], a[192:195], a[160:163], v[64:67]
    v_mfma_f32_16x16x32_bf16 v[64:67], a[196:199], a[164:167], v[64:67]
    v_mfma_f32_16x16x32_bf16 v[80:83], a[200:203], a[160:163], v[80:83]
    buffer_store_dwordx4 v[152:155], v2, s[24:27], s41 offen offset:2048 sc1
    v_mfma_f32_16x16x32_bf16 v[80:83], a[204:207], a[164:167], v[80:83]
    v_cvt_pk_bf16_f32 v100, v100, v101
    v_cvt_pk_bf16_f32 v101, v102, v103
    v_mfma_f32_16x16x32_bf16 v[96:99], a[208:211], a[160:163], v[96:99]
    v_cvt_pk_bf16_f32 v102, v116, v117
    v_cvt_pk_bf16_f32 v103, v118, v119
    v_mfma_f32_16x16x32_bf16 v[96:99], a[212:215], a[164:167], v[96:99]
    v_mfma_f32_16x16x32_bf16 v[112:115], a[216:219], a[160:163], v[112:115]
    v_mfma_f32_16x16x32_bf16 v[112:115], a[220:223], a[164:167], v[112:115]
    v_mfma_f32_16x16x32_bf16 v[144:147], a[224:227], a[160:163], v[144:147]
    ds_read_b64_tr_b16 a[192:193], v9 offset:0
    ds_read_b64_tr_b16 a[194:195], v9 offset:20480
    v_mfma_f32_16x16x32_bf16 v[144:147], a[228:231], a[164:167], v[144:147]
    ds_read_b64_tr_b16 a[196:197], v9 offset:1024
    ds_read_b64_tr_b16 a[198:199], v9 offset:21504
    v_mfma_f32_16x16x32_bf16 v[176:179], a[232:235], a[160:163], v[176:179]
    ds_read_b64_tr_b16 a[200:201], v10 offset:0
    ds_read_b64_tr_b16 a[202:203], v10 offset:20480
    v_mfma_f32_16x16x32_bf16 v[176:179], a[236:239], a[164:167], v[176:179]
    ds_read_b64_tr_b16 a[204:205], v10 offset:1024
    ds_read_b64_tr_b16 a[206:207], v10 offset:21504
    v_mfma_f32_16x16x32_bf16 v[208:211], a[240:243], a[160:163], v[208:211]
    ds_read_b64_tr_b16 a[208:209], v9 offset:512
    ds_read_b64_tr_b16 a[210:211], v9 offset:20992
    v_mfma_f32_16x16x32_bf16 v[208:211], a[244:247], a[164:167], v[208:211]
    ds_read_b64_tr_b16 a[212:213], v9 offset:1536
    ds_read_b64_tr_b16 a[214:215], v9 offset:22016
    v_mfma_f32_16x16x32_bf16 v[240:243], a[248:251], a[160:163], v[240:243]
    ds_read_b64_tr_b16 a[216:217], v10 offset:512
    ds_read_b64_tr_b16 a[218:219], v10 offset:20992
    v_mfma_f32_16x16x32_bf16 v[240:243], a[252:255], a[164:167], v[240:243]
    ds_read_b64_tr_b16 a[220:221], v10 offset:1536
    ds_read_b64_tr_b16 a[222:223], v10 offset:22016
    s_waitcnt vmcnt(33) lgkmcnt(12)
    v_mfma_f32_16x16x32_bf16 v[32:35], a[192:195], a[32:35], 0
    ds_read_b64_tr_b16 a[224:225], v9 offset:2048
    ds_read_b64_tr_b16 a[226:227], v9 offset:22528
    v_mfma_f32_16x16x32_bf16 v[32:35], a[196:199], a[36:39], v[32:35]
    ds_read_b64_tr_b16 a[228:229], v9 offset:3072
    ds_read_b64_tr_b16 a[230:231], v9 offset:23552
    buffer_store_dwordx4 v[216:219], v2, s[24:27], s41 offen offset:3072 sc1
    s_waitcnt lgkmcnt(12)
    v_mfma_f32_16x16x32_bf16 v[36:39], a[200:203], a[32:35], 0
    ds_read_b64_tr_b16 a[232:233], v10 offset:2048
    ds_read_b64_tr_b16 a[234:235], v10 offset:22528
    v_mfma_f32_16x16x32_bf16 v[36:39], a[204:207], a[36:39], v[36:39]
    ds_read_b64_tr_b16 a[236:237], v10 offset:3072
    ds_read_b64_tr_b16 a[238:239], v10 offset:23552
    s_waitcnt lgkmcnt(12)
    v_mfma_f32_16x16x32_bf16 v[40:43], a[208:211], a[32:35], 0
    ds_read_b64_tr_b16 a[240:241], v9 offset:2560
    ds_read_b64_tr_b16 a[242:243], v9 offset:23040
    v_mfma_f32_16x16x32_bf16 v[40:43], a[212:215], a[36:39], v[40:43]
    ds_read_b64_tr_b16 a[244:245], v9 offset:3584
    ds_read_b64_tr_b16 a[246:247], v9 offset:24064
    s_waitcnt lgkmcnt(12)
    v_mfma_f32_16x16x32_bf16 v[44:47], a[216:219], a[32:35], 0
    ds_read_b64_tr_b16 a[248:249], v10 offset:2560
    ds_read_b64_tr_b16 a[250:251], v10 offset:23040
    v_mfma_f32_16x16x32_bf16 v[44:47], a[220:223], a[36:39], v[44:47]
    ds_read_b64_tr_b16 a[252:253], v10 offset:3584
    ds_read_b64_tr_b16 a[254:255], v10 offset:24064
    s_waitcnt lgkmcnt(12)
    v_mfma_f32_16x16x32_bf16 v[48:51], a[224:227], a[32:35], 0
    ds_read_b64_tr_b16 a[192:193], v11 offset:0
    ds_read_b64_tr_b16 a[194:195], v11 offset:20480
    v_mfma_f32_16x16x32_bf16 v[48:51], a[228:231], a[36:39], v[48:51]
    ds_read_b64_tr_b16 a[196:197], v11 offset:1024
    ds_read_b64_tr_b16 a[198:199], v11 offset:21504
    buffer_store_dwordx4 v[72:75], v2, s[24:27], s41 offen offset:0 sc1
    s_waitcnt lgkmcnt(12)
    v_mfma_f32_16x16x32_bf16 v[52:55], a[232:235], a[32:35], 0
    ds_read_b64_tr_b16 a[200:201], v12 offset:0
    ds_read_b64_tr_b16 a[202:203], v12 offset:20480
    v_mfma_f32_16x16x32_bf16 v[52:55], a[236:239], a[36:39], v[52:55]
    ds_read_b64_tr_b16 a[204:205], v12 offset:1024
    ds_read_b64_tr_b16 a[206:207], v12 offset:21504
    s_waitcnt lgkmcnt(12)
    v_mfma_f32_16x16x32_bf16 v[56:59], a[240:243], a[32:35], 0
    ds_read_b64_tr_b16 a[208:209], v11 offset:512
    ds_read_b64_tr_b16 a[210:211], v11 offset:20992
    v_mfma_f32_16x16x32_bf16 v[56:59], a[244:247], a[36:39], v[56:59]
    ds_read_b64_tr_b16 a[212:213], v11 offset:1536
    ds_read_b64_tr_b16 a[214:215], v11 offset:22016
    s_waitcnt lgkmcnt(12)
    v_mfma_f32_16x16x32_bf16 v[60:63], a[248:251], a[32:35], 0
    ds_read_b64_tr_b16 a[216:217], v12 offset:512
    ds_read_b64_tr_b16 a[218:219], v12 offset:20992
    v_mfma_f32_16x16x32_bf16 v[60:63], a[252:255], a[36:39], v[60:63]
    ds_read_b64_tr_b16 a[220:221], v12 offset:1536
    ds_read_b64_tr_b16 a[222:223], v12 offset:22016
    s_waitcnt lgkmcnt(12)
    v_mfma_f32_16x16x32_bf16 v[32:35], a[192:195], a[40:43], v[32:35]
    ds_read_b64_tr_b16 a[224:225], v11 offset:2048
    ds_read_b64_tr_b16 a[226:227], v11 offset:22528
    v_mfma_f32_16x16x32_bf16 v[32:35], a[196:199], a[44:47], v[32:35]
    ds_read_b64_tr_b16 a[228:229], v11 offset:3072
    ds_read_b64_tr_b16 a[230:231], v11 offset:23552
    buffer_store_dwordx4 v[104:107], v2, s[24:27], s41 offen offset:1024 sc1
    s_waitcnt lgkmcnt(12)
    v_mfma_f32_16x16x32_bf16 v[36:39], a[200:203], a[40:43], v[36:39]
    ds_read_b64_tr_b16 a[232:233], v12 offset:2048
    ds_read_b64_tr_b16 a[234:235], v12 offset:22528
    v_mfma_f32_16x16x32_bf16 v[36:39], a[204:207], a[44:47], v[36:39]
    ds_read_b64_tr_b16 a[236:237], v12 offset:3072
    ds_read_b64_tr_b16 a[238:239], v12 offset:23552
    s_waitcnt lgkmcnt(12)
    v_mfma_f32_16x16x32_bf16 v[40:43], a[208:211], a[40:43], v[40:43]
    ds_read_b64_tr_b16 a[240:241], v11 offset:2560
    ds_read_b64_tr_b16 a[242:243], v11 offset:23040
    v_mfma_f32_16x16x32_bf16 v[40:43], a[212:215], a[44:47], v[40:43]
    ds_read_b64_tr_b16 a[244:245], v11 offset:3584
    ds_read_b64_tr_b16 a[246:247], v11 offset:24064
    s_add_u32 m0, s19, 0
    s_mov_b32 s11, 1048576
    buffer_load_dwordx4 v17, s[36:39], s11 offen offset:0 lds
    s_waitcnt lgkmcnt(12)
    v_mfma_f32_16x16x32_bf16 v[44:47], a[216:219], a[40:43], v[44:47]
    ds_read_b64_tr_b16 a[248:249], v12 offset:2560
    ds_read_b64_tr_b16 a[250:251], v12 offset:23040
    v_mfma_f32_16x16x32_bf16 v[44:47], a[220:223], a[44:47], v[44:47]
    ds_read_b64_tr_b16 a[252:253], v12 offset:3584
    ds_read_b64_tr_b16 a[254:255], v12 offset:24064
    s_waitcnt lgkmcnt(12)
    v_mfma_f32_16x16x32_bf16 v[48:51], a[224:227], a[40:43], v[48:51]
    ds_read_b64_tr_b16 a[192:193], v7 offset:8192
    ds_read_b64_tr_b16 a[194:195], v7 offset:28672
    v_mfma_f32_16x16x32_bf16 v[48:51], a[228:231], a[44:47], v[48:51]
    ds_read_b64_tr_b16 a[196:197], v7 offset:9216
    ds_read_b64_tr_b16 a[198:199], v7 offset:29696
    buffer_store_dwordx4 v[148:151], v2, s[24:27], s40 offen offset:2048 sc1
    s_waitcnt lgkmcnt(12)
    v_mfma_f32_16x16x32_bf16 v[52:55], a[232:235], a[40:43], v[52:55]
    ds_read_b64_tr_b16 a[200:201], v8 offset:8192
    ds_read_b64_tr_b16 a[202:203], v8 offset:28672
    v_mfma_f32_16x16x32_bf16 v[52:55], a[236:239], a[44:47], v[52:55]
    ds_read_b64_tr_b16 a[204:205], v8 offset:9216
    ds_read_b64_tr_b16 a[206:207], v8 offset:29696
    s_waitcnt lgkmcnt(12)
    v_mfma_f32_16x16x32_bf16 v[56:59], a[240:243], a[40:43], v[56:59]
    ds_read_b64_tr_b16 a[208:209], v7 offset:8704
    ds_read_b64_tr_b16 a[210:211], v7 offset:29184
    v_mfma_f32_16x16x32_bf16 v[56:59], a[244:247], a[44:47], v[56:59]
    ds_read_b64_tr_b16 a[212:213], v7 offset:9728
    ds_read_b64_tr_b16 a[214:215], v7 offset:30208
    buffer_load_dwordx4 v18, s[36:39], s11 offen offset:1024 lds
    s_waitcnt lgkmcnt(12)
    v_mfma_f32_16x16x32_bf16 v[60:63], a[248:251], a[40:43], v[60:63]
    ds_read_b64_tr_b16 a[216:217], v8 offset:8704
    ds_read_b64_tr_b16 a[218:219], v8 offset:29184
    v_mfma_f32_16x16x32_bf16 v[60:63], a[252:255], a[44:47], v[60:63]
    ds_read_b64_tr_b16 a[220:221], v8 offset:9728
    ds_read_b64_tr_b16 a[222:223], v8 offset:30208
    s_waitcnt lgkmcnt(12)
    v_mfma_f32_16x16x32_bf16 v[32:35], a[192:195], a[48:51], v[32:35]
    ds_read_b64_tr_b16 a[224:225], v9 offset:8192
    ds_read_b64_tr_b16 a[226:227], v9 offset:28672
    v_mfma_f32_16x16x32_bf16 v[32:35], a[196:199], a[52:55], v[32:35]
    ds_read_b64_tr_b16 a[228:229], v9 offset:9216
    ds_read_b64_tr_b16 a[230:231], v9 offset:29696
    buffer_store_dwordx4 v[212:215], v2, s[24:27], s40 offen offset:3072 sc1
    s_waitcnt vmcnt(20) lgkmcnt(12)
    s_barrier
    v_mfma_f32_16x16x32_bf16 v[36:39], a[200:203], a[48:51], v[36:39]
    ds_read_b64_tr_b16 a[232:233], v10 offset:8192
    ds_read_b64_tr_b16 a[234:235], v10 offset:28672
    v_mfma_f32_16x16x32_bf16 v[36:39], a[204:207], a[52:55], v[36:39]
    ds_read_b64_tr_b16 a[236:237], v10 offset:9216
    ds_read_b64_tr_b16 a[238:239], v10 offset:29696
    s_waitcnt lgkmcnt(12)
    v_mfma_f32_16x16x32_bf16 v[40:43], a[208:211], a[48:51], v[40:43]
    ds_read_b64_tr_b16 a[240:241], v9 offset:8704
    ds_read_b64_tr_b16 a[242:243], v9 offset:29184
    v_mfma_f32_16x16x32_bf16 v[40:43], a[212:215], a[52:55], v[40:43]
    ds_read_b64_tr_b16 a[244:245], v9 offset:9728
    ds_read_b64_tr_b16 a[246:247], v9 offset:30208
    buffer_load_dwordx4 v19, s[36:39], s11 offen offset:2048 lds
    s_waitcnt lgkmcnt(12)
    v_mfma_f32_16x16x32_bf16 v[44:47], a[216:219], a[48:51], v[44:47]
    ds_read_b64_tr_b16 a[248:249], v10 offset:8704
    ds_read_b64_tr_b16 a[250:251], v10 offset:29184
    v_mfma_f32_16x16x32_bf16 v[44:47], a[220:223], a[52:55], v[44:47]
    ds_read_b64_tr_b16 a[252:253], v10 offset:9728
    ds_read_b64_tr_b16 a[254:255], v10 offset:30208
    s_waitcnt lgkmcnt(12)
    v_mfma_f32_16x16x32_bf16 v[48:51], a[224:227], a[48:51], v[48:51]
    ds_read_b64_tr_b16 a[192:193], v13 offset:0
    ds_read_b64_tr_b16 a[194:195], v13 offset:20480
    v_mfma_f32_16x16x32_bf16 v[48:51], a[228:231], a[52:55], v[48:51]
    ds_read_b64_tr_b16 a[196:197], v13 offset:1024
    ds_read_b64_tr_b16 a[198:199], v13 offset:21504
    buffer_store_dwordx4 v[68:71], v2, s[24:27], s40 offen offset:0 sc1
    s_waitcnt lgkmcnt(12)
    v_mfma_f32_16x16x32_bf16 v[52:55], a[232:235], a[48:51], v[52:55]
    ds_read_b64_tr_b16 a[200:201], v14 offset:0
    ds_read_b64_tr_b16 a[202:203], v14 offset:20480
    v_mfma_f32_16x16x32_bf16 v[52:55], a[236:239], a[52:55], v[52:55]
    ds_read_b64_tr_b16 a[204:205], v14 offset:1024
    ds_read_b64_tr_b16 a[206:207], v14 offset:21504
    s_waitcnt lgkmcnt(12)
    v_mfma_f32_16x16x32_bf16 v[56:59], a[240:243], a[48:51], v[56:59]
    ds_read_b64_tr_b16 a[208:209], v13 offset:512
    ds_read_b64_tr_b16 a[210:211], v13 offset:20992
    v_mfma_f32_16x16x32_bf16 v[56:59], a[244:247], a[52:55], v[56:59]
    ds_read_b64_tr_b16 a[212:213], v13 offset:1536
    ds_read_b64_tr_b16 a[214:215], v13 offset:22016
    buffer_load_dwordx4 v20, s[36:39], s11 offen offset:3072 lds
    s_waitcnt lgkmcnt(12)
    v_mfma_f32_16x16x32_bf16 v[60:63], a[248:251], a[48:51], v[60:63]
    ds_read_b64_tr_b16 a[216:217], v14 offset:512
    ds_read_b64_tr_b16 a[218:219], v14 offset:20992
    v_mfma_f32_16x16x32_bf16 v[60:63], a[252:255], a[52:55], v[60:63]
    ds_read_b64_tr_b16 a[220:221], v14 offset:1536
    ds_read_b64_tr_b16 a[222:223], v14 offset:22016
    s_waitcnt lgkmcnt(12)
    v_mfma_f32_16x16x32_bf16 v[32:35], a[192:195], a[56:59], v[32:35]
    ds_read_b64_tr_b16 a[224:225], v13 offset:2048
    ds_read_b64_tr_b16 a[226:227], v13 offset:22528
    v_mfma_f32_16x16x32_bf16 v[32:35], a[196:199], a[60:63], v[32:35]
    ds_read_b64_tr_b16 a[228:229], v13 offset:3072
    ds_read_b64_tr_b16 a[230:231], v13 offset:23552
    buffer_store_dwordx4 v[100:103], v2, s[24:27], s40 offen offset:1024 sc1
    s_waitcnt lgkmcnt(12)
    v_mfma_f32_16x16x32_bf16 v[36:39], a[200:203], a[56:59], v[36:39]
    ds_read_b64_tr_b16 a[232:233], v14 offset:2048
    ds_read_b64_tr_b16 a[234:235], v14 offset:22528
    v_mfma_f32_16x16x32_bf16 v[36:39], a[204:207], a[60:63], v[36:39]
    ds_read_b64_tr_b16 a[236:237], v14 offset:3072
    ds_read_b64_tr_b16 a[238:239], v14 offset:23552
    s_waitcnt lgkmcnt(12)
    v_mfma_f32_16x16x32_bf16 v[40:43], a[208:211], a[56:59], v[40:43]
    ds_read_b64_tr_b16 a[240:241], v13 offset:2560
    ds_read_b64_tr_b16 a[242:243], v13 offset:23040
    v_mfma_f32_16x16x32_bf16 v[40:43], a[212:215], a[60:63], v[40:43]
    ds_read_b64_tr_b16 a[244:245], v13 offset:3584
    ds_read_b64_tr_b16 a[246:247], v13 offset:24064
    s_add_u32 m0, s19, 4096
    s_mov_b32 s11, 1179648
    buffer_load_dwordx4 v17, s[36:39], s11 offen offset:0 lds
    s_waitcnt lgkmcnt(12)
    v_mfma_f32_16x16x32_bf16 v[44:47], a[216:219], a[56:59], v[44:47]
    ds_read_b64_tr_b16 a[248:249], v14 offset:2560
    ds_read_b64_tr_b16 a[250:251], v14 offset:23040
    v_mfma_f32_16x16x32_bf16 v[44:47], a[220:223], a[60:63], v[44:47]
    ds_read_b64_tr_b16 a[252:253], v14 offset:3584
    ds_read_b64_tr_b16 a[254:255], v14 offset:24064
    s_waitcnt lgkmcnt(12)
    v_mfma_f32_16x16x32_bf16 v[48:51], a[224:227], a[56:59], v[48:51]
    ds_read_b64_tr_b16 a[192:193], v11 offset:8192
    ds_read_b64_tr_b16 a[194:195], v11 offset:28672
    v_mfma_f32_16x16x32_bf16 v[48:51], a[228:231], a[60:63], v[48:51]
    ds_read_b64_tr_b16 a[196:197], v11 offset:9216
    ds_read_b64_tr_b16 a[198:199], v11 offset:29696
    buffer_load_dwordx4 v18, s[36:39], s11 offen offset:1024 lds
    s_waitcnt lgkmcnt(12)
    v_mfma_f32_16x16x32_bf16 v[52:55], a[232:235], a[56:59], v[52:55]
    ds_read_b64_tr_b16 a[200:201], v12 offset:8192
    ds_read_b64_tr_b16 a[202:203], v12 offset:28672
    v_mfma_f32_16x16x32_bf16 v[52:55], a[236:239], a[60:63], v[52:55]
    ds_read_b64_tr_b16 a[204:205], v12 offset:9216
    ds_read_b64_tr_b16 a[206:207], v12 offset:29696
    s_waitcnt lgkmcnt(12)
    v_mfma_f32_16x16x32_bf16 v[56:59], a[240:243], a[56:59], v[56:59]
    ds_read_b64_tr_b16 a[208:209], v11 offset:8704
    ds_read_b64_tr_b16 a[210:211], v11 offset:29184
    v_mfma_f32_16x16x32_bf16 v[56:59], a[244:247], a[60:63], v[56:59]
    ds_read_b64_tr_b16 a[212:213], v11 offset:9728
    ds_read_b64_tr_b16 a[214:215], v11 offset:30208
    buffer_load_dwordx4 v19, s[36:39], s11 offen offset:2048 lds
    s_waitcnt lgkmcnt(12)
    v_mfma_f32_16x16x32_bf16 v[60:63], a[248:251], a[56:59], v[60:63]
    ds_read_b64_tr_b16 a[216:217], v12 offset:8704
    ds_read_b64_tr_b16 a[218:219], v12 offset:29184
    v_mfma_f32_16x16x32_bf16 v[60:63], a[252:255], a[60:63], v[60:63]
    ds_read_b64_tr_b16 a[220:221], v12 offset:9728
    ds_read_b64_tr_b16 a[222:223], v12 offset:30208
    s_waitcnt vmcnt(39) lgkmcnt(12)
    v_mfma_f32_16x16x32_bf16 v[32:35], a[192:195], a[0:3], v[32:35]
    ds_read_b64_tr_b16 a[224:225], v13 offset:8192
    ds_read_b64_tr_b16 a[226:227], v13 offset:28672
    v_mfma_f32_16x16x32_bf16 v[32:35], a[196:199], a[4:7], v[32:35]
    ds_read_b64_tr_b16 a[228:229], v13 offset:9216
    ds_read_b64_tr_b16 a[230:231], v13 offset:29696
    buffer_load_dwordx4 v20, s[36:39], s11 offen offset:3072 lds
    s_waitcnt lgkmcnt(12)
    v_mfma_f32_16x16x32_bf16 v[36:39], a[200:203], a[0:3], v[36:39]
    ds_read_b64_tr_b16 a[232:233], v14 offset:8192
    ds_read_b64_tr_b16 a[234:235], v14 offset:28672
    v_mfma_f32_16x16x32_bf16 v[36:39], a[204:207], a[4:7], v[36:39]
    ds_read_b64_tr_b16 a[236:237], v14 offset:9216
    ds_read_b64_tr_b16 a[238:239], v14 offset:29696
    s_waitcnt lgkmcnt(12)
    v_mfma_f32_16x16x32_bf16 v[40:43], a[208:211], a[0:3], v[40:43]
    ds_read_b64_tr_b16 a[240:241], v13 offset:8704
    ds_read_b64_tr_b16 a[242:243], v13 offset:29184
    v_mfma_f32_16x16x32_bf16 v[40:43], a[212:215], a[4:7], v[40:43]
    ds_read_b64_tr_b16 a[244:245], v13 offset:9728
    ds_read_b64_tr_b16 a[246:247], v13 offset:30208
    s_add_u32 m0, s19, 40960
    s_mov_b32 s11, 1310720
    buffer_load_dwordx4 v17, s[36:39], s11 offen offset:0 lds
    s_waitcnt lgkmcnt(12)
    v_mfma_f32_16x16x32_bf16 v[44:47], a[216:219], a[0:3], v[44:47]
    ds_read_b64_tr_b16 a[248:249], v14 offset:8704
    ds_read_b64_tr_b16 a[250:251], v14 offset:29184
    v_mfma_f32_16x16x32_bf16 v[44:47], a[220:223], a[4:7], v[44:47]
    ds_read_b64_tr_b16 a[252:253], v14 offset:9728
    ds_read_b64_tr_b16 a[254:255], v14 offset:30208
    s_waitcnt lgkmcnt(12)
    v_mfma_f32_16x16x32_bf16 v[48:51], a[224:227], a[0:3], v[48:51]
    ds_read_b64_tr_b16 a[192:193], v9 offset:4096
    ds_read_b64_tr_b16 a[194:195], v9 offset:24576
    v_mfma_f32_16x16x32_bf16 v[48:51], a[228:231], a[4:7], v[48:51]
    ds_read_b64_tr_b16 a[196:197], v9 offset:5120
    ds_read_b64_tr_b16 a[198:199], v9 offset:25600
    buffer_load_dwordx4 v18, s[36:39], s11 offen offset:1024 lds
    s_waitcnt lgkmcnt(12)
    v_mfma_f32_16x16x32_bf16 v[52:55], a[232:235], a[0:3], v[52:55]
    ds_read_b64_tr_b16 a[200:201], v10 offset:4096
    ds_read_b64_tr_b16 a[202:203], v10 offset:24576
    v_mfma_f32_16x16x32_bf16 v[52:55], a[236:239], a[4:7], v[52:55]
    ds_read_b64_tr_b16 a[204:205], v10 offset:5120
    ds_read_b64_tr_b16 a[206:207], v10 offset:25600
    s_waitcnt lgkmcnt(12)
    v_mfma_f32_16x16x32_bf16 v[56:59], a[240:243], a[0:3], v[56:59]
    ds_read_b64_tr_b16 a[208:209], v9 offset:4608
    ds_read_b64_tr_b16 a[210:211], v9 offset:25088
    v_mfma_f32_16x16x32_bf16 v[56:59], a[244:247], a[4:7], v[56:59]
    ds_read_b64_tr_b16 a[212:213], v9 offset:5632
    ds_read_b64_tr_b16 a[214:215], v9 offset:26112
    buffer_load_dwordx4 v19, s[36:39], s11 offen offset:2048 lds
    s_waitcnt lgkmcnt(12)
    v_mfma_f32_16x16x32_bf16 v[60:63], a[248:251], a[0:3], v[60:63]
    ds_read_b64_tr_b16 a[216:217], v10 offset:4608
    ds_read_b64_tr_b16 a[218:219], v10 offset:25088
    v_mfma_f32_16x16x32_bf16 v[60:63], a[252:255], a[4:7], v[60:63]
    ds_read_b64_tr_b16 a[220:221], v10 offset:5632
    ds_read_b64_tr_b16 a[222:223], v10 offset:26112
    s_waitcnt lgkmcnt(12)
    v_mfma_f32_16x16x32_bf16 v[32:35], a[192:195], a[8:11], v[32:35]
    ds_read_b64_tr_b16 a[224:225], v9 offset:6144
    ds_read_b64_tr_b16 a[226:227], v9 offset:26624
    v_mfma_f32_16x16x32_bf16 v[32:35], a[196:199], a[12:15], v[32:35]
    ds_read_b64_tr_b16 a[228:229], v9 offset:7168
    ds_read_b64_tr_b16 a[230:231], v9 offset:27648
    buffer_load_dwordx4 v20, s[36:39], s11 offen offset:3072 lds
    s_waitcnt lgkmcnt(12)
    v_mfma_f32_16x16x32_bf16 v[36:39], a[200:203], a[8:11], v[36:39]
    ds_read_b64_tr_b16 a[232:233], v10 offset:6144
    ds_read_b64_tr_b16 a[234:235], v10 offset:26624
    v_mfma_f32_16x16x32_bf16 v[36:39], a[204:207], a[12:15], v[36:39]
    ds_read_b64_tr_b16 a[236:237], v10 offset:7168
    ds_read_b64_tr_b16 a[238:239], v10 offset:27648
    s_waitcnt lgkmcnt(12)
    v_mfma_f32_16x16x32_bf16 v[40:43], a[208:211], a[8:11], v[40:43]
    ds_read_b64_tr_b16 a[240:241], v9 offset:6656
    ds_read_b64_tr_b16 a[242:243], v9 offset:27136
    v_mfma_f32_16x16x32_bf16 v[40:43], a[212:215], a[12:15], v[40:43]
    ds_read_b64_tr_b16 a[244:245], v9 offset:7680
    ds_read_b64_tr_b16 a[246:247], v9 offset:28160
    s_add_u32 m0, s19, 81920
    s_mov_b32 s11, 1441792
    buffer_load_dwordx4 v17, s[36:39], s11 offen offset:0 lds
    s_waitcnt lgkmcnt(12)
    v_mfma_f32_16x16x32_bf16 v[44:47], a[216:219], a[8:11], v[44:47]
    ds_read_b64_tr_b16 a[248:249], v10 offset:6656
    ds_read_b64_tr_b16 a[250:251], v10 offset:27136
    v_mfma_f32_16x16x32_bf16 v[44:47], a[220:223], a[12:15], v[44:47]
    ds_read_b64_tr_b16 a[252:253], v10 offset:7680
    ds_read_b64_tr_b16 a[254:255], v10 offset:28160
    s_waitcnt lgkmcnt(12)
    v_mfma_f32_16x16x32_bf16 v[48:51], a[224:227], a[8:11], v[48:51]
    ds_read_b64_tr_b16 a[192:193], v11 offset:4096
    ds_read_b64_tr_b16 a[194:195], v11 offset:24576
    v_mfma_f32_16x16x32_bf16 v[48:51], a[228:231], a[12:15], v[48:51]
    ds_read_b64_tr_b16 a[196:197], v11 offset:5120
    ds_read_b64_tr_b16 a[198:199], v11 offset:25600
    buffer_load_dwordx4 v18, s[36:39], s11 offen offset:1024 lds
    s_waitcnt lgkmcnt(12)
    v_mfma_f32_16x16x32_bf16 v[52:55], a[232:235], a[8:11], v[52:55]
    ds_read_b64_tr_b16 a[200:201], v12 offset:4096
    ds_read_b64_tr_b16 a[202:203], v12 offset:24576
    v_mfma_f32_16x16x32_bf16 v[52:55], a[236:239], a[12:15], v[52:55]
    ds_read_b64_tr_b16 a[204:205], v12 offset:5120
    ds_read_b64_tr_b16 a[206:207], v12 offset:25600
    s_waitcnt lgkmcnt(12)
    v_mfma_f32_16x16x32_bf16 v[56:59], a[240:243], a[8:11], v[56:59]
    ds_read_b64_tr_b16 a[208:209], v11 offset:4608
    ds_read_b64_tr_b16 a[210:211], v11 offset:25088
    v_mfma_f32_16x16x32_bf16 v[56:59], a[244:247], a[12:15], v[56:59]
    ds_read_b64_tr_b16 a[212:213], v11 offset:5632
    ds_read_b64_tr_b16 a[214:215], v11 offset:26112
    buffer_load_dwordx4 v19, s[36:39], s11 offen offset:2048 lds
    s_waitcnt lgkmcnt(12)
    v_mfma_f32_16x16x32_bf16 v[60:63], a[248:251], a[8:11], v[60:63]
    ds_read_b64_tr_b16 a[216:217], v12 offset:4608
    ds_read_b64_tr_b16 a[218:219], v12 offset:25088
    v_mfma_f32_16x16x32_bf16 v[60:63], a[252:255], a[12:15], v[60:63]
    ds_read_b64_tr_b16 a[220:221], v12 offset:5632
    ds_read_b64_tr_b16 a[222:223], v12 offset:26112
    s_waitcnt vmcnt(11)
    s_add_u32 s74, s63, s68
    s_mov_b64 exec, 1
    buffer_store_dword v21, off, s[52:55], s74 sc1
    s_mov_b64 exec, -1
    s_waitcnt lgkmcnt(12)
    v_mfma_f32_16x16x32_bf16 v[32:35], a[192:195], a[16:19], v[32:35]
    ds_read_b64_tr_b16 a[224:225], v11 offset:6144
    ds_read_b64_tr_b16 a[226:227], v11 offset:26624
    v_mfma_f32_16x16x32_bf16 v[32:35], a[196:199], a[20:23], v[32:35]
    ds_read_b64_tr_b16 a[228:229], v11 offset:7168
    ds_read_b64_tr_b16 a[230:231], v11 offset:27648
    buffer_load_dwordx4 v20, s[36:39], s11 offen offset:3072 lds
    s_waitcnt vmcnt(14) lgkmcnt(12)
    s_barrier
    v_mfma_f32_16x16x32_bf16 v[36:39], a[200:203], a[16:19], v[36:39]
    ds_read_b64_tr_b16 a[232:233], v12 offset:6144
    ds_read_b64_tr_b16 a[234:235], v12 offset:26624
    v_mfma_f32_16x16x32_bf16 v[36:39], a[204:207], a[20:23], v[36:39]
    ds_read_b64_tr_b16 a[236:237], v12 offset:7168
    ds_read_b64_tr_b16 a[238:239], v12 offset:27648
    s_waitcnt lgkmcnt(12)
    v_mfma_f32_16x16x32_bf16 v[40:43], a[208:211], a[16:19], v[40:43]
    ds_read_b64_tr_b16 a[240:241], v11 offset:6656
    ds_read_b64_tr_b16 a[242:243], v11 offset:27136
    v_mfma_f32_16x16x32_bf16 v[40:43], a[212:215], a[20:23], v[40:43]
    ds_read_b64_tr_b16 a[244:245], v11 offset:7680
    ds_read_b64_tr_b16 a[246:247], v11 offset:28160
    s_add_u32 m0, s19, 8192
    s_mov_b32 s11, 1572864
    buffer_load_dwordx4 v17, s[36:39], s11 offen offset:0 lds
    s_waitcnt lgkmcnt(12)
    v_mfma_f32_16x16x32_bf16 v[44:47], a[216:219], a[16:19], v[44:47]
    ds_read_b64_tr_b16 a[248:249], v12 offset:6656
    ds_read_b64_tr_b16 a[250:251], v12 offset:27136
    v_mfma_f32_16x16x32_bf16 v[44:47], a[220:223], a[20:23], v[44:47]
    ds_read_b64_tr_b16 a[252:253], v12 offset:7680
    ds_read_b64_tr_b16 a[254:255], v12 offset:28160
    s_waitcnt lgkmcnt(12)
    v_mfma_f32_16x16x32_bf16 v[48:51], a[224:227], a[16:19], v[48:51]
    ds_read_b64_tr_b16 a[192:193], v13 offset:4096
    ds_read_b64_tr_b16 a[194:195], v13 offset:24576
    v_mfma_f32_16x16x32_bf16 v[48:51], a[228:231], a[20:23], v[48:51]
    ds_read_b64_tr_b16 a[196:197], v13 offset:5120
    ds_read_b64_tr_b16 a[198:199], v13 offset:25600
    buffer_load_dwordx4 v18, s[36:39], s11 offen offset:1024 lds
    s_waitcnt lgkmcnt(12)
    v_mfma_f32_16x16x32_bf16 v[52:55], a[232:235], a[16:19], v[52:55]
    ds_read_b64_tr_b16 a[200:201], v14 offset:4096
    ds_read_b64_tr_b16 a[202:203], v14 offset:24576
    v_mfma_f32_16x16x32_bf16 v[52:55], a[236:239], a[20:23], v[52:55]
    ds_read_b64_tr_b16 a[204:205], v14 offset:5120
    ds_read_b64_tr_b16 a[206:207], v14 offset:25600
    s_waitcnt lgkmcnt(12)
    v_mfma_f32_16x16x32_bf16 v[56:59], a[240:243], a[16:19], v[56:59]
    ds_read_b64_tr_b16 a[208:209], v13 offset:4608
    ds_read_b64_tr_b16 a[210:211], v13 offset:25088
    v_mfma_f32_16x16x32_bf16 v[56:59], a[244:247], a[20:23], v[56:59]
    ds_read_b64_tr_b16 a[212:213], v13 offset:5632
    ds_read_b64_tr_b16 a[214:215], v13 offset:26112
    s_add_u32 m0, s19, 47104
    s_nop 0
    buffer_load_dwordx4 v19, s[36:39], s11 offen offset:2048 lds
    s_waitcnt lgkmcnt(12)
    v_mfma_f32_16x16x32_bf16 v[60:63], a[248:251], a[16:19], v[60:63]
    ds_read_b64_tr_b16 a[216:217], v14 offset:4608
    ds_read_b64_tr_b16 a[218:219], v14 offset:25088
    v_mfma_f32_16x16x32_bf16 v[60:63], a[252:255], a[20:23], v[60:63]
    ds_read_b64_tr_b16 a[220:221], v14 offset:5632
    ds_read_b64_tr_b16 a[222:223], v14 offset:26112
    s_waitcnt lgkmcnt(12)
    v_mfma_f32_16x16x32_bf16 v[32:35], a[192:195], a[24:27], v[32:35]
    ds_read_b64_tr_b16 a[224:225], v13 offset:6144
    ds_read_b64_tr_b16 a[226:227], v13 offset:26624
    v_mfma_f32_16x16x32_bf16 v[32:35], a[196:199], a[28:31], v[32:35]
    ds_read_b64_tr_b16 a[228:229], v13 offset:7168
    ds_read_b64_tr_b16 a[230:231], v13 offset:27648
    buffer_load_dwordx4 v20, s[36:39], s11 offen offset:3072 lds
    s_waitcnt lgkmcnt(12)
    v_mfma_f32_16x16x32_bf16 v[36:39], a[200:203], a[24:27], v[36:39]
    ds_read_b64_tr_b16 a[232:233], v14 offset:6144
    ds_read_b64_tr_b16 a[234:235], v14 offset:26624
    v_mfma_f32_16x16x32_bf16 v[36:39], a[204:207], a[28:31], v[36:39]
    ds_read_b64_tr_b16 a[236:237], v14 offset:7168
    ds_read_b64_tr_b16 a[238:239], v14 offset:27648
    s_waitcnt lgkmcnt(12)
    v_mfma_f32_16x16x32_bf16 v[40:43], a[208:211], a[24:27], v[40:43]
    ds_read_b64_tr_b16 a[240:241], v13 offset:6656
    ds_read_b64_tr_b16 a[242:243], v13 offset:27136
    v_mfma_f32_16x16x32_bf16 v[40:43], a[212:215], a[28:31], v[40:43]
    ds_read_b64_tr_b16 a[244:245], v13 offset:7680
    ds_read_b64_tr_b16 a[246:247], v13 offset:28160
    s_mov_b32 s10, 557056
    buffer_load_dwordx4 a[128:131], v3, s[44:47], s10 offen offset:0 sc1
    s_waitcnt lgkmcnt(12)
    v_mfma_f32_16x16x32_bf16 v[44:47], a[216:219], a[24:27], v[44:47]
    ds_read_b64_tr_b16 a[248:249], v14 offset:6656
    ds_read_b64_tr_b16 a[250:251], v14 offset:27136
    v_mfma_f32_16x16x32_bf16 v[44:47], a[220:223], a[28:31], v[44:47]
    ds_read_b64_tr_b16 a[252:253], v14 offset:7680
    ds_read_b64_tr_b16 a[254:255], v14 offset:28160
    s_waitcnt lgkmcnt(12)
    v_mfma_f32_16x16x32_bf16 v[48:51], a[224:227], a[24:27], v[48:51]
    ds_read_b64_tr_b16 a[192:193], v7 offset:0
    ds_read_b64_tr_b16 a[194:195], v7 offset:20480
    v_mfma_f32_16x16x32_bf16 v[48:51], a[228:231], a[28:31], v[48:51]
    ds_read_b64_tr_b16 a[196:197], v7 offset:1024
    ds_read_b64_tr_b16 a[198:199], v7 offset:21504
    buffer_load_dwordx4 a[132:135], v3, s[44:47], s10 offen offset:1024 sc1
    s_waitcnt lgkmcnt(12)
    v_mfma_f32_16x16x32_bf16 v[52:55], a[232:235], a[24:27], v[52:55]
    ds_read_b64_tr_b16 a[200:201], v8 offset:0
    ds_read_b64_tr_b16 a[202:203], v8 offset:20480
    v_mfma_f32_16x16x32_bf16 v[52:55], a[236:239], a[28:31], v[52:55]
    ds_read_b64_tr_b16 a[204:205], v8 offset:1024
    ds_read_b64_tr_b16 a[206:207], v8 offset:21504
    s_waitcnt lgkmcnt(12)
    v_mfma_f32_16x16x32_bf16 v[56:59], a[240:243], a[24:27], v[56:59]
    ds_read_b64_tr_b16 a[208:209], v7 offset:512
    ds_read_b64_tr_b16 a[210:211], v7 offset:20992
    v_mfma_f32_16x16x32_bf16 v[56:59], a[244:247], a[28:31], v[56:59]
    ds_read_b64_tr_b16 a[212:213], v7 offset:1536
    ds_read_b64_tr_b16 a[214:215], v7 offset:22016
    s_mov_b32 s10, 565248
    buffer_load_dwordx4 a[136:139], v3, s[44:47], s10 offen offset:0 sc1
    s_waitcnt lgkmcnt(12)
    v_mfma_f32_16x16x32_bf16 v[60:63], a[248:251], a[24:27], v[60:63]
    ds_read_b64_tr_b16 a[216:217], v8 offset:512
    ds_read_b64_tr_b16 a[218:219], v8 offset:20992
    v_mfma_f32_16x16x32_bf16 v[60:63], a[252:255], a[28:31], v[60:63]
    ds_read_b64_tr_b16 a[220:221], v8 offset:1536
    ds_read_b64_tr_b16 a[222:223], v8 offset:22016
    s_waitcnt vmcnt(36) lgkmcnt(12)
    v_mfma_f32_16x16x32_bf16 v[32:35], a[192:195], a[96:99], v[32:35]
    ds_read_b64_tr_b16 a[224:225], v7 offset:2048
    ds_read_b64_tr_b16 a[226:227], v7 offset:22528
    v_mfma_f32_16x16x32_bf16 v[32:35], a[196:199], a[100:103], v[32:35]
    ds_read_b64_tr_b16 a[228:229], v7 offset:3072
    ds_read_b64_tr_b16 a[230:231], v7 offset:23552
    buffer_load_dwordx4 a[140:143], v3, s[44:47], s10 offen offset:1024 sc1
    s_waitcnt vmcnt(13) lgkmcnt(12)
    s_barrier
    v_mfma_f32_16x16x32_bf16 v[36:39], a[200:203], a[96:99], v[36:39]
    ds_read_b64_tr_b16 a[232:233], v8 offset:2048
    ds_read_b64_tr_b16 a[234:235], v8 offset:22528
    v_mfma_f32_16x16x32_bf16 v[36:39], a[204:207], a[100:103], v[36:39]
    ds_read_b64_tr_b16 a[236:237], v8 offset:3072
    ds_read_b64_tr_b16 a[238:239], v8 offset:23552
    s_waitcnt lgkmcnt(12)
    v_mfma_f32_16x16x32_bf16 v[40:43], a[208:211], a[96:99], v[40:43]
    ds_read_b64_tr_b16 a[240:241], v7 offset:2560
    ds_read_b64_tr_b16 a[242:243], v7 offset:23040
    v_mfma_f32_16x16x32_bf16 v[40:43], a[212:215], a[100:103], v[40:43]
    ds_read_b64_tr_b16 a[244:245], v7 offset:3584
    ds_read_b64_tr_b16 a[246:247], v7 offset:24064
    s_mov_b32 s10, 573440
    buffer_load_dwordx4 a[144:147], v3, s[44:47], s10 offen offset:0 sc1
    s_waitcnt lgkmcnt(12)
    v_mfma_f32_16x16x32_bf16 v[44:47], a[216:219], a[96:99], v[44:47]
    ds_read_b64_tr_b16 a[248:249], v8 offset:2560
    ds_read_b64_tr_b16 a[250:251], v8 offset:23040
    v_mfma_f32_16x16x32_bf16 v[44:47], a[220:223], a[100:103], v[44:47]
    ds_read_b64_tr_b16 a[252:253], v8 offset:3584
    ds_read_b64_tr_b16 a[254:255], v8 offset:24064
    s_waitcnt lgkmcnt(12)
    v_mfma_f32_16x16x32_bf16 v[48:51], a[224:227], a[96:99], v[48:51]
    ds_read_b64_tr_b16 a[192:193], v7 offset:4096
    ds_read_b64_tr_b16 a[194:195], v7 offset:24576
    v_mfma_f32_16x16x32_bf16 v[48:51], a[228:231], a[100:103], v[48:51]
    ds_read_b64_tr_b16 a[196:197], v7 offset:5120
    ds_read_b64_tr_b16 a[198:199], v7 offset:25600
    buffer_load_dwordx4 a[148:151], v3, s[44:47], s10 offen offset:1024 sc1
    s_waitcnt lgkmcnt(12)
    v_mfma_f32_16x16x32_bf16 v[52:55], a[232:235], a[96:99], v[52:55]
    ds_read_b64_tr_b16 a[200:201], v8 offset:4096
    ds_read_b64_tr_b16 a[202:203], v8 offset:24576
    v_mfma_f32_16x16x32_bf16 v[52:55], a[236:239], a[100:103], v[52:55]
    ds_read_b64_tr_b16 a[204:205], v8 offset:5120
    ds_read_b64_tr_b16 a[206:207], v8 offset:25600
    s_waitcnt lgkmcnt(12)
    v_mfma_f32_16x16x32_bf16 v[56:59], a[240:243], a[96:99], v[56:59]
    ds_read_b64_tr_b16 a[208:209], v7 offset:4608
    ds_read_b64_tr_b16 a[210:211], v7 offset:25088
    v_mfma_f32_16x16x32_bf16 v[56:59], a[244:247], a[100:103], v[56:59]
    ds_read_b64_tr_b16 a[212:213], v7 offset:5632
    ds_read_b64_tr_b16 a[214:215], v7 offset:26112
    s_mov_b32 s10, 581632
    buffer_load_dwordx4 a[152:155], v3, s[44:47], s10 offen offset:0 sc1
    s_waitcnt lgkmcnt(12)
    v_mfma_f32_16x16x32_bf16 v[60:63], a[248:251], a[96:99], v[60:63]
    ds_read_b64_tr_b16 a[216:217], v8 offset:4608
    ds_read_b64_tr_b16 a[218:219], v8 offset:25088
    v_mfma_f32_16x16x32_bf16 v[60:63], a[252:255], a[100:103], v[60:63]
    ds_read_b64_tr_b16 a[220:221], v8 offset:5632
    ds_read_b64_tr_b16 a[222:223], v8 offset:26112
    s_waitcnt lgkmcnt(12)
    v_mfma_f32_16x16x32_bf16 v[32:35], a[192:195], a[104:107], v[32:35]
    ds_read_b64_tr_b16 a[224:225], v7 offset:6144
    ds_read_b64_tr_b16 a[226:227], v7 offset:26624
    v_mfma_f32_16x16x32_bf16 v[32:35], a[196:199], a[108:111], v[32:35]
    ds_read_b64_tr_b16 a[228:229], v7 offset:7168
    ds_read_b64_tr_b16 a[230:231], v7 offset:27648
    buffer_load_dwordx4 a[156:159], v3, s[44:47], s10 offen offset:1024 sc1
    s_waitcnt lgkmcnt(12)
    v_mfma_f32_16x16x32_bf16 v[36:39], a[200:203], a[104:107], v[36:39]
    ds_read_b64_tr_b16 a[232:233], v8 offset:6144
    ds_read_b64_tr_b16 a[234:235], v8 offset:26624
    v_mfma_f32_16x16x32_bf16 v[36:39], a[204:207], a[108:111], v[36:39]
    ds_read_b64_tr_b16 a[236:237], v8 offset:7168
    ds_read_b64_tr_b16 a[238:239], v8 offset:27648
    s_waitcnt lgkmcnt(12)
    v_mfma_f32_16x16x32_bf16 v[40:43], a[208:211], a[104:107], v[40:43]
    ds_read_b64_tr_b16 a[240:241], v7 offset:6656
    ds_read_b64_tr_b16 a[242:243], v7 offset:27136
    v_mfma_f32_16x16x32_bf16 v[40:43], a[212:215], a[108:111], v[40:43]
    ds_read_b64_tr_b16 a[244:245], v7 offset:7680
    ds_read_b64_tr_b16 a[246:247], v7 offset:28160
    s_add_u32 m0, s19, 122880
    s_mov_b32 s11, 1703936
    buffer_load_dwordx4 v17, s[36:39], s11 offen offset:0 lds
    s_waitcnt lgkmcnt(12)
    v_mfma_f32_16x16x32_bf16 v[44:47], a[216:219], a[104:107], v[44:47]
    ds_read_b64_tr_b16 a[248:249], v8 offset:6656
    ds_read_b64_tr_b16 a[250:251], v8 offset:27136
    v_mfma_f32_16x16x32_bf16 v[44:47], a[220:223], a[108:111], v[44:47]
    ds_read_b64_tr_b16 a[252:253], v8 offset:7680
    ds_read_b64_tr_b16 a[254:255], v8 offset:28160
    s_waitcnt lgkmcnt(12)
    v_mfma_f32_16x16x32_bf16 v[48:51], a[224:227], a[104:107], v[48:51]
    ds_read_b64_tr_b16 a[192:193], v9 offset:0
    ds_read_b64_tr_b16 a[194:195], v9 offset:20480
    v_mfma_f32_16x16x32_bf16 v[48:51], a[228:231], a[108:111], v[48:51]
    ds_read_b64_tr_b16 a[196:197], v9 offset:1024
    ds_read_b64_tr_b16 a[198:199], v9 offset:21504
    buffer_load_dwordx4 v18, s[36:39], s11 offen offset:1024 lds
    s_waitcnt lgkmcnt(12)
    v_mfma_f32_16x16x32_bf16 v[52:55], a[232:235], a[104:107], v[52:55]
    ds_read_b64_tr_b16 a[200:201], v10 offset:0
    ds_read_b64_tr_b16 a[202:203], v10 offset:20480
    v_mfma_f32_16x16x32_bf16 v[52:55], a[236:239], a[108:111], v[52:55]
    ds_read_b64_tr_b16 a[204:205], v10 offset:1024
    ds_read_b64_tr_b16 a[206:207], v10 offset:21504
    s_waitcnt lgkmcnt(12)
    v_mfma_f32_16x16x32_bf16 v[56:59], a[240:243], a[104:107], v[56:59]
    ds_read_b64_tr_b16 a[208:209], v9 offset:512
    ds_read_b64_tr_b16 a[210:211], v9 offset:20992
    v_mfma_f32_16x16x32_bf16 v[56:59], a[244:247], a[108:111], v[56:59]
    ds_read_b64_tr_b16 a[212:213], v9 offset:1536
    ds_read_b64_tr_b16 a[214:215], v9 offset:22016
    buffer_load_dwordx4 v19, s[36:39], s11 offen offset:2048 lds
    s_waitcnt lgkmcnt(12)
    v_mfma_f32_16x16x32_bf16 v[60:63], a[248:251], a[104:107], v[60:63]
    ds_read_b64_tr_b16 a[216:217], v10 offset:512
    ds_read_b64_tr_b16 a[218:219], v10 offset:20992
    v_mfma_f32_16x16x32_bf16 v[60:63], a[252:255], a[108:111], v[60:63]
    ds_read_b64_tr_b16 a[220:221], v10 offset:1536
    ds_read_b64_tr_b16 a[222:223], v10 offset:22016
    s_waitcnt lgkmcnt(12)
    v_mfma_f32_16x16x32_bf16 v[32:35], a[192:195], a[112:115], v[32:35]
    ds_read_b64_tr_b16 a[224:225], v9 offset:2048
    ds_read_b64_tr_b16 a[226:227], v9 offset:22528
    v_mfma_f32_16x16x32_bf16 v[32:35], a[196:199], a[116:119], v[32:35]
    ds_read_b64_tr_b16 a[228:229], v9 offset:3072
    ds_read_b64_tr_b16 a[230:231], v9 offset:23552
    buffer_load_dwordx4 v20, s[36:39], s11 offen offset:3072 lds
    s_waitcnt vmcnt(12) lgkmcnt(12)
    s_barrier
    v_mfma_f32_16x16x32_bf16 v[36:39], a[200:203], a[112:115], v[36:39]
    ds_read_b64_tr_b16 a[232:233], v10 offset:2048
    ds_read_b64_tr_b16 a[234:235], v10 offset:22528
    v_mfma_f32_16x16x32_bf16 v[36:39], a[204:207], a[116:119], v[36:39]
    ds_read_b64_tr_b16 a[236:237], v10 offset:3072
    ds_read_b64_tr_b16 a[238:239], v10 offset:23552
    s_waitcnt lgkmcnt(12)
    v_mfma_f32_16x16x32_bf16 v[40:43], a[208:211], a[112:115], v[40:43]
    ds_read_b64_tr_b16 a[240:241], v9 offset:2560
    ds_read_b64_tr_b16 a[242:243], v9 offset:23040
    v_mfma_f32_16x16x32_bf16 v[40:43], a[212:215], a[116:119], v[40:43]
    ds_read_b64_tr_b16 a[244:245], v9 offset:3584
    ds_read_b64_tr_b16 a[246:247], v9 offset:24064
    s_add_u32 m0, s19, 90112
    s_mov_b32 s11, 1835008
    buffer_load_dwordx4 v17, s[36:39], s11 offen offset:0 lds
    s_waitcnt lgkmcnt(12)
    v_mfma_f32_16x16x32_bf16 v[44:47], a[216:219], a[112:115], v[44:47]
    ds_read_b64_tr_b16 a[248:249], v10 offset:2560
    ds_read_b64_tr_b16 a[250:251], v10 offset:23040
    v_mfma_f32_16x16x32_bf16 v[44:47], a[220:223], a[116:119], v[44:47]
    ds_read_b64_tr_b16 a[252:253], v10 offset:3584
    ds_read_b64_tr_b16 a[254:255], v10 offset:24064
    s_waitcnt lgkmcnt(12)
    v_mfma_f32_16x16x32_bf16 v[48:51], a[224:227], a[112:115], v[48:51]
    ds_read_b64_tr_b16 a[192:193], v11 offset:0
    ds_read_b64_tr_b16 a[194:195], v11 offset:20480
    v_mfma_f32_16x16x32_bf16 v[48:51], a[228:231], a[116:119], v[48:51]
    ds_read_b64_tr_b16 a[196:197], v11 offset:1024
    ds_read_b64_tr_b16 a[198:199], v11 offset:21504
    buffer_load_dwordx4 v18, s[36:39], s11 offen offset:1024 lds
    s_waitcnt lgkmcnt(12)
    v_mfma_f32_16x16x32_bf16 v[52:55], a[232:235], a[112:115], v[52:55]
    ds_read_b64_tr_b16 a[200:201], v12 offset:0
    ds_read_b64_tr_b16 a[202:203], v12 offset:20480
    v_mfma_f32_16x16x32_bf16 v[52:55], a[236:239], a[116:119], v[52:55]
    ds_read_b64_tr_b16 a[204:205], v12 offset:1024
    ds_read_b64_tr_b16 a[206:207], v12 offset:21504
    s_waitcnt lgkmcnt(12)
    v_mfma_f32_16x16x32_bf16 v[56:59], a[240:243], a[112:115], v[56:59]
    ds_read_b64_tr_b16 a[208:209], v11 offset:512
    ds_read_b64_tr_b16 a[210:211], v11 offset:20992
    v_mfma_f32_16x16x32_bf16 v[56:59], a[244:247], a[116:119], v[56:59]
    ds_read_b64_tr_b16 a[212:213], v11 offset:1536
    ds_read_b64_tr_b16 a[214:215], v11 offset:22016
    s_add_u32 m0, s19, 129024
    s_nop 0
    buffer_load_dwordx4 v19, s[36:39], s11 offen offset:2048 lds
    s_waitcnt lgkmcnt(12)
    v_mfma_f32_16x16x32_bf16 v[60:63], a[248:251], a[112:115], v[60:63]
    ds_read_b64_tr_b16 a[216:217], v12 offset:512
    ds_read_b64_tr_b16 a[218:219], v12 offset:20992
    v_mfma_f32_16x16x32_bf16 v[60:63], a[252:255], a[116:119], v[60:63]
    ds_read_b64_tr_b16 a[220:221], v12 offset:1536
    ds_read_b64_tr_b16 a[222:223], v12 offset:22016
    v_and_b32 v16, 3, v1
    v_lshlrev_b32 v16, 2, v16
    buffer_load_dword v16, v16, s[52:55], s68 offen offset:0 sc1
    s_waitcnt lgkmcnt(12)
    v_mfma_f32_16x16x32_bf16 v[32:35], a[192:195], a[120:123], v[32:35]
    ds_read_b64_tr_b16 a[224:225], v11 offset:2048
    ds_read_b64_tr_b16 a[226:227], v11 offset:22528
    v_mfma_f32_16x16x32_bf16 v[32:35], a[196:199], a[124:127], v[32:35]
    ds_read_b64_tr_b16 a[228:229], v11 offset:3072
    ds_read_b64_tr_b16 a[230:231], v11 offset:23552
    buffer_load_dwordx4 v20, s[36:39], s11 offen offset:3072 lds
    s_waitcnt lgkmcnt(12)
    v_mfma_f32_16x16x32_bf16 v[36:39], a[200:203], a[120:123], v[36:39]
    ds_read_b64_tr_b16 a[232:233], v12 offset:2048
    ds_read_b64_tr_b16 a[234:235], v12 offset:22528
    v_mfma_f32_16x16x32_bf16 v[36:39], a[204:207], a[124:127], v[36:39]
    ds_read_b64_tr_b16 a[236:237], v12 offset:3072
    ds_read_b64_tr_b16 a[238:239], v12 offset:23552
    s_waitcnt lgkmcnt(12)
    v_mfma_f32_16x16x32_bf16 v[40:43], a[208:211], a[120:123], v[40:43]
    ds_read_b64_tr_b16 a[240:241], v11 offset:2560
    ds_read_b64_tr_b16 a[242:243], v11 offset:23040
    v_mfma_f32_16x16x32_bf16 v[40:43], a[212:215], a[124:127], v[40:43]
    ds_read_b64_tr_b16 a[244:245], v11 offset:3584
    ds_read_b64_tr_b16 a[246:247], v11 offset:24064
    s_add_u32 m0, s19, 45056
    s_mov_b32 s11, 1966080
    buffer_load_dwordx4 v17, s[36:39], s11 offen offset:0 lds
    s_waitcnt lgkmcnt(12)
    v_mfma_f32_16x16x32_bf16 v[44:47], a[216:219], a[120:123], v[44:47]
    ds_read_b64_tr_b16 a[248:249], v12 offset:2560
    ds_read_b64_tr_b16 a[250:251], v12 offset:23040
    v_mfma_f32_16x16x32_bf16 v[44:47], a[220:223], a[124:127], v[44:47]
    ds_read_b64_tr_b16 a[252:253], v12 offset:3584
    ds_read_b64_tr_b16 a[254:255], v12 offset:24064
    s_waitcnt lgkmcnt(12)
    v_mfma_f32_16x16x32_bf16 v[48:51], a[224:227], a[120:123], v[48:51]
    ds_read_b64_tr_b16 a[192:193], v7 offset:8192
    ds_read_b64_tr_b16 a[194:195], v7 offset:28672
    v_mfma_f32_16x16x32_bf16 v[48:51], a[228:231], a[124:127], v[48:51]
    ds_read_b64_tr_b16 a[196:197], v7 offset:9216
    ds_read_b64_tr_b16 a[198:199], v7 offset:29696
    buffer_load_dwordx4 v18, s[36:39], s11 offen offset:1024 lds
    s_waitcnt lgkmcnt(12)
    v_mfma_f32_16x16x32_bf16 v[52:55], a[232:235], a[120:123], v[52:55]
    ds_read_b64_tr_b16 a[200:201], v8 offset:8192
    ds_read_b64_tr_b16 a[202:203], v8 offset:28672
    v_mfma_f32_16x16x32_bf16 v[52:55], a[236:239], a[124:127], v[52:55]
    ds_read_b64_tr_b16 a[204:205], v8 offset:9216
    ds_read_b64_tr_b16 a[206:207], v8 offset:29696
    s_waitcnt lgkmcnt(12)
    v_mfma_f32_16x16x32_bf16 v[56:59], a[240:243], a[120:123], v[56:59]
    ds_read_b64_tr_b16 a[208:209], v7 offset:8704
    ds_read_b64_tr_b16 a[210:211], v7 offset:29184
    v_mfma_f32_16x16x32_bf16 v[56:59], a[244:247], a[124:127], v[56:59]
    ds_read_b64_tr_b16 a[212:213], v7 offset:9728
    ds_read_b64_tr_b16 a[214:215], v7 offset:30208
    buffer_load_dwordx4 v19, s[36:39], s11 offen offset:2048 lds
    s_waitcnt lgkmcnt(12)
    v_mfma_f32_16x16x32_bf16 v[60:63], a[248:251], a[120:123], v[60:63]
    ds_read_b64_tr_b16 a[216:217], v8 offset:8704
    ds_read_b64_tr_b16 a[218:219], v8 offset:29184
    v_mfma_f32_16x16x32_bf16 v[60:63], a[252:255], a[124:127], v[60:63]
    ds_read_b64_tr_b16 a[220:221], v8 offset:9728
    ds_read_b64_tr_b16 a[222:223], v8 offset:30208
    s_waitcnt vmcnt(12) lgkmcnt(12)
    v_mfma_f32_16x16x32_bf16 v[32:35], a[192:195], a[128:131], v[32:35]
    ds_read_b64_tr_b16 a[224:225], v9 offset:8192
    ds_read_b64_tr_b16 a[226:227], v9 offset:28672
    v_mfma_f32_16x16x32_bf16 v[32:35], a[196:199], a[132:135], v[32:35]
    ds_read_b64_tr_b16 a[228:229], v9 offset:9216
    ds_read_b64_tr_b16 a[230:231], v9 offset:29696
    buffer_load_dwordx4 v20, s[36:39], s11 offen offset:3072 lds
    s_waitcnt vmcnt(9) lgkmcnt(12)
    s_barrier
    v_mfma_f32_16x16x32_bf16 v[36:39], a[200:203], a[128:131], v[36:39]
    ds_read_b64_tr_b16 a[232:233], v10 offset:8192
    ds_read_b64_tr_b16 a[234:235], v10 offset:28672
    v_mfma_f32_16x16x32_bf16 v[36:39], a[204:207], a[132:135], v[36:39]
    ds_read_b64_tr_b16 a[236:237], v10 offset:9216
    ds_read_b64_tr_b16 a[238:239], v10 offset:29696
    s_waitcnt lgkmcnt(12)
    v_mfma_f32_16x16x32_bf16 v[40:43], a[208:211], a[128:131], v[40:43]
    ds_read_b64_tr_b16 a[240:241], v9 offset:8704
    ds_read_b64_tr_b16 a[242:243], v9 offset:29184
    v_mfma_f32_16x16x32_bf16 v[40:43], a[212:215], a[132:135], v[40:43]
    ds_read_b64_tr_b16 a[244:245], v9 offset:9728
    ds_read_b64_tr_b16 a[246:247], v9 offset:30208
    s_waitcnt lgkmcnt(12)
    v_mfma_f32_16x16x32_bf16 v[44:47], a[216:219], a[128:131], v[44:47]
    ds_read_b64_tr_b16 a[248:249], v10 offset:8704
    ds_read_b64_tr_b16 a[250:251], v10 offset:29184
    v_mfma_f32_16x16x32_bf16 v[44:47], a[220:223], a[132:135], v[44:47]
    ds_read_b64_tr_b16 a[252:253], v10 offset:9728
    ds_read_b64_tr_b16 a[254:255], v10 offset:30208
    s_waitcnt lgkmcnt(12)
    v_mfma_f32_16x16x32_bf16 v[48:51], a[224:227], a[128:131], v[48:51]
    ds_read_b64_tr_b16 a[192:193], v13 offset:0
    ds_read_b64_tr_b16 a[194:195], v13 offset:20480
    v_mfma_f32_16x16x32_bf16 v[48:51], a[228:231], a[132:135], v[48:51]
    ds_read_b64_tr_b16 a[196:197], v13 offset:1024
    ds_read_b64_tr_b16 a[198:199], v13 offset:21504
    s_waitcnt lgkmcnt(12)
    v_mfma_f32_16x16x32_bf16 v[52:55], a[232:235], a[128:131], v[52:55]
    ds_read_b64_tr_b16 a[200:201], v14 offset:0
    ds_read_b64_tr_b16 a[202:203], v14 offset:20480
    v_mfma_f32_16x16x32_bf16 v[52:55], a[236:239], a[132:135], v[52:55]
    ds_read_b64_tr_b16 a[204:205], v14 offset:1024
    ds_read_b64_tr_b16 a[206:207], v14 offset:21504
    s_waitcnt lgkmcnt(12)
    v_mfma_f32_16x16x32_bf16 v[56:59], a[240:243], a[128:131], v[56:59]
    ds_read_b64_tr_b16 a[208:209], v13 offset:512
    ds_read_b64_tr_b16 a[210:211], v13 offset:20992
    v_mfma_f32_16x16x32_bf16 v[56:59], a[244:247], a[132:135], v[56:59]
    ds_read_b64_tr_b16 a[212:213], v13 offset:1536
    ds_read_b64_tr_b16 a[214:215], v13 offset:22016
    s_waitcnt lgkmcnt(12)
    v_mfma_f32_16x16x32_bf16 v[60:63], a[248:251], a[128:131], v[60:63]
    ds_read_b64_tr_b16 a[216:217], v14 offset:512
    ds_read_b64_tr_b16 a[218:219], v14 offset:20992
    v_mfma_f32_16x16x32_bf16 v[60:63], a[252:255], a[132:135], v[60:63]
    ds_read_b64_tr_b16 a[220:221], v14 offset:1536
    ds_read_b64_tr_b16 a[222:223], v14 offset:22016
    s_waitcnt vmcnt(5)
    v_cmp_ne_u32 vcc, s18, v16
    s_cbranch_vccnz L_pl11_d
L_pl11_b_d:
    s_waitcnt lgkmcnt(12)
    v_mfma_f32_16x16x32_bf16 v[32:35], a[192:195], a[136:139], v[32:35]
    ds_read_b64_tr_b16 a[224:225], v13 offset:2048
    ds_read_b64_tr_b16 a[226:227], v13 offset:22528
    v_mfma_f32_16x16x32_bf16 v[32:35], a[196:199], a[140:143], v[32:35]
    ds_read_b64_tr_b16 a[228:229], v13 offset:3072
    ds_read_b64_tr_b16 a[230:231], v13 offset:23552
    buffer_load_dwordx4 v[128:131], v2, s[24:27], s60 offen offset:0 sc1
    s_waitcnt vmcnt(5) lgkmcnt(12)
    s_barrier
    v_mfma_f32_16x16x32_bf16 v[36:39], a[200:203], a[136:139], v[36:39]
    ds_read_b64_tr_b16 a[232:233], v14 offset:2048
    ds_read_b64_tr_b16 a[234:235], v14 offset:22528
    v_mfma_f32_16x16x32_bf16 v[36:39], a[204:207], a[140:143], v[36:39]
    ds_read_b64_tr_b16 a[236:237], v14 offset:3072
    ds_read_b64_tr_b16 a[238:239], v14 offset:23552
    buffer_load_dwordx4 v[160:163], v2, s[24:27], s61 offen offset:0 sc1
    s_waitcnt lgkmcnt(12)
    v_mfma_f32_16x16x32_bf16 v[40:43], a[208:211], a[136:139], v[40:43]
    ds_read_b64_tr_b16 a[240:241], v13 offset:2560
    ds_read_b64_tr_b16 a[242:243], v13 offset:23040
    v_mfma_f32_16x16x32_bf16 v[40:43], a[212:215], a[140:143], v[40:43]
    ds_read_b64_tr_b16 a[244:245], v13 offset:3584
    ds_read_b64_tr_b16 a[246:247], v13 offset:24064
    buffer_load_dwordx4 v[192:195], v2, s[24:27], s62 offen offset:0 sc1
    s_waitcnt lgkmcnt(12)
    v_mfma_f32_16x16x32_bf16 v[44:47], a[216:219], a[136:139], v[44:47]
    ds_read_b64_tr_b16 a[248:249], v14 offset:2560
    ds_read_b64_tr_b16 a[250:251], v14 offset:23040
    v_mfma_f32_16x16x32_bf16 v[44:47], a[220:223], a[140:143], v[44:47]
    ds_read_b64_tr_b16 a[252:253], v14 offset:3584
    ds_read_b64_tr_b16 a[254:255], v14 offset:24064
    buffer_load_dwordx4 v[132:135], v2, s[24:27], s60 offen offset:1024 sc1
    s_waitcnt lgkmcnt(12)
    v_mfma_f32_16x16x32_bf16 v[48:51], a[224:227], a[136:139], v[48:51]
    ds_read_b64_tr_b16 a[192:193], v11 offset:8192
    ds_read_b64_tr_b16 a[194:195], v11 offset:28672
    v_mfma_f32_16x16x32_bf16 v[48:51], a[228:231], a[140:143], v[48:51]
    ds_read_b64_tr_b16 a[196:197], v11 offset:9216
    ds_read_b64_tr_b16 a[198:199], v11 offset:29696
    buffer_load_dwordx4 v[164:167], v2, s[24:27], s61 offen offset:1024 sc1
    s_waitcnt lgkmcnt(12)
    v_mfma_f32_16x16x32_bf16 v[52:55], a[232:235], a[136:139], v[52:55]
    ds_read_b64_tr_b16 a[200:201], v12 offset:8192
    ds_read_b64_tr_b16 a[202:203], v12 offset:28672
    v_mfma_f32_16x16x32_bf16 v[52:55], a[236:239], a[140:143], v[52:55]
    ds_read_b64_tr_b16 a[204:205], v12 offset:9216
    ds_read_b64_tr_b16 a[206:207], v12 offset:29696
    buffer_load_dwordx4 v[196:199], v2, s[24:27], s62 offen offset:1024 sc1
    s_waitcnt lgkmcnt(12)
    v_mfma_f32_16x16x32_bf16 v[56:59], a[240:243], a[136:139], v[56:59]
    ds_read_b64_tr_b16 a[208:209], v11 offset:8704
    ds_read_b64_tr_b16 a[210:211], v11 offset:29184
    v_mfma_f32_16x16x32_bf16 v[56:59], a[244:247], a[140:143], v[56:59]
    ds_read_b64_tr_b16 a[212:213], v11 offset:9728
    ds_read_b64_tr_b16 a[214:215], v11 offset:30208
    buffer_load_dwordx4 v[136:139], v2, s[24:27], s60 offen offset:2048 sc1
    s_waitcnt lgkmcnt(12)
    v_mfma_f32_16x16x32_bf16 v[60:63], a[248:251], a[136:139], v[60:63]
    ds_read_b64_tr_b16 a[216:217], v12 offset:8704
    ds_read_b64_tr_b16 a[218:219], v12 offset:29184
    v_mfma_f32_16x16x32_bf16 v[60:63], a[252:255], a[140:143], v[60:63]
    ds_read_b64_tr_b16 a[220:221], v12 offset:9728
    ds_read_b64_tr_b16 a[222:223], v12 offset:30208
    buffer_load_dwordx4 v[168:171], v2, s[24:27], s61 offen offset:2048 sc1
    s_waitcnt lgkmcnt(12)
    v_mfma_f32_16x16x32_bf16 v[32:35], a[192:195], a[144:147], v[32:35]
    ds_read_b64_tr_b16 a[224:225], v13 offset:8192
    ds_read_b64_tr_b16 a[226:227], v13 offset:28672
    v_mfma_f32_16x16x32_bf16 v[32:35], a[196:199], a[148:151], v[32:35]
    ds_read_b64_tr_b16 a[228:229], v13 offset:9216
    ds_read_b64_tr_b16 a[230:231], v13 offset:29696
    buffer_load_dwordx4 v[200:203], v2, s[24:27], s62 offen offset:2048 sc1
    s_waitcnt vmcnt(9) lgkmcnt(12)
    s_barrier
    v_mfma_f32_16x16x32_bf16 v[36:39], a[200:203], a[144:147], v[36:39]
    ds_read_b64_tr_b16 a[232:233], v14 offset:8192
    ds_read_b64_tr_b16 a[234:235], v14 offset:28672
    v_mfma_f32_16x16x32_bf16 v[36:39], a[204:207], a[148:151], v[36:39]
    ds_read_b64_tr_b16 a[236:237], v14 offset:9216
    ds_read_b64_tr_b16 a[238:239], v14 offset:29696
    buffer_load_dwordx4 v[140:143], v2, s[24:27], s60 offen offset:3072 sc1
    s_waitcnt lgkmcnt(12)
    v_mfma_f32_16x16x32_bf16 v[40:43], a[208:211], a[144:147], v[40:43]
    ds_read_b64_tr_b16 a[240:241], v13 offset:8704
    ds_read_b64_tr_b16 a[242:243], v13 offset:29184
    v_mfma_f32_16x16x32_bf16 v[40:43], a[212:215], a[148:151], v[40:43]
    ds_read_b64_tr_b16 a[244:245], v13 offset:9728
    ds_read_b64_tr_b16 a[246:247], v13 offset:30208
    buffer_load_dwordx4 v[172:175], v2, s[24:27], s61 offen offset:3072 sc1
    s_waitcnt lgkmcnt(12)
    v_mfma_f32_16x16x32_bf16 v[44:47], a[216:219], a[144:147], v[44:47]
    ds_read_b64_tr_b16 a[248:249], v14 offset:8704
    ds_read_b64_tr_b16 a[250:251], v14 offset:29184
    v_mfma_f32_16x16x32_bf16 v[44:47], a[220:223], a[148:151], v[44:47]
    ds_read_b64_tr_b16 a[252:253], v14 offset:9728
    ds_read_b64_tr_b16 a[254:255], v14 offset:30208
    buffer_load_dwordx4 v[204:207], v2, s[24:27], s62 offen offset:3072 sc1
    s_waitcnt lgkmcnt(12)
    v_mfma_f32_16x16x32_bf16 v[48:51], a[224:227], a[144:147], v[48:51]
    ds_read_b64_tr_b16 a[192:193], v9 offset:4096
    ds_read_b64_tr_b16 a[194:195], v9 offset:24576
    v_mfma_f32_16x16x32_bf16 v[48:51], a[228:231], a[148:151], v[48:51]
    ds_read_b64_tr_b16 a[196:197], v9 offset:5120
    ds_read_b64_tr_b16 a[198:199], v9 offset:25600
    s_waitcnt lgkmcnt(12)
    v_mfma_f32_16x16x32_bf16 v[52:55], a[232:235], a[144:147], v[52:55]
    ds_read_b64_tr_b16 a[200:201], v10 offset:4096
    ds_read_b64_tr_b16 a[202:203], v10 offset:24576
    v_mfma_f32_16x16x32_bf16 v[52:55], a[236:239], a[148:151], v[52:55]
    ds_read_b64_tr_b16 a[204:205], v10 offset:5120
    ds_read_b64_tr_b16 a[206:207], v10 offset:25600
    s_waitcnt lgkmcnt(12)
    v_mfma_f32_16x16x32_bf16 v[56:59], a[240:243], a[144:147], v[56:59]
    ds_read_b64_tr_b16 a[208:209], v9 offset:4608
    ds_read_b64_tr_b16 a[210:211], v9 offset:25088
    v_mfma_f32_16x16x32_bf16 v[56:59], a[244:247], a[148:151], v[56:59]
    ds_read_b64_tr_b16 a[212:213], v9 offset:5632
    ds_read_b64_tr_b16 a[214:215], v9 offset:26112
    s_waitcnt lgkmcnt(12)
    v_mfma_f32_16x16x32_bf16 v[60:63], a[248:251], a[144:147], v[60:63]
    ds_read_b64_tr_b16 a[216:217], v10 offset:4608
    ds_read_b64_tr_b16 a[218:219], v10 offset:25088
    v_mfma_f32_16x16x32_bf16 v[60:63], a[252:255], a[148:151], v[60:63]
    ds_read_b64_tr_b16 a[220:221], v10 offset:5632
    ds_read_b64_tr_b16 a[222:223], v10 offset:26112
    s_waitcnt lgkmcnt(12)
    v_mfma_f32_16x16x32_bf16 v[32:35], a[192:195], a[152:155], v[32:35]
    ds_read_b64_tr_b16 a[224:225], v9 offset:6144
    ds_read_b64_tr_b16 a[226:227], v9 offset:26624
    v_mfma_f32_16x16x32_bf16 v[32:35], a[196:199], a[156:159], v[32:35]
    ds_read_b64_tr_b16 a[228:229], v9 offset:7168
    ds_read_b64_tr_b16 a[230:231], v9 offset:27648
    s_waitcnt lgkmcnt(12)
    v_mfma_f32_16x16x32_bf16 v[36:39], a[200:203], a[152:155], v[36:39]
    ds_read_b64_tr_b16 a[232:233], v10 offset:6144
    ds_read_b64_tr_b16 a[234:235], v10 offset:26624
    v_mfma_f32_16x16x32_bf16 v[36:39], a[204:207], a[156:159], v[36:39]
    ds_read_b64_tr_b16 a[236:237], v10 offset:7168
    ds_read_b64_tr_b16 a[238:239], v10 offset:27648
    s_waitcnt lgkmcnt(12)
    v_mfma_f32_16x16x32_bf16 v[40:43], a[208:211], a[152:155], v[40:43]
    ds_read_b64_tr_b16 a[240:241], v9 offset:6656
    ds_read_b64_tr_b16 a[242:243], v9 offset:27136
    v_mfma_f32_16x16x32_bf16 v[40:43], a[212:215], a[156:159], v[40:43]
    ds_read_b64_tr_b16 a[244:245], v9 offset:7680
    ds_read_b64_tr_b16 a[246:247], v9 offset:28160
    s_waitcnt lgkmcnt(12)
    v_mfma_f32_16x16x32_bf16 v[44:47], a[216:219], a[152:155], v[44:47]
    ds_read_b64_tr_b16 a[248:249], v10 offset:6656
    ds_read_b64_tr_b16 a[250:251], v10 offset:27136
    v_mfma_f32_16x16x32_bf16 v[44:47], a[220:223], a[156:159], v[44:47]
    ds_read_b64_tr_b16 a[252:253], v10 offset:7680
    ds_read_b64_tr_b16 a[254:255], v10 offset:28160
    s_waitcnt lgkmcnt(12)
    v_mfma_f32_16x16x32_bf16 v[48:51], a[224:227], a[152:155], v[48:51]
    v_mfma_f32_16x16x32_bf16 v[48:51], a[228:231], a[156:159], v[48:51]
    s_waitcnt lgkmcnt(8)
    v_mfma_f32_16x16x32_bf16 v[52:55], a[232:235], a[152:155], v[52:55]
    v_mfma_f32_16x16x32_bf16 v[52:55], a[236:239], a[156:159], v[52:55]
    s_waitcnt lgkmcnt(4)
    v_mfma_f32_16x16x32_bf16 v[56:59], a[240:243], a[152:155], v[56:59]
    v_mfma_f32_16x16x32_bf16 v[56:59], a[244:247], a[156:159], v[56:59]
    s_waitcnt lgkmcnt(0)
    v_mfma_f32_16x16x32_bf16 v[60:63], a[248:251], a[152:155], v[60:63]
    v_mfma_f32_16x16x32_bf16 v[60:63], a[252:255], a[156:159], v[60:63]
    s_mov_b32 s97, 0xffff0000
    s_waitcnt vmcnt(63)
    v_permlane16_swap_b32 v224, v226
    v_permlane16_swap_b32 v225, v227
    v_permlane16_swap_b32 v228, v230
    v_permlane16_swap_b32 v229, v231
    v_permlane16_swap_b32 v232, v234
    v_permlane16_swap_b32 v233, v235
    v_permlane16_swap_b32 v236, v238
    v_permlane16_swap_b32 v237, v239
    s_waitcnt vmcnt(9)
    v_lshlrev_b32 v68, 16, v128
    v_and_b32 v69, s97, v128
    v_lshlrev_b32 v70, 16, v129
    v_and_b32 v71, s97, v129
    v_pk_add_f32 v[64:65], v[64:65], v[68:69]
    v_pk_add_f32 v[66:67], v[66:67], v[70:71]
    v_lshlrev_b32 v68, 16, v160
    v_and_b32 v69, s97, v160
    v_lshlrev_b32 v70, 16, v161
    v_and_b32 v71, s97, v161
    v_pk_add_f32 v[64:65], v[64:65], v[68:69]
    v_pk_add_f32 v[66:67], v[66:67], v[70:71]
    v_lshlrev_b32 v68, 16, v192
    v_and_b32 v69, s97, v192
    v_lshlrev_b32 v70, 16, v193
    v_and_b32 v71, s97, v193
    v_pk_add_f32 v[64:65], v[64:65], v[68:69]
    v_pk_add_f32 v[66:67], v[66:67], v[70:71]
    v_pk_mul_f32 v[72:73], v[64:65], s[76:77] op_sel_hi:[1,0]
    v_pk_mul_f32 v[74:75], v[66:67], s[76:77] op_sel_hi:[1,0]
    v_exp_f32 v72, v72
    v_exp_f32 v73, v73
    v_exp_f32 v74, v74
    v_exp_f32 v75, v75
    v_pk_mul_f32 v[64:65], v[64:65], v[32:33]
    v_pk_mul_f32 v[66:67], v[66:67], v[34:35]
    v_pk_add_f32 v[72:73], v[72:73], 1.0 op_sel_hi:[1,0]
    v_pk_add_f32 v[74:75], v[74:75], 1.0 op_sel_hi:[1,0]
    v_rcp_f32 v72, v72
    v_rcp_f32 v73, v73
    v_rcp_f32 v74, v74
    v_rcp_f32 v75, v75
    v_lshlrev_b32 v76, 16, v224
    v_and_b32 v77, s97, v224
    v_lshlrev_b32 v78, 16, v225
    v_and_b32 v79, s97, v225
    v_pk_fma_f32 v[64:65], v[64:65], v[72:73], v[76:77]
    v_pk_fma_f32 v[66:67], v[66:67], v[74:75], v[78:79]
    v_cvt_pk_bf16_f32 v32, v64, v65
    v_cvt_pk_bf16_f32 v33, v66, v67
    v_lshlrev_b32 v84, 16, v130
    v_and_b32 v85, s97, v130
    v_lshlrev_b32 v86, 16, v131
    v_and_b32 v87, s97, v131
    v_pk_add_f32 v[80:81], v[80:81], v[84:85]
    v_pk_add_f32 v[82:83], v[82:83], v[86:87]
    v_lshlrev_b32 v84, 16, v162
    v_and_b32 v85, s97, v162
    v_lshlrev_b32 v86, 16, v163
    v_and_b32 v87, s97, v163
    v_pk_add_f32 v[80:81], v[80:81], v[84:85]
    v_pk_add_f32 v[82:83], v[82:83], v[86:87]
    v_lshlrev_b32 v84, 16, v194
    v_and_b32 v85, s97, v194
    v_lshlrev_b32 v86, 16, v195
    v_and_b32 v87, s97, v195
    v_pk_add_f32 v[80:81], v[80:81], v[84:85]
    v_pk_add_f32 v[82:83], v[82:83], v[86:87]
    v_pk_mul_f32 v[88:89], v[80:81], s[76:77] op_sel_hi:[1,0]
    v_pk_mul_f32 v[90:91], v[82:83], s[76:77] op_sel_hi:[1,0]
    v_exp_f32 v88, v88
    v_exp_f32 v89, v89
    v_exp_f32 v90, v90
    v_exp_f32 v91, v91
    v_pk_mul_f32 v[80:81], v[80:81], v[36:37]
    v_pk_mul_f32 v[82:83], v[82:83], v[38:39]
    v_pk_add_f32 v[88:89], v[88:89], 1.0 op_sel_hi:[1,0]
    v_pk_add_f32 v[90:91], v[90:91], 1.0 op_sel_hi:[1,0]
    v_rcp_f32 v88, v88
    v_rcp_f32 v89, v89
    v_rcp_f32 v90, v90
    v_rcp_f32 v91, v91
    v_lshlrev_b32 v92, 16, v226
    v_and_b32 v93, s97, v226
    v_lshlrev_b32 v94, 16, v227
    v_and_b32 v95, s97, v227
    v_pk_fma_f32 v[80:81], v[80:81], v[88:89], v[92:93]
    v_pk_fma_f32 v[82:83], v[82:83], v[90:91], v[94:95]
    v_cvt_pk_bf16_f32 v34, v80, v81
    v_cvt_pk_bf16_f32 v35, v82, v83
    s_nop 0
    v_permlane16_swap_b32 v32, v34
    v_permlane16_swap_b32 v33, v35
    buffer_store_dwordx4 v[32:35], v30, s[32:35], 0 offen offset:0 sc1
    s_waitcnt vmcnt(7)
    v_lshlrev_b32 v100, 16, v132
    v_and_b32 v101, s97, v132
    v_lshlrev_b32 v102, 16, v133
    v_and_b32 v103, s97, v133
    v_pk_add_f32 v[96:97], v[96:97], v[100:101]
    v_pk_add_f32 v[98:99], v[98:99], v[102:103]
    v_lshlrev_b32 v100, 16, v164
    v_and_b32 v101, s97, v164
    v_lshlrev_b32 v102, 16, v165
    v_and_b32 v103, s97, v165
    v_pk_add_f32 v[96:97], v[96:97], v[100:101]
    v_pk_add_f32 v[98:99], v[98:99], v[102:103]
    v_lshlrev_b32 v100, 16, v196
    v_and_b32 v101, s97, v196
    v_lshlrev_b32 v102, 16, v197
    v_and_b32 v103, s97, v197
    v_pk_add_f32 v[96:97], v[96:97], v[100:101]
    v_pk_add_f32 v[98:99], v[98:99], v[102:103]
    v_pk_mul_f32 v[104:105], v[96:97], s[76:77] op_sel_hi:[1,0]
    v_pk_mul_f32 v[106:107], v[98:99], s[76:77] op_sel_hi:[1,0]
    v_exp_f32 v104, v104
    v_exp_f32 v105, v105
    v_exp_f32 v106, v106
    v_exp_f32 v107, v107
    v_pk_mul_f32 v[96:97], v[96:97], v[40:41]
    v_pk_mul_f32 v[98:99], v[98:99], v[42:43]
    v_pk_add_f32 v[104:105], v[104:105], 1.0 op_sel_hi:[1,0]
    v_pk_add_f32 v[106:107], v[106:107], 1.0 op_sel_hi:[1,0]
    v_rcp_f32 v104, v104
    v_rcp_f32 v105, v105
    v_rcp_f32 v106, v106
    v_rcp_f32 v107, v107
    v_lshlrev_b32 v108, 16, v228
    v_and_b32 v109, s97, v228
    v_lshlrev_b32 v110, 16, v229
    v_and_b32 v111, s97, v229
    v_pk_fma_f32 v[96:97], v[96:97], v[104:105], v[108:109]
    v_pk_fma_f32 v[98:99], v[98:99], v[106:107], v[110:111]
    v_cvt_pk_bf16_f32 v40, v96, v97
    v_cvt_pk_bf16_f32 v41, v98, v99
    v_lshlrev_b32 v116, 16, v134
    v_and_b32 v117, s97, v134
    v_lshlrev_b32 v118, 16, v135
    v_and_b32 v119, s97, v135
    v_pk_add_f32 v[112:113], v[112:113], v[116:117]
    v_pk_add_f32 v[114:115], v[114:115], v[118:119]
    v_lshlrev_b32 v116, 16, v166
    v_and_b32 v117, s97, v166
    v_lshlrev_b32 v118, 16, v167
    v_and_b32 v119, s97, v167
    v_pk_add_f32 v[112:113], v[112:113], v[116:117]
    v_pk_add_f32 v[114:115], v[114:115], v[118:119]
    v_lshlrev_b32 v116, 16, v198
    v_and_b32 v117, s97, v198
    v_lshlrev_b32 v118, 16, v199
    v_and_b32 v119, s97, v199
    v_pk_add_f32 v[112:113], v[112:113], v[116:117]
    v_pk_add_f32 v[114:115], v[114:115], v[118:119]
    v_pk_mul_f32 v[120:121], v[112:113], s[76:77] op_sel_hi:[1,0]
    v_pk_mul_f32 v[122:123], v[114:115], s[76:77] op_sel_hi:[1,0]
    v_exp_f32 v120, v120
    v_exp_f32 v121, v121
    v_exp_f32 v122, v122
    v_exp_f32 v123, v123
    v_pk_mul_f32 v[112:113], v[112:113], v[44:45]
    v_pk_mul_f32 v[114:115], v[114:115], v[46:47]
    v_pk_add_f32 v[120:121], v[120:121], 1.0 op_sel_hi:[1,0]
    v_pk_add_f32 v[122:123], v[122:123], 1.0 op_sel_hi:[1,0]
    v_rcp_f32 v120, v120
    v_rcp_f32 v121, v121
    v_rcp_f32 v122, v122
    v_rcp_f32 v123, v123
    v_lshlrev_b32 v124, 16, v230
    v_and_b32 v125, s97, v230
    v_lshlrev_b32 v126, 16, v231
    v_and_b32 v127, s97, v231
    v_pk_fma_f32 v[112:113], v[112:113], v[120:121], v[124:125]
    v_pk_fma_f32 v[114:115], v[114:115], v[122:123], v[126:127]
    v_cvt_pk_bf16_f32 v42, v112, v113
    v_cvt_pk_bf16_f32 v43, v114, v115
    s_nop 0
    v_permlane16_swap_b32 v40, v42
    v_permlane16_swap_b32 v41, v43
    buffer_store_dwordx4 v[40:43], v30, s[32:35], 0 offen offset:64 sc1
    s_waitcnt vmcnt(5)
    v_lshlrev_b32 v148, 16, v136
    v_and_b32 v149, s97, v136
    v_lshlrev_b32 v150, 16, v137
    v_and_b32 v151, s97, v137
    v_pk_add_f32 v[144:145], v[144:145], v[148:149]
    v_pk_add_f32 v[146:147], v[146:147], v[150:151]
    v_lshlrev_b32 v148, 16, v168
    v_and_b32 v149, s97, v168
    v_lshlrev_b32 v150, 16, v169
    v_and_b32 v151, s97, v169
    v_pk_add_f32 v[144:145], v[144:145], v[148:149]
    v_pk_add_f32 v[146:147], v[146:147], v[150:151]
    v_lshlrev_b32 v148, 16, v200
    v_and_b32 v149, s97, v200
    v_lshlrev_b32 v150, 16, v201
    v_and_b32 v151, s97, v201
    v_pk_add_f32 v[144:145], v[144:145], v[148:149]
    v_pk_add_f32 v[146:147], v[146:147], v[150:151]
    v_pk_mul_f32 v[152:153], v[144:145], s[76:77] op_sel_hi:[1,0]
    v_pk_mul_f32 v[154:155], v[146:147], s[76:77] op_sel_hi:[1,0]
    v_exp_f32 v152, v152
    v_exp_f32 v153, v153
    v_exp_f32 v154, v154
    v_exp_f32 v155, v155
    v_pk_mul_f32 v[144:145], v[144:145], v[48:49]
    v_pk_mul_f32 v[146:147], v[146:147], v[50:51]
    v_pk_add_f32 v[152:153], v[152:153], 1.0 op_sel_hi:[1,0]
    v_pk_add_f32 v[154:155], v[154:155], 1.0 op_sel_hi:[1,0]
    v_rcp_f32 v152, v152
    v_rcp_f32 v153, v153
    v_rcp_f32 v154, v154
    v_rcp_f32 v155, v155
    v_lshlrev_b32 v156, 16, v232
    v_and_b32 v157, s97, v232
    v_lshlrev_b32 v158, 16, v233
    v_and_b32 v159, s97, v233
    v_pk_fma_f32 v[144:145], v[144:145], v[152:153], v[156:157]
    v_pk_fma_f32 v[146:147], v[146:147], v[154:155], v[158:159]
    v_cvt_pk_bf16_f32 v48, v144, v145
    v_cvt_pk_bf16_f32 v49, v146, v147
    v_lshlrev_b32 v180, 16, v138
    v_and_b32 v181, s97, v138
    v_lshlrev_b32 v182, 16, v139
    v_and_b32 v183, s97, v139
    v_pk_add_f32 v[176:177], v[176:177], v[180:181]
    v_pk_add_f32 v[178:179], v[178:179], v[182:183]
    v_lshlrev_b32 v180, 16, v170
    v_and_b32 v181, s97, v170
    v_lshlrev_b32 v182, 16, v171
    v_and_b32 v183, s97, v171
    v_pk_add_f32 v[176:177], v[176:177], v[180:181]
    v_pk_add_f32 v[178:179], v[178:179], v[182:183]
    v_lshlrev_b32 v180, 16, v202
    v_and_b32 v181, s97, v202
    v_lshlrev_b32 v182, 16, v203
    v_and_b32 v183, s97, v203
    v_pk_add_f32 v[176:177], v[176:177], v[180:181]
    v_pk_add_f32 v[178:179], v[178:179], v[182:183]
    v_pk_mul_f32 v[184:185], v[176:177], s[76:77] op_sel_hi:[1,0]
    v_pk_mul_f32 v[186:187], v[178:179], s[76:77] op_sel_hi:[1,0]
    v_exp_f32 v184, v184
    v_exp_f32 v185, v185
    v_exp_f32 v186, v186
    v_exp_f32 v187, v187
    v_pk_mul_f32 v[176:177], v[176:177], v[52:53]
    v_pk_mul_f32 v[178:179], v[178:179], v[54:55]
    v_pk_add_f32 v[184:185], v[184:185], 1.0 op_sel_hi:[1,0]
    v_pk_add_f32 v[186:187], v[186:187], 1.0 op_sel_hi:[1,0]
    v_rcp_f32 v184, v184
    v_rcp_f32 v185, v185
    v_rcp_f32 v186, v186
    v_rcp_f32 v187, v187
    v_lshlrev_b32 v188, 16, v234
    v_and_b32 v189, s97, v234
    v_lshlrev_b32 v190, 16, v235
    v_and_b32 v191, s97, v235
    v_pk_fma_f32 v[176:177], v[176:177], v[184:185], v[188:189]
    v_pk_fma_f32 v[178:179], v[178:179], v[186:187], v[190:191]
    v_cvt_pk_bf16_f32 v50, v176, v177
    v_cvt_pk_bf16_f32 v51, v178, v179
    s_nop 0
    v_permlane16_swap_b32 v48, v50
    v_permlane16_swap_b32 v49, v51
    buffer_store_dwordx4 v[48:51], v30, s[32:35], 0 offen offset:128 sc1
    s_waitcnt vmcnt(3)
    v_lshlrev_b32 v212, 16, v140
    v_and_b32 v213, s97, v140
    v_lshlrev_b32 v214, 16, v141
    v_and_b32 v215, s97, v141
    v_pk_add_f32 v[208:209], v[208:209], v[212:213]
    v_pk_add_f32 v[210:211], v[210:211], v[214:215]
    v_lshlrev_b32 v212, 16, v172
    v_and_b32 v213, s97, v172
    v_lshlrev_b32 v214, 16, v173
    v_and_b32 v215, s97, v173
    v_pk_add_f32 v[208:209], v[208:209], v[212:213]
    v_pk_add_f32 v[210:211], v[210:211], v[214:215]
    v_lshlrev_b32 v212, 16, v204
    v_and_b32 v213, s97, v204
    v_lshlrev_b32 v214, 16, v205
    v_and_b32 v215, s97, v205
    v_pk_add_f32 v[208:209], v[208:209], v[212:213]
    v_pk_add_f32 v[210:211], v[210:211], v[214:215]
    v_pk_mul_f32 v[216:217], v[208:209], s[76:77] op_sel_hi:[1,0]
    v_pk_mul_f32 v[218:219], v[210:211], s[76:77] op_sel_hi:[1,0]
    v_exp_f32 v216, v216
    v_exp_f32 v217, v217
    v_exp_f32 v218, v218
    v_exp_f32 v219, v219
    v_pk_mul_f32 v[208:209], v[208:209], v[56:57]
    v_pk_mul_f32 v[210:211], v[210:211], v[58:59]
    v_pk_add_f32 v[216:217], v[216:217], 1.0 op_sel_hi:[1,0]
    v_pk_add_f32 v[218:219], v[218:219], 1.0 op_sel_hi:[1,0]
    v_rcp_f32 v216, v216
    v_rcp_f32 v217, v217
    v_rcp_f32 v218, v218
    v_rcp_f32 v219, v219
    v_lshlrev_b32 v220, 16, v236
    v_and_b32 v221, s97, v236
    v_lshlrev_b32 v222, 16, v237
    v_and_b32 v223, s97, v237
    v_pk_fma_f32 v[208:209], v[208:209], v[216:217], v[220:221]
    v_pk_fma_f32 v[210:211], v[210:211], v[218:219], v[222:223]
    v_cvt_pk_bf16_f32 v56, v208, v209
    v_cvt_pk_bf16_f32 v57, v210, v211
    v_lshlrev_b32 v244, 16, v142
    v_and_b32 v245, s97, v142
    v_lshlrev_b32 v246, 16, v143
    v_and_b32 v247, s97, v143
    v_pk_add_f32 v[240:241], v[240:241], v[244:245]
    v_pk_add_f32 v[242:243], v[242:243], v[246:247]
    v_lshlrev_b32 v244, 16, v174
    v_and_b32 v245, s97, v174
    v_lshlrev_b32 v246, 16, v175
    v_and_b32 v247, s97, v175
    v_pk_add_f32 v[240:241], v[240:241], v[244:245]
    v_pk_add_f32 v[242:243], v[242:243], v[246:247]
    v_lshlrev_b32 v244, 16, v206
    v_and_b32 v245, s97, v206
    v_lshlrev_b32 v246, 16, v207
    v_and_b32 v247, s97, v207
    v_pk_add_f32 v[240:241], v[240:241], v[244:245]
    v_pk_add_f32 v[242:243], v[242:243], v[246:247]
    v_pk_mul_f32 v[248:249], v[240:241], s[76:77] op_sel_hi:[1,0]
    v_pk_mul_f32 v[250:251], v[242:243], s[76:77] op_sel_hi:[1,0]
    v_exp_f32 v248, v248
    v_exp_f32 v249, v249
    v_exp_f32 v250, v250
    v_exp_f32 v251, v251
    v_pk_mul_f32 v[240:241], v[240:241], v[60:61]
    v_pk_mul_f32 v[242:243], v[242:243], v[62:63]
    v_pk_add_f32 v[248:249], v[248:249], 1.0 op_sel_hi:[1,0]
    v_pk_add_f32 v[250:251], v[250:251], 1.0 op_sel_hi:[1,0]
    v_rcp_f32 v248, v248
    v_rcp_f32 v249, v249
    v_rcp_f32 v250, v250
    v_rcp_f32 v251, v251
    v_lshlrev_b32 v252, 16, v238
    v_and_b32 v253, s97, v238
    v_lshlrev_b32 v254, 16, v239
    v_and_b32 v255, s97, v239
    v_pk_fma_f32 v[240:241], v[240:241], v[248:249], v[252:253]
    v_pk_fma_f32 v[242:243], v[242:243], v[250:251], v[254:255]
    v_cvt_pk_bf16_f32 v58, v240, v241
    v_cvt_pk_bf16_f32 v59, v242, v243
    s_nop 0
    v_permlane16_swap_b32 v56, v58
    v_permlane16_swap_b32 v57, v59
    buffer_store_dwordx4 v[56:59], v30, s[32:35], 0 offen offset:192 sc1
    s_or_b32 s10, s2, s3
    s_cmp_lg_u32 s10, 0
    s_cbranch_scc1 L_nogen_d
    s_mov_b32 s10, 65536
    s_mov_b64 exec, 1
    buffer_store_dword v21, off, s[52:55], s10 sc1
    s_mov_b64 exec, -1
L_nogen_d:
    s_endpgm
L_px:
    s_mov_b32 s10, 0x40000
L_px_l:
    buffer_load_dword v23, v22, s[52:55], s95 offen sc1
    s_sub_u32 s10, s10, 1
    s_cbranch_scc1 L_px_b
    s_waitcnt vmcnt(0)
    v_cmp_ne_u32 vcc, s18, v23
    s_cbranch_vccnz L_px_l
    s_branch L_px_b
L_pl1:
    s_mov_b32 s75, 0x40000
L_pl1_l:
    v_and_b32 v16, 3, v1
    v_lshlrev_b32 v16, 2, v16
    buffer_load_dword v16, v16, s[52:55], s67 offen offset:0 sc1
    s_sub_u32 s75, s75, 1
    s_cbranch_scc1 L_pl1_b
    s_waitcnt vmcnt(0)
    v_cmp_ne_u32 vcc, s18, v16
    s_cbranch_vccnz L_pl1_l
    s_branch L_pl1_b
L_pl2:
    s_mov_b32 s75, 0x40000
L_pl2_l:
    v_and_b32 v16, 3, v1
    v_lshlrev_b32 v16, 2, v16
    buffer_load_dword v16, v16, s[52:55], s73 offen offset:0 sc1
    s_sub_u32 s75, s75, 1
    s_cbranch_scc1 L_pl2_b
    s_waitcnt vmcnt(0)
    v_cmp_ne_u32 vcc, s18, v16
    s_cbranch_vccnz L_pl2_l
    s_branch L_pl2_b
L_pl3:
    s_mov_b32 s75, 0x40000
L_pl3_l:
    v_and_b32 v16, 3, v1
    v_lshlrev_b32 v16, 2, v16
    buffer_load_dword v16, v16, s[52:55], s73 offen offset:64 sc1
    s_sub_u32 s75, s75, 1
    s_cbranch_scc1 L_pl3_b
    s_waitcnt vmcnt(0)
    v_cmp_ne_u32 vcc, s18, v16
    s_cbranch_vccnz L_pl3_l
    s_branch L_pl3_b
L_pl4:
    s_mov_b32 s75, 0x40000
L_pl4_l:
    v_and_b32 v0, 3, v1
    v_lshlrev_b32 v0, 2, v0
    buffer_load_dword v0, v0, s[52:55], s67 offen offset:64 sc1
    s_sub_u32 s75, s75, 1
    s_cbranch_scc1 L_pl4_b
    s_waitcnt vmcnt(0)
    v_cmp_ne_u32 vcc, s18, v0
    s_cbranch_vccnz L_pl4_l
    s_branch L_pl4_b
L_pl10_d:
    s_mov_b32 s75, 0x40000
L_pl10_l_d:
    v_and_b32 v16, 15, v1
    v_lshlrev_b32 v16, 2, v16
    buffer_load_dword v16, v16, s[52:55], s64 offen offset:0 sc1
    s_sub_u32 s75, s75, 1
    s_cbranch_scc1 L_pl10_b_d
    s_waitcnt vmcnt(0)
    v_cmp_ne_u32 vcc, s18, v16
    s_cbranch_vccnz L_pl10_l_d
    s_branch L_pl10_b_d
L_pl11_d:
    s_mov_b32 s75, 0x40000
L_pl11_l_d:
    v_and_b32 v16, 3, v1
    v_lshlrev_b32 v16, 2, v16
    buffer_load_dword v16, v16, s[52:55], s68 offen offset:0 sc1
    s_sub_u32 s75, s75, 1
    s_cbranch_scc1 L_pl11_b_d
    s_waitcnt vmcnt(0)
    v_cmp_ne_u32 vcc, s18, v16
    s_cbranch_vccnz L_pl11_l_d
    s_branch L_pl11_b_d
L_Q:
    s_waitcnt vmcnt(7)
    s_mov_b32 m0, s70
    s_nop 0
    buffer_load_dwordx4 v7, s[24:27], s64 offen offset:0 lds
    buffer_load_dwordx4 v8, s[24:27], s64 offen offset:1024 lds
    buffer_load_dwordx4 v7, s[28:31], s64 offen offset:2048 lds
    buffer_load_dwordx4 v8, s[28:31], s64 offen offset:3072 lds
    ds_read_b128 v[224:227], v190 offset:40960
    ds_read_b128 v[228:231], v191 offset:40960
    ds_read_b128 v[232:235], v190 offset:43008
    ds_read_b128 v[236:239], v191 offset:43008
    ds_read_b128 v[240:243], v190 offset:45056
    ds_read_b128 v[244:247], v191 offset:45056
    ds_read_b128 v[248:251], v190 offset:47104
    ds_read_b128 v[252:255], v191 offset:47104
    s_barrier
    s_waitcnt lgkmcnt(0)
    ds_read_b64_tr_b16 a[224:225], v30 offset:0
    ds_read_b64_tr_b16 a[226:227], v30 offset:10240
    ds_read_b64_tr_b16 a[228:229], v30 offset:32
    ds_read_b64_tr_b16 a[230:231], v30 offset:10272
    ds_read_b64_tr_b16 a[232:233], v30 offset:20480
    ds_read_b64_tr_b16 a[234:235], v30 offset:30720
    ds_read_b64_tr_b16 a[236:237], v30 offset:20512
    ds_read_b64_tr_b16 a[238:239], v30 offset:30752
    v_lshlrev_b32 v192, 16, v224
    v_and_b32 v193, s94, v224
    v_lshlrev_b32 v194, 16, v225
    v_and_b32 v195, s94, v225
    v_lshlrev_b32 v196, 16, v226
    v_and_b32 v197, s94, v226
    v_lshlrev_b32 v198, 16, v227
    v_and_b32 v199, s94, v227
    v_lshlrev_b32 v200, 16, v228
    v_and_b32 v201, s94, v228
    v_lshlrev_b32 v202, 16, v229
    v_and_b32 v203, s94, v229
    v_lshlrev_b32 v204, 16, v230
    v_and_b32 v205, s94, v230
    v_lshlrev_b32 v206, 16, v231
    v_and_b32 v207, s94, v231
    v_lshlrev_b32 v208, 16, v232
    v_and_b32 v209, s94, v232
    v_lshlrev_b32 v210, 16, v233
    v_and_b32 v211, s94, v233
    v_lshlrev_b32 v212, 16, v234
    v_and_b32 v213, s94, v234
    v_lshlrev_b32 v214, 16, v235
    v_and_b32 v215, s94, v235
    v_lshlrev_b32 v216, 16, v236
    v_and_b32 v217, s94, v236
    v_lshlrev_b32 v218, 16, v237
    v_and_b32 v219, s94, v237
    v_lshlrev_b32 v220, 16, v238
    v_and_b32 v221, s94, v238
    v_lshlrev_b32 v222, 16, v239
    v_and_b32 v223, s94, v239
    ds_read_b64_tr_b16 a[192:193], v13 offset:0
    ds_read_b64_tr_b16 a[194:195], v13 offset:20480
    ds_read_b64_tr_b16 a[196:197], v13 offset:1024
    ds_read_b64_tr_b16 a[198:199], v13 offset:21504
    ds_read_b64_tr_b16 a[200:201], v14 offset:0
    ds_read_b64_tr_b16 a[202:203], v14 offset:20480
    ds_read_b64_tr_b16 a[204:205], v14 offset:1024
    ds_read_b64_tr_b16 a[206:207], v14 offset:21504
    v_lshlrev_b32 v224, 16, v240
    v_and_b32 v225, s94, v240
    v_lshlrev_b32 v226, 16, v241
    v_and_b32 v227, s94, v241
    v_lshlrev_b32 v228, 16, v242
    v_and_b32 v229, s94, v242
    v_lshlrev_b32 v230, 16, v243
    v_and_b32 v231, s94, v243
    v_lshlrev_b32 v232, 16, v244
    v_and_b32 v233, s94, v244
    v_lshlrev_b32 v234, 16, v245
    v_and_b32 v235, s94, v245
    v_lshlrev_b32 v236, 16, v246
    v_and_b32 v237, s94, v246
    v_lshlrev_b32 v238, 16, v247
    v_and_b32 v239, s94, v247
    v_lshlrev_b32 v240, 16, v248
    v_and_b32 v241, s94, v248
    v_lshlrev_b32 v242, 16, v249
    v_and_b32 v243, s94, v249
    v_lshlrev_b32 v244, 16, v250
    v_and_b32 v245, s94, v250
    v_lshlrev_b32 v246, 16, v251
    v_and_b32 v247, s94, v251
    v_lshlrev_b32 v248, 16, v252
    v_and_b32 v249, s94, v252
    v_lshlrev_b32 v250, 16, v253
    v_and_b32 v251, s94, v253
    v_lshlrev_b32 v252, 16, v254
    v_and_b32 v253, s94, v254
    v_lshlrev_b32 v254, 16, v255
    v_and_b32 v255, s94, v255
    s_mov_b32 s10, 0x40000
    s_waitcnt vmcnt(10)
    v_cmp_ne_u32 vcc, s18, v185
    v_mov_b32 v176, v184
    s_cbranch_vccz L_ps_out_d
    buffer_load_dwordx2 v[184:185], v188, s[52:55], 0 offen sc1
    s_waitcnt vmcnt(6)
L_ps_d:
    v_cmp_ne_u32 vcc, s18, v187
    v_mov_b32 v176, v186
    s_cbranch_vccz L_ps_out_d
    buffer_load_dwordx2 v[186:187], v188, s[52:55], 0 offen sc1
    s_waitcnt vmcnt(1)
    v_cmp_ne_u32 vcc, s18, v185
    v_mov_b32 v176, v184
    s_cbranch_vccz L_ps_out_d
    buffer_load_dwordx2 v[184:185], v188, s[52:55], 0 offen sc1
    s_sub_u32 s10, s10, 1
    s_waitcnt vmcnt(1)
    s_cbranch_scc0 L_ps_d
L_ps_out_d:
    s_waitcnt vmcnt(6)
    s_mov_b64 exec, 1
    buffer_store_dword v21, off, s[52:55], s79 sc1
    s_mov_b64 exec, -1
    v_lshlrev_b32 v177, 16, v176
    v_and_b32 v176, s94, v176
    v_rcp_f32 v176, v176
    s_nop 0
    v_mul_f32_e64 v177, -v177, v176
    v_mov_b32 v180, v176
    v_mov_b32 v181, v177
    s_nop 0
    v_permlane32_swap_b32 v176, v180
    v_permlane32_swap_b32 v177, v181
    v_mov_b32 v178, v176
    v_mov_b32 v179, v177
    v_mov_b32 v26, v180
    v_mov_b32 v27, v181
    v_permlane16_swap_b32 v176, v178
    v_permlane16_swap_b32 v177, v179
    v_permlane16_swap_b32 v180, v26
    v_permlane16_swap_b32 v181, v27
    v_pk_fma_f32 v[96:97], v[96:97], v[176:177], v[176:177] op_sel:[0,0,1] op_sel_hi:[1,0,1]
    v_pk_fma_f32 v[98:99], v[98:99], v[176:177], v[176:177] op_sel:[0,0,1] op_sel_hi:[1,0,1]
    v_pk_fma_f32 v[100:101], v[100:101], v[176:177], v[176:177] op_sel:[0,0,1] op_sel_hi:[1,0,1]
    v_pk_fma_f32 v[102:103], v[102:103], v[176:177], v[176:177] op_sel:[0,0,1] op_sel_hi:[1,0,1]
    v_cvt_pk_bf16_f32 v96, v96, v97
    v_cvt_pk_bf16_f32 v98, v98, v99
    v_cvt_pk_bf16_f32 v100, v100, v101
    v_cvt_pk_bf16_f32 v102, v102, v103
    v_accvgpr_write_b32 a96, v96
    v_accvgpr_write_b32 a97, v98
    v_accvgpr_write_b32 a98, v100
    v_accvgpr_write_b32 a99, v102
    v_pk_fma_f32 v[104:105], v[104:105], v[176:177], v[176:177] op_sel:[0,0,1] op_sel_hi:[1,0,1]
    v_pk_fma_f32 v[106:107], v[106:107], v[176:177], v[176:177] op_sel:[0,0,1] op_sel_hi:[1,0,1]
    v_pk_fma_f32 v[108:109], v[108:109], v[176:177], v[176:177] op_sel:[0,0,1] op_sel_hi:[1,0,1]
    v_pk_fma_f32 v[110:111], v[110:111], v[176:177], v[176:177] op_sel:[0,0,1] op_sel_hi:[1,0,1]
    v_cvt_pk_bf16_f32 v104, v104, v105
    v_cvt_pk_bf16_f32 v106, v106, v107
    v_cvt_pk_bf16_f32 v108, v108, v109
    v_cvt_pk_bf16_f32 v110, v110, v111
    v_accvgpr_write_b32 a100, v104
    v_accvgpr_write_b32 a101, v106
    v_accvgpr_write_b32 a102, v108
    v_accvgpr_write_b32 a103, v110
    v_pk_fma_f32 v[112:113], v[112:113], v[178:179], v[178:179] op_sel:[0,0,1] op_sel_hi:[1,0,1]
    v_pk_fma_f32 v[114:115], v[114:115], v[178:179], v[178:179] op_sel:[0,0,1] op_sel_hi:[1,0,1]
    v_pk_fma_f32 v[116:117], v[116:117], v[178:179], v[178:179] op_sel:[0,0,1] op_sel_hi:[1,0,1]
    v_pk_fma_f32 v[118:119], v[118:119], v[178:179], v[178:179] op_sel:[0,0,1] op_sel_hi:[1,0,1]
    v_cvt_pk_bf16_f32 v112, v112, v113
    v_cvt_pk_bf16_f32 v114, v114, v115
    v_cvt_pk_bf16_f32 v116, v116, v117
    v_cvt_pk_bf16_f32 v118, v118, v119
    v_accvgpr_write_b32 a104, v112
    v_accvgpr_write_b32 a105, v114
    v_accvgpr_write_b32 a106, v116
    v_accvgpr_write_b32 a107, v118
    v_pk_fma_f32 v[120:121], v[120:121], v[178:179], v[178:179] op_sel:[0,0,1] op_sel_hi:[1,0,1]
    v_pk_fma_f32 v[122:123], v[122:123], v[178:179], v[178:179] op_sel:[0,0,1] op_sel_hi:[1,0,1]
    v_pk_fma_f32 v[124:125], v[124:125], v[178:179], v[178:179] op_sel:[0,0,1] op_sel_hi:[1,0,1]
    v_pk_fma_f32 v[126:127], v[126:127], v[178:179], v[178:179] op_sel:[0,0,1] op_sel_hi:[1,0,1]
    v_cvt_pk_bf16_f32 v120, v120, v121
    v_cvt_pk_bf16_f32 v122, v122, v123
    v_cvt_pk_bf16_f32 v124, v124, v125
    v_cvt_pk_bf16_f32 v126, v126, v127
    v_accvgpr_write_b32 a108, v120
    v_accvgpr_write_b32 a109, v122
    v_accvgpr_write_b32 a110, v124
    v_accvgpr_write_b32 a111, v126
    v_pk_fma_f32 v[128:129], v[128:129], v[180:181], v[180:181] op_sel:[0,0,1] op_sel_hi:[1,0,1]
    v_pk_fma_f32 v[130:131], v[130:131], v[180:181], v[180:181] op_sel:[0,0,1] op_sel_hi:[1,0,1]
    v_pk_fma_f32 v[132:133], v[132:133], v[180:181], v[180:181] op_sel:[0,0,1] op_sel_hi:[1,0,1]
    v_pk_fma_f32 v[134:135], v[134:135], v[180:181], v[180:181] op_sel:[0,0,1] op_sel_hi:[1,0,1]
    v_cvt_pk_bf16_f32 v128, v128, v129
    v_cvt_pk_bf16_f32 v130, v130, v131
    v_cvt_pk_bf16_f32 v132, v132, v133
    v_cvt_pk_bf16_f32 v134, v134, v135
    v_accvgpr_write_b32 a112, v128
    v_accvgpr_write_b32 a113, v130
    v_accvgpr_write_b32 a114, v132
    v_accvgpr_write_b32 a115, v134
    v_pk_fma_f32 v[136:137], v[136:137], v[180:181], v[180:181] op_sel:[0,0,1] op_sel_hi:[1,0,1]
    v_pk_fma_f32 v[138:139], v[138:139], v[180:181], v[180:181] op_sel:[0,0,1] op_sel_hi:[1,0,1]
    v_pk_fma_f32 v[140:141], v[140:141], v[180:181], v[180:181] op_sel:[0,0,1] op_sel_hi:[1,0,1]
    v_pk_fma_f32 v[142:143], v[142:143], v[180:181], v[180:181] op_sel:[0,0,1] op_sel_hi:[1,0,1]
    v_cvt_pk_bf16_f32 v136, v136, v137
    v_cvt_pk_bf16_f32 v138, v138, v139
    v_cvt_pk_bf16_f32 v140, v140, v141
    v_cvt_pk_bf16_f32 v142, v142, v143
    v_accvgpr_write_b32 a116, v136
    v_accvgpr_write_b32 a117, v138
    v_accvgpr_write_b32 a118, v140
    v_accvgpr_write_b32 a119, v142
    v_pk_fma_f32 v[144:145], v[144:145], v[26:27], v[26:27] op_sel:[0,0,1] op_sel_hi:[1,0,1]
    v_pk_fma_f32 v[146:147], v[146:147], v[26:27], v[26:27] op_sel:[0,0,1] op_sel_hi:[1,0,1]
    v_pk_fma_f32 v[148:149], v[148:149], v[26:27], v[26:27] op_sel:[0,0,1] op_sel_hi:[1,0,1]
    v_pk_fma_f32 v[150:151], v[150:151], v[26:27], v[26:27] op_sel:[0,0,1] op_sel_hi:[1,0,1]
    v_cvt_pk_bf16_f32 v144, v144, v145
    v_cvt_pk_bf16_f32 v146, v146, v147
    v_cvt_pk_bf16_f32 v148, v148, v149
    v_cvt_pk_bf16_f32 v150, v150, v151
    v_accvgpr_write_b32 a120, v144
    v_accvgpr_write_b32 a121, v146
    v_accvgpr_write_b32 a122, v148
    v_accvgpr_write_b32 a123, v150
    v_pk_fma_f32 v[152:153], v[152:153], v[26:27], v[26:27] op_sel:[0,0,1] op_sel_hi:[1,0,1]
    v_pk_fma_f32 v[154:155], v[154:155], v[26:27], v[26:27] op_sel:[0,0,1] op_sel_hi:[1,0,1]
    v_pk_fma_f32 v[156:157], v[156:157], v[26:27], v[26:27] op_sel:[0,0,1] op_sel_hi:[1,0,1]
    v_pk_fma_f32 v[158:159], v[158:159], v[26:27], v[26:27] op_sel:[0,0,1] op_sel_hi:[1,0,1]
    v_cvt_pk_bf16_f32 v152, v152, v153
    v_cvt_pk_bf16_f32 v154, v154, v155
    v_cvt_pk_bf16_f32 v156, v156, v157
    v_cvt_pk_bf16_f32 v158, v158, v159
    v_accvgpr_write_b32 a124, v152
    v_accvgpr_write_b32 a125, v154
    v_accvgpr_write_b32 a126, v156
    v_accvgpr_write_b32 a127, v158
L_st0_d:
    s_waitcnt lgkmcnt(4)
    v_mfma_f32_16x16x32_bf16 v[32:35], a[192:195], a[96:99], 0
    ds_read_b64_tr_b16 a[208:209], v13 offset:512
    v_fma_f32 v192, v192, v176, v177
    v_mfma_f32_16x16x32_bf16 v[32:35], a[196:199], a[100:103], v[32:35]
    v_fma_f32 v193, v193, v176, v177
    v_cvt_pk_bf16_f32 v192, v192, v193
    v_mfma_f32_16x16x32_bf16 v[36:39], a[196:199], a[108:111], 0
    ds_read_b64_tr_b16 a[210:211], v13 offset:20992
    v_accvgpr_write_b32 a128, v192
    v_mfma_f32_16x16x32_bf16 v[36:39], a[192:195], a[104:107], v[36:39]
    v_fma_f32 v194, v194, v176, v177
    v_fma_f32 v195, v195, v176, v177
    v_mfma_f32_16x16x32_bf16 v[40:43], a[192:195], a[112:115], 0
    ds_read_b64_tr_b16 a[212:213], v13 offset:1536
    v_cvt_pk_bf16_f32 v194, v194, v195
    v_mfma_f32_16x16x32_bf16 v[40:43], a[196:199], a[116:119], v[40:43]
    v_accvgpr_write_b32 a129, v194
    v_fma_f32 v196, v196, v176, v177
    v_mfma_f32_16x16x32_bf16 v[44:47], a[196:199], a[124:127], 0
    ds_read_b64_tr_b16 a[214:215], v13 offset:22016
    v_fma_f32 v197, v197, v176, v177
    v_mfma_f32_16x16x32_bf16 v[44:47], a[192:195], a[120:123], v[44:47]
    v_cvt_pk_bf16_f32 v196, v196, v197
    s_waitcnt lgkmcnt(4)
    s_barrier
    v_mfma_f32_16x16x32_bf16 v[60:63], a[200:203], a[120:123], 0
    ds_read_b64_tr_b16 a[216:217], v14 offset:512
    v_accvgpr_write_b32 a130, v196
    v_mfma_f32_16x16x32_bf16 v[60:63], a[204:207], a[124:127], v[60:63]
    v_fma_f32 v198, v198, v176, v177
    v_fma_f32 v199, v199, v176, v177
    v_mfma_f32_16x16x32_bf16 v[56:59], a[204:207], a[116:119], 0
    ds_read_b64_tr_b16 a[218:219], v14 offset:20992
    v_cvt_pk_bf16_f32 v198, v198, v199
    v_mfma_f32_16x16x32_bf16 v[56:59], a[200:203], a[112:115], v[56:59]
    v_accvgpr_write_b32 a131, v198
    v_fma_f32 v200, v200, v176, v177
    v_mfma_f32_16x16x32_bf16 v[52:55], a[200:203], a[104:107], 0
    s_add_u32 m0, s70, 4096
    ds_read_b64_tr_b16 a[220:221], v14 offset:1536
    v_mfma_f32_16x16x32_bf16 v[52:55], a[204:207], a[108:111], v[52:55]
    buffer_load_dwordx4 v9, s[32:35], s65 offen offset:0 lds
    v_mfma_f32_16x16x32_bf16 v[48:51], a[204:207], a[100:103], 0
    ds_read_b64_tr_b16 a[222:223], v14 offset:22016
    v_fma_f32 v201, v201, v176, v177
    v_mfma_f32_16x16x32_bf16 v[48:51], a[200:203], a[96:99], v[48:51]
    v_cvt_pk_bf16_f32 v200, v200, v201
    s_waitcnt lgkmcnt(4)
    v_mfma_f32_16x16x32_bf16 a[0:3], a[208:211], a[96:99], 0
    ds_read_b64_tr_b16 a[192:193], v13 offset:2048
    v_accvgpr_write_b32 a132, v200
    v_mfma_f32_16x16x32_bf16 a[0:3], a[212:215], a[100:103], a[0:3]
    buffer_load_dwordx4 v10, s[32:35], s65 offen offset:1024 lds
    v_mfma_f32_16x16x32_bf16 a[4:7], a[212:215], a[108:111], 0
    ds_read_b64_tr_b16 a[194:195], v13 offset:22528
    v_fma_f32 v202, v202, v176, v177
    v_mfma_f32_16x16x32_bf16 a[4:7], a[208:211], a[104:107], a[4:7]
    v_fma_f32 v203, v203, v176, v177
    v_cvt_pk_bf16_f32 v202, v202, v203
    v_mfma_f32_16x16x32_bf16 a[8:11], a[208:211], a[112:115], 0
    ds_read_b64_tr_b16 a[196:197], v13 offset:3072
    v_accvgpr_write_b32 a133, v202
    v_mfma_f32_16x16x32_bf16 a[8:11], a[212:215], a[116:119], a[8:11]
    buffer_load_dwordx4 v9, s[36:39], s65 offen offset:2048 lds
    v_mfma_f32_16x16x32_bf16 a[12:15], a[212:215], a[124:127], 0
    ds_read_b64_tr_b16 a[198:199], v13 offset:23552
    v_fma_f32 v204, v204, v176, v177
    v_mfma_f32_16x16x32_bf16 a[12:15], a[208:211], a[120:123], a[12:15]
    v_fma_f32 v205, v205, v176, v177
    s_waitcnt lgkmcnt(4)
    v_mfma_f32_16x16x32_bf16 a[28:31], a[216:219], a[120:123], 0
    ds_read_b64_tr_b16 a[200:201], v14 offset:2048
    v_cvt_pk_bf16_f32 v204, v204, v205
    v_mfma_f32_16x16x32_bf16 a[28:31], a[220:223], a[124:127], a[28:31]
    buffer_load_dwordx4 v10, s[36:39], s65 offen offset:3072 lds
    v_mfma_f32_16x16x32_bf16 a[24:27], a[220:223], a[116:119], 0
    ds_read_b64_tr_b16 a[202:203], v14 offset:22528
    v_accvgpr_write_b32 a134, v204
    v_mfma_f32_16x16x32_bf16 a[24:27], a[216:219], a[112:115], a[24:27]
    v_fma_f32 v206, v206, v176, v177
    v_fma_f32 v207, v207, v176, v177
    v_mfma_f32_16x16x32_bf16 a[20:23], a[216:219], a[104:107], 0
    s_add_u32 m0, s70, 8192
    ds_read_b64_tr_b16 a[204:205], v14 offset:3072
    v_mfma_f32_16x16x32_bf16 a[20:23], a[220:223], a[108:111], a[20:23]
    buffer_load_dwordx4 v11, s[40:43], s66 offen offset:0 lds
    v_mfma_f32_16x16x32_bf16 a[16:19], a[220:223], a[100:103], 0
    ds_read_b64_tr_b16 a[206:207], v14 offset:23552
    v_cvt_pk_bf16_f32 v206, v206, v207
    v_mfma_f32_16x16x32_bf16 a[16:19], a[216:219], a[96:99], a[16:19]
    v_accvgpr_write_b32 a135, v206
    s_waitcnt lgkmcnt(4)
    v_mfma_f32_16x16x32_bf16 a[32:35], a[192:195], a[96:99], 0
    ds_read_b64_tr_b16 a[208:209], v13 offset:2560
    v_fma_f32 v208, v208, v178, v179
    v_mfma_f32_16x16x32_bf16 a[32:35], a[196:199], a[100:103], a[32:35]
    buffer_load_dwordx4 v12, s[40:43], s66 offen offset:1024 lds
    v_mfma_f32_16x16x32_bf16 a[36:39], a[196:199], a[108:111], 0
    s_add_u32 s64, s64, 458752
    ds_read_b64_tr_b16 a[210:211], v13 offset:23040
    v_mfma_f32_16x16x32_bf16 a[36:39], a[192:195], a[104:107], a[36:39]
    s_add_u32 s65, s65, s67
    s_add_u32 s66, s66, s68
    v_mfma_f32_16x16x32_bf16 a[40:43], a[192:195], a[112:115], 0
    s_add_u32 s70, s70, 40960
    ds_read_b64_tr_b16 a[212:213], v13 offset:3584
    v_mfma_f32_16x16x32_bf16 a[40:43], a[196:199], a[116:119], a[40:43]
    v_fma_f32 v209, v209, v178, v179
    v_cvt_pk_bf16_f32 v208, v208, v209
    v_mfma_f32_16x16x32_bf16 a[44:47], a[196:199], a[124:127], 0
    s_mov_b32 m0, s70
    ds_read_b64_tr_b16 a[214:215], v13 offset:24064
    v_mfma_f32_16x16x32_bf16 a[44:47], a[192:195], a[120:123], a[44:47]
    buffer_load_dwordx4 v7, s[24:27], s64 offen offset:0 lds
    s_waitcnt lgkmcnt(4)
    v_mfma_f32_16x16x32_bf16 a[60:63], a[200:203], a[120:123], 0
    ds_read_b64_tr_b16 a[216:217], v14 offset:2560
    v_accvgpr_write_b32 a136, v208
    v_mfma_f32_16x16x32_bf16 a[60:63], a[204:207], a[124:127], a[60:63]
    v_fma_f32 v210, v210, v178, v179
    v_fma_f32 v211, v211, v178, v179
    v_mfma_f32_16x16x32_bf16 a[56:59], a[204:207], a[116:119], 0
    ds_read_b64_tr_b16 a[218:219], v14 offset:23040
    v_cvt_pk_bf16_f32 v210, v210, v211
    v_mfma_f32_16x16x32_bf16 a[56:59], a[200:203], a[112:115], a[56:59]
    buffer_load_dwordx4 v8, s[24:27], s64 offen offset:1024 lds
    v_mfma_f32_16x16x32_bf16 a[52:55], a[200:203], a[104:107], 0
    ds_read_b64_tr_b16 a[220:221], v14 offset:3584
    v_accvgpr_write_b32 a137, v210
    v_mfma_f32_16x16x32_bf16 a[52:55], a[204:207], a[108:111], a[52:55]
    v_fma_f32 v212, v212, v178, v179
    v_fma_f32 v213, v213, v178, v179
    v_mfma_f32_16x16x32_bf16 a[48:51], a[204:207], a[100:103], 0
    ds_read_b64_tr_b16 a[222:223], v14 offset:24064
    v_cvt_pk_bf16_f32 v212, v212, v213
    v_mfma_f32_16x16x32_bf16 a[48:51], a[200:203], a[96:99], a[48:51]
    buffer_load_dwordx4 v7, s[28:31], s64 offen offset:2048 lds
    s_waitcnt lgkmcnt(4)
    v_mfma_f32_16x16x32_bf16 a[64:67], a[208:211], a[96:99], 0
    ds_read_b64_tr_b16 a[192:193], v13 offset:4096
    v_accvgpr_write_b32 a138, v212
    v_mfma_f32_16x16x32_bf16 a[64:67], a[212:215], a[100:103], a[64:67]
    v_fma_f32 v214, v214, v178, v179
    v_fma_f32 v215, v215, v178, v179
    v_mfma_f32_16x16x32_bf16 a[68:71], a[212:215], a[108:111], 0
    ds_read_b64_tr_b16 a[194:195], v13 offset:24576
    v_cvt_pk_bf16_f32 v214, v214, v215
    v_mfma_f32_16x16x32_bf16 a[68:71], a[208:211], a[104:107], a[68:71]
    buffer_load_dwordx4 v8, s[28:31], s64 offen offset:3072 lds
    v_mfma_f32_16x16x32_bf16 a[72:75], a[208:211], a[112:115], 0
    ds_read_b64_tr_b16 a[196:197], v13 offset:5120
    v_accvgpr_write_b32 a139, v214
    v_mfma_f32_16x16x32_bf16 a[72:75], a[212:215], a[116:119], a[72:75]
    v_fma_f32 v216, v216, v178, v179
    v_fma_f32 v217, v217, v178, v179
    v_mfma_f32_16x16x32_bf16 a[76:79], a[212:215], a[124:127], 0
    s_add_u32 m0, s70, 4096
    ds_read_b64_tr_b16 a[198:199], v13 offset:25600
    v_mfma_f32_16x16x32_bf16 a[76:79], a[208:211], a[120:123], a[76:79]
    buffer_load_dwordx4 v9, s[32:35], s65 offen offset:0 lds
    s_waitcnt lgkmcnt(4)
    v_mfma_f32_16x16x32_bf16 a[92:95], a[216:219], a[120:123], 0
    ds_read_b64_tr_b16 a[200:201], v14 offset:4096
    v_cvt_pk_bf16_f32 v216, v216, v217
    v_mfma_f32_16x16x32_bf16 a[92:95], a[220:223], a[124:127], a[92:95]
    v_accvgpr_write_b32 a140, v216
    v_fma_f32 v218, v218, v178, v179
    v_mfma_f32_16x16x32_bf16 a[88:91], a[220:223], a[116:119], 0
    ds_read_b64_tr_b16 a[202:203], v14 offset:24576
    v_fma_f32 v219, v219, v178, v179
    v_mfma_f32_16x16x32_bf16 a[88:91], a[216:219], a[112:115], a[88:91]
    buffer_load_dwordx4 v10, s[32:35], s65 offen offset:1024 lds
    v_mfma_f32_16x16x32_bf16 a[84:87], a[216:219], a[104:107], 0
    ds_read_b64_tr_b16 a[204:205], v14 offset:5120
    v_cvt_pk_bf16_f32 v218, v218, v219
    v_mfma_f32_16x16x32_bf16 a[84:87], a[220:223], a[108:111], a[84:87]
    v_accvgpr_write_b32 a141, v218
    v_fma_f32 v220, v220, v178, v179
    v_mfma_f32_16x16x32_bf16 a[80:83], a[220:223], a[100:103], 0
    ds_read_b64_tr_b16 a[206:207], v14 offset:25600
    v_fma_f32 v221, v221, v178, v179
    v_mfma_f32_16x16x32_bf16 a[80:83], a[216:219], a[96:99], a[80:83]
    buffer_load_dwordx4 v9, s[36:39], s65 offen offset:2048 lds
    s_waitcnt lgkmcnt(4)
    v_mfma_f32_16x16x32_bf16 v[64:67], a[192:195], a[96:99], 0
    ds_read_b64_tr_b16 a[208:209], v13 offset:4608
    v_cvt_pk_bf16_f32 v220, v220, v221
    v_mfma_f32_16x16x32_bf16 v[64:67], a[196:199], a[100:103], v[64:67]
    v_accvgpr_write_b32 a142, v220
    v_fma_f32 v222, v222, v178, v179
    v_mfma_f32_16x16x32_bf16 v[68:71], a[196:199], a[108:111], 0
    ds_read_b64_tr_b16 a[210:211], v13 offset:25088
    v_fma_f32 v223, v223, v178, v179
    v_mfma_f32_16x16x32_bf16 v[68:71], a[192:195], a[104:107], v[68:71]
    buffer_load_dwordx4 v10, s[36:39], s65 offen offset:3072 lds
    v_mfma_f32_16x16x32_bf16 v[72:75], a[192:195], a[112:115], 0
    ds_read_b64_tr_b16 a[212:213], v13 offset:5632
    v_cvt_pk_bf16_f32 v222, v222, v223
    v_mfma_f32_16x16x32_bf16 v[72:75], a[196:199], a[116:119], v[72:75]
    v_accvgpr_write_b32 a143, v222
    v_fma_f32 v224, v224, v180, v181
    v_mfma_f32_16x16x32_bf16 v[76:79], a[196:199], a[124:127], 0
    s_add_u32 m0, s70, 8192
    ds_read_b64_tr_b16 a[214:215], v13 offset:26112
    v_mfma_f32_16x16x32_bf16 v[76:79], a[192:195], a[120:123], v[76:79]
    buffer_load_dwordx4 v11, s[40:43], s66 offen offset:0 lds
    s_waitcnt lgkmcnt(4)
    v_mfma_f32_16x16x32_bf16 v[92:95], a[200:203], a[120:123], 0
    ds_read_b64_tr_b16 a[216:217], v14 offset:4608
    v_fma_f32 v225, v225, v180, v181
    v_mfma_f32_16x16x32_bf16 v[92:95], a[204:207], a[124:127], v[92:95]
    v_cvt_pk_bf16_f32 v224, v224, v225
    v_accvgpr_write_b32 a144, v224
    v_mfma_f32_16x16x32_bf16 v[88:91], a[204:207], a[116:119], 0
    ds_read_b64_tr_b16 a[218:219], v14 offset:25088
    v_fma_f32 v226, v226, v180, v181
    v_mfma_f32_16x16x32_bf16 v[88:91], a[200:203], a[112:115], v[88:91]
    buffer_load_dword v23, v22, s[52:55], s95 offen sc1
    v_mfma_f32_16x16x32_bf16 v[84:87], a[200:203], a[104:107], 0
    ds_read_b64_tr_b16 a[220:221], v14 offset:5632
    v_fma_f32 v227, v227, v180, v181
    v_mfma_f32_16x16x32_bf16 v[84:87], a[204:207], a[108:111], v[84:87]
    v_cvt_pk_bf16_f32 v226, v226, v227
    v_accvgpr_write_b32 a145, v226
    v_mfma_f32_16x16x32_bf16 v[80:83], a[204:207], a[100:103], 0
    ds_read_b64_tr_b16 a[222:223], v14 offset:26112
    v_fma_f32 v228, v228, v180, v181
    v_mfma_f32_16x16x32_bf16 v[80:83], a[200:203], a[96:99], v[80:83]
    buffer_load_dwordx4 v12, s[40:43], s66 offen offset:1024 lds
    s_waitcnt lgkmcnt(4)
    v_mfma_f32_16x16x32_bf16 v[96:99], a[208:211], a[96:99], 0
    s_add_u32 s64, s64, 458752
    ds_read_b64_tr_b16 a[192:193], v13 offset:6144
    v_mfma_f32_16x16x32_bf16 v[96:99], a[212:215], a[100:103], v[96:99]
    s_add_u32 s65, s65, s67
    s_add_u32 s66, s66, s68
    v_mfma_f32_16x16x32_bf16 v[100:103], a[212:215], a[108:111], 0
    s_add_u32 s70, s70, 40960
    ds_read_b64_tr_b16 a[194:195], v13 offset:26624
    v_mfma_f32_16x16x32_bf16 v[100:103], a[208:211], a[104:107], v[100:103]
    v_fma_f32 v229, v229, v180, v181
    v_cvt_pk_bf16_f32 v228, v228, v229
    v_mfma_f32_16x16x32_bf16 v[104:107], a[208:211], a[112:115], 0
    ds_read_b64_tr_b16 a[196:197], v13 offset:7168
    v_accvgpr_write_b32 a146, v228
    v_mfma_f32_16x16x32_bf16 v[104:107], a[212:215], a[116:119], v[104:107]
    buffer_load_dword v0, v29, s[60:63], 0 offen
    v_mfma_f32_16x16x32_bf16 v[108:111], a[212:215], a[124:127], 0
    v_add_u32 v29, v28, v29
    ds_read_b64_tr_b16 a[198:199], v13 offset:27648
    v_mfma_f32_16x16x32_bf16 v[108:111], a[208:211], a[120:123], v[108:111]
    v_fma_f32 v230, v230, v180, v181
    s_waitcnt lgkmcnt(4)
    v_mfma_f32_16x16x32_bf16 v[124:127], a[216:219], a[120:123], 0
    s_mov_b32 m0, s70
    ds_read_b64_tr_b16 a[200:201], v14 offset:6144
    v_mfma_f32_16x16x32_bf16 v[124:127], a[220:223], a[124:127], v[124:127]
    buffer_load_dwordx4 v7, s[24:27], s64 offen offset:0 lds
    v_mfma_f32_16x16x32_bf16 v[120:123], a[220:223], a[116:119], 0
    ds_read_b64_tr_b16 a[202:203], v14 offset:26624
    v_fma_f32 v231, v231, v180, v181
    v_mfma_f32_16x16x32_bf16 v[120:123], a[216:219], a[112:115], v[120:123]
    v_cvt_pk_bf16_f32 v230, v230, v231
    v_accvgpr_write_b32 a147, v230
    v_mfma_f32_16x16x32_bf16 v[116:119], a[216:219], a[104:107], 0
    ds_read_b64_tr_b16 a[204:205], v14 offset:7168
    v_fma_f32 v232, v232, v180, v181
    v_mfma_f32_16x16x32_bf16 v[116:119], a[220:223], a[108:111], v[116:119]
    buffer_load_dwordx4 v8, s[24:27], s64 offen offset:1024 lds
    v_mfma_f32_16x16x32_bf16 v[112:115], a[220:223], a[100:103], 0
    ds_read_b64_tr_b16 a[206:207], v14 offset:27648
    v_fma_f32 v233, v233, v180, v181
    v_mfma_f32_16x16x32_bf16 v[112:115], a[216:219], a[96:99], v[112:115]
    v_cvt_pk_bf16_f32 v232, v232, v233
    s_waitcnt lgkmcnt(4)
    v_mfma_f32_16x16x32_bf16 v[128:131], a[192:195], a[96:99], 0
    ds_read_b64_tr_b16 a[208:209], v13 offset:6656
    v_accvgpr_write_b32 a148, v232
    v_mfma_f32_16x16x32_bf16 v[128:131], a[196:199], a[100:103], v[128:131]
    buffer_load_dwordx4 v7, s[28:31], s64 offen offset:2048 lds
    v_mfma_f32_16x16x32_bf16 v[132:135], a[196:199], a[108:111], 0
    ds_read_b64_tr_b16 a[210:211], v13 offset:27136
    v_fma_f32 v234, v234, v180, v181
    v_mfma_f32_16x16x32_bf16 v[132:135], a[192:195], a[104:107], v[132:135]
    v_fma_f32 v235, v235, v180, v181
    v_cvt_pk_bf16_f32 v234, v234, v235
    v_mfma_f32_16x16x32_bf16 v[136:139], a[192:195], a[112:115], 0
    ds_read_b64_tr_b16 a[212:213], v13 offset:7680
    v_accvgpr_write_b32 a149, v234
    v_mfma_f32_16x16x32_bf16 v[136:139], a[196:199], a[116:119], v[136:139]
    buffer_load_dwordx4 v8, s[28:31], s64 offen offset:3072 lds
    v_mfma_f32_16x16x32_bf16 v[140:143], a[196:199], a[124:127], 0
    ds_read_b64_tr_b16 a[214:215], v13 offset:28160
    v_fma_f32 v236, v236, v180, v181
    v_mfma_f32_16x16x32_bf16 v[140:143], a[192:195], a[120:123], v[140:143]
    v_fma_f32 v237, v237, v180, v181
    s_waitcnt lgkmcnt(4)
    v_mfma_f32_16x16x32_bf16 v[156:159], a[200:203], a[120:123], 0
    s_add_u32 m0, s70, 4096
    ds_read_b64_tr_b16 a[216:217], v14 offset:6656
    v_mfma_f32_16x16x32_bf16 v[156:159], a[204:207], a[124:127], v[156:159]
    buffer_load_dwordx4 v9, s[32:35], s65 offen offset:0 lds
    v_mfma_f32_16x16x32_bf16 v[152:155], a[204:207], a[116:119], 0
    ds_read_b64_tr_b16 a[218:219], v14 offset:27136
    v_cvt_pk_bf16_f32 v236, v236, v237
    v_mfma_f32_16x16x32_bf16 v[152:155], a[200:203], a[112:115], v[152:155]
    v_accvgpr_write_b32 a150, v236
    v_fma_f32 v238, v238, v180, v181
    v_mfma_f32_16x16x32_bf16 v[148:151], a[200:203], a[104:107], 0
    ds_read_b64_tr_b16 a[220:221], v14 offset:7680
    v_fma_f32 v239, v239, v180, v181
    v_mfma_f32_16x16x32_bf16 v[148:151], a[204:207], a[108:111], v[148:151]
    buffer_load_dwordx4 v10, s[32:35], s65 offen offset:1024 lds
    v_mfma_f32_16x16x32_bf16 v[144:147], a[204:207], a[100:103], 0
    ds_read_b64_tr_b16 a[222:223], v14 offset:28160
    v_cvt_pk_bf16_f32 v238, v238, v239
    v_mfma_f32_16x16x32_bf16 v[144:147], a[200:203], a[96:99], v[144:147]
    v_accvgpr_write_b32 a151, v238
    s_waitcnt lgkmcnt(4)
    v_mfma_f32_16x16x32_bf16 v[160:163], a[208:211], a[96:99], 0
    ds_read_b64_tr_b16 a[192:193], v15 offset:8192
    v_fma_f32 v240, v240, v26, v27
    v_mfma_f32_16x16x32_bf16 v[160:163], a[212:215], a[100:103], v[160:163]
    buffer_load_dwordx4 v9, s[36:39], s65 offen offset:2048 lds
    v_mfma_f32_16x16x32_bf16 v[164:167], a[212:215], a[108:111], 0
    ds_read_b64_tr_b16 a[194:195], v15 offset:28672
    v_fma_f32 v241, v241, v26, v27
    v_mfma_f32_16x16x32_bf16 v[164:167], a[208:211], a[104:107], v[164:167]
    v_cvt_pk_bf16_f32 v240, v240, v241
    v_accvgpr_write_b32 a152, v240
    v_mfma_f32_16x16x32_bf16 v[168:171], a[208:211], a[112:115], 0
    ds_read_b64_tr_b16 a[196:197], v15 offset:9216
    v_fma_f32 v242, v242, v26, v27
    v_mfma_f32_16x16x32_bf16 v[168:171], a[212:215], a[116:119], v[168:171]
    buffer_load_dwordx4 v10, s[36:39], s65 offen offset:3072 lds
    v_mfma_f32_16x16x32_bf16 v[172:175], a[212:215], a[124:127], 0
    ds_read_b64_tr_b16 a[198:199], v15 offset:29696
    v_fma_f32 v243, v243, v26, v27
    v_mfma_f32_16x16x32_bf16 v[172:175], a[208:211], a[120:123], v[172:175]
    v_cvt_pk_bf16_f32 v242, v242, v243
    s_waitcnt vmcnt(27) lgkmcnt(4)
    v_mfma_f32_16x16x32_bf16 v[188:191], a[216:219], a[120:123], 0
    s_add_u32 m0, s70, 8192
    ds_read_b64_tr_b16 a[200:201], v16 offset:8192
    v_mfma_f32_16x16x32_bf16 v[188:191], a[220:223], a[124:127], v[188:191]
    buffer_load_dwordx4 v11, s[40:43], s66 offen offset:0 lds
    v_mfma_f32_16x16x32_bf16 v[184:187], a[220:223], a[116:119], 0
    ds_read_b64_tr_b16 a[202:203], v16 offset:28672
    v_accvgpr_write_b32 a153, v242
    v_mfma_f32_16x16x32_bf16 v[184:187], a[216:219], a[112:115], v[184:187]
    v_fma_f32 v244, v244, v26, v27
    v_fma_f32 v245, v245, v26, v27
    v_mfma_f32_16x16x32_bf16 v[180:183], a[216:219], a[104:107], 0
    ds_read_b64_tr_b16 a[204:205], v16 offset:9216
    v_cvt_pk_bf16_f32 v244, v244, v245
    v_mfma_f32_16x16x32_bf16 v[180:183], a[220:223], a[108:111], v[180:183]
    buffer_load_dwordx4 v12, s[40:43], s66 offen offset:1024 lds
    v_add_u32 v13, s73, v13
    v_mfma_f32_16x16x32_bf16 v[176:179], a[220:223], a[100:103], 0
    ds_read_b64_tr_b16 a[206:207], v16 offset:29696
    v_accvgpr_write_b32 a154, v244
    v_mfma_f32_16x16x32_bf16 v[176:179], a[216:219], a[96:99], v[176:179]
    v_add_u32 v14, s73, v14
    s_waitcnt vmcnt(12) lgkmcnt(4)
    v_cmp_ne_u32 vcc, s18, v23
    s_cbranch_vccnz L_px_d
L_px_b_d:
    s_barrier
    v_mfma_f32_16x16x32_bf16 v[192:195], a[192:195], a[96:99], 0
    ds_read_b64_tr_b16 a[208:209], v15 offset:18432
    v_fma_f32 v246, v246, v26, v27
    v_mfma_f32_16x16x32_bf16 v[192:195], a[196:199], a[100:103], v[192:195]
    buffer_load_dwordx4 a[160:163], v3, s[20:23], s69 offen offset:0 sc1
    v_mfma_f32_16x16x32_bf16 v[196:199], a[196:199], a[108:111], 0
    ds_read_b64_tr_b16 a[210:211], v15 offset:38912
    v_fma_f32 v247, v247, v26, v27
    v_mfma_f32_16x16x32_bf16 v[196:199], a[192:195], a[104:107], v[196:199]
    v_cvt_pk_bf16_f32 v246, v246, v247
    v_accvgpr_write_b32 a155, v246
    v_mfma_f32_16x16x32_bf16 v[200:203], a[192:195], a[112:115], 0
    ds_read_b64_tr_b16 a[212:213], v15 offset:19456
    v_fma_f32 v248, v248, v26, v27
    v_mfma_f32_16x16x32_bf16 v[200:203], a[196:199], a[116:119], v[200:203]
    buffer_load_dwordx4 a[164:167], v3, s[20:23], s69 offen offset:1024 sc1
    v_mfma_f32_16x16x32_bf16 v[204:207], a[196:199], a[124:127], 0
    ds_read_b64_tr_b16 a[214:215], v15 offset:39936
    v_fma_f32 v249, v249, v26, v27
    v_mfma_f32_16x16x32_bf16 v[204:207], a[192:195], a[120:123], v[204:207]
    v_cvt_pk_bf16_f32 v248, v248, v249
    s_waitcnt lgkmcnt(4)
    v_mfma_f32_16x16x32_bf16 v[220:223], a[200:203], a[120:123], 0
    ds_read_b64_tr_b16 a[216:217], v16 offset:18432
    v_accvgpr_write_b32 a156, v248
    v_mfma_f32_16x16x32_bf16 v[220:223], a[204:207], a[124:127], v[220:223]
    buffer_load_dwordx4 a[168:171], v4, s[20:23], s69 offen offset:0 sc1
    v_mfma_f32_16x16x32_bf16 v[216:219], a[204:207], a[116:119], 0
    ds_read_b64_tr_b16 a[218:219], v16 offset:38912
    v_fma_f32 v250, v250, v26, v27
    v_mfma_f32_16x16x32_bf16 v[216:219], a[200:203], a[112:115], v[216:219]
    v_fma_f32 v251, v251, v26, v27
    v_cvt_pk_bf16_f32 v250, v250, v251
    v_mfma_f32_16x16x32_bf16 v[212:215], a[200:203], a[104:107], 0
    ds_read_b64_tr_b16 a[220:221], v16 offset:19456
    v_accvgpr_write_b32 a157, v250
    v_mfma_f32_16x16x32_bf16 v[212:215], a[204:207], a[108:111], v[212:215]
    buffer_load_dwordx4 a[172:175], v4, s[20:23], s69 offen offset:1024 sc1
    v_mfma_f32_16x16x32_bf16 v[208:211], a[204:207], a[100:103], 0
    ds_read_b64_tr_b16 a[222:223], v16 offset:39936
    v_fma_f32 v252, v252, v26, v27
    v_mfma_f32_16x16x32_bf16 v[208:211], a[200:203], a[96:99], v[208:211]
    v_fma_f32 v253, v253, v26, v27
    s_waitcnt lgkmcnt(4)
    v_mfma_f32_16x16x32_bf16 v[224:227], a[208:211], a[96:99], 0
    ds_read_b64_tr_b16 a[192:193], v13 offset:0
    v_cvt_pk_bf16_f32 v252, v252, v253
    v_mfma_f32_16x16x32_bf16 v[224:227], a[212:215], a[100:103], v[224:227]
    buffer_load_dwordx4 a[176:179], v5, s[20:23], s69 offen offset:0 sc1
    v_add_u32 v15, s73, v15
    v_mfma_f32_16x16x32_bf16 v[228:231], a[212:215], a[108:111], 0
    ds_read_b64_tr_b16 a[194:195], v13 offset:20480
    v_accvgpr_write_b32 a158, v252
    v_mfma_f32_16x16x32_bf16 v[228:231], a[208:211], a[104:107], v[228:231]
    v_fma_f32 v254, v254, v26, v27
    v_fma_f32 v255, v255, v26, v27
    v_mfma_f32_16x16x32_bf16 v[232:235], a[208:211], a[112:115], 0
    ds_read_b64_tr_b16 a[196:197], v13 offset:1024
    v_cvt_pk_bf16_f32 v254, v254, v255
    v_mfma_f32_16x16x32_bf16 v[232:235], a[212:215], a[116:119], v[232:235]
    buffer_load_dwordx4 a[180:183], v5, s[20:23], s69 offen offset:1024 sc1
    s_add_u32 s64, s64, 458752
    v_mfma_f32_16x16x32_bf16 v[236:239], a[212:215], a[124:127], 0
    ds_read_b64_tr_b16 a[198:199], v13 offset:21504
    v_accvgpr_write_b32 a159, v254
    v_mfma_f32_16x16x32_bf16 v[236:239], a[208:211], a[120:123], v[236:239]
    s_add_u32 s65, s65, s67
    s_waitcnt vmcnt(17) lgkmcnt(4)
    v_mfma_f32_16x16x32_bf16 v[252:255], a[216:219], a[120:123], 0
    ds_read_b64_tr_b16 a[200:201], v14 offset:0
    v_mfma_f32_16x16x32_bf16 v[252:255], a[220:223], a[124:127], v[252:255]
    buffer_load_dwordx4 a[184:187], v6, s[20:23], s69 offen offset:0 sc1
    s_add_u32 s66, s66, s68
    v_mfma_f32_16x16x32_bf16 v[248:251], a[220:223], a[116:119], 0
    ds_read_b64_tr_b16 a[202:203], v14 offset:20480
    v_mfma_f32_16x16x32_bf16 v[248:251], a[216:219], a[112:115], v[248:251]
    s_add_u32 s70, s70, 40960
    s_sub_u32 s10, s70, 163840
    v_mfma_f32_16x16x32_bf16 v[244:247], a[216:219], a[104:107], 0
    ds_read_b64_tr_b16 a[204:205], v14 offset:1024
    v_mfma_f32_16x16x32_bf16 v[244:247], a[220:223], a[108:111], v[244:247]
    buffer_load_dwordx4 a[188:191], v6, s[20:23], s69 offen offset:1024 sc1
    s_cmp_ge_u32 s70, 163840
    s_cselect_b32 s70, s10, s70
    v_mfma_f32_16x16x32_bf16 v[240:243], a[220:223], a[100:103], 0
    s_add_u32 s69, s69, 8192
    ds_read_b64_tr_b16 a[206:207], v14 offset:21504
    v_mfma_f32_16x16x32_bf16 v[240:243], a[216:219], a[96:99], v[240:243]
    buffer_load_dword v0, v29, s[60:63], 0 offen
    v_add_u32 v29, v28, v29
    v_add_u32 v16, s73, v16
L_loop_d:
    s_waitcnt vmcnt(30) lgkmcnt(4)
    v_mfma_f32_16x16x32_bf16 v[32:35], a[192:195], a[128:131], v[32:35]
    ds_read_b64_tr_b16 a[208:209], v13 offset:512
    v_mfma_f32_16x16x32_bf16 v[32:35], a[196:199], a[132:135], v[32:35]
    v_mfma_f32_16x16x32_bf16 v[36:39], a[196:199], a[140:143], v[36:39]
    ds_read_b64_tr_b16 a[210:211], v13 offset:20992
    v_mfma_f32_16x16x32_bf16 v[36:39], a[192:195], a[136:139], v[36:39]
    v_mfma_f32_16x16x32_bf16 v[40:43], a[192:195], a[144:147], v[40:43]
    ds_read_b64_tr_b16 a[212:213], v13 offset:1536
    v_mfma_f32_16x16x32_bf16 v[40:43], a[196:199], a[148:151], v[40:43]
    v_mfma_f32_16x16x32_bf16 v[44:47], a[196:199], a[156:159], v[44:47]
    ds_read_b64_tr_b16 a[214:215], v13 offset:22016
    v_mfma_f32_16x16x32_bf16 v[44:47], a[192:195], a[152:155], v[44:47]
    s_waitcnt vmcnt(20) lgkmcnt(4)
    s_barrier
    v_mfma_f32_16x16x32_bf16 v[60:63], a[200:203], a[152:155], v[60:63]
    ds_read_b64_tr_b16 a[216:217], v14 offset:512
    v_mfma_f32_16x16x32_bf16 v[60:63], a[204:207], a[156:159], v[60:63]
    v_mfma_f32_16x16x32_bf16 v[56:59], a[204:207], a[148:151], v[56:59]
    ds_read_b64_tr_b16 a[218:219], v14 offset:20992
    v_mfma_f32_16x16x32_bf16 v[56:59], a[200:203], a[144:147], v[56:59]
    buffer_load_dwordx4 a[96:99], v3, s[20:23], s69 offen offset:0 sc1
    v_mfma_f32_16x16x32_bf16 v[52:55], a[200:203], a[136:139], v[52:55]
    ds_read_b64_tr_b16 a[220:221], v14 offset:1536
    v_mfma_f32_16x16x32_bf16 v[52:55], a[204:207], a[140:143], v[52:55]
    v_mfma_f32_16x16x32_bf16 v[48:51], a[204:207], a[132:135], v[48:51]
    ds_read_b64_tr_b16 a[222:223], v14 offset:22016
    v_mfma_f32_16x16x32_bf16 v[48:51], a[200:203], a[128:131], v[48:51]
    s_waitcnt lgkmcnt(4)
    v_mfma_f32_16x16x32_bf16 a[0:3], a[208:211], a[128:131], a[0:3]
    ds_read_b64_tr_b16 a[192:193], v13 offset:2048
    v_mfma_f32_16x16x32_bf16 a[0:3], a[212:215], a[132:135], a[0:3]
    v_mfma_f32_16x16x32_bf16 a[4:7], a[212:215], a[140:143], a[4:7]
    ds_read_b64_tr_b16 a[194:195], v13 offset:22528
    v_mfma_f32_16x16x32_bf16 a[4:7], a[208:211], a[136:139], a[4:7]
    buffer_load_dwordx4 a[100:103], v3, s[20:23], s69 offen offset:1024 sc1
    v_mfma_f32_16x16x32_bf16 a[8:11], a[208:211], a[144:147], a[8:11]
    ds_read_b64_tr_b16 a[196:197], v13 offset:3072
    v_mfma_f32_16x16x32_bf16 a[8:11], a[212:215], a[148:151], a[8:11]
    v_mfma_f32_16x16x32_bf16 a[12:15], a[212:215], a[156:159], a[12:15]
    ds_read_b64_tr_b16 a[198:199], v13 offset:23552
    v_mfma_f32_16x16x32_bf16 a[12:15], a[208:211], a[152:155], a[12:15]
    s_waitcnt lgkmcnt(4)
    v_mfma_f32_16x16x32_bf16 a[28:31], a[216:219], a[152:155], a[28:31]
    ds_read_b64_tr_b16 a[200:201], v14 offset:2048
    v_mfma_f32_16x16x32_bf16 a[28:31], a[220:223], a[156:159], a[28:31]
    v_mfma_f32_16x16x32_bf16 a[24:27], a[220:223], a[148:151], a[24:27]
    ds_read_b64_tr_b16 a[202:203], v14 offset:22528
    v_mfma_f32_16x16x32_bf16 a[24:27], a[216:219], a[144:147], a[24:27]
    buffer_load_dwordx4 a[104:107], v4, s[20:23], s69 offen offset:0 sc1
    v_mfma_f32_16x16x32_bf16 a[20:23], a[216:219], a[136:139], a[20:23]
    ds_read_b64_tr_b16 a[204:205], v14 offset:3072
    v_mfma_f32_16x16x32_bf16 a[20:23], a[220:223], a[140:143], a[20:23]
    v_mfma_f32_16x16x32_bf16 a[16:19], a[220:223], a[132:135], a[16:19]
    ds_read_b64_tr_b16 a[206:207], v14 offset:23552
    v_mfma_f32_16x16x32_bf16 a[16:19], a[216:219], a[128:131], a[16:19]
    s_waitcnt lgkmcnt(4)
    v_mfma_f32_16x16x32_bf16 a[32:35], a[192:195], a[128:131], a[32:35]
    ds_read_b64_tr_b16 a[208:209], v13 offset:2560
    v_mfma_f32_16x16x32_bf16 a[32:35], a[196:199], a[132:135], a[32:35]
    v_mfma_f32_16x16x32_bf16 a[36:39], a[196:199], a[140:143], a[36:39]
    ds_read_b64_tr_b16 a[210:211], v13 offset:23040
    v_mfma_f32_16x16x32_bf16 a[36:39], a[192:195], a[136:139], a[36:39]
    buffer_load_dwordx4 a[108:111], v4, s[20:23], s69 offen offset:1024 sc1
    v_mfma_f32_16x16x32_bf16 a[40:43], a[192:195], a[144:147], a[40:43]
    ds_read_b64_tr_b16 a[212:213], v13 offset:3584
    v_mfma_f32_16x16x32_bf16 a[40:43], a[196:199], a[148:151], a[40:43]
    v_mfma_f32_16x16x32_bf16 a[44:47], a[196:199], a[156:159], a[44:47]
    ds_read_b64_tr_b16 a[214:215], v13 offset:24064
    v_mfma_f32_16x16x32_bf16 a[44:47], a[192:195], a[152:155], a[44:47]
    s_waitcnt lgkmcnt(4)
    v_mfma_f32_16x16x32_bf16 a[60:63], a[200:203], a[152:155], a[60:63]
    ds_read_b64_tr_b16 a[216:217], v14 offset:2560
    v_mfma_f32_16x16x32_bf16 a[60:63], a[204:207], a[156:159], a[60:63]
    v_mfma_f32_16x16x32_bf16 a[56:59], a[204:207], a[148:151], a[56:59]
    ds_read_b64_tr_b16 a[218:219], v14 offset:23040
    v_mfma_f32_16x16x32_bf16 a[56:59], a[200:203], a[144:147], a[56:59]
    buffer_load_dwordx4 a[112:115], v5, s[20:23], s69 offen offset:0 sc1
    v_mfma_f32_16x16x32_bf16 a[52:55], a[200:203], a[136:139], a[52:55]
    ds_read_b64_tr_b16 a[220:221], v14 offset:3584
    v_mfma_f32_16x16x32_bf16 a[52:55], a[204:207], a[140:143], a[52:55]
    v_mfma_f32_16x16x32_bf16 a[48:51], a[204:207], a[132:135], a[48:51]
    ds_read_b64_tr_b16 a[222:223], v14 offset:24064
    v_mfma_f32_16x16x32_bf16 a[48:51], a[200:203], a[128:131], a[48:51]
    s_waitcnt lgkmcnt(4)
    v_mfma_f32_16x16x32_bf16 a[64:67], a[208:211], a[128:131], a[64:67]
    ds_read_b64_tr_b16 a[192:193], v13 offset:4096
    v_mfma_f32_16x16x32_bf16 a[64:67], a[212:215], a[132:135], a[64:67]
    v_mfma_f32_16x16x32_bf16 a[68:71], a[212:215], a[140:143], a[68:71]
    ds_read_b64_tr_b16 a[194:195], v13 offset:24576
    v_mfma_f32_16x16x32_bf16 a[68:71], a[208:211], a[136:139], a[68:71]
    buffer_load_dwordx4 a[116:119], v5, s[20:23], s69 offen offset:1024 sc1
    v_mfma_f32_16x16x32_bf16 a[72:75], a[208:211], a[144:147], a[72:75]
    ds_read_b64_tr_b16 a[196:197], v13 offset:5120
    v_mfma_f32_16x16x32_bf16 a[72:75], a[212:215], a[148:151], a[72:75]
    v_mfma_f32_16x16x32_bf16 a[76:79], a[212:215], a[156:159], a[76:79]
    ds_read_b64_tr_b16 a[198:199], v13 offset:25600
    v_mfma_f32_16x16x32_bf16 a[76:79], a[208:211], a[152:155], a[76:79]
    s_waitcnt lgkmcnt(4)
    v_mfma_f32_16x16x32_bf16 a[92:95], a[216:219], a[152:155], a[92:95]
    ds_read_b64_tr_b16 a[200:201], v14 offset:4096
    v_mfma_f32_16x16x32_bf16 a[92:95], a[220:223], a[156:159], a[92:95]
    v_mfma_f32_16x16x32_bf16 a[88:91], a[220:223], a[148:151], a[88:91]
    ds_read_b64_tr_b16 a[202:203], v14 offset:24576
    v_mfma_f32_16x16x32_bf16 a[88:91], a[216:219], a[144:147], a[88:91]
    buffer_load_dwordx4 a[120:123], v6, s[20:23], s69 offen offset:0 sc1
    v_mfma_f32_16x16x32_bf16 a[84:87], a[216:219], a[136:139], a[84:87]
    ds_read_b64_tr_b16 a[204:205], v14 offset:5120
    v_mfma_f32_16x16x32_bf16 a[84:87], a[220:223], a[140:143], a[84:87]
    v_mfma_f32_16x16x32_bf16 a[80:83], a[220:223], a[132:135], a[80:83]
    ds_read_b64_tr_b16 a[206:207], v14 offset:25600
    v_mfma_f32_16x16x32_bf16 a[80:83], a[216:219], a[128:131], a[80:83]
    s_waitcnt lgkmcnt(4)
    v_mfma_f32_16x16x32_bf16 v[64:67], a[192:195], a[128:131], v[64:67]
    ds_read_b64_tr_b16 a[208:209], v13 offset:4608
    v_mfma_f32_16x16x32_bf16 v[64:67], a[196:199], a[132:135], v[64:67]
    v_mfma_f32_16x16x32_bf16 v[68:71], a[196:199], a[140:143], v[68:71]
    ds_read_b64_tr_b16 a[210:211], v13 offset:25088
    v_mfma_f32_16x16x32_bf16 v[68:71], a[192:195], a[136:139], v[68:71]
    buffer_load_dwordx4 a[124:127], v6, s[20:23], s69 offen offset:1024 sc1
    v_mfma_f32_16x16x32_bf16 v[72:75], a[192:195], a[144:147], v[72:75]
    ds_read_b64_tr_b16 a[212:213], v13 offset:5632
    v_mfma_f32_16x16x32_bf16 v[72:75], a[196:199], a[148:151], v[72:75]
    s_add_u32 s69, s69, 8192
    v_mfma_f32_16x16x32_bf16 v[76:79], a[196:199], a[156:159], v[76:79]
    ds_read_b64_tr_b16 a[214:215], v13 offset:26112
    v_mfma_f32_16x16x32_bf16 v[76:79], a[192:195], a[152:155], v[76:79]
    s_waitcnt lgkmcnt(4)
    v_mfma_f32_16x16x32_bf16 v[92:95], a[200:203], a[152:155], v[92:95]
    ds_read_b64_tr_b16 a[216:217], v14 offset:4608
    v_mfma_f32_16x16x32_bf16 v[92:95], a[204:207], a[156:159], v[92:95]
    s_add_u32 m0, s70, 4096
    v_mfma_f32_16x16x32_bf16 v[88:91], a[204:207], a[148:151], v[88:91]
    ds_read_b64_tr_b16 a[218:219], v14 offset:25088
    v_mfma_f32_16x16x32_bf16 v[88:91], a[200:203], a[144:147], v[88:91]
    buffer_load_dwordx4 v9, s[32:35], s65 offen offset:0 lds
    v_mfma_f32_16x16x32_bf16 v[84:87], a[200:203], a[136:139], v[84:87]
    ds_read_b64_tr_b16 a[220:221], v14 offset:5632
    v_mfma_f32_16x16x32_bf16 v[84:87], a[204:207], a[140:143], v[84:87]
    v_mfma_f32_16x16x32_bf16 v[80:83], a[204:207], a[132:135], v[80:83]
    ds_read_b64_tr_b16 a[222:223], v14 offset:26112
    v_mfma_f32_16x16x32_bf16 v[80:83], a[200:203], a[128:131], v[80:83]
    s_waitcnt lgkmcnt(4)
    v_mfma_f32_16x16x32_bf16 v[96:99], a[208:211], a[128:131], v[96:99]
    ds_read_b64_tr_b16 a[192:193], v13 offset:6144
    v_mfma_f32_16x16x32_bf16 v[96:99], a[212:215], a[132:135], v[96:99]
    v_mfma_f32_16x16x32_bf16 v[100:103], a[212:215], a[140:143], v[100:103]
    ds_read_b64_tr_b16 a[194:195], v13 offset:26624
    v_mfma_f32_16x16x32_bf16 v[100:103], a[208:211], a[136:139], v[100:103]
    buffer_load_dwordx4 v10, s[32:35], s65 offen offset:1024 lds
    v_mfma_f32_16x16x32_bf16 v[104:107], a[208:211], a[144:147], v[104:107]
    ds_read_b64_tr_b16 a[196:197], v13 offset:7168
    v_mfma_f32_16x16x32_bf16 v[104:107], a[212:215], a[148:151], v[104:107]
    v_mfma_f32_16x16x32_bf16 v[108:111], a[212:215], a[156:159], v[108:111]
    ds_read_b64_tr_b16 a[198:199], v13 offset:27648
    v_mfma_f32_16x16x32_bf16 v[108:111], a[208:211], a[152:155], v[108:111]
    s_waitcnt lgkmcnt(4)
    v_mfma_f32_16x16x32_bf16 v[124:127], a[216:219], a[152:155], v[124:127]
    ds_read_b64_tr_b16 a[200:201], v14 offset:6144
    v_mfma_f32_16x16x32_bf16 v[124:127], a[220:223], a[156:159], v[124:127]
    v_mfma_f32_16x16x32_bf16 v[120:123], a[220:223], a[148:151], v[120:123]
    ds_read_b64_tr_b16 a[202:203], v14 offset:26624
    v_mfma_f32_16x16x32_bf16 v[120:123], a[216:219], a[144:147], v[120:123]
    buffer_load_dwordx4 v9, s[36:39], s65 offen offset:2048 lds
    v_mfma_f32_16x16x32_bf16 v[116:119], a[216:219], a[136:139], v[116:119]
    ds_read_b64_tr_b16 a[204:205], v14 offset:7168
    v_mfma_f32_16x16x32_bf16 v[116:119], a[220:223], a[140:143], v[116:119]
    v_mfma_f32_16x16x32_bf16 v[112:115], a[220:223], a[132:135], v[112:115]
    ds_read_b64_tr_b16 a[206:207], v14 offset:27648
    v_mfma_f32_16x16x32_bf16 v[112:115], a[216:219], a[128:131], v[112:115]
    s_waitcnt lgkmcnt(4)
    v_mfma_f32_16x16x32_bf16 v[128:131], a[192:195], a[128:131], v[128:131]
    ds_read_b64_tr_b16 a[208:209], v13 offset:6656
    v_mfma_f32_16x16x32_bf16 v[128:131], a[196:199], a[132:135], v[128:131]
    v_mfma_f32_16x16x32_bf16 v[132:135], a[196:199], a[140:143], v[132:135]
    ds_read_b64_tr_b16 a[210:211], v13 offset:27136
    v_mfma_f32_16x16x32_bf16 v[132:135], a[192:195], a[136:139], v[132:135]
    buffer_load_dwordx4 v10, s[36:39], s65 offen offset:3072 lds
    v_mfma_f32_16x16x32_bf16 v[136:139], a[192:195], a[144:147], v[136:139]
    ds_read_b64_tr_b16 a[212:213], v13 offset:7680
    v_mfma_f32_16x16x32_bf16 v[136:139], a[196:199], a[148:151], v[136:139]
    v_mfma_f32_16x16x32_bf16 v[140:143], a[196:199], a[156:159], v[140:143]
    ds_read_b64_tr_b16 a[214:215], v13 offset:28160
    v_mfma_f32_16x16x32_bf16 v[140:143], a[192:195], a[152:155], v[140:143]
    s_waitcnt lgkmcnt(4)
    v_mfma_f32_16x16x32_bf16 v[156:159], a[200:203], a[152:155], v[156:159]
    ds_read_b64_tr_b16 a[216:217], v14 offset:6656
    v_mfma_f32_16x16x32_bf16 v[156:159], a[204:207], a[156:159], v[156:159]
    s_mov_b32 m0, s70
    v_mfma_f32_16x16x32_bf16 v[152:155], a[204:207], a[148:151], v[152:155]
    ds_read_b64_tr_b16 a[218:219], v14 offset:27136
    v_mfma_f32_16x16x32_bf16 v[152:155], a[200:203], a[144:147], v[152:155]
    buffer_load_dwordx4 v7, s[24:27], s64 offen offset:0 lds
    v_mfma_f32_16x16x32_bf16 v[148:151], a[200:203], a[136:139], v[148:151]
    ds_read_b64_tr_b16 a[220:221], v14 offset:7680
    v_mfma_f32_16x16x32_bf16 v[148:151], a[204:207], a[140:143], v[148:151]
    s_add_u32 s72, s72, 1
    s_and_b32 s72, s72, 3
    v_mfma_f32_16x16x32_bf16 v[144:147], a[204:207], a[132:135], v[144:147]
    ds_read_b64_tr_b16 a[222:223], v14 offset:28160
    v_mfma_f32_16x16x32_bf16 v[144:147], a[200:203], a[128:131], v[144:147]
    s_cselect_b32 s73, s74, s75
    s_waitcnt lgkmcnt(4)
    v_mfma_f32_16x16x32_bf16 v[160:163], a[208:211], a[128:131], v[160:163]
    ds_read_b64_tr_b16 a[192:193], v15 offset:8192
    v_mfma_f32_16x16x32_bf16 v[160:163], a[212:215], a[132:135], v[160:163]
    v_mfma_f32_16x16x32_bf16 v[164:167], a[212:215], a[140:143], v[164:167]
    ds_read_b64_tr_b16 a[194:195], v15 offset:28672
    v_mfma_f32_16x16x32_bf16 v[164:167], a[208:211], a[136:139], v[164:167]
    buffer_load_dwordx4 v8, s[24:27], s64 offen offset:1024 lds
    v_mfma_f32_16x16x32_bf16 v[168:171], a[208:211], a[144:147], v[168:171]
    ds_read_b64_tr_b16 a[196:197], v15 offset:9216
    v_mfma_f32_16x16x32_bf16 v[168:171], a[212:215], a[148:151], v[168:171]
    v_mfma_f32_16x16x32_bf16 v[172:175], a[212:215], a[156:159], v[172:175]
    ds_read_b64_tr_b16 a[198:199], v15 offset:29696
    v_mfma_f32_16x16x32_bf16 v[172:175], a[208:211], a[152:155], v[172:175]
    s_waitcnt lgkmcnt(4)
    v_mfma_f32_16x16x32_bf16 v[188:191], a[216:219], a[152:155], v[188:191]
    ds_read_b64_tr_b16 a[200:201], v16 offset:8192
    v_mfma_f32_16x16x32_bf16 v[188:191], a[220:223], a[156:159], v[188:191]
    v_mfma_f32_16x16x32_bf16 v[184:187], a[220:223], a[148:151], v[184:187]
    ds_read_b64_tr_b16 a[202:203], v16 offset:28672
    v_mfma_f32_16x16x32_bf16 v[184:187], a[216:219], a[144:147], v[184:187]
    buffer_load_dwordx4 v7, s[28:31], s64 offen offset:2048 lds
    v_mfma_f32_16x16x32_bf16 v[180:183], a[216:219], a[136:139], v[180:183]
    ds_read_b64_tr_b16 a[204:205], v16 offset:9216
    v_mfma_f32_16x16x32_bf16 v[180:183], a[220:223], a[140:143], v[180:183]
    v_add_u32 v13, s73, v13
    v_mfma_f32_16x16x32_bf16 v[176:179], a[220:223], a[132:135], v[176:179]
    ds_read_b64_tr_b16 a[206:207], v16 offset:29696
    v_mfma_f32_16x16x32_bf16 v[176:179], a[216:219], a[128:131], v[176:179]
    v_add_u32 v14, s73, v14
    s_waitcnt lgkmcnt(4)
    v_mfma_f32_16x16x32_bf16 v[192:195], a[192:195], a[128:131], v[192:195]
    ds_read_b64_tr_b16 a[208:209], v15 offset:18432
    v_mfma_f32_16x16x32_bf16 v[192:195], a[196:199], a[132:135], v[192:195]
    v_mfma_f32_16x16x32_bf16 v[196:199], a[196:199], a[140:143], v[196:199]
    ds_read_b64_tr_b16 a[210:211], v15 offset:38912
    v_mfma_f32_16x16x32_bf16 v[196:199], a[192:195], a[136:139], v[196:199]
    buffer_load_dwordx4 v8, s[28:31], s64 offen offset:3072 lds
    v_mfma_f32_16x16x32_bf16 v[200:203], a[192:195], a[144:147], v[200:203]
    ds_read_b64_tr_b16 a[212:213], v15 offset:19456
    v_mfma_f32_16x16x32_bf16 v[200:203], a[196:199], a[148:151], v[200:203]
    v_mfma_f32_16x16x32_bf16 v[204:207], a[196:199], a[156:159], v[204:207]
    ds_read_b64_tr_b16 a[214:215], v15 offset:39936
    v_mfma_f32_16x16x32_bf16 v[204:207], a[192:195], a[152:155], v[204:207]
    s_waitcnt lgkmcnt(4)
    v_mfma_f32_16x16x32_bf16 v[220:223], a[200:203], a[152:155], v[220:223]
    ds_read_b64_tr_b16 a[216:217], v16 offset:18432
    v_mfma_f32_16x16x32_bf16 v[220:223], a[204:207], a[156:159], v[220:223]
    s_add_u32 m0, s70, 8192
    v_mfma_f32_16x16x32_bf16 v[216:219], a[204:207], a[148:151], v[216:219]
    ds_read_b64_tr_b16 a[218:219], v16 offset:38912
    v_mfma_f32_16x16x32_bf16 v[216:219], a[200:203], a[144:147], v[216:219]
    buffer_load_dwordx4 v11, s[40:43], s66 offen offset:0 lds
    v_mfma_f32_16x16x32_bf16 v[212:215], a[200:203], a[136:139], v[212:215]
    ds_read_b64_tr_b16 a[220:221], v16 offset:19456
    v_mfma_f32_16x16x32_bf16 v[212:215], a[204:207], a[140:143], v[212:215]
    v_mfma_f32_16x16x32_bf16 v[208:211], a[204:207], a[132:135], v[208:211]
    ds_read_b64_tr_b16 a[222:223], v16 offset:39936
    v_mfma_f32_16x16x32_bf16 v[208:211], a[200:203], a[128:131], v[208:211]
    s_waitcnt lgkmcnt(4)
    v_mfma_f32_16x16x32_bf16 v[224:227], a[208:211], a[128:131], v[224:227]
    ds_read_b64_tr_b16 a[192:193], v13 offset:0
    v_mfma_f32_16x16x32_bf16 v[224:227], a[212:215], a[132:135], v[224:227]
    v_add_u32 v15, s73, v15
    v_mfma_f32_16x16x32_bf16 v[228:231], a[212:215], a[140:143], v[228:231]
    ds_read_b64_tr_b16 a[194:195], v13 offset:20480
    v_mfma_f32_16x16x32_bf16 v[228:231], a[208:211], a[136:139], v[228:231]
    buffer_load_dwordx4 v12, s[40:43], s66 offen offset:1024 lds
    v_mfma_f32_16x16x32_bf16 v[232:235], a[208:211], a[144:147], v[232:235]
    ds_read_b64_tr_b16 a[196:197], v13 offset:1024
    v_mfma_f32_16x16x32_bf16 v[232:235], a[212:215], a[148:151], v[232:235]
    s_add_u32 s64, s64, 458752
    v_mfma_f32_16x16x32_bf16 v[236:239], a[212:215], a[156:159], v[236:239]
    ds_read_b64_tr_b16 a[198:199], v13 offset:21504
    v_mfma_f32_16x16x32_bf16 v[236:239], a[208:211], a[152:155], v[236:239]
    s_add_u32 s65, s65, s67
    s_waitcnt lgkmcnt(4)
    v_mfma_f32_16x16x32_bf16 v[252:255], a[216:219], a[152:155], v[252:255]
    ds_read_b64_tr_b16 a[200:201], v14 offset:0
    v_mfma_f32_16x16x32_bf16 v[252:255], a[220:223], a[156:159], v[252:255]
    s_add_u32 s66, s66, s68
    v_mfma_f32_16x16x32_bf16 v[248:251], a[220:223], a[148:151], v[248:251]
    ds_read_b64_tr_b16 a[202:203], v14 offset:20480
    v_mfma_f32_16x16x32_bf16 v[248:251], a[216:219], a[144:147], v[248:251]
    buffer_load_dword v0, v29, s[60:63], 0 offen
    s_add_u32 s70, s70, 40960
    s_sub_u32 s10, s70, 163840
    v_mfma_f32_16x16x32_bf16 v[244:247], a[216:219], a[136:139], v[244:247]
    ds_read_b64_tr_b16 a[204:205], v14 offset:1024
    v_mfma_f32_16x16x32_bf16 v[244:247], a[220:223], a[140:143], v[244:247]
    v_add_u32 v29, v28, v29
    s_cmp_ge_u32 s70, 163840
    s_cselect_b32 s70, s10, s70
    v_mfma_f32_16x16x32_bf16 v[240:243], a[220:223], a[132:135], v[240:243]
    ds_read_b64_tr_b16 a[206:207], v14 offset:21504
    v_mfma_f32_16x16x32_bf16 v[240:243], a[216:219], a[128:131], v[240:243]
    v_add_u32 v16, s73, v16
    s_waitcnt vmcnt(20) lgkmcnt(4)
    v_mfma_f32_16x16x32_bf16 v[32:35], a[192:195], a[160:163], v[32:35]
    ds_read_b64_tr_b16 a[208:209], v13 offset:512
    v_mfma_f32_16x16x32_bf16 v[32:35], a[196:199], a[164:167], v[32:35]
    v_mfma_f32_16x16x32_bf16 v[36:39], a[196:199], a[172:175], v[36:39]
    ds_read_b64_tr_b16 a[210:211], v13 offset:20992
    v_mfma_f32_16x16x32_bf16 v[36:39], a[192:195], a[168:171], v[36:39]
    v_mfma_f32_16x16x32_bf16 v[40:43], a[192:195], a[176:179], v[40:43]
    ds_read_b64_tr_b16 a[212:213], v13 offset:1536
    v_mfma_f32_16x16x32_bf16 v[40:43], a[196:199], a[180:183], v[40:43]
    v_mfma_f32_16x16x32_bf16 v[44:47], a[196:199], a[188:191], v[44:47]
    ds_read_b64_tr_b16 a[214:215], v13 offset:22016
    v_mfma_f32_16x16x32_bf16 v[44:47], a[192:195], a[184:187], v[44:47]
    s_waitcnt vmcnt(20) lgkmcnt(4)
    s_barrier
    v_mfma_f32_16x16x32_bf16 v[60:63], a[200:203], a[184:187], v[60:63]
    ds_read_b64_tr_b16 a[216:217], v14 offset:512
    v_mfma_f32_16x16x32_bf16 v[60:63], a[204:207], a[188:191], v[60:63]
    v_mfma_f32_16x16x32_bf16 v[56:59], a[204:207], a[180:183], v[56:59]
    ds_read_b64_tr_b16 a[218:219], v14 offset:20992
    v_mfma_f32_16x16x32_bf16 v[56:59], a[200:203], a[176:179], v[56:59]
    buffer_load_dwordx4 a[128:131], v3, s[20:23], s69 offen offset:0 sc1
    v_mfma_f32_16x16x32_bf16 v[52:55], a[200:203], a[168:171], v[52:55]
    ds_read_b64_tr_b16 a[220:221], v14 offset:1536
    v_mfma_f32_16x16x32_bf16 v[52:55], a[204:207], a[172:175], v[52:55]
    v_mfma_f32_16x16x32_bf16 v[48:51], a[204:207], a[164:167], v[48:51]
    ds_read_b64_tr_b16 a[222:223], v14 offset:22016
    v_mfma_f32_16x16x32_bf16 v[48:51], a[200:203], a[160:163], v[48:51]
    s_waitcnt lgkmcnt(4)
    v_mfma_f32_16x16x32_bf16 a[0:3], a[208:211], a[160:163], a[0:3]
    ds_read_b64_tr_b16 a[192:193], v13 offset:2048
    v_mfma_f32_16x16x32_bf16 a[0:3], a[212:215], a[164:167], a[0:3]
    v_mfma_f32_16x16x32_bf16 a[4:7], a[212:215], a[172:175], a[4:7]
    ds_read_b64_tr_b16 a[194:195], v13 offset:22528
    v_mfma_f32_16x16x32_bf16 a[4:7], a[208:211], a[168:171], a[4:7]
    buffer_load_dwordx4 a[132:135], v3, s[20:23], s69 offen offset:1024 sc1
    v_mfma_f32_16x16x32_bf16 a[8:11], a[208:211], a[176:179], a[8:11]
    ds_read_b64_tr_b16 a[196:197], v13 offset:3072
    v_mfma_f32_16x16x32_bf16 a[8:11], a[212:215], a[180:183], a[8:11]
    v_mfma_f32_16x16x32_bf16 a[12:15], a[212:215], a[188:191], a[12:15]
    ds_read_b64_tr_b16 a[198:199], v13 offset:23552
    v_mfma_f32_16x16x32_bf16 a[12:15], a[208:211], a[184:187], a[12:15]
    s_waitcnt lgkmcnt(4)
    v_mfma_f32_16x16x32_bf16 a[28:31], a[216:219], a[184:187], a[28:31]
    ds_read_b64_tr_b16 a[200:201], v14 offset:2048
    v_mfma_f32_16x16x32_bf16 a[28:31], a[220:223], a[188:191], a[28:31]
    v_mfma_f32_16x16x32_bf16 a[24:27], a[220:223], a[180:183], a[24:27]
    ds_read_b64_tr_b16 a[202:203], v14 offset:22528
    v_mfma_f32_16x16x32_bf16 a[24:27], a[216:219], a[176:179], a[24:27]
    buffer_load_dwordx4 a[136:139], v4, s[20:23], s69 offen offset:0 sc1
    v_mfma_f32_16x16x32_bf16 a[20:23], a[216:219], a[168:171], a[20:23]
    ds_read_b64_tr_b16 a[204:205], v14 offset:3072
    v_mfma_f32_16x16x32_bf16 a[20:23], a[220:223], a[172:175], a[20:23]
    v_mfma_f32_16x16x32_bf16 a[16:19], a[220:223], a[164:167], a[16:19]
    ds_read_b64_tr_b16 a[206:207], v14 offset:23552
    v_mfma_f32_16x16x32_bf16 a[16:19], a[216:219], a[160:163], a[16:19]
    s_waitcnt lgkmcnt(4)
    v_mfma_f32_16x16x32_bf16 a[32:35], a[192:195], a[160:163], a[32:35]
    ds_read_b64_tr_b16 a[208:209], v13 offset:2560
    v_mfma_f32_16x16x32_bf16 a[32:35], a[196:199], a[164:167], a[32:35]
    v_mfma_f32_16x16x32_bf16 a[36:39], a[196:199], a[172:175], a[36:39]
    ds_read_b64_tr_b16 a[210:211], v13 offset:23040
    v_mfma_f32_16x16x32_bf16 a[36:39], a[192:195], a[168:171], a[36:39]
    buffer_load_dwordx4 a[140:143], v4, s[20:23], s69 offen offset:1024 sc1
    v_mfma_f32_16x16x32_bf16 a[40:43], a[192:195], a[176:179], a[40:43]
    ds_read_b64_tr_b16 a[212:213], v13 offset:3584
    v_mfma_f32_16x16x32_bf16 a[40:43], a[196:199], a[180:183], a[40:43]
    v_mfma_f32_16x16x32_bf16 a[44:47], a[196:199], a[188:191], a[44:47]
    ds_read_b64_tr_b16 a[214:215], v13 offset:24064
    v_mfma_f32_16x16x32_bf16 a[44:47], a[192:195], a[184:187], a[44:47]
    s_waitcnt lgkmcnt(4)
    v_mfma_f32_16x16x32_bf16 a[60:63], a[200:203], a[184:187], a[60:63]
    ds_read_b64_tr_b16 a[216:217], v14 offset:2560
    v_mfma_f32_16x16x32_bf16 a[60:63], a[204:207], a[188:191], a[60:63]
    v_mfma_f32_16x16x32_bf16 a[56:59], a[204:207], a[180:183], a[56:59]
    ds_read_b64_tr_b16 a[218:219], v14 offset:23040
    v_mfma_f32_16x16x32_bf16 a[56:59], a[200:203], a[176:179], a[56:59]
    buffer_load_dwordx4 a[144:147], v5, s[20:23], s69 offen offset:0 sc1
    v_mfma_f32_16x16x32_bf16 a[52:55], a[200:203], a[168:171], a[52:55]
    ds_read_b64_tr_b16 a[220:221], v14 offset:3584
    v_mfma_f32_16x16x32_bf16 a[52:55], a[204:207], a[172:175], a[52:55]
    v_mfma_f32_16x16x32_bf16 a[48:51], a[204:207], a[164:167], a[48:51]
    ds_read_b64_tr_b16 a[222:223], v14 offset:24064
    v_mfma_f32_16x16x32_bf16 a[48:51], a[200:203], a[160:163], a[48:51]
    s_waitcnt lgkmcnt(4)
    v_mfma_f32_16x16x32_bf16 a[64:67], a[208:211], a[160:163], a[64:67]
    ds_read_b64_tr_b16 a[192:193], v13 offset:4096
    v_mfma_f32_16x16x32_bf16 a[64:67], a[212:215], a[164:167], a[64:67]
    v_mfma_f32_16x16x32_bf16 a[68:71], a[212:215], a[172:175], a[68:71]
    ds_read_b64_tr_b16 a[194:195], v13 offset:24576
    v_mfma_f32_16x16x32_bf16 a[68:71], a[208:211], a[168:171], a[68:71]
    buffer_load_dwordx4 a[148:151], v5, s[20:23], s69 offen offset:1024 sc1
    v_mfma_f32_16x16x32_bf16 a[72:75], a[208:211], a[176:179], a[72:75]
    ds_read_b64_tr_b16 a[196:197], v13 offset:5120
    v_mfma_f32_16x16x32_bf16 a[72:75], a[212:215], a[180:183], a[72:75]
    v_mfma_f32_16x16x32_bf16 a[76:79], a[212:215], a[188:191], a[76:79]
    ds_read_b64_tr_b16 a[198:199], v13 offset:25600
    v_mfma_f32_16x16x32_bf16 a[76:79], a[208:211], a[184:187], a[76:79]
    s_waitcnt lgkmcnt(4)
    v_mfma_f32_16x16x32_bf16 a[92:95], a[216:219], a[184:187], a[92:95]
    ds_read_b64_tr_b16 a[200:201], v14 offset:4096
    v_mfma_f32_16x16x32_bf16 a[92:95], a[220:223], a[188:191], a[92:95]
    v_mfma_f32_16x16x32_bf16 a[88:91], a[220:223], a[180:183], a[88:91]
    ds_read_b64_tr_b16 a[202:203], v14 offset:24576
    v_mfma_f32_16x16x32_bf16 a[88:91], a[216:219], a[176:179], a[88:91]
    buffer_load_dwordx4 a[152:155], v6, s[20:23], s69 offen offset:0 sc1
    v_mfma_f32_16x16x32_bf16 a[84:87], a[216:219], a[168:171], a[84:87]
    ds_read_b64_tr_b16 a[204:205], v14 offset:5120
    v_mfma_f32_16x16x32_bf16 a[84:87], a[220:223], a[172:175], a[84:87]
    v_mfma_f32_16x16x32_bf16 a[80:83], a[220:223], a[164:167], a[80:83]
    ds_read_b64_tr_b16 a[206:207], v14 offset:25600
    v_mfma_f32_16x16x32_bf16 a[80:83], a[216:219], a[160:163], a[80:83]
    s_waitcnt lgkmcnt(4)
    v_mfma_f32_16x16x32_bf16 v[64:67], a[192:195], a[160:163], v[64:67]
    ds_read_b64_tr_b16 a[208:209], v13 offset:4608
    v_mfma_f32_16x16x32_bf16 v[64:67], a[196:199], a[164:167], v[64:67]
    v_mfma_f32_16x16x32_bf16 v[68:71], a[196:199], a[172:175], v[68:71]
    ds_read_b64_tr_b16 a[210:211], v13 offset:25088
    v_mfma_f32_16x16x32_bf16 v[68:71], a[192:195], a[168:171], v[68:71]
    buffer_load_dwordx4 a[156:159], v6, s[20:23], s69 offen offset:1024 sc1
    v_mfma_f32_16x16x32_bf16 v[72:75], a[192:195], a[176:179], v[72:75]
    ds_read_b64_tr_b16 a[212:213], v13 offset:5632
    v_mfma_f32_16x16x32_bf16 v[72:75], a[196:199], a[180:183], v[72:75]
    s_add_u32 s69, s69, 8192
    v_mfma_f32_16x16x32_bf16 v[76:79], a[196:199], a[188:191], v[76:79]
    ds_read_b64_tr_b16 a[214:215], v13 offset:26112
    v_mfma_f32_16x16x32_bf16 v[76:79], a[192:195], a[184:187], v[76:79]
    s_waitcnt lgkmcnt(4)
    v_mfma_f32_16x16x32_bf16 v[92:95], a[200:203], a[184:187], v[92:95]
    ds_read_b64_tr_b16 a[216:217], v14 offset:4608
    v_mfma_f32_16x16x32_bf16 v[92:95], a[204:207], a[188:191], v[92:95]
    s_add_u32 m0, s70, 4096
    v_mfma_f32_16x16x32_bf16 v[88:91], a[204:207], a[180:183], v[88:91]
    ds_read_b64_tr_b16 a[218:219], v14 offset:25088
    v_mfma_f32_16x16x32_bf16 v[88:91], a[200:203], a[176:179], v[88:91]
    buffer_load_dwordx4 v9, s[32:35], s65 offen offset:0 lds
    v_mfma_f32_16x16x32_bf16 v[84:87], a[200:203], a[168:171], v[84:87]
    ds_read_b64_tr_b16 a[220:221], v14 offset:5632
    v_mfma_f32_16x16x32_bf16 v[84:87], a[204:207], a[172:175], v[84:87]
    v_mfma_f32_16x16x32_bf16 v[80:83], a[204:207], a[164:167], v[80:83]
    ds_read_b64_tr_b16 a[222:223], v14 offset:26112
    v_mfma_f32_16x16x32_bf16 v[80:83], a[200:203], a[160:163], v[80:83]
    s_waitcnt lgkmcnt(4)
    v_mfma_f32_16x16x32_bf16 v[96:99], a[208:211], a[160:163], v[96:99]
    ds_read_b64_tr_b16 a[192:193], v13 offset:6144
    v_mfma_f32_16x16x32_bf16 v[96:99], a[212:215], a[164:167], v[96:99]
    v_mfma_f32_16x16x32_bf16 v[100:103], a[212:215], a[172:175], v[100:103]
    ds_read_b64_tr_b16 a[194:195], v13 offset:26624
    v_mfma_f32_16x16x32_bf16 v[100:103], a[208:211], a[168:171], v[100:103]
    buffer_load_dwordx4 v10, s[32:35], s65 offen offset:1024 lds
    v_mfma_f32_16x16x32_bf16 v[104:107], a[208:211], a[176:179], v[104:107]
    ds_read_b64_tr_b16 a[196:197], v13 offset:7168
    v_mfma_f32_16x16x32_bf16 v[104:107], a[212:215], a[180:183], v[104:107]
    v_mfma_f32_16x16x32_bf16 v[108:111], a[212:215], a[188:191], v[108:111]
    ds_read_b64_tr_b16 a[198:199], v13 offset:27648
    v_mfma_f32_16x16x32_bf16 v[108:111], a[208:211], a[184:187], v[108:111]
    s_waitcnt lgkmcnt(4)
    v_mfma_f32_16x16x32_bf16 v[124:127], a[216:219], a[184:187], v[124:127]
    ds_read_b64_tr_b16 a[200:201], v14 offset:6144
    v_mfma_f32_16x16x32_bf16 v[124:127], a[220:223], a[188:191], v[124:127]
    v_mfma_f32_16x16x32_bf16 v[120:123], a[220:223], a[180:183], v[120:123]
    ds_read_b64_tr_b16 a[202:203], v14 offset:26624
    v_mfma_f32_16x16x32_bf16 v[120:123], a[216:219], a[176:179], v[120:123]
    buffer_load_dwordx4 v9, s[36:39], s65 offen offset:2048 lds
    v_mfma_f32_16x16x32_bf16 v[116:119], a[216:219], a[168:171], v[116:119]
    ds_read_b64_tr_b16 a[204:205], v14 offset:7168
    v_mfma_f32_16x16x32_bf16 v[116:119], a[220:223], a[172:175], v[116:119]
    v_mfma_f32_16x16x32_bf16 v[112:115], a[220:223], a[164:167], v[112:115]
    ds_read_b64_tr_b16 a[206:207], v14 offset:27648
    v_mfma_f32_16x16x32_bf16 v[112:115], a[216:219], a[160:163], v[112:115]
    s_waitcnt lgkmcnt(4)
    v_mfma_f32_16x16x32_bf16 v[128:131], a[192:195], a[160:163], v[128:131]
    ds_read_b64_tr_b16 a[208:209], v13 offset:6656
    v_mfma_f32_16x16x32_bf16 v[128:131], a[196:199], a[164:167], v[128:131]
    v_mfma_f32_16x16x32_bf16 v[132:135], a[196:199], a[172:175], v[132:135]
    ds_read_b64_tr_b16 a[210:211], v13 offset:27136
    v_mfma_f32_16x16x32_bf16 v[132:135], a[192:195], a[168:171], v[132:135]
    buffer_load_dwordx4 v10, s[36:39], s65 offen offset:3072 lds
    v_mfma_f32_16x16x32_bf16 v[136:139], a[192:195], a[176:179], v[136:139]
    ds_read_b64_tr_b16 a[212:213], v13 offset:7680
    v_mfma_f32_16x16x32_bf16 v[136:139], a[196:199], a[180:183], v[136:139]
    v_mfma_f32_16x16x32_bf16 v[140:143], a[196:199], a[188:191], v[140:143]
    ds_read_b64_tr_b16 a[214:215], v13 offset:28160
    v_mfma_f32_16x16x32_bf16 v[140:143], a[192:195], a[184:187], v[140:143]
    s_waitcnt lgkmcnt(4)
    v_mfma_f32_16x16x32_bf16 v[156:159], a[200:203], a[184:187], v[156:159]
    ds_read_b64_tr_b16 a[216:217], v14 offset:6656
    v_mfma_f32_16x16x32_bf16 v[156:159], a[204:207], a[188:191], v[156:159]
    s_mov_b32 m0, s70
    v_mfma_f32_16x16x32_bf16 v[152:155], a[204:207], a[180:183], v[152:155]
    ds_read_b64_tr_b16 a[218:219], v14 offset:27136
    v_mfma_f32_16x16x32_bf16 v[152:155], a[200:203], a[176:179], v[152:155]
    buffer_load_dwordx4 v7, s[24:27], s64 offen offset:0 lds
    v_mfma_f32_16x16x32_bf16 v[148:151], a[200:203], a[168:171], v[148:151]
    ds_read_b64_tr_b16 a[220:221], v14 offset:7680
    v_mfma_f32_16x16x32_bf16 v[148:151], a[204:207], a[172:175], v[148:151]
    s_add_u32 s72, s72, 1
    s_and_b32 s72, s72, 3
    v_mfma_f32_16x16x32_bf16 v[144:147], a[204:207], a[164:167], v[144:147]
    ds_read_b64_tr_b16 a[222:223], v14 offset:28160
    v_mfma_f32_16x16x32_bf16 v[144:147], a[200:203], a[160:163], v[144:147]
    s_cselect_b32 s73, s74, s75
    s_waitcnt lgkmcnt(4)
    v_mfma_f32_16x16x32_bf16 v[160:163], a[208:211], a[160:163], v[160:163]
    ds_read_b64_tr_b16 a[192:193], v15 offset:8192
    v_mfma_f32_16x16x32_bf16 v[160:163], a[212:215], a[164:167], v[160:163]
    v_mfma_f32_16x16x32_bf16 v[164:167], a[212:215], a[172:175], v[164:167]
    ds_read_b64_tr_b16 a[194:195], v15 offset:28672
    v_mfma_f32_16x16x32_bf16 v[164:167], a[208:211], a[168:171], v[164:167]
    buffer_load_dwordx4 v8, s[24:27], s64 offen offset:1024 lds
    v_mfma_f32_16x16x32_bf16 v[168:171], a[208:211], a[176:179], v[168:171]
    ds_read_b64_tr_b16 a[196:197], v15 offset:9216
    v_mfma_f32_16x16x32_bf16 v[168:171], a[212:215], a[180:183], v[168:171]
    v_mfma_f32_16x16x32_bf16 v[172:175], a[212:215], a[188:191], v[172:175]
    ds_read_b64_tr_b16 a[198:199], v15 offset:29696
    v_mfma_f32_16x16x32_bf16 v[172:175], a[208:211], a[184:187], v[172:175]
    s_waitcnt lgkmcnt(4)
    v_mfma_f32_16x16x32_bf16 v[188:191], a[216:219], a[184:187], v[188:191]
    ds_read_b64_tr_b16 a[200:201], v16 offset:8192
    v_mfma_f32_16x16x32_bf16 v[188:191], a[220:223], a[188:191], v[188:191]
    v_mfma_f32_16x16x32_bf16 v[184:187], a[220:223], a[180:183], v[184:187]
    ds_read_b64_tr_b16 a[202:203], v16 offset:28672
    v_mfma_f32_16x16x32_bf16 v[184:187], a[216:219], a[176:179], v[184:187]
    buffer_load_dwordx4 v7, s[28:31], s64 offen offset:2048 lds
    v_mfma_f32_16x16x32_bf16 v[180:183], a[216:219], a[168:171], v[180:183]
    ds_read_b64_tr_b16 a[204:205], v16 offset:9216
    v_mfma_f32_16x16x32_bf16 v[180:183], a[220:223], a[172:175], v[180:183]
    v_add_u32 v13, s73, v13
    v_mfma_f32_16x16x32_bf16 v[176:179], a[220:223], a[164:167], v[176:179]
    ds_read_b64_tr_b16 a[206:207], v16 offset:29696
    v_mfma_f32_16x16x32_bf16 v[176:179], a[216:219], a[160:163], v[176:179]
    v_add_u32 v14, s73, v14
    s_waitcnt lgkmcnt(4)
    v_mfma_f32_16x16x32_bf16 v[192:195], a[192:195], a[160:163], v[192:195]
    ds_read_b64_tr_b16 a[208:209], v15 offset:18432
    v_mfma_f32_16x16x32_bf16 v[192:195], a[196:199], a[164:167], v[192:195]
    v_mfma_f32_16x16x32_bf16 v[196:199], a[196:199], a[172:175], v[196:199]
    ds_read_b64_tr_b16 a[210:211], v15 offset:38912
    v_mfma_f32_16x16x32_bf16 v[196:199], a[192:195], a[168:171], v[196:199]
    buffer_load_dwordx4 v8, s[28:31], s64 offen offset:3072 lds
    v_mfma_f32_16x16x32_bf16 v[200:203], a[192:195], a[176:179], v[200:203]
    ds_read_b64_tr_b16 a[212:213], v15 offset:19456
    v_mfma_f32_16x16x32_bf16 v[200:203], a[196:199], a[180:183], v[200:203]
    v_mfma_f32_16x16x32_bf16 v[204:207], a[196:199], a[188:191], v[204:207]
    ds_read_b64_tr_b16 a[214:215], v15 offset:39936
    v_mfma_f32_16x16x32_bf16 v[204:207], a[192:195], a[184:187], v[204:207]
    s_waitcnt lgkmcnt(4)
    v_mfma_f32_16x16x32_bf16 v[220:223], a[200:203], a[184:187], v[220:223]
    ds_read_b64_tr_b16 a[216:217], v16 offset:18432
    v_mfma_f32_16x16x32_bf16 v[220:223], a[204:207], a[188:191], v[220:223]
    s_add_u32 m0, s70, 8192
    v_mfma_f32_16x16x32_bf16 v[216:219], a[204:207], a[180:183], v[216:219]
    ds_read_b64_tr_b16 a[218:219], v16 offset:38912
    v_mfma_f32_16x16x32_bf16 v[216:219], a[200:203], a[176:179], v[216:219]
    buffer_load_dwordx4 v11, s[40:43], s66 offen offset:0 lds
    v_mfma_f32_16x16x32_bf16 v[212:215], a[200:203], a[168:171], v[212:215]
    ds_read_b64_tr_b16 a[220:221], v16 offset:19456
    v_mfma_f32_16x16x32_bf16 v[212:215], a[204:207], a[172:175], v[212:215]
    v_mfma_f32_16x16x32_bf16 v[208:211], a[204:207], a[164:167], v[208:211]
    ds_read_b64_tr_b16 a[222:223], v16 offset:39936
    v_mfma_f32_16x16x32_bf16 v[208:211], a[200:203], a[160:163], v[208:211]
    s_waitcnt lgkmcnt(4)
    v_mfma_f32_16x16x32_bf16 v[224:227], a[208:211], a[160:163], v[224:227]
    ds_read_b64_tr_b16 a[192:193], v13 offset:0
    v_mfma_f32_16x16x32_bf16 v[224:227], a[212:215], a[164:167], v[224:227]
    v_add_u32 v15, s73, v15
    v_mfma_f32_16x16x32_bf16 v[228:231], a[212:215], a[172:175], v[228:231]
    ds_read_b64_tr_b16 a[194:195], v13 offset:20480
    v_mfma_f32_16x16x32_bf16 v[228:231], a[208:211], a[168:171], v[228:231]
    buffer_load_dwordx4 v12, s[40:43], s66 offen offset:1024 lds
    v_mfma_f32_16x16x32_bf16 v[232:235], a[208:211], a[176:179], v[232:235]
    ds_read_b64_tr_b16 a[196:197], v13 offset:1024
    v_mfma_f32_16x16x32_bf16 v[232:235], a[212:215], a[180:183], v[232:235]
    s_add_u32 s64, s64, 458752
    v_mfma_f32_16x16x32_bf16 v[236:239], a[212:215], a[188:191], v[236:239]
    ds_read_b64_tr_b16 a[198:199], v13 offset:21504
    v_mfma_f32_16x16x32_bf16 v[236:239], a[208:211], a[184:187], v[236:239]
    s_add_u32 s65, s65, s67
    s_waitcnt lgkmcnt(4)
    v_mfma_f32_16x16x32_bf16 v[252:255], a[216:219], a[184:187], v[252:255]
    ds_read_b64_tr_b16 a[200:201], v14 offset:0
    v_mfma_f32_16x16x32_bf16 v[252:255], a[220:223], a[188:191], v[252:255]
    s_add_u32 s66, s66, s68
    v_mfma_f32_16x16x32_bf16 v[248:251], a[220:223], a[180:183], v[248:251]
    ds_read_b64_tr_b16 a[202:203], v14 offset:20480
    v_mfma_f32_16x16x32_bf16 v[248:251], a[216:219], a[176:179], v[248:251]
    buffer_load_dword v0, v29, s[60:63], 0 offen
    s_add_u32 s70, s70, 40960
    s_sub_u32 s10, s70, 163840
    v_mfma_f32_16x16x32_bf16 v[244:247], a[216:219], a[168:171], v[244:247]
    ds_read_b64_tr_b16 a[204:205], v14 offset:1024
    v_mfma_f32_16x16x32_bf16 v[244:247], a[220:223], a[172:175], v[244:247]
    v_add_u32 v29, v28, v29
    s_cmp_ge_u32 s70, 163840
    s_cselect_b32 s70, s10, s70
    v_mfma_f32_16x16x32_bf16 v[240:243], a[220:223], a[164:167], v[240:243]
    ds_read_b64_tr_b16 a[206:207], v14 offset:21504
    v_mfma_f32_16x16x32_bf16 v[240:243], a[216:219], a[160:163], v[240:243]
    v_add_u32 v16, s73, v16
    s_waitcnt vmcnt(30) lgkmcnt(4)
    v_mfma_f32_16x16x32_bf16 v[32:35], a[192:195], a[96:99], v[32:35]
    ds_read_b64_tr_b16 a[208:209], v13 offset:512
    v_mfma_f32_16x16x32_bf16 v[32:35], a[196:199], a[100:103], v[32:35]
    v_mfma_f32_16x16x32_bf16 v[36:39], a[196:199], a[108:111], v[36:39]
    ds_read_b64_tr_b16 a[210:211], v13 offset:20992
    v_mfma_f32_16x16x32_bf16 v[36:39], a[192:195], a[104:107], v[36:39]
    v_mfma_f32_16x16x32_bf16 v[40:43], a[192:195], a[112:115], v[40:43]
    ds_read_b64_tr_b16 a[212:213], v13 offset:1536
    v_mfma_f32_16x16x32_bf16 v[40:43], a[196:199], a[116:119], v[40:43]
    v_mfma_f32_16x16x32_bf16 v[44:47], a[196:199], a[124:127], v[44:47]
    ds_read_b64_tr_b16 a[214:215], v13 offset:22016
    v_mfma_f32_16x16x32_bf16 v[44:47], a[192:195], a[120:123], v[44:47]
    s_waitcnt vmcnt(20) lgkmcnt(4)
    s_barrier
    v_mfma_f32_16x16x32_bf16 v[60:63], a[200:203], a[120:123], v[60:63]
    ds_read_b64_tr_b16 a[216:217], v14 offset:512
    v_mfma_f32_16x16x32_bf16 v[60:63], a[204:207], a[124:127], v[60:63]
    v_mfma_f32_16x16x32_bf16 v[56:59], a[204:207], a[116:119], v[56:59]
    ds_read_b64_tr_b16 a[218:219], v14 offset:20992
    v_mfma_f32_16x16x32_bf16 v[56:59], a[200:203], a[112:115], v[56:59]
    buffer_load_dwordx4 a[160:163], v3, s[20:23], s69 offen offset:0 sc1
    v_mfma_f32_16x16x32_bf16 v[52:55], a[200:203], a[104:107], v[52:55]
    ds_read_b64_tr_b16 a[220:221], v14 offset:1536
    v_mfma_f32_16x16x32_bf16 v[52:55], a[204:207], a[108:111], v[52:55]
    v_mfma_f32_16x16x32_bf16 v[48:51], a[204:207], a[100:103], v[48:51]
    ds_read_b64_tr_b16 a[222:223], v14 offset:22016
    v_mfma_f32_16x16x32_bf16 v[48:51], a[200:203], a[96:99], v[48:51]
    s_waitcnt lgkmcnt(4)
    v_mfma_f32_16x16x32_bf16 a[0:3], a[208:211], a[96:99], a[0:3]
    ds_read_b64_tr_b16 a[192:193], v13 offset:2048
    v_mfma_f32_16x16x32_bf16 a[0:3], a[212:215], a[100:103], a[0:3]
    v_mfma_f32_16x16x32_bf16 a[4:7], a[212:215], a[108:111], a[4:7]
    ds_read_b64_tr_b16 a[194:195], v13 offset:22528
    v_mfma_f32_16x16x32_bf16 a[4:7], a[208:211], a[104:107], a[4:7]
    buffer_load_dwordx4 a[164:167], v3, s[20:23], s69 offen offset:1024 sc1
    v_mfma_f32_16x16x32_bf16 a[8:11], a[208:211], a[112:115], a[8:11]
    ds_read_b64_tr_b16 a[196:197], v13 offset:3072
    v_mfma_f32_16x16x32_bf16 a[8:11], a[212:215], a[116:119], a[8:11]
    v_mfma_f32_16x16x32_bf16 a[12:15], a[212:215], a[124:127], a[12:15]
    ds_read_b64_tr_b16 a[198:199], v13 offset:23552
    v_mfma_f32_16x16x32_bf16 a[12:15], a[208:211], a[120:123], a[12:15]
    s_waitcnt lgkmcnt(4)
    v_mfma_f32_16x16x32_bf16 a[28:31], a[216:219], a[120:123], a[28:31]
    ds_read_b64_tr_b16 a[200:201], v14 offset:2048
    v_mfma_f32_16x16x32_bf16 a[28:31], a[220:223], a[124:127], a[28:31]
    v_mfma_f32_16x16x32_bf16 a[24:27], a[220:223], a[116:119], a[24:27]
    ds_read_b64_tr_b16 a[202:203], v14 offset:22528
    v_mfma_f32_16x16x32_bf16 a[24:27], a[216:219], a[112:115], a[24:27]
    buffer_load_dwordx4 a[168:171], v4, s[20:23], s69 offen offset:0 sc1
    v_mfma_f32_16x16x32_bf16 a[20:23], a[216:219], a[104:107], a[20:23]
    ds_read_b64_tr_b16 a[204:205], v14 offset:3072
    v_mfma_f32_16x16x32_bf16 a[20:23], a[220:223], a[108:111], a[20:23]
    v_mfma_f32_16x16x32_bf16 a[16:19], a[220:223], a[100:103], a[16:19]
    ds_read_b64_tr_b16 a[206:207], v14 offset:23552
    v_mfma_f32_16x16x32_bf16 a[16:19], a[216:219], a[96:99], a[16:19]
    s_waitcnt lgkmcnt(4)
    v_mfma_f32_16x16x32_bf16 a[32:35], a[192:195], a[96:99], a[32:35]
    ds_read_b64_tr_b16 a[208:209], v13 offset:2560
    v_mfma_f32_16x16x32_bf16 a[32:35], a[196:199], a[100:103], a[32:35]
    v_mfma_f32_16x16x32_bf16 a[36:39], a[196:199], a[108:111], a[36:39]
    ds_read_b64_tr_b16 a[210:211], v13 offset:23040
    v_mfma_f32_16x16x32_bf16 a[36:39], a[192:195], a[104:107], a[36:39]
    buffer_load_dwordx4 a[172:175], v4, s[20:23], s69 offen offset:1024 sc1
    v_mfma_f32_16x16x32_bf16 a[40:43], a[192:195], a[112:115], a[40:43]
    ds_read_b64_tr_b16 a[212:213], v13 offset:3584
    v_mfma_f32_16x16x32_bf16 a[40:43], a[196:199], a[116:119], a[40:43]
    v_mfma_f32_16x16x32_bf16 a[44:47], a[196:199], a[124:127], a[44:47]
    ds_read_b64_tr_b16 a[214:215], v13 offset:24064
    v_mfma_f32_16x16x32_bf16 a[44:47], a[192:195], a[120:123], a[44:47]
    s_waitcnt lgkmcnt(4)
    v_mfma_f32_16x16x32_bf16 a[60:63], a[200:203], a[120:123], a[60:63]
    ds_read_b64_tr_b16 a[216:217], v14 offset:2560
    v_mfma_f32_16x16x32_bf16 a[60:63], a[204:207], a[124:127], a[60:63]
    v_mfma_f32_16x16x32_bf16 a[56:59], a[204:207], a[116:119], a[56:59]
    ds_read_b64_tr_b16 a[218:219], v14 offset:23040
    v_mfma_f32_16x16x32_bf16 a[56:59], a[200:203], a[112:115], a[56:59]
    buffer_load_dwordx4 a[176:179], v5, s[20:23], s69 offen offset:0 sc1
    v_mfma_f32_16x16x32_bf16 a[52:55], a[200:203], a[104:107], a[52:55]
    ds_read_b64_tr_b16 a[220:221], v14 offset:3584
    v_mfma_f32_16x16x32_bf16 a[52:55], a[204:207], a[108:111], a[52:55]
    v_mfma_f32_16x16x32_bf16 a[48:51], a[204:207], a[100:103], a[48:51]
    ds_read_b64_tr_b16 a[222:223], v14 offset:24064
    v_mfma_f32_16x16x32_bf16 a[48:51], a[200:203], a[96:99], a[48:51]
    s_waitcnt lgkmcnt(4)
    v_mfma_f32_16x16x32_bf16 a[64:67], a[208:211], a[96:99], a[64:67]
    ds_read_b64_tr_b16 a[192:193], v13 offset:4096
    v_mfma_f32_16x16x32_bf16 a[64:67], a[212:215], a[100:103], a[64:67]
    v_mfma_f32_16x16x32_bf16 a[68:71], a[212:215], a[108:111], a[68:71]
    ds_read_b64_tr_b16 a[194:195], v13 offset:24576
    v_mfma_f32_16x16x32_bf16 a[68:71], a[208:211], a[104:107], a[68:71]
    buffer_load_dwordx4 a[180:183], v5, s[20:23], s69 offen offset:1024 sc1
    v_mfma_f32_16x16x32_bf16 a[72:75], a[208:211], a[112:115], a[72:75]
    ds_read_b64_tr_b16 a[196:197], v13 offset:5120
    v_mfma_f32_16x16x32_bf16 a[72:75], a[212:215], a[116:119], a[72:75]
    v_mfma_f32_16x16x32_bf16 a[76:79], a[212:215], a[124:127], a[76:79]
    ds_read_b64_tr_b16 a[198:199], v13 offset:25600
    v_mfma_f32_16x16x32_bf16 a[76:79], a[208:211], a[120:123], a[76:79]
    s_waitcnt lgkmcnt(4)
    v_mfma_f32_16x16x32_bf16 a[92:95], a[216:219], a[120:123], a[92:95]
    ds_read_b64_tr_b16 a[200:201], v14 offset:4096
    v_mfma_f32_16x16x32_bf16 a[92:95], a[220:223], a[124:127], a[92:95]
    v_mfma_f32_16x16x32_bf16 a[88:91], a[220:223], a[116:119], a[88:91]
    ds_read_b64_tr_b16 a[202:203], v14 offset:24576
    v_mfma_f32_16x16x32_bf16 a[88:91], a[216:219], a[112:115], a[88:91]
    buffer_load_dwordx4 a[184:187], v6, s[20:23], s69 offen offset:0 sc1
    v_mfma_f32_16x16x32_bf16 a[84:87], a[216:219], a[104:107], a[84:87]
    ds_read_b64_tr_b16 a[204:205], v14 offset:5120
    v_mfma_f32_16x16x32_bf16 a[84:87], a[220:223], a[108:111], a[84:87]
    v_mfma_f32_16x16x32_bf16 a[80:83], a[220:223], a[100:103], a[80:83]
    ds_read_b64_tr_b16 a[206:207], v14 offset:25600
    v_mfma_f32_16x16x32_bf16 a[80:83], a[216:219], a[96:99], a[80:83]
    s_waitcnt lgkmcnt(4)
    v_mfma_f32_16x16x32_bf16 v[64:67], a[192:195], a[96:99], v[64:67]
    ds_read_b64_tr_b16 a[208:209], v13 offset:4608
    v_mfma_f32_16x16x32_bf16 v[64:67], a[196:199], a[100:103], v[64:67]
    v_mfma_f32_16x16x32_bf16 v[68:71], a[196:199], a[108:111], v[68:71]
    ds_read_b64_tr_b16 a[210:211], v13 offset:25088
    v_mfma_f32_16x16x32_bf16 v[68:71], a[192:195], a[104:107], v[68:71]
    buffer_load_dwordx4 a[188:191], v6, s[20:23], s69 offen offset:1024 sc1
    v_mfma_f32_16x16x32_bf16 v[72:75], a[192:195], a[112:115], v[72:75]
    ds_read_b64_tr_b16 a[212:213], v13 offset:5632
    v_mfma_f32_16x16x32_bf16 v[72:75], a[196:199], a[116:119], v[72:75]
    s_add_u32 s69, s69, 8192
    v_mfma_f32_16x16x32_bf16 v[76:79], a[196:199], a[124:127], v[76:79]
    ds_read_b64_tr_b16 a[214:215], v13 offset:26112
    v_mfma_f32_16x16x32_bf16 v[76:79], a[192:195], a[120:123], v[76:79]
    s_waitcnt lgkmcnt(4)
    v_mfma_f32_16x16x32_bf16 v[92:95], a[200:203], a[120:123], v[92:95]
    ds_read_b64_tr_b16 a[216:217], v14 offset:4608
    v_mfma_f32_16x16x32_bf16 v[92:95], a[204:207], a[124:127], v[92:95]
    s_add_u32 m0, s70, 4096
    v_mfma_f32_16x16x32_bf16 v[88:91], a[204:207], a[116:119], v[88:91]
    ds_read_b64_tr_b16 a[218:219], v14 offset:25088
    v_mfma_f32_16x16x32_bf16 v[88:91], a[200:203], a[112:115], v[88:91]
    buffer_load_dwordx4 v9, s[32:35], s65 offen offset:0 lds
    v_mfma_f32_16x16x32_bf16 v[84:87], a[200:203], a[104:107], v[84:87]
    ds_read_b64_tr_b16 a[220:221], v14 offset:5632
    v_mfma_f32_16x16x32_bf16 v[84:87], a[204:207], a[108:111], v[84:87]
    v_mfma_f32_16x16x32_bf16 v[80:83], a[204:207], a[100:103], v[80:83]
    ds_read_b64_tr_b16 a[222:223], v14 offset:26112
    v_mfma_f32_16x16x32_bf16 v[80:83], a[200:203], a[96:99], v[80:83]
    s_waitcnt lgkmcnt(4)
    v_mfma_f32_16x16x32_bf16 v[96:99], a[208:211], a[96:99], v[96:99]
    ds_read_b64_tr_b16 a[192:193], v13 offset:6144
    v_mfma_f32_16x16x32_bf16 v[96:99], a[212:215], a[100:103], v[96:99]
    v_mfma_f32_16x16x32_bf16 v[100:103], a[212:215], a[108:111], v[100:103]
    ds_read_b64_tr_b16 a[194:195], v13 offset:26624
    v_mfma_f32_16x16x32_bf16 v[100:103], a[208:211], a[104:107], v[100:103]
    buffer_load_dwordx4 v10, s[32:35], s65 offen offset:1024 lds
    v_mfma_f32_16x16x32_bf16 v[104:107], a[208:211], a[112:115], v[104:107]
    ds_read_b64_tr_b16 a[196:197], v13 offset:7168
    v_mfma_f32_16x16x32_bf16 v[104:107], a[212:215], a[116:119], v[104:107]
    v_mfma_f32_16x16x32_bf16 v[108:111], a[212:215], a[124:127], v[108:111]
    ds_read_b64_tr_b16 a[198:199], v13 offset:27648
    v_mfma_f32_16x16x32_bf16 v[108:111], a[208:211], a[120:123], v[108:111]
    s_waitcnt lgkmcnt(4)
    v_mfma_f32_16x16x32_bf16 v[124:127], a[216:219], a[120:123], v[124:127]
    ds_read_b64_tr_b16 a[200:201], v14 offset:6144
    v_mfma_f32_16x16x32_bf16 v[124:127], a[220:223], a[124:127], v[124:127]
    v_mfma_f32_16x16x32_bf16 v[120:123], a[220:223], a[116:119], v[120:123]
    ds_read_b64_tr_b16 a[202:203], v14 offset:26624
    v_mfma_f32_16x16x32_bf16 v[120:123], a[216:219], a[112:115], v[120:123]
    buffer_load_dwordx4 v9, s[36:39], s65 offen offset:2048 lds
    v_mfma_f32_16x16x32_bf16 v[116:119], a[216:219], a[104:107], v[116:119]
    ds_read_b64_tr_b16 a[204:205], v14 offset:7168
    v_mfma_f32_16x16x32_bf16 v[116:119], a[220:223], a[108:111], v[116:119]
    v_mfma_f32_16x16x32_bf16 v[112:115], a[220:223], a[100:103], v[112:115]
    ds_read_b64_tr_b16 a[206:207], v14 offset:27648
    v_mfma_f32_16x16x32_bf16 v[112:115], a[216:219], a[96:99], v[112:115]
    s_waitcnt lgkmcnt(4)
    v_mfma_f32_16x16x32_bf16 v[128:131], a[192:195], a[96:99], v[128:131]
    ds_read_b64_tr_b16 a[208:209], v13 offset:6656
    v_mfma_f32_16x16x32_bf16 v[128:131], a[196:199], a[100:103], v[128:131]
    v_mfma_f32_16x16x32_bf16 v[132:135], a[196:199], a[108:111], v[132:135]
    ds_read_b64_tr_b16 a[210:211], v13 offset:27136
    v_mfma_f32_16x16x32_bf16 v[132:135], a[192:195], a[104:107], v[132:135]
    buffer_load_dwordx4 v10, s[36:39], s65 offen offset:3072 lds
    v_mfma_f32_16x16x32_bf16 v[136:139], a[192:195], a[112:115], v[136:139]
    ds_read_b64_tr_b16 a[212:213], v13 offset:7680
    v_mfma_f32_16x16x32_bf16 v[136:139], a[196:199], a[116:119], v[136:139]
    v_mfma_f32_16x16x32_bf16 v[140:143], a[196:199], a[124:127], v[140:143]
    ds_read_b64_tr_b16 a[214:215], v13 offset:28160
    v_mfma_f32_16x16x32_bf16 v[140:143], a[192:195], a[120:123], v[140:143]
    s_waitcnt lgkmcnt(4)
    v_mfma_f32_16x16x32_bf16 v[156:159], a[200:203], a[120:123], v[156:159]
    ds_read_b64_tr_b16 a[216:217], v14 offset:6656
    v_mfma_f32_16x16x32_bf16 v[156:159], a[204:207], a[124:127], v[156:159]
    s_mov_b32 m0, s70
    v_mfma_f32_16x16x32_bf16 v[152:155], a[204:207], a[116:119], v[152:155]
    ds_read_b64_tr_b16 a[218:219], v14 offset:27136
    v_mfma_f32_16x16x32_bf16 v[152:155], a[200:203], a[112:115], v[152:155]
    buffer_load_dwordx4 v7, s[24:27], s64 offen offset:0 lds
    v_mfma_f32_16x16x32_bf16 v[148:151], a[200:203], a[104:107], v[148:151]
    ds_read_b64_tr_b16 a[220:221], v14 offset:7680
    v_mfma_f32_16x16x32_bf16 v[148:151], a[204:207], a[108:111], v[148:151]
    s_add_u32 s72, s72, 1
    s_and_b32 s72, s72, 3
    v_mfma_f32_16x16x32_bf16 v[144:147], a[204:207], a[100:103], v[144:147]
    ds_read_b64_tr_b16 a[222:223], v14 offset:28160
    v_mfma_f32_16x16x32_bf16 v[144:147], a[200:203], a[96:99], v[144:147]
    s_cselect_b32 s73, s74, s75
    s_waitcnt lgkmcnt(4)
    v_mfma_f32_16x16x32_bf16 v[160:163], a[208:211], a[96:99], v[160:163]
    ds_read_b64_tr_b16 a[192:193], v15 offset:8192
    v_mfma_f32_16x16x32_bf16 v[160:163], a[212:215], a[100:103], v[160:163]
    v_mfma_f32_16x16x32_bf16 v[164:167], a[212:215], a[108:111], v[164:167]
    ds_read_b64_tr_b16 a[194:195], v15 offset:28672
    v_mfma_f32_16x16x32_bf16 v[164:167], a[208:211], a[104:107], v[164:167]
    buffer_load_dwordx4 v8, s[24:27], s64 offen offset:1024 lds
    v_mfma_f32_16x16x32_bf16 v[168:171], a[208:211], a[112:115], v[168:171]
    ds_read_b64_tr_b16 a[196:197], v15 offset:9216
    v_mfma_f32_16x16x32_bf16 v[168:171], a[212:215], a[116:119], v[168:171]
    v_mfma_f32_16x16x32_bf16 v[172:175], a[212:215], a[124:127], v[172:175]
    ds_read_b64_tr_b16 a[198:199], v15 offset:29696
    v_mfma_f32_16x16x32_bf16 v[172:175], a[208:211], a[120:123], v[172:175]
    s_waitcnt lgkmcnt(4)
    v_mfma_f32_16x16x32_bf16 v[188:191], a[216:219], a[120:123], v[188:191]
    ds_read_b64_tr_b16 a[200:201], v16 offset:8192
    v_mfma_f32_16x16x32_bf16 v[188:191], a[220:223], a[124:127], v[188:191]
    v_mfma_f32_16x16x32_bf16 v[184:187], a[220:223], a[116:119], v[184:187]
    ds_read_b64_tr_b16 a[202:203], v16 offset:28672
    v_mfma_f32_16x16x32_bf16 v[184:187], a[216:219], a[112:115], v[184:187]
    buffer_load_dwordx4 v7, s[28:31], s64 offen offset:2048 lds
    v_mfma_f32_16x16x32_bf16 v[180:183], a[216:219], a[104:107], v[180:183]
    ds_read_b64_tr_b16 a[204:205], v16 offset:9216
    v_mfma_f32_16x16x32_bf16 v[180:183], a[220:223], a[108:111], v[180:183]
    v_add_u32 v13, s73, v13
    v_mfma_f32_16x16x32_bf16 v[176:179], a[220:223], a[100:103], v[176:179]
    ds_read_b64_tr_b16 a[206:207], v16 offset:29696
    v_mfma_f32_16x16x32_bf16 v[176:179], a[216:219], a[96:99], v[176:179]
    v_add_u32 v14, s73, v14
    s_waitcnt lgkmcnt(4)
    v_mfma_f32_16x16x32_bf16 v[192:195], a[192:195], a[96:99], v[192:195]
    ds_read_b64_tr_b16 a[208:209], v15 offset:18432
    v_mfma_f32_16x16x32_bf16 v[192:195], a[196:199], a[100:103], v[192:195]
    v_mfma_f32_16x16x32_bf16 v[196:199], a[196:199], a[108:111], v[196:199]
    ds_read_b64_tr_b16 a[210:211], v15 offset:38912
    v_mfma_f32_16x16x32_bf16 v[196:199], a[192:195], a[104:107], v[196:199]
    buffer_load_dwordx4 v8, s[28:31], s64 offen offset:3072 lds
    v_mfma_f32_16x16x32_bf16 v[200:203], a[192:195], a[112:115], v[200:203]
    ds_read_b64_tr_b16 a[212:213], v15 offset:19456
    v_mfma_f32_16x16x32_bf16 v[200:203], a[196:199], a[116:119], v[200:203]
    v_mfma_f32_16x16x32_bf16 v[204:207], a[196:199], a[124:127], v[204:207]
    ds_read_b64_tr_b16 a[214:215], v15 offset:39936
    v_mfma_f32_16x16x32_bf16 v[204:207], a[192:195], a[120:123], v[204:207]
    s_waitcnt lgkmcnt(4)
    v_mfma_f32_16x16x32_bf16 v[220:223], a[200:203], a[120:123], v[220:223]
    ds_read_b64_tr_b16 a[216:217], v16 offset:18432
    v_mfma_f32_16x16x32_bf16 v[220:223], a[204:207], a[124:127], v[220:223]
    s_add_u32 m0, s70, 8192
    v_mfma_f32_16x16x32_bf16 v[216:219], a[204:207], a[116:119], v[216:219]
    ds_read_b64_tr_b16 a[218:219], v16 offset:38912
    v_mfma_f32_16x16x32_bf16 v[216:219], a[200:203], a[112:115], v[216:219]
    buffer_load_dwordx4 v11, s[40:43], s66 offen offset:0 lds
    v_mfma_f32_16x16x32_bf16 v[212:215], a[200:203], a[104:107], v[212:215]
    ds_read_b64_tr_b16 a[220:221], v16 offset:19456
    v_mfma_f32_16x16x32_bf16 v[212:215], a[204:207], a[108:111], v[212:215]
    v_mfma_f32_16x16x32_bf16 v[208:211], a[204:207], a[100:103], v[208:211]
    ds_read_b64_tr_b16 a[222:223], v16 offset:39936
    v_mfma_f32_16x16x32_bf16 v[208:211], a[200:203], a[96:99], v[208:211]
    s_waitcnt lgkmcnt(4)
    v_mfma_f32_16x16x32_bf16 v[224:227], a[208:211], a[96:99], v[224:227]
    ds_read_b64_tr_b16 a[192:193], v13 offset:0
    v_mfma_f32_16x16x32_bf16 v[224:227], a[212:215], a[100:103], v[224:227]
    v_add_u32 v15, s73, v15
    v_mfma_f32_16x16x32_bf16 v[228:231], a[212:215], a[108:111], v[228:231]
    ds_read_b64_tr_b16 a[194:195], v13 offset:20480
    v_mfma_f32_16x16x32_bf16 v[228:231], a[208:211], a[104:107], v[228:231]
    buffer_load_dwordx4 v12, s[40:43], s66 offen offset:1024 lds
    v_mfma_f32_16x16x32_bf16 v[232:235], a[208:211], a[112:115], v[232:235]
    ds_read_b64_tr_b16 a[196:197], v13 offset:1024
    v_mfma_f32_16x16x32_bf16 v[232:235], a[212:215], a[116:119], v[232:235]
    s_add_u32 s64, s64, 458752
    v_mfma_f32_16x16x32_bf16 v[236:239], a[212:215], a[124:127], v[236:239]
    ds_read_b64_tr_b16 a[198:199], v13 offset:21504
    v_mfma_f32_16x16x32_bf16 v[236:239], a[208:211], a[120:123], v[236:239]
    s_add_u32 s65, s65, s67
    s_waitcnt lgkmcnt(4)
    v_mfma_f32_16x16x32_bf16 v[252:255], a[216:219], a[120:123], v[252:255]
    ds_read_b64_tr_b16 a[200:201], v14 offset:0
    v_mfma_f32_16x16x32_bf16 v[252:255], a[220:223], a[124:127], v[252:255]
    s_add_u32 s66, s66, s68
    v_mfma_f32_16x16x32_bf16 v[248:251], a[220:223], a[116:119], v[248:251]
    ds_read_b64_tr_b16 a[202:203], v14 offset:20480
    v_mfma_f32_16x16x32_bf16 v[248:251], a[216:219], a[112:115], v[248:251]
    buffer_load_dword v0, v29, s[60:63], 0 offen
    s_add_u32 s70, s70, 40960
    s_sub_u32 s10, s70, 163840
    v_mfma_f32_16x16x32_bf16 v[244:247], a[216:219], a[104:107], v[244:247]
    ds_read_b64_tr_b16 a[204:205], v14 offset:1024
    v_mfma_f32_16x16x32_bf16 v[244:247], a[220:223], a[108:111], v[244:247]
    v_add_u32 v29, v28, v29
    s_cmp_ge_u32 s70, 163840
    s_cselect_b32 s70, s10, s70
    v_mfma_f32_16x16x32_bf16 v[240:243], a[220:223], a[100:103], v[240:243]
    ds_read_b64_tr_b16 a[206:207], v14 offset:21504
    v_mfma_f32_16x16x32_bf16 v[240:243], a[216:219], a[96:99], v[240:243]
    global_load_dword v0, v[24:25], off
    v_add_u32 v16, s73, v16
    s_sub_u32 s71, s71, 1
    s_cmp_lg_u32 s71, 0
    s_cbranch_scc1 L_loop_d
    v_mov_b32 v9, v13
    v_subrev_u32 v7, 40960, v13
    v_add_u32 v11, 40960, v13
    v_add_u32 v13, 81920, v13
    v_mov_b32 v10, v14
    v_subrev_u32 v8, 40960, v14
    v_add_u32 v12, 40960, v14
    v_add_u32 v14, 81920, v14
    s_waitcnt vmcnt(31) lgkmcnt(4)
    v_mfma_f32_16x16x32_bf16 v[32:35], a[192:195], a[128:131], v[32:35]
    ds_read_b64_tr_b16 a[208:209], v9 offset:6144
    s_and_b32 s70, s14, 3
    v_mfma_f32_16x16x32_bf16 v[32:35], a[196:199], a[132:135], v[32:35]
    buffer_load_dwordx4 a[96:99], v3, s[20:23], s69 offen offset:0 sc1
    s_lshl_b32 s70, s70, 2
    v_mfma_f32_16x16x32_bf16 v[36:39], a[196:199], a[140:143], v[36:39]
    ds_read_b64_tr_b16 a[210:211], v9 offset:26624
    s_add_u32 s70, s70, s3
    v_mfma_f32_16x16x32_bf16 v[36:39], a[192:195], a[136:139], v[36:39]
    s_mul_i32 s96, s70, 114688
    s_mul_i32 s97, s17, 1835008
    v_mfma_f32_16x16x32_bf16 v[40:43], a[192:195], a[144:147], v[40:43]
    ds_read_b64_tr_b16 a[212:213], v9 offset:7168
    s_add_u32 s96, s96, s97
    v_mfma_f32_16x16x32_bf16 v[40:43], a[196:199], a[148:151], v[40:43]
    buffer_load_dwordx4 a[100:103], v3, s[20:23], s69 offen offset:1024 sc1
    s_add_u32 s97, s96, 49152
    v_mfma_f32_16x16x32_bf16 v[44:47], a[196:199], a[156:159], v[44:47]
    ds_read_b64_tr_b16 a[214:215], v9 offset:27648
    s_lshl_b32 s79, s70, 17
    v_mfma_f32_16x16x32_bf16 v[44:47], a[192:195], a[152:155], v[44:47]
    s_waitcnt vmcnt(23) lgkmcnt(4)
    s_barrier
    v_mfma_f32_16x16x32_bf16 v[60:63], a[200:203], a[152:155], v[60:63]
    ds_read_b64_tr_b16 a[216:217], v10 offset:6144
    s_add_u32 s72, s79, 65536
    v_mfma_f32_16x16x32_bf16 v[60:63], a[204:207], a[156:159], v[60:63]
    buffer_load_dwordx4 a[104:107], v4, s[20:23], s69 offen offset:0 sc1
    v_lshrrev_b32 v22, 1, v1
    v_mfma_f32_16x16x32_bf16 v[56:59], a[204:207], a[148:151], v[56:59]
    ds_read_b64_tr_b16 a[218:219], v10 offset:26624
    v_lshlrev_b32 v22, 11, v22
    v_mfma_f32_16x16x32_bf16 v[56:59], a[200:203], a[144:147], v[56:59]
    s_sub_u32 s71, s8, 2048
    s_ashr_i32 s74, s71, 31
    s_add_u32 s36, s6, s71
    s_addc_u32 s37, s7, s74
    v_mfma_f32_16x16x32_bf16 v[52:55], a[200:203], a[136:139], v[52:55]
    ds_read_b64_tr_b16 a[220:221], v10 offset:7168
    v_and_b32 v23, 1, v1
    v_mfma_f32_16x16x32_bf16 v[52:55], a[204:207], a[140:143], v[52:55]
    buffer_load_dwordx4 a[108:111], v4, s[20:23], s69 offen offset:1024 sc1
    v_lshl_add_u32 v22, v23, 7, v22
    v_mfma_f32_16x16x32_bf16 v[48:51], a[204:207], a[132:135], v[48:51]
    ds_read_b64_tr_b16 a[222:223], v10 offset:27648
    s_sub_u32 s38, 2097152, s71
    v_mfma_f32_16x16x32_bf16 v[48:51], a[200:203], a[128:131], v[48:51]
    s_mov_b32 s39, 0x20000
    s_waitcnt lgkmcnt(4)
    v_mfma_f32_16x16x32_bf16 v[128:131], a[208:211], a[128:131], v[128:131]
    ds_read_b64_tr_b16 a[192:193], v11 offset:6144
    v_lshrrev_b32 v24, 4, v1
    v_mfma_f32_16x16x32_bf16 v[128:131], a[212:215], a[132:135], v[128:131]
    buffer_load_dwordx4 a[112:115], v5, s[20:23], s69 offen offset:0 sc1
    v_lshlrev_b32 v23, 7, v1
    v_mfma_f32_16x16x32_bf16 v[132:135], a[212:215], a[140:143], v[132:135]
    ds_read_b64_tr_b16 a[194:195], v11 offset:26624
    v_lshl_add_u32 v23, v24, 28, v23
    v_mfma_f32_16x16x32_bf16 v[132:135], a[208:211], a[136:139], v[132:135]
    s_lshl_b32 s72, s2, 2
    s_add_u32 s72, s72, s3
    v_mfma_f32_16x16x32_bf16 v[136:139], a[208:211], a[144:147], v[136:139]
    ds_read_b64_tr_b16 a[196:197], v11 offset:7168
    s_lshl_b32 s72, s72, 11
    v_mfma_f32_16x16x32_bf16 v[136:139], a[212:215], a[148:151], v[136:139]
    buffer_load_dwordx4 a[116:119], v5, s[20:23], s69 offen offset:1024 sc1
    s_sub_u32 s72, s72, s8
    v_mfma_f32_16x16x32_bf16 v[140:143], a[212:215], a[156:159], v[140:143]
    ds_read_b64_tr_b16 a[198:199], v11 offset:27648
    s_lshl_b32 s64, s9, 7
    v_mfma_f32_16x16x32_bf16 v[140:143], a[208:211], a[152:155], v[140:143]
    s_lshl_b32 s66, s15, 2
    s_waitcnt lgkmcnt(4)
    v_mfma_f32_16x16x32_bf16 v[156:159], a[216:219], a[152:155], v[156:159]
    ds_read_b64_tr_b16 a[200:201], v12 offset:6144
    s_add_u32 s70, s66, s3
    v_mfma_f32_16x16x32_bf16 v[156:159], a[220:223], a[156:159], v[156:159]
    buffer_load_dwordx4 a[120:123], v6, s[20:23], s69 offen offset:0 sc1
    s_add_u32 s66, s66, s64
    v_mfma_f32_16x16x32_bf16 v[152:155], a[220:223], a[148:151], v[152:155]
    ds_read_b64_tr_b16 a[202:203], v12 offset:26624
    s_lshl_b32 s65, s70, 7
    v_mfma_f32_16x16x32_bf16 v[152:155], a[216:219], a[144:147], v[152:155]
    s_add_u32 s65, s65, 12288
    s_lshl_b32 s67, s17, 4
    v_mfma_f32_16x16x32_bf16 v[148:151], a[216:219], a[136:139], v[148:151]
    ds_read_b64_tr_b16 a[204:205], v12 offset:7168
    s_add_u32 s67, s67, s64
    v_mfma_f32_16x16x32_bf16 v[148:151], a[220:223], a[140:143], v[148:151]
    buffer_load_dwordx4 a[124:127], v6, s[20:23], s69 offen offset:1024 sc1
    s_add_u32 s73, s67, 57344
    v_mfma_f32_16x16x32_bf16 v[144:147], a[220:223], a[132:135], v[144:147]
    ds_read_b64_tr_b16 a[206:207], v12 offset:27648
    s_add_u32 s67, s67, 4096
    v_mfma_f32_16x16x32_bf16 v[144:147], a[216:219], a[128:131], v[144:147]
    s_add_u32 s64, s64, 8192
    s_waitcnt vmcnt(20) lgkmcnt(4)
    v_mfma_f32_16x16x32_bf16 v[128:131], a[192:195], a[160:163], v[128:131]
    ds_read_b64_tr_b16 a[208:209], v9 offset:4096
    s_lshl_b32 s70, s14, 3
    v_mfma_f32_16x16x32_bf16 v[128:131], a[196:199], a[164:167], v[128:131]
    s_lshr_b32 s71, s8, 8
    s_add_u32 s70, s70, s71
    v_mfma_f32_16x16x32_bf16 v[132:135], a[196:199], a[172:175], v[132:135]
    ds_read_b64_tr_b16 a[210:211], v9 offset:24576
    s_lshl_b32 s71, s70, 18
    v_mfma_f32_16x16x32_bf16 v[132:135], a[192:195], a[168:171], v[132:135]
    s_lshl_b32 s74, s3, 12
    s_add_u32 s71, s71, s74
    v_mfma_f32_16x16x32_bf16 v[136:139], a[192:195], a[176:179], v[136:139]
    ds_read_b64_tr_b16 a[212:213], v9 offset:5120
    s_add_u32 s71, s71, 33554432
    v_mfma_f32_16x16x32_bf16 v[136:139], a[196:199], a[180:183], v[136:139]
    buffer_load_dword v0, v22, s[56:59], s96 offen offset:2048
    v_mfma_f32_16x16x32_bf16 v[140:143], a[196:199], a[188:191], v[140:143]
    ds_read_b64_tr_b16 a[214:215], v9 offset:25600
    v_mfma_f32_16x16x32_bf16 v[140:143], a[192:195], a[184:187], v[140:143]
    s_waitcnt lgkmcnt(4)
    v_mfma_f32_16x16x32_bf16 v[156:159], a[200:203], a[184:187], v[156:159]
    ds_read_b64_tr_b16 a[216:217], v11 offset:4096
    v_mfma_f32_16x16x32_bf16 v[156:159], a[204:207], a[188:191], v[156:159]
    s_add_u32 s24, s12, s71
    s_addc_u32 s25, s13, 0
    s_mov_b32 s26, 262144
    s_mov_b32 s27, 0x20000
    v_mfma_f32_16x16x32_bf16 v[152:155], a[204:207], a[180:183], v[152:155]
    ds_read_b64_tr_b16 a[218:219], v11 offset:24576
    s_lshl_b32 s70, s70, 2
    v_mfma_f32_16x16x32_bf16 v[152:155], a[200:203], a[176:179], v[152:155]
    s_add_u32 s70, s70, s3
    s_lshl_b32 s70, s70, 7
    v_mfma_f32_16x16x32_bf16 v[148:151], a[200:203], a[168:171], v[148:151]
    ds_read_b64_tr_b16 a[220:221], v11 offset:5120
    s_add_u32 s68, s70, 20480
    v_mfma_f32_16x16x32_bf16 v[148:151], a[204:207], a[172:175], v[148:151]
    buffer_load_dword v0, v22, s[56:59], s97 offen offset:2048
    s_lshl_b32 s70, s9, 17
    v_mfma_f32_16x16x32_bf16 v[144:147], a[204:207], a[164:167], v[144:147]
    ds_read_b64_tr_b16 a[222:223], v11 offset:25600
    s_lshl_b32 s71, s17, 15
    v_mfma_f32_16x16x32_bf16 v[144:147], a[200:203], a[160:163], v[144:147]
    s_add_u32 s70, s70, s71
    s_waitcnt lgkmcnt(4)
    v_mfma_f32_16x16x32_bf16 v[64:67], a[208:211], a[128:131], v[64:67]
    ds_read_b64_tr_b16 a[192:193], v10 offset:4096
    s_add_u32 s70, s70, s8
    v_mfma_f32_16x16x32_bf16 v[64:67], a[212:215], a[132:135], v[64:67]
    s_sub_u32 s71, 4194304, s70
    v_mfma_f32_16x16x32_bf16 v[68:71], a[212:215], a[140:143], v[68:71]
    ds_read_b64_tr_b16 a[194:195], v10 offset:24576
    v_mfma_f32_16x16x32_bf16 v[68:71], a[208:211], a[136:139], v[68:71]
    s_add_u32 s28, s4, s70
    s_addc_u32 s29, s5, 0
    s_mov_b32 s30, s71
    s_mov_b32 s31, 0x20000
    v_mfma_f32_16x16x32_bf16 v[72:75], a[208:211], a[144:147], v[72:75]
    ds_read_b64_tr_b16 a[196:197], v10 offset:5120
    v_mfma_f32_16x16x32_bf16 v[72:75], a[212:215], a[148:151], v[72:75]
    buffer_load_dword v0, v23, s[36:39], s72 offen offset:2048
    v_mfma_f32_16x16x32_bf16 v[76:79], a[212:215], a[156:159], v[76:79]
    ds_read_b64_tr_b16 a[198:199], v10 offset:25600
    v_mfma_f32_16x16x32_bf16 v[76:79], a[208:211], a[152:155], v[76:79]
    s_waitcnt lgkmcnt(4)
    v_mfma_f32_16x16x32_bf16 v[76:79], a[216:219], a[184:187], v[76:79]
    ds_read_b64_tr_b16 a[200:201], v12 offset:4096
    v_mfma_f32_16x16x32_bf16 v[76:79], a[220:223], a[188:191], v[76:79]
    s_add_u32 s32, s98, s70
    s_addc_u32 s33, s99, 0
    s_mov_b32 s34, s71
    s_mov_b32 s35, 0x20000
    v_mfma_f32_16x16x32_bf16 v[72:75], a[220:223], a[180:183], v[72:75]
    ds_read_b64_tr_b16 a[202:203], v12 offset:24576
    s_xor_b32 s70, s17, 1
    v_mfma_f32_16x16x32_bf16 v[72:75], a[216:219], a[176:179], v[72:75]
    s_lshl_b32 s40, s70, 16
    s_lshl_b32 s71, s17, 14
    v_mfma_f32_16x16x32_bf16 v[68:71], a[216:219], a[168:171], v[68:71]
    ds_read_b64_tr_b16 a[204:205], v12 offset:5120
    s_add_u32 s40, s40, s71
    v_mfma_f32_16x16x32_bf16 v[68:71], a[220:223], a[172:175], v[68:71]
    s_lshl_b32 s60, s70, 14
    s_lshl_b32 s71, s17, 16
    v_mfma_f32_16x16x32_bf16 v[64:67], a[220:223], a[164:167], v[64:67]
    ds_read_b64_tr_b16 a[206:207], v12 offset:25600
    s_add_u32 s60, s60, s71
    v_mfma_f32_16x16x32_bf16 v[64:67], a[216:219], a[160:163], v[64:67]
    s_waitcnt vmcnt(19) lgkmcnt(4)
    s_barrier
    v_mfma_f32_16x16x32_bf16 v[80:83], a[192:195], a[128:131], v[80:83]
    ds_read_b64_tr_b16 a[208:209], v13 offset:6144
    s_xor_b32 s70, s17, 2
    v_mfma_f32_16x16x32_bf16 v[80:83], a[196:199], a[132:135], v[80:83]
    s_lshl_b32 s41, s70, 16
    s_lshl_b32 s71, s17, 14
    v_mfma_f32_16x16x32_bf16 v[84:87], a[196:199], a[140:143], v[84:87]
    ds_read_b64_tr_b16 a[210:211], v13 offset:26624
    s_add_u32 s41, s41, s71
    v_mfma_f32_16x16x32_bf16 v[84:87], a[192:195], a[136:139], v[84:87]
    s_lshl_b32 s61, s70, 14
    s_lshl_b32 s71, s17, 16
    v_mfma_f32_16x16x32_bf16 v[88:91], a[192:195], a[144:147], v[88:91]
    ds_read_b64_tr_b16 a[212:213], v13 offset:7168
    s_add_u32 s61, s61, s71
    v_mfma_f32_16x16x32_bf16 v[88:91], a[196:199], a[148:151], v[88:91]
    s_xor_b32 s70, s17, 3
    s_lshl_b32 s42, s70, 16
    v_mfma_f32_16x16x32_bf16 v[92:95], a[196:199], a[156:159], v[92:95]
    ds_read_b64_tr_b16 a[214:215], v13 offset:27648
    s_lshl_b32 s71, s17, 14
    v_mfma_f32_16x16x32_bf16 v[92:95], a[192:195], a[152:155], v[92:95]
    s_add_u32 s42, s42, s71
    s_waitcnt lgkmcnt(4)
    v_mfma_f32_16x16x32_bf16 v[92:95], a[200:203], a[184:187], v[92:95]
    ds_read_b64_tr_b16 a[216:217], v14 offset:6144
    s_lshl_b32 s62, s70, 14
    v_mfma_f32_16x16x32_bf16 v[92:95], a[204:207], a[188:191], v[92:95]
    s_lshl_b32 s71, s17, 16
    s_add_u32 s62, s62, s71
    v_mfma_f32_16x16x32_bf16 v[88:91], a[204:207], a[180:183], v[88:91]
    ds_read_b64_tr_b16 a[218:219], v14 offset:26624
    s_lshl_b32 s63, s17, 2
    v_mfma_f32_16x16x32_bf16 v[88:91], a[200:203], a[176:179], v[88:91]
    v_mfma_f32_16x16x32_bf16 v[84:87], a[200:203], a[168:171], v[84:87]
    ds_read_b64_tr_b16 a[220:221], v14 offset:7168
    v_mfma_f32_16x16x32_bf16 v[84:87], a[204:207], a[172:175], v[84:87]
    v_mfma_f32_16x16x32_bf16 v[80:83], a[204:207], a[164:167], v[80:83]
    ds_read_b64_tr_b16 a[222:223], v14 offset:27648
    v_mfma_f32_16x16x32_bf16 v[80:83], a[200:203], a[160:163], v[80:83]
    s_waitcnt vmcnt(3) lgkmcnt(4)
    v_mfma_f32_16x16x32_bf16 v[128:131], a[208:211], a[96:99], v[128:131]
    ds_read_b64_tr_b16 a[192:193], v13 offset:4096
    s_lshl_b32 s96, s15, 13
    v_mfma_f32_16x16x32_bf16 v[128:131], a[212:215], a[100:103], v[128:131]
    s_add_u32 s96, s96, 458752
    s_mov_b32 s97, 0x358637bd
    v_mfma_f32_16x16x32_bf16 v[132:135], a[212:215], a[108:111], v[132:135]
    ds_read_b64_tr_b16 a[194:195], v13 offset:24576
    v_lshlrev_b32 v30, 7, v1
    v_mfma_f32_16x16x32_bf16 v[132:135], a[208:211], a[104:107], v[132:135]
    v_mfma_f32_16x16x32_bf16 v[136:139], a[208:211], a[112:115], v[136:139]
    ds_read_b64_tr_b16 a[196:197], v13 offset:5120
    v_mfma_f32_16x16x32_bf16 v[136:139], a[212:215], a[116:119], v[136:139]
    v_mfma_f32_16x16x32_bf16 v[140:143], a[212:215], a[124:127], v[140:143]
    ds_read_b64_tr_b16 a[198:199], v13 offset:25600
    v_mfma_f32_16x16x32_bf16 v[140:143], a[208:211], a[120:123], v[140:143]
    s_waitcnt lgkmcnt(4)
    v_mfma_f32_16x16x32_bf16 v[156:159], a[216:219], a[120:123], v[156:159]
    ds_read_b64_tr_b16 a[200:201], v14 offset:4096
    v_mfma_f32_16x16x32_bf16 v[156:159], a[220:223], a[124:127], v[156:159]
    v_mfma_f32_16x16x32_bf16 v[152:155], a[220:223], a[116:119], v[152:155]
    ds_read_b64_tr_b16 a[202:203], v14 offset:24576
    v_mfma_f32_16x16x32_bf16 v[152:155], a[216:219], a[112:115], v[152:155]
    v_mfma_f32_16x16x32_bf16 v[148:151], a[216:219], a[104:107], v[148:151]
    ds_read_b64_tr_b16 a[204:205], v14 offset:5120
    v_mfma_f32_16x16x32_bf16 v[148:151], a[220:223], a[108:111], v[148:151]
    v_mfma_f32_16x16x32_bf16 v[144:147], a[220:223], a[100:103], v[144:147]
    ds_read_b64_tr_b16 a[206:207], v14 offset:25600
    v_mfma_f32_16x16x32_bf16 v[144:147], a[216:219], a[96:99], v[144:147]
    s_waitcnt lgkmcnt(4)
    v_mfma_f32_16x16x32_bf16 v[64:67], a[192:195], a[96:99], v[64:67]
    ds_read_b64_tr_b16 a[208:209], v9 offset:6656
    v_mfma_f32_16x16x32_bf16 v[64:67], a[196:199], a[100:103], v[64:67]
    v_mfma_f32_16x16x32_bf16 v[68:71], a[196:199], a[108:111], v[68:71]
    ds_read_b64_tr_b16 a[210:211], v9 offset:27136
    v_mfma_f32_16x16x32_bf16 v[68:71], a[192:195], a[104:107], v[68:71]
    v_mfma_f32_16x16x32_bf16 v[72:75], a[192:195], a[112:115], v[72:75]
    ds_read_b64_tr_b16 a[212:213], v9 offset:7680
    v_mfma_f32_16x16x32_bf16 v[72:75], a[196:199], a[116:119], v[72:75]
    v_mfma_f32_16x16x32_bf16 v[76:79], a[196:199], a[124:127], v[76:79]
    ds_read_b64_tr_b16 a[214:215], v9 offset:28160
    v_mfma_f32_16x16x32_bf16 v[76:79], a[192:195], a[120:123], v[76:79]
    s_waitcnt lgkmcnt(4)
    v_mfma_f32_16x16x32_bf16 v[92:95], a[200:203], a[120:123], v[92:95]
    ds_read_b64_tr_b16 a[216:217], v11 offset:6656
    v_mfma_f32_16x16x32_bf16 v[92:95], a[204:207], a[124:127], v[92:95]
    v_mfma_f32_16x16x32_bf16 v[88:91], a[204:207], a[116:119], v[88:91]
    ds_read_b64_tr_b16 a[218:219], v11 offset:27136
    v_mfma_f32_16x16x32_bf16 v[88:91], a[200:203], a[112:115], v[88:91]
    v_mfma_f32_16x16x32_bf16 v[84:87], a[200:203], a[104:107], v[84:87]
    ds_read_b64_tr_b16 a[220:221], v11 offset:7680
    v_mfma_f32_16x16x32_bf16 v[84:87], a[204:207], a[108:111], v[84:87]
    v_mfma_f32_16x16x32_bf16 v[80:83], a[204:207], a[100:103], v[80:83]
    ds_read_b64_tr_b16 a[222:223], v11 offset:28160
    v_mfma_f32_16x16x32_bf16 v[80:83], a[200:203], a[96:99], v[80:83]
    s_waitcnt lgkmcnt(4)
    v_mfma_f32_16x16x32_bf16 v[160:163], a[208:211], a[128:131], v[160:163]
    ds_read_b64_tr_b16 a[192:193], v13 offset:6656
    v_mfma_f32_16x16x32_bf16 v[160:163], a[212:215], a[132:135], v[160:163]
    v_mul_f32 v64, s76, v64
    v_mul_f32 v65, s76, v65
    v_mfma_f32_16x16x32_bf16 v[164:167], a[212:215], a[140:143], v[164:167]
    ds_read_b64_tr_b16 a[194:195], v13 offset:27136
    v_mul_f32 v66, s76, v66
    v_mfma_f32_16x16x32_bf16 v[164:167], a[208:211], a[136:139], v[164:167]
    v_exp_f32 v64, v64
    v_mfma_f32_16x16x32_bf16 v[168:171], a[208:211], a[144:147], v[168:171]
    ds_read_b64_tr_b16 a[196:197], v13 offset:7680
    v_mul_f32 v67, s76, v67
    v_mfma_f32_16x16x32_bf16 v[168:171], a[212:215], a[148:151], v[168:171]
    v_exp_f32 v65, v65
    v_mfma_f32_16x16x32_bf16 v[172:175], a[212:215], a[156:159], v[172:175]
    ds_read_b64_tr_b16 a[198:199], v13 offset:28160
    v_mul_f32 v80, s76, v80
    v_mfma_f32_16x16x32_bf16 v[172:175], a[208:211], a[152:155], v[172:175]
    v_mul_f32 v81, s76, v81
    s_waitcnt lgkmcnt(4)
    v_mfma_f32_16x16x32_bf16 v[172:175], a[216:219], a[184:187], v[172:175]
    ds_read_b64_tr_b16 a[200:201], v10 offset:6656
    v_mul_f32 v82, s76, v82
    v_mfma_f32_16x16x32_bf16 v[172:175], a[220:223], a[188:191], v[172:175]
    v_exp_f32 v66, v66
    v_mfma_f32_16x16x32_bf16 v[168:171], a[220:223], a[180:183], v[168:171]
    ds_read_b64_tr_b16 a[202:203], v10 offset:27136
    v_mul_f32 v83, s76, v83
    v_mfma_f32_16x16x32_bf16 v[168:171], a[216:219], a[176:179], v[168:171]
    v_exp_f32 v67, v67
    v_mfma_f32_16x16x32_bf16 v[164:167], a[216:219], a[168:171], v[164:167]
    ds_read_b64_tr_b16 a[204:205], v10 offset:7680
    v_add_f32 v64, 1.0, v64
    v_mfma_f32_16x16x32_bf16 v[164:167], a[220:223], a[172:175], v[164:167]
    v_exp_f32 v80, v80
    v_mfma_f32_16x16x32_bf16 v[160:163], a[220:223], a[164:167], v[160:163]
    ds_read_b64_tr_b16 a[206:207], v10 offset:28160
    v_add_f32 v65, 1.0, v65
    v_mfma_f32_16x16x32_bf16 v[160:163], a[216:219], a[160:163], v[160:163]
    v_add_f32 v66, 1.0, v66
    s_waitcnt lgkmcnt(4)
    v_mfma_f32_16x16x32_bf16 v[160:163], a[192:195], a[96:99], v[160:163]
    ds_read_b64_tr_b16 a[208:209], v12 offset:6656
    v_add_f32 v67, 1.0, v67
    v_mfma_f32_16x16x32_bf16 v[160:163], a[196:199], a[100:103], v[160:163]
    v_exp_f32 v81, v81
    v_mfma_f32_16x16x32_bf16 v[164:167], a[196:199], a[108:111], v[164:167]
    ds_read_b64_tr_b16 a[210:211], v12 offset:27136
    v_add_f32 v80, 1.0, v80
    v_mfma_f32_16x16x32_bf16 v[164:167], a[192:195], a[104:107], v[164:167]
    v_exp_f32 v82, v82
    v_mfma_f32_16x16x32_bf16 v[168:171], a[192:195], a[112:115], v[168:171]
    ds_read_b64_tr_b16 a[212:213], v12 offset:7680
    v_add_f32 v81, 1.0, v81
    v_mfma_f32_16x16x32_bf16 v[168:171], a[196:199], a[116:119], v[168:171]
    v_exp_f32 v83, v83
    v_mfma_f32_16x16x32_bf16 v[172:175], a[196:199], a[124:127], v[172:175]
    ds_read_b64_tr_b16 a[214:215], v12 offset:28160
    v_add_f32 v82, 1.0, v82
    v_mfma_f32_16x16x32_bf16 v[172:175], a[192:195], a[120:123], v[172:175]
    v_add_f32 v83, 1.0, v83
    s_waitcnt lgkmcnt(4)
    v_mfma_f32_16x16x32_bf16 v[188:191], a[200:203], a[152:155], v[188:191]
    ds_read_b64_tr_b16 a[216:217], v14 offset:6656
    v_mul_f32 v68, s76, v68
    v_mfma_f32_16x16x32_bf16 v[188:191], a[204:207], a[156:159], v[188:191]
    v_rcp_f32 v64, v64
    v_mfma_f32_16x16x32_bf16 v[184:187], a[204:207], a[148:151], v[184:187]
    ds_read_b64_tr_b16 a[218:219], v14 offset:27136
    v_mul_f32 v69, s76, v69
    v_mfma_f32_16x16x32_bf16 v[184:187], a[200:203], a[144:147], v[184:187]
    v_rcp_f32 v65, v65
    v_mfma_f32_16x16x32_bf16 v[180:183], a[200:203], a[136:139], v[180:183]
    ds_read_b64_tr_b16 a[220:221], v14 offset:7680
    v_mul_f32 v64, v64, v128
    v_mfma_f32_16x16x32_bf16 v[180:183], a[204:207], a[140:143], v[180:183]
    v_rcp_f32 v66, v66
    v_mfma_f32_16x16x32_bf16 v[176:179], a[204:207], a[132:135], v[176:179]
    ds_read_b64_tr_b16 a[222:223], v14 offset:28160
    v_mul_f32 v65, v65, v129
    v_mfma_f32_16x16x32_bf16 v[176:179], a[200:203], a[128:131], v[176:179]
    v_cvt_pk_bf16_f32 v128, v64, v65
    s_waitcnt lgkmcnt(4)
    v_mfma_f32_16x16x32_bf16 v[176:179], a[208:211], a[160:163], v[176:179]
    ds_read_b64_tr_b16 a[192:193], v9 offset:4608
    v_mul_f32 v70, s76, v70
    v_mfma_f32_16x16x32_bf16 v[176:179], a[212:215], a[164:167], v[176:179]
    v_rcp_f32 v67, v67
    v_mfma_f32_16x16x32_bf16 v[180:183], a[212:215], a[172:175], v[180:183]
    ds_read_b64_tr_b16 a[194:195], v9 offset:25088
    v_mul_f32 v66, v66, v130
    v_mfma_f32_16x16x32_bf16 v[180:183], a[208:211], a[168:171], v[180:183]
    v_rcp_f32 v80, v80
    v_mfma_f32_16x16x32_bf16 v[184:187], a[208:211], a[176:179], v[184:187]
    ds_read_b64_tr_b16 a[196:197], v9 offset:5632
    v_mul_f32 v67, v67, v131
    v_mfma_f32_16x16x32_bf16 v[184:187], a[212:215], a[180:183], v[184:187]
    v_rcp_f32 v81, v81
    v_mfma_f32_16x16x32_bf16 v[188:191], a[212:215], a[188:191], v[188:191]
    ds_read_b64_tr_b16 a[198:199], v9 offset:26112
    v_mul_f32 v80, v80, v144
    v_mfma_f32_16x16x32_bf16 v[188:191], a[208:211], a[184:187], v[188:191]
    v_mul_f32 v81, v81, v145
    s_waitcnt lgkmcnt(4)
    v_mfma_f32_16x16x32_bf16 v[188:191], a[216:219], a[120:123], v[188:191]
    ds_read_b64_tr_b16 a[200:201], v11 offset:4608
    v_cvt_pk_bf16_f32 v129, v66, v67
    v_mfma_f32_16x16x32_bf16 v[188:191], a[220:223], a[124:127], v[188:191]
    v_rcp_f32 v82, v82
    v_mfma_f32_16x16x32_bf16 v[184:187], a[220:223], a[116:119], v[184:187]
    ds_read_b64_tr_b16 a[202:203], v11 offset:25088
    v_cvt_pk_bf16_f32 v130, v80, v81
    v_mfma_f32_16x16x32_bf16 v[184:187], a[216:219], a[112:115], v[184:187]
    v_rcp_f32 v83, v83
    v_mfma_f32_16x16x32_bf16 v[180:183], a[216:219], a[104:107], v[180:183]
    ds_read_b64_tr_b16 a[204:205], v11 offset:5632
    v_mul_f32 v82, v82, v146
    v_mfma_f32_16x16x32_bf16 v[180:183], a[220:223], a[108:111], v[180:183]
    v_exp_f32 v68, v68
    v_mfma_f32_16x16x32_bf16 v[176:179], a[220:223], a[100:103], v[176:179]
    ds_read_b64_tr_b16 a[206:207], v11 offset:26112
    v_mul_f32 v83, v83, v147
    v_mfma_f32_16x16x32_bf16 v[176:179], a[216:219], a[96:99], v[176:179]
    v_cvt_pk_bf16_f32 v131, v82, v83
    s_waitcnt lgkmcnt(4)
    v_mfma_f32_16x16x32_bf16 v[96:99], a[192:195], a[128:131], v[96:99]
    ds_read_b64_tr_b16 a[208:209], v13 offset:4608
    v_mul_f32 v71, s76, v71
    v_mfma_f32_16x16x32_bf16 v[96:99], a[196:199], a[132:135], v[96:99]
    buffer_store_dwordx4 v[128:131], v3, s[44:47], s78 offen offset:0 sc1
    v_mfma_f32_16x16x32_bf16 v[100:103], a[196:199], a[140:143], v[100:103]
    ds_read_b64_tr_b16 a[210:211], v13 offset:25088
    v_mul_f32 v84, s76, v84
    v_mfma_f32_16x16x32_bf16 v[100:103], a[192:195], a[136:139], v[100:103]
    v_exp_f32 v69, v69
    v_mfma_f32_16x16x32_bf16 v[104:107], a[192:195], a[144:147], v[104:107]
    ds_read_b64_tr_b16 a[212:213], v13 offset:5632
    v_mul_f32 v85, s76, v85
    v_mfma_f32_16x16x32_bf16 v[104:107], a[196:199], a[148:151], v[104:107]
    v_exp_f32 v70, v70
    v_mfma_f32_16x16x32_bf16 v[108:111], a[196:199], a[156:159], v[108:111]
    ds_read_b64_tr_b16 a[214:215], v13 offset:26112
    v_mul_f32 v86, s76, v86
    v_mfma_f32_16x16x32_bf16 v[108:111], a[192:195], a[152:155], v[108:111]
    v_mul_f32 v87, s76, v87
    s_waitcnt lgkmcnt(4)
    v_mfma_f32_16x16x32_bf16 v[108:111], a[200:203], a[184:187], v[108:111]
    ds_read_b64_tr_b16 a[216:217], v10 offset:4608
    v_add_f32 v68, 1.0, v68
    v_mfma_f32_16x16x32_bf16 v[108:111], a[204:207], a[188:191], v[108:111]
    v_exp_f32 v71, v71
    v_mfma_f32_16x16x32_bf16 v[104:107], a[204:207], a[180:183], v[104:107]
    ds_read_b64_tr_b16 a[218:219], v10 offset:25088
    v_add_f32 v69, 1.0, v69
    v_mfma_f32_16x16x32_bf16 v[104:107], a[200:203], a[176:179], v[104:107]
    v_exp_f32 v84, v84
    v_mfma_f32_16x16x32_bf16 v[100:103], a[200:203], a[168:171], v[100:103]
    ds_read_b64_tr_b16 a[220:221], v10 offset:5632
    v_add_f32 v70, 1.0, v70
    v_mfma_f32_16x16x32_bf16 v[100:103], a[204:207], a[172:175], v[100:103]
    v_exp_f32 v85, v85
    v_mfma_f32_16x16x32_bf16 v[96:99], a[204:207], a[164:167], v[96:99]
    ds_read_b64_tr_b16 a[222:223], v10 offset:26112
    v_add_f32 v71, 1.0, v71
    v_mfma_f32_16x16x32_bf16 v[96:99], a[200:203], a[160:163], v[96:99]
    v_add_f32 v84, 1.0, v84
    s_waitcnt lgkmcnt(4)
    v_mfma_f32_16x16x32_bf16 v[96:99], a[208:211], a[96:99], v[96:99]
    ds_read_b64_tr_b16 a[192:193], v12 offset:4608
    v_add_f32 v85, 1.0, v85
    v_mfma_f32_16x16x32_bf16 v[96:99], a[212:215], a[100:103], v[96:99]
    v_exp_f32 v86, v86
    v_mfma_f32_16x16x32_bf16 v[100:103], a[212:215], a[108:111], v[100:103]
    ds_read_b64_tr_b16 a[194:195], v12 offset:25088
    v_mul_f32 v72, s76, v72
    v_mfma_f32_16x16x32_bf16 v[100:103], a[208:211], a[104:107], v[100:103]
    v_exp_f32 v87, v87
    v_mfma_f32_16x16x32_bf16 v[104:107], a[208:211], a[112:115], v[104:107]
    ds_read_b64_tr_b16 a[196:197], v12 offset:5632
    v_add_f32 v86, 1.0, v86
    v_mfma_f32_16x16x32_bf16 v[104:107], a[212:215], a[116:119], v[104:107]
    v_rcp_f32 v68, v68
    v_mfma_f32_16x16x32_bf16 v[108:111], a[212:215], a[124:127], v[108:111]
    ds_read_b64_tr_b16 a[198:199], v12 offset:26112
    v_add_f32 v87, 1.0, v87
    v_mfma_f32_16x16x32_bf16 v[108:111], a[208:211], a[120:123], v[108:111]
    v_mul_f32 v73, s76, v73
    s_waitcnt lgkmcnt(4)
    v_mfma_f32_16x16x32_bf16 v[124:127], a[216:219], a[152:155], v[124:127]
    ds_read_b64_tr_b16 a[200:201], v14 offset:4608
    v_mul_f32 v74, s76, v74
    v_mfma_f32_16x16x32_bf16 v[124:127], a[220:223], a[156:159], v[124:127]
    v_rcp_f32 v69, v69
    v_mfma_f32_16x16x32_bf16 v[120:123], a[220:223], a[148:151], v[120:123]
    ds_read_b64_tr_b16 a[202:203], v14 offset:25088
    v_mul_f32 v68, v68, v132
    v_mfma_f32_16x16x32_bf16 v[120:123], a[216:219], a[144:147], v[120:123]
    v_rcp_f32 v70, v70
    v_mfma_f32_16x16x32_bf16 v[116:119], a[216:219], a[136:139], v[116:119]
    ds_read_b64_tr_b16 a[204:205], v14 offset:5632
    v_mul_f32 v69, v69, v133
    v_mfma_f32_16x16x32_bf16 v[116:119], a[220:223], a[140:143], v[116:119]
    v_rcp_f32 v71, v71
    v_mfma_f32_16x16x32_bf16 v[112:115], a[220:223], a[132:135], v[112:115]
    ds_read_b64_tr_b16 a[206:207], v14 offset:26112
    v_mul_f32 v70, v70, v134
    v_mfma_f32_16x16x32_bf16 v[112:115], a[216:219], a[128:131], v[112:115]
    v_mul_f32 v71, v71, v135
    s_waitcnt lgkmcnt(4)
    v_mfma_f32_16x16x32_bf16 v[112:115], a[192:195], a[160:163], v[112:115]
    ds_read_b64_tr_b16 a[208:209], v11 offset:0
    v_cvt_pk_bf16_f32 v132, v68, v69
    v_mfma_f32_16x16x32_bf16 v[112:115], a[196:199], a[164:167], v[112:115]
    v_rcp_f32 v84, v84
    v_mfma_f32_16x16x32_bf16 v[116:119], a[196:199], a[172:175], v[116:119]
    ds_read_b64_tr_b16 a[210:211], v11 offset:20480
    v_cvt_pk_bf16_f32 v133, v70, v71
    v_mfma_f32_16x16x32_bf16 v[116:119], a[192:195], a[168:171], v[116:119]
    v_rcp_f32 v85, v85
    v_mfma_f32_16x16x32_bf16 v[120:123], a[192:195], a[176:179], v[120:123]
    ds_read_b64_tr_b16 a[212:213], v11 offset:1024
    v_mul_f32 v84, v84, v148
    v_mfma_f32_16x16x32_bf16 v[120:123], a[196:199], a[180:183], v[120:123]
    v_rcp_f32 v86, v86
    v_mfma_f32_16x16x32_bf16 v[124:127], a[196:199], a[188:191], v[124:127]
    ds_read_b64_tr_b16 a[214:215], v11 offset:21504
    v_mul_f32 v85, v85, v149
    v_mfma_f32_16x16x32_bf16 v[124:127], a[192:195], a[184:187], v[124:127]
    v_cvt_pk_bf16_f32 v134, v84, v85
    s_waitcnt lgkmcnt(4)
    v_mfma_f32_16x16x32_bf16 v[124:127], a[200:203], a[120:123], v[124:127]
    ds_read_b64_tr_b16 a[216:217], v12 offset:0
    v_mul_f32 v75, s76, v75
    v_mfma_f32_16x16x32_bf16 v[124:127], a[204:207], a[124:127], v[124:127]
    v_rcp_f32 v87, v87
    v_mfma_f32_16x16x32_bf16 v[120:123], a[204:207], a[116:119], v[120:123]
    ds_read_b64_tr_b16 a[218:219], v12 offset:20480
    v_mul_f32 v86, v86, v150
    v_mfma_f32_16x16x32_bf16 v[120:123], a[200:203], a[112:115], v[120:123]
    v_exp_f32 v72, v72
    v_mfma_f32_16x16x32_bf16 v[116:119], a[200:203], a[104:107], v[116:119]
    ds_read_b64_tr_b16 a[220:221], v12 offset:1024
    v_mul_f32 v87, v87, v151
    v_mfma_f32_16x16x32_bf16 v[116:119], a[204:207], a[108:111], v[116:119]
    v_exp_f32 v73, v73
    v_mfma_f32_16x16x32_bf16 v[112:115], a[204:207], a[100:103], v[112:115]
    ds_read_b64_tr_b16 a[222:223], v12 offset:21504
    v_cvt_pk_bf16_f32 v135, v86, v87
    v_mfma_f32_16x16x32_bf16 v[112:115], a[200:203], a[96:99], v[112:115]
    s_waitcnt vmcnt(14) lgkmcnt(4)
    s_barrier
    v_mfma_f32_16x16x32_bf16 v[32:35], a[208:211], a[160:163], v[32:35]
    ds_read_b64_tr_b16 a[192:193], v13 offset:0
    s_add_u32 m0, s19, 45056
    v_mfma_f32_16x16x32_bf16 v[32:35], a[212:215], a[164:167], v[32:35]
    s_lshl_b32 s11, s81, 4
    v_mul_f32 v88, s76, v88
    v_mfma_f32_16x16x32_bf16 v[36:39], a[212:215], a[172:175], v[36:39]
    ds_read_b64_tr_b16 a[194:195], v13 offset:20480
    v_mul_f32 v89, s76, v89
    v_mfma_f32_16x16x32_bf16 v[36:39], a[208:211], a[168:171], v[36:39]
    buffer_load_dwordx4 v17, s[56:59], s11 offen offset:0 lds
    v_mul_f32 v90, s76, v90
    v_mfma_f32_16x16x32_bf16 v[40:43], a[208:211], a[176:179], v[40:43]
    ds_read_b64_tr_b16 a[196:197], v13 offset:1024
    v_mul_f32 v91, s76, v91
    v_mfma_f32_16x16x32_bf16 v[40:43], a[212:215], a[180:183], v[40:43]
    buffer_store_dwordx4 v[132:135], v4, s[44:47], s78 offen offset:0 sc1
    v_mfma_f32_16x16x32_bf16 v[44:47], a[212:215], a[188:191], v[44:47]
    ds_read_b64_tr_b16 a[198:199], v13 offset:21504
    v_add_f32 v72, 1.0, v72
    v_mfma_f32_16x16x32_bf16 v[44:47], a[208:211], a[184:187], v[44:47]
    v_add_f32 v73, 1.0, v73
    s_waitcnt lgkmcnt(4)
    v_mfma_f32_16x16x32_bf16 v[60:63], a[216:219], a[184:187], v[60:63]
    ds_read_b64_tr_b16 a[200:201], v14 offset:0
    v_mul_f32 v76, s76, v76
    v_mfma_f32_16x16x32_bf16 v[60:63], a[220:223], a[188:191], v[60:63]
    v_exp_f32 v74, v74
    v_mfma_f32_16x16x32_bf16 v[56:59], a[220:223], a[180:183], v[56:59]
    ds_read_b64_tr_b16 a[202:203], v14 offset:20480
    v_mul_f32 v77, s76, v77
    v_mfma_f32_16x16x32_bf16 v[56:59], a[216:219], a[176:179], v[56:59]
    buffer_load_dwordx4 v18, s[56:59], s11 offen offset:1024 lds
    v_mul_f32 v78, s76, v78
    v_mfma_f32_16x16x32_bf16 v[52:55], a[216:219], a[168:171], v[52:55]
    ds_read_b64_tr_b16 a[204:205], v14 offset:1024
    v_mul_f32 v79, s76, v79
    v_mfma_f32_16x16x32_bf16 v[52:55], a[220:223], a[172:175], v[52:55]
    v_exp_f32 v75, v75
    v_mfma_f32_16x16x32_bf16 v[48:51], a[220:223], a[164:167], v[48:51]
    ds_read_b64_tr_b16 a[206:207], v14 offset:21504
    v_add_f32 v74, 1.0, v74
    v_mfma_f32_16x16x32_bf16 v[48:51], a[216:219], a[160:163], v[48:51]
    v_add_f32 v75, 1.0, v75
    s_waitcnt lgkmcnt(4)
    v_mfma_f32_16x16x32_bf16 v[32:35], a[192:195], a[96:99], v[32:35]
    ds_read_b64_tr_b16 a[208:209], v9 offset:2048
    v_mul_f32 v92, s76, v92
    v_mfma_f32_16x16x32_bf16 v[32:35], a[196:199], a[100:103], v[32:35]
    v_exp_f32 v88, v88
    v_mfma_f32_16x16x32_bf16 v[36:39], a[196:199], a[108:111], v[36:39]
    ds_read_b64_tr_b16 a[210:211], v9 offset:22528
    v_mul_f32 v93, s76, v93
    v_mfma_f32_16x16x32_bf16 v[36:39], a[192:195], a[104:107], v[36:39]
    buffer_load_dwordx4 v19, s[56:59], s11 offen offset:2048 lds
    v_mul_f32 v94, s76, v94
    v_mfma_f32_16x16x32_bf16 v[40:43], a[192:195], a[112:115], v[40:43]
    ds_read_b64_tr_b16 a[212:213], v9 offset:3072
    v_mul_f32 v95, s76, v95
    v_mfma_f32_16x16x32_bf16 v[40:43], a[196:199], a[116:119], v[40:43]
    v_exp_f32 v89, v89
    v_mfma_f32_16x16x32_bf16 v[44:47], a[196:199], a[124:127], v[44:47]
    ds_read_b64_tr_b16 a[214:215], v9 offset:23552
    v_add_f32 v88, 1.0, v88
    v_mfma_f32_16x16x32_bf16 v[44:47], a[192:195], a[120:123], v[44:47]
    v_add_f32 v89, 1.0, v89
    s_waitcnt lgkmcnt(4)
    v_mfma_f32_16x16x32_bf16 v[60:63], a[200:203], a[120:123], v[60:63]
    ds_read_b64_tr_b16 a[216:217], v11 offset:2048
    v_exp_f32 v90, v90
    v_mfma_f32_16x16x32_bf16 v[60:63], a[204:207], a[124:127], v[60:63]
    v_exp_f32 v91, v91
    v_mfma_f32_16x16x32_bf16 v[56:59], a[204:207], a[116:119], v[56:59]
    ds_read_b64_tr_b16 a[218:219], v11 offset:22528
    v_add_f32 v90, 1.0, v90
    v_mfma_f32_16x16x32_bf16 v[56:59], a[200:203], a[112:115], v[56:59]
    buffer_load_dwordx4 v20, s[56:59], s11 offen offset:3072 lds
    v_add_f32 v91, 1.0, v91
    v_mfma_f32_16x16x32_bf16 v[52:55], a[200:203], a[104:107], v[52:55]
    ds_read_b64_tr_b16 a[220:221], v11 offset:3072
    v_rcp_f32 v72, v72
    v_mfma_f32_16x16x32_bf16 v[52:55], a[204:207], a[108:111], v[52:55]
    v_rcp_f32 v73, v73
    v_mfma_f32_16x16x32_bf16 v[48:51], a[204:207], a[100:103], v[48:51]
    ds_read_b64_tr_b16 a[222:223], v11 offset:23552
    v_mul_f32 v72, v72, v136
    v_mfma_f32_16x16x32_bf16 v[48:51], a[200:203], a[96:99], v[48:51]
    v_mul_f32 v73, v73, v137
    s_waitcnt lgkmcnt(4)
    v_mfma_f32_16x16x32_bf16 a[32:35], a[208:211], a[128:131], a[32:35]
    ds_read_b64_tr_b16 a[192:193], v13 offset:2048
    v_cvt_pk_bf16_f32 v136, v72, v73
    v_mfma_f32_16x16x32_bf16 a[32:35], a[212:215], a[132:135], a[32:35]
    v_rcp_f32 v74, v74
    v_mfma_f32_16x16x32_bf16 a[36:39], a[212:215], a[140:143], a[36:39]
    ds_read_b64_tr_b16 a[194:195], v13 offset:22528
    s_add_u32 m0, s19, 86016
    v_mfma_f32_16x16x32_bf16 a[36:39], a[208:211], a[136:139], a[36:39]
    s_lshl_b32 s11, s80, 4
    v_rcp_f32 v75, v75
    v_mfma_f32_16x16x32_bf16 a[40:43], a[208:211], a[144:147], a[40:43]
    ds_read_b64_tr_b16 a[196:197], v13 offset:3072
    v_mul_f32 v74, v74, v138
    v_mfma_f32_16x16x32_bf16 a[40:43], a[212:215], a[148:151], a[40:43]
    buffer_load_dwordx4 v17, s[56:59], s11 offen offset:0 lds
    v_mul_f32 v75, v75, v139
    v_mfma_f32_16x16x32_bf16 a[44:47], a[212:215], a[156:159], a[44:47]
    ds_read_b64_tr_b16 a[198:199], v13 offset:23552
    v_cvt_pk_bf16_f32 v137, v74, v75
    v_mfma_f32_16x16x32_bf16 a[44:47], a[208:211], a[152:155], a[44:47]
    v_rcp_f32 v88, v88
    s_waitcnt lgkmcnt(4)
    v_mfma_f32_16x16x32_bf16 a[44:47], a[216:219], a[184:187], a[44:47]
    ds_read_b64_tr_b16 a[200:201], v10 offset:2048
    v_rcp_f32 v89, v89
    v_mfma_f32_16x16x32_bf16 a[44:47], a[220:223], a[188:191], a[44:47]
    v_rcp_f32 v90, v90
    v_mfma_f32_16x16x32_bf16 a[40:43], a[220:223], a[180:183], a[40:43]
    ds_read_b64_tr_b16 a[202:203], v10 offset:22528
    v_mul_f32 v88, v88, v152
    v_mfma_f32_16x16x32_bf16 a[40:43], a[216:219], a[176:179], a[40:43]
    v_rcp_f32 v91, v91
    v_mfma_f32_16x16x32_bf16 a[36:39], a[216:219], a[168:171], a[36:39]
    ds_read_b64_tr_b16 a[204:205], v10 offset:3072
    v_mul_f32 v89, v89, v153
    v_mfma_f32_16x16x32_bf16 a[36:39], a[220:223], a[172:175], a[36:39]
    buffer_load_dwordx4 v18, s[56:59], s11 offen offset:1024 lds
    v_mul_f32 v90, v90, v154
    v_mfma_f32_16x16x32_bf16 a[32:35], a[220:223], a[164:167], a[32:35]
    ds_read_b64_tr_b16 a[206:207], v10 offset:23552
    v_mul_f32 v91, v91, v155
    v_mfma_f32_16x16x32_bf16 a[32:35], a[216:219], a[160:163], a[32:35]
    v_cvt_pk_bf16_f32 v138, v88, v89
    s_waitcnt lgkmcnt(4)
    v_mfma_f32_16x16x32_bf16 a[32:35], a[192:195], a[96:99], a[32:35]
    ds_read_b64_tr_b16 a[208:209], v12 offset:2048
    v_cvt_pk_bf16_f32 v139, v90, v91
    v_mfma_f32_16x16x32_bf16 a[32:35], a[196:199], a[100:103], a[32:35]
    buffer_store_dwordx4 v[136:139], v5, s[44:47], s78 offen offset:0 sc1
    v_mfma_f32_16x16x32_bf16 a[36:39], a[196:199], a[108:111], a[36:39]
    ds_read_b64_tr_b16 a[210:211], v12 offset:22528
    v_exp_f32 v76, v76
    v_mfma_f32_16x16x32_bf16 a[36:39], a[192:195], a[104:107], a[36:39]
    v_exp_f32 v77, v77
    v_mfma_f32_16x16x32_bf16 a[40:43], a[192:195], a[112:115], a[40:43]
    ds_read_b64_tr_b16 a[212:213], v12 offset:3072
    v_add_f32 v76, 1.0, v76
    v_mfma_f32_16x16x32_bf16 a[40:43], a[196:199], a[116:119], a[40:43]
    buffer_load_dwordx4 v19, s[56:59], s11 offen offset:2048 lds
    v_add_f32 v77, 1.0, v77
    v_mfma_f32_16x16x32_bf16 a[44:47], a[196:199], a[124:127], a[44:47]
    ds_read_b64_tr_b16 a[214:215], v12 offset:23552
    v_exp_f32 v78, v78
    v_mfma_f32_16x16x32_bf16 a[44:47], a[192:195], a[120:123], a[44:47]
    v_exp_f32 v79, v79
    s_waitcnt lgkmcnt(4)
    v_mfma_f32_16x16x32_bf16 a[60:63], a[200:203], a[152:155], a[60:63]
    ds_read_b64_tr_b16 a[216:217], v14 offset:2048
    v_add_f32 v78, 1.0, v78
    v_mfma_f32_16x16x32_bf16 a[60:63], a[204:207], a[156:159], a[60:63]
    v_exp_f32 v92, v92
    v_mfma_f32_16x16x32_bf16 a[56:59], a[204:207], a[148:151], a[56:59]
    ds_read_b64_tr_b16 a[218:219], v14 offset:22528
    v_add_f32 v79, 1.0, v79
    v_mfma_f32_16x16x32_bf16 a[56:59], a[200:203], a[144:147], a[56:59]
    v_exp_f32 v93, v93
    v_mfma_f32_16x16x32_bf16 a[52:55], a[200:203], a[136:139], a[52:55]
    ds_read_b64_tr_b16 a[220:221], v14 offset:3072
    v_add_f32 v92, 1.0, v92
    v_mfma_f32_16x16x32_bf16 a[52:55], a[204:207], a[140:143], a[52:55]
    buffer_load_dwordx4 v20, s[56:59], s11 offen offset:3072 lds
    v_add_f32 v93, 1.0, v93
    v_mfma_f32_16x16x32_bf16 a[48:51], a[204:207], a[132:135], a[48:51]
    ds_read_b64_tr_b16 a[222:223], v14 offset:23552
    v_exp_f32 v94, v94
    v_mfma_f32_16x16x32_bf16 a[48:51], a[200:203], a[128:131], a[48:51]
    v_exp_f32 v95, v95
    s_waitcnt lgkmcnt(4)
    v_mfma_f32_16x16x32_bf16 a[48:51], a[208:211], a[160:163], a[48:51]
    ds_read_b64_tr_b16 a[192:193], v9 offset:512
    v_add_f32 v94, 1.0, v94
    v_mfma_f32_16x16x32_bf16 a[48:51], a[212:215], a[164:167], a[48:51]
    v_rcp_f32 v76, v76
    v_mfma_f32_16x16x32_bf16 a[52:55], a[212:215], a[172:175], a[52:55]
    ds_read_b64_tr_b16 a[194:195], v9 offset:20992
    v_add_f32 v95, 1.0, v95
    v_mfma_f32_16x16x32_bf16 a[52:55], a[208:211], a[168:171], a[52:55]
    v_rcp_f32 v77, v77
    v_mfma_f32_16x16x32_bf16 a[56:59], a[208:211], a[176:179], a[56:59]
    ds_read_b64_tr_b16 a[196:197], v9 offset:1536
    s_add_u32 m0, s19, 126976
    v_mfma_f32_16x16x32_bf16 a[56:59], a[212:215], a[180:183], a[56:59]
    s_lshl_b32 s11, s83, 4
    v_mul_f32 v76, v76, v140
    v_mfma_f32_16x16x32_bf16 a[60:63], a[212:215], a[188:191], a[60:63]
    ds_read_b64_tr_b16 a[198:199], v9 offset:22016
    v_mul_f32 v77, v77, v141
    v_mfma_f32_16x16x32_bf16 a[60:63], a[208:211], a[184:187], a[60:63]
    v_cvt_pk_bf16_f32 v140, v76, v77
    s_waitcnt lgkmcnt(4)
    v_mfma_f32_16x16x32_bf16 a[60:63], a[216:219], a[120:123], a[60:63]
    ds_read_b64_tr_b16 a[200:201], v11 offset:512
    v_rcp_f32 v78, v78
    v_mfma_f32_16x16x32_bf16 a[60:63], a[220:223], a[124:127], a[60:63]
    buffer_load_dwordx4 v17, s[56:59], s11 offen offset:0 lds
    v_rcp_f32 v79, v79
    v_mfma_f32_16x16x32_bf16 a[56:59], a[220:223], a[116:119], a[56:59]
    ds_read_b64_tr_b16 a[202:203], v11 offset:20992
    v_mul_f32 v78, v78, v142
    v_mfma_f32_16x16x32_bf16 a[56:59], a[216:219], a[112:115], a[56:59]
    v_rcp_f32 v92, v92
    v_mfma_f32_16x16x32_bf16 a[52:55], a[216:219], a[104:107], a[52:55]
    ds_read_b64_tr_b16 a[204:205], v11 offset:1536
    v_mul_f32 v79, v79, v143
    v_mfma_f32_16x16x32_bf16 a[52:55], a[220:223], a[108:111], a[52:55]
    v_rcp_f32 v93, v93
    v_mfma_f32_16x16x32_bf16 a[48:51], a[220:223], a[100:103], a[48:51]
    ds_read_b64_tr_b16 a[206:207], v11 offset:22016
    v_mul_f32 v92, v92, v156
    v_mfma_f32_16x16x32_bf16 a[48:51], a[216:219], a[96:99], a[48:51]
    v_mul_f32 v93, v93, v157
    v_rcp_f32 v94, v94
    v_rcp_f32 v95, v95
    s_nop 0
    v_pk_mul_f32 v[94:95], v[94:95], v[158:159]
    v_cvt_pk_bf16_f32 v141, v78, v79
    v_cvt_pk_bf16_f32 v142, v92, v93
    v_cvt_pk_bf16_f32 v143, v94, v95
    buffer_store_dwordx4 v[140:143], v6, s[44:47], s78 offen offset:0 sc1
    v_pk_mul_f32 v[96:97], v[96:97], s[76:77] op_sel_hi:[1,0]
    v_pk_mul_f32 v[98:99], v[98:99], s[76:77] op_sel_hi:[1,0]
    v_pk_mul_f32 v[112:113], v[112:113], s[76:77] op_sel_hi:[1,0]
    v_pk_mul_f32 v[114:115], v[114:115], s[76:77] op_sel_hi:[1,0]
    v_exp_f32 v96, v96
    v_exp_f32 v97, v97
    v_exp_f32 v98, v98
    v_exp_f32 v99, v99
    v_exp_f32 v112, v112
    v_exp_f32 v113, v113
    buffer_load_dwordx4 v18, s[56:59], s11 offen offset:1024 lds
    v_exp_f32 v114, v114
    v_exp_f32 v115, v115
    v_pk_add_f32 v[96:97], v[96:97], 1.0 op_sel_hi:[1,0]
    v_pk_add_f32 v[98:99], v[98:99], 1.0 op_sel_hi:[1,0]
    v_pk_add_f32 v[112:113], v[112:113], 1.0 op_sel_hi:[1,0]
    v_pk_add_f32 v[114:115], v[114:115], 1.0 op_sel_hi:[1,0]
    v_rcp_f32 v96, v96
    v_rcp_f32 v97, v97
    v_rcp_f32 v98, v98
    v_rcp_f32 v99, v99
    v_rcp_f32 v112, v112
    v_rcp_f32 v113, v113
    v_rcp_f32 v114, v114
    v_rcp_f32 v115, v115
    v_pk_mul_f32 v[96:97], v[96:97], v[160:161]
    v_pk_mul_f32 v[98:99], v[98:99], v[162:163]
    buffer_load_dwordx4 v19, s[56:59], s11 offen offset:2048 lds
    v_pk_mul_f32 v[112:113], v[112:113], v[176:177]
    v_pk_mul_f32 v[114:115], v[114:115], v[178:179]
    v_cvt_pk_bf16_f32 v160, v96, v97
    v_cvt_pk_bf16_f32 v161, v98, v99
    v_cvt_pk_bf16_f32 v162, v112, v113
    v_cvt_pk_bf16_f32 v163, v114, v115
    buffer_store_dwordx4 v[160:163], v3, s[44:47], s78 offen offset:1024 sc1
    v_pk_mul_f32 v[100:101], v[100:101], s[76:77] op_sel_hi:[1,0]
    v_pk_mul_f32 v[102:103], v[102:103], s[76:77] op_sel_hi:[1,0]
    v_pk_mul_f32 v[116:117], v[116:117], s[76:77] op_sel_hi:[1,0]
    v_pk_mul_f32 v[118:119], v[118:119], s[76:77] op_sel_hi:[1,0]
    v_exp_f32 v100, v100
    v_exp_f32 v101, v101
    v_exp_f32 v102, v102
    v_exp_f32 v103, v103
    v_exp_f32 v116, v116
    v_exp_f32 v117, v117
    v_exp_f32 v118, v118
    buffer_load_dwordx4 v20, s[56:59], s11 offen offset:3072 lds
    v_exp_f32 v119, v119
    v_pk_add_f32 v[100:101], v[100:101], 1.0 op_sel_hi:[1,0]
    v_pk_add_f32 v[102:103], v[102:103], 1.0 op_sel_hi:[1,0]
    v_pk_add_f32 v[116:117], v[116:117], 1.0 op_sel_hi:[1,0]
    v_pk_add_f32 v[118:119], v[118:119], 1.0 op_sel_hi:[1,0]
    v_rcp_f32 v100, v100
    v_rcp_f32 v101, v101
    v_rcp_f32 v102, v102
    v_rcp_f32 v103, v103
    v_rcp_f32 v116, v116
    v_rcp_f32 v117, v117
    v_rcp_f32 v118, v118
    v_rcp_f32 v119, v119
    v_pk_mul_f32 v[100:101], v[100:101], v[164:165]
    v_pk_mul_f32 v[102:103], v[102:103], v[166:167]
    v_pk_mul_f32 v[116:117], v[116:117], v[180:181]
    v_pk_mul_f32 v[118:119], v[118:119], v[182:183]
    s_add_u32 m0, s19, 0
    s_lshl_b32 s11, s85, 4
    buffer_load_dwordx4 v17, s[56:59], s11 offen offset:0 lds
    v_cvt_pk_bf16_f32 v164, v100, v101
    v_cvt_pk_bf16_f32 v165, v102, v103
    v_cvt_pk_bf16_f32 v166, v116, v117
    v_cvt_pk_bf16_f32 v167, v118, v119
    buffer_store_dwordx4 v[164:167], v4, s[44:47], s78 offen offset:1024 sc1
    v_pk_mul_f32 v[104:105], v[104:105], s[76:77] op_sel_hi:[1,0]
    v_pk_mul_f32 v[106:107], v[106:107], s[76:77] op_sel_hi:[1,0]
    v_pk_mul_f32 v[120:121], v[120:121], s[76:77] op_sel_hi:[1,0]
    v_pk_mul_f32 v[122:123], v[122:123], s[76:77] op_sel_hi:[1,0]
    v_exp_f32 v104, v104
    v_exp_f32 v105, v105
    v_exp_f32 v106, v106
    v_exp_f32 v107, v107
    v_exp_f32 v120, v120
    v_exp_f32 v121, v121
    v_exp_f32 v122, v122
    v_exp_f32 v123, v123
    buffer_load_dwordx4 v18, s[56:59], s11 offen offset:1024 lds
    v_pk_add_f32 v[104:105], v[104:105], 1.0 op_sel_hi:[1,0]
    v_pk_add_f32 v[106:107], v[106:107], 1.0 op_sel_hi:[1,0]
    v_pk_add_f32 v[120:121], v[120:121], 1.0 op_sel_hi:[1,0]
    v_pk_add_f32 v[122:123], v[122:123], 1.0 op_sel_hi:[1,0]
    v_rcp_f32 v104, v104
    v_rcp_f32 v105, v105
    v_rcp_f32 v106, v106
    v_rcp_f32 v107, v107
    v_rcp_f32 v120, v120
    v_rcp_f32 v121, v121
    v_rcp_f32 v122, v122
    v_rcp_f32 v123, v123
    v_pk_mul_f32 v[104:105], v[104:105], v[168:169]
    v_pk_mul_f32 v[106:107], v[106:107], v[170:171]
    v_pk_mul_f32 v[120:121], v[120:121], v[184:185]
    v_pk_mul_f32 v[122:123], v[122:123], v[186:187]
    v_cvt_pk_bf16_f32 v168, v104, v105
    v_cvt_pk_bf16_f32 v169, v106, v107
    buffer_load_dwordx4 v19, s[56:59], s11 offen offset:2048 lds
    v_cvt_pk_bf16_f32 v170, v120, v121
    v_cvt_pk_bf16_f32 v171, v122, v123
    buffer_store_dwordx4 v[168:171], v5, s[44:47], s78 offen offset:1024 sc1
    v_pk_mul_f32 v[108:109], v[108:109], s[76:77] op_sel_hi:[1,0]
    v_pk_mul_f32 v[110:111], v[110:111], s[76:77] op_sel_hi:[1,0]
    v_pk_mul_f32 v[124:125], v[124:125], s[76:77] op_sel_hi:[1,0]
    v_pk_mul_f32 v[126:127], v[126:127], s[76:77] op_sel_hi:[1,0]
    v_exp_f32 v108, v108
    v_exp_f32 v109, v109
    v_exp_f32 v110, v110
    v_exp_f32 v111, v111
    v_exp_f32 v124, v124
    v_exp_f32 v125, v125
    v_exp_f32 v126, v126
    v_exp_f32 v127, v127
    v_pk_add_f32 v[108:109], v[108:109], 1.0 op_sel_hi:[1,0]
    v_pk_add_f32 v[110:111], v[110:111], 1.0 op_sel_hi:[1,0]
    buffer_load_dwordx4 v20, s[56:59], s11 offen offset:3072 lds
    v_pk_add_f32 v[124:125], v[124:125], 1.0 op_sel_hi:[1,0]
    v_pk_add_f32 v[126:127], v[126:127], 1.0 op_sel_hi:[1,0]
    v_rcp_f32 v108, v108
    v_rcp_f32 v109, v109
    v_rcp_f32 v110, v110
    v_rcp_f32 v111, v111
    v_rcp_f32 v124, v124
    v_rcp_f32 v125, v125
    v_rcp_f32 v126, v126
    v_rcp_f32 v127, v127
    v_pk_mul_f32 v[108:109], v[108:109], v[172:173]
    v_pk_mul_f32 v[110:111], v[110:111], v[174:175]
    v_pk_mul_f32 v[124:125], v[124:125], v[188:189]
    v_pk_mul_f32 v[126:127], v[126:127], v[190:191]
    v_cvt_pk_bf16_f32 v172, v108, v109
    v_cvt_pk_bf16_f32 v173, v110, v111
    v_cvt_pk_bf16_f32 v174, v124, v125
    v_cvt_pk_bf16_f32 v175, v126, v127
    s_add_u32 m0, s19, 4096
    s_lshl_b32 s11, s87, 4
    buffer_load_dwordx4 v17, s[56:59], s11 offen offset:0 lds
    buffer_store_dwordx4 v[172:175], v6, s[44:47], s78 offen offset:1024 sc1
    s_waitcnt lgkmcnt(4)
    v_mfma_f32_16x16x32_bf16 a[0:3], a[192:195], a[128:131], a[0:3]
    ds_read_b64_tr_b16 a[208:209], v13 offset:512
    v_mfma_f32_16x16x32_bf16 a[0:3], a[196:199], a[132:135], a[0:3]
    v_mul_f32 v32, s76, v32
    v_mul_f32 v33, s76, v33
    v_mfma_f32_16x16x32_bf16 a[4:7], a[196:199], a[140:143], a[4:7]
    ds_read_b64_tr_b16 a[210:211], v13 offset:20992
    v_mul_f32 v34, s76, v34
    v_mfma_f32_16x16x32_bf16 a[4:7], a[192:195], a[136:139], a[4:7]
    v_exp_f32 v32, v32
    v_mfma_f32_16x16x32_bf16 a[8:11], a[192:195], a[144:147], a[8:11]
    ds_read_b64_tr_b16 a[212:213], v13 offset:1536
    v_mul_f32 v35, s76, v35
    v_mfma_f32_16x16x32_bf16 a[8:11], a[196:199], a[148:151], a[8:11]
    v_exp_f32 v33, v33
    v_mfma_f32_16x16x32_bf16 a[12:15], a[196:199], a[156:159], a[12:15]
    ds_read_b64_tr_b16 a[214:215], v13 offset:22016
    v_mul_f32 v48, s76, v48
    v_mfma_f32_16x16x32_bf16 a[12:15], a[192:195], a[152:155], a[12:15]
    v_mul_f32 v49, s76, v49
    s_waitcnt lgkmcnt(4)
    v_mfma_f32_16x16x32_bf16 a[12:15], a[200:203], a[184:187], a[12:15]
    ds_read_b64_tr_b16 a[216:217], v10 offset:512
    v_mul_f32 v50, s76, v50
    v_mfma_f32_16x16x32_bf16 a[12:15], a[204:207], a[188:191], a[12:15]
    buffer_load_dwordx4 v18, s[56:59], s11 offen offset:1024 lds
    v_mul_f32 v51, s76, v51
    v_mfma_f32_16x16x32_bf16 a[8:11], a[204:207], a[180:183], a[8:11]
    ds_read_b64_tr_b16 a[218:219], v10 offset:20992
    v_add_f32 v32, 1.0, v32
    v_mfma_f32_16x16x32_bf16 a[8:11], a[200:203], a[176:179], a[8:11]
    v_exp_f32 v34, v34
    v_mfma_f32_16x16x32_bf16 a[4:7], a[200:203], a[168:171], a[4:7]
    ds_read_b64_tr_b16 a[220:221], v10 offset:1536
    v_add_f32 v33, 1.0, v33
    v_mfma_f32_16x16x32_bf16 a[4:7], a[204:207], a[172:175], a[4:7]
    v_exp_f32 v35, v35
    v_mfma_f32_16x16x32_bf16 a[0:3], a[204:207], a[164:167], a[0:3]
    ds_read_b64_tr_b16 a[222:223], v10 offset:22016
    v_add_f32 v34, 1.0, v34
    v_mfma_f32_16x16x32_bf16 a[0:3], a[200:203], a[160:163], a[0:3]
    v_add_f32 v35, 1.0, v35
    s_waitcnt lgkmcnt(4)
    v_mfma_f32_16x16x32_bf16 a[0:3], a[208:211], a[96:99], a[0:3]
    ds_read_b64_tr_b16 a[192:193], v12 offset:512
    v_accvgpr_read_b32 v144, a32
    v_mfma_f32_16x16x32_bf16 a[0:3], a[212:215], a[100:103], a[0:3]
    buffer_load_dwordx4 v19, s[56:59], s11 offen offset:2048 lds
    v_accvgpr_read_b32 v145, a33
    v_mfma_f32_16x16x32_bf16 a[4:7], a[212:215], a[108:111], a[4:7]
    ds_read_b64_tr_b16 a[194:195], v12 offset:20992
    v_accvgpr_read_b32 v146, a34
    v_mfma_f32_16x16x32_bf16 a[4:7], a[208:211], a[104:107], a[4:7]
    v_exp_f32 v48, v48
    v_mfma_f32_16x16x32_bf16 a[8:11], a[208:211], a[112:115], a[8:11]
    ds_read_b64_tr_b16 a[196:197], v12 offset:1536
    v_accvgpr_read_b32 v147, a35
    v_mfma_f32_16x16x32_bf16 a[8:11], a[212:215], a[116:119], a[8:11]
    v_exp_f32 v49, v49
    v_mfma_f32_16x16x32_bf16 a[12:15], a[212:215], a[124:127], a[12:15]
    ds_read_b64_tr_b16 a[198:199], v12 offset:22016
    v_add_f32 v48, 1.0, v48
    v_mfma_f32_16x16x32_bf16 a[12:15], a[208:211], a[120:123], a[12:15]
    v_add_f32 v49, 1.0, v49
    s_waitcnt lgkmcnt(4)
    v_mfma_f32_16x16x32_bf16 a[28:31], a[216:219], a[152:155], a[28:31]
    ds_read_b64_tr_b16 a[200:201], v14 offset:512
    v_accvgpr_read_b32 v148, a48
    v_mfma_f32_16x16x32_bf16 a[28:31], a[220:223], a[156:159], a[28:31]
    buffer_load_dwordx4 v20, s[56:59], s11 offen offset:3072 lds
    v_accvgpr_read_b32 v149, a49
    v_mfma_f32_16x16x32_bf16 a[24:27], a[220:223], a[148:151], a[24:27]
    ds_read_b64_tr_b16 a[202:203], v14 offset:20992
    v_accvgpr_read_b32 v150, a50
    v_mfma_f32_16x16x32_bf16 a[24:27], a[216:219], a[144:147], a[24:27]
    v_exp_f32 v50, v50
    v_mfma_f32_16x16x32_bf16 a[20:23], a[216:219], a[136:139], a[20:23]
    ds_read_b64_tr_b16 a[204:205], v14 offset:1536
    v_accvgpr_read_b32 v151, a51
    v_mfma_f32_16x16x32_bf16 a[20:23], a[220:223], a[140:143], a[20:23]
    v_exp_f32 v51, v51
    v_mfma_f32_16x16x32_bf16 a[16:19], a[220:223], a[132:135], a[16:19]
    ds_read_b64_tr_b16 a[206:207], v14 offset:22016
    v_add_f32 v50, 1.0, v50
    v_mfma_f32_16x16x32_bf16 a[16:19], a[216:219], a[128:131], a[16:19]
    v_add_f32 v51, 1.0, v51
    s_waitcnt lgkmcnt(4)
    v_mfma_f32_16x16x32_bf16 a[16:19], a[192:195], a[160:163], a[16:19]
    ds_read_b64_tr_b16 a[208:209], v9 offset:2560
    v_mul_f32 v36, s76, v36
    v_mfma_f32_16x16x32_bf16 a[16:19], a[196:199], a[164:167], a[16:19]
    v_rcp_f32 v32, v32
    v_mfma_f32_16x16x32_bf16 a[20:23], a[196:199], a[172:175], a[20:23]
    ds_read_b64_tr_b16 a[210:211], v9 offset:23040
    v_mul_f32 v37, s76, v37
    v_mfma_f32_16x16x32_bf16 a[20:23], a[192:195], a[168:171], a[20:23]
    v_rcp_f32 v33, v33
    v_mfma_f32_16x16x32_bf16 a[24:27], a[192:195], a[176:179], a[24:27]
    ds_read_b64_tr_b16 a[212:213], v9 offset:3584
    v_mul_f32 v32, v32, v144
    v_mfma_f32_16x16x32_bf16 a[24:27], a[196:199], a[180:183], a[24:27]
    v_rcp_f32 v34, v34
    v_mfma_f32_16x16x32_bf16 a[28:31], a[196:199], a[188:191], a[28:31]
    ds_read_b64_tr_b16 a[214:215], v9 offset:24064
    v_mul_f32 v33, v33, v145
    v_mfma_f32_16x16x32_bf16 a[28:31], a[192:195], a[184:187], a[28:31]
    v_cvt_pk_bf16_f32 v32, v32, v33
    s_waitcnt lgkmcnt(4)
    v_mfma_f32_16x16x32_bf16 a[28:31], a[200:203], a[120:123], a[28:31]
    ds_read_b64_tr_b16 a[216:217], v11 offset:2560
    v_mul_f32 v38, s76, v38
    v_mfma_f32_16x16x32_bf16 a[28:31], a[204:207], a[124:127], a[28:31]
    v_rcp_f32 v35, v35
    v_mfma_f32_16x16x32_bf16 a[24:27], a[204:207], a[116:119], a[24:27]
    ds_read_b64_tr_b16 a[218:219], v11 offset:23040
    v_mul_f32 v34, v34, v146
    v_mfma_f32_16x16x32_bf16 a[24:27], a[200:203], a[112:115], a[24:27]
    v_rcp_f32 v48, v48
    v_mfma_f32_16x16x32_bf16 a[20:23], a[200:203], a[104:107], a[20:23]
    ds_read_b64_tr_b16 a[220:221], v11 offset:3584
    v_mul_f32 v35, v35, v147
    v_mfma_f32_16x16x32_bf16 a[20:23], a[204:207], a[108:111], a[20:23]
    v_rcp_f32 v49, v49
    v_mfma_f32_16x16x32_bf16 a[16:19], a[204:207], a[100:103], a[16:19]
    ds_read_b64_tr_b16 a[222:223], v11 offset:24064
    v_mul_f32 v48, v48, v148
    v_mfma_f32_16x16x32_bf16 a[16:19], a[200:203], a[96:99], a[16:19]
    v_mul_f32 v49, v49, v149
    s_waitcnt lgkmcnt(4)
    v_mfma_f32_16x16x32_bf16 a[64:67], a[208:211], a[128:131], a[64:67]
    ds_read_b64_tr_b16 a[192:193], v13 offset:2560
    v_cvt_pk_bf16_f32 v33, v34, v35
    v_mfma_f32_16x16x32_bf16 a[64:67], a[212:215], a[132:135], a[64:67]
    v_rcp_f32 v50, v50
    v_mfma_f32_16x16x32_bf16 a[68:71], a[212:215], a[140:143], a[68:71]
    ds_read_b64_tr_b16 a[194:195], v13 offset:23040
    v_cvt_pk_bf16_f32 v34, v48, v49
    v_mfma_f32_16x16x32_bf16 a[68:71], a[208:211], a[136:139], a[68:71]
    v_rcp_f32 v51, v51
    v_mfma_f32_16x16x32_bf16 a[72:75], a[208:211], a[144:147], a[72:75]
    ds_read_b64_tr_b16 a[196:197], v13 offset:3584
    v_mul_f32 v50, v50, v150
    v_mfma_f32_16x16x32_bf16 a[72:75], a[212:215], a[148:151], a[72:75]
    v_exp_f32 v36, v36
    v_mfma_f32_16x16x32_bf16 a[76:79], a[212:215], a[156:159], a[76:79]
    ds_read_b64_tr_b16 a[198:199], v13 offset:24064
    v_mul_f32 v51, v51, v151
    v_mfma_f32_16x16x32_bf16 a[76:79], a[208:211], a[152:155], a[76:79]
    v_cvt_pk_bf16_f32 v35, v50, v51
    s_waitcnt lgkmcnt(4)
    v_mfma_f32_16x16x32_bf16 a[76:79], a[216:219], a[184:187], a[76:79]
    ds_read_b64_tr_b16 a[200:201], v10 offset:2560
    v_mul_f32 v39, s76, v39
    v_mfma_f32_16x16x32_bf16 a[76:79], a[220:223], a[188:191], a[76:79]
    buffer_store_dwordx4 v[32:35], v3, s[44:47], s80 offen offset:0 sc1
    v_mfma_f32_16x16x32_bf16 a[72:75], a[220:223], a[180:183], a[72:75]
    ds_read_b64_tr_b16 a[202:203], v10 offset:23040
    v_mul_f32 v52, s76, v52
    v_mfma_f32_16x16x32_bf16 a[72:75], a[216:219], a[176:179], a[72:75]
    v_exp_f32 v37, v37
    v_mfma_f32_16x16x32_bf16 a[68:71], a[216:219], a[168:171], a[68:71]
    ds_read_b64_tr_b16 a[204:205], v10 offset:3584
    v_mul_f32 v53, s76, v53
    v_mfma_f32_16x16x32_bf16 a[68:71], a[220:223], a[172:175], a[68:71]
    v_exp_f32 v38, v38
    v_mfma_f32_16x16x32_bf16 a[64:67], a[220:223], a[164:167], a[64:67]
    ds_read_b64_tr_b16 a[206:207], v10 offset:24064
    v_mul_f32 v54, s76, v54
    v_mfma_f32_16x16x32_bf16 a[64:67], a[216:219], a[160:163], a[64:67]
    v_mul_f32 v55, s76, v55
    s_waitcnt lgkmcnt(4)
    v_mfma_f32_16x16x32_bf16 a[64:67], a[192:195], a[96:99], a[64:67]
    ds_read_b64_tr_b16 a[208:209], v12 offset:2560
    v_add_f32 v36, 1.0, v36
    v_mfma_f32_16x16x32_bf16 a[64:67], a[196:199], a[100:103], a[64:67]
    v_exp_f32 v39, v39
    v_mfma_f32_16x16x32_bf16 a[68:71], a[196:199], a[108:111], a[68:71]
    ds_read_b64_tr_b16 a[210:211], v12 offset:23040
    v_add_f32 v37, 1.0, v37
    v_mfma_f32_16x16x32_bf16 a[68:71], a[192:195], a[104:107], a[68:71]
    v_exp_f32 v52, v52
    v_mfma_f32_16x16x32_bf16 a[72:75], a[192:195], a[112:115], a[72:75]
    ds_read_b64_tr_b16 a[212:213], v12 offset:3584
    v_add_f32 v38, 1.0, v38
    v_mfma_f32_16x16x32_bf16 a[72:75], a[196:199], a[116:119], a[72:75]
    v_exp_f32 v53, v53
    v_mfma_f32_16x16x32_bf16 a[76:79], a[196:199], a[124:127], a[76:79]
    ds_read_b64_tr_b16 a[214:215], v12 offset:24064
    v_add_f32 v39, 1.0, v39
    v_mfma_f32_16x16x32_bf16 a[76:79], a[192:195], a[120:123], a[76:79]
    v_add_f32 v52, 1.0, v52
    s_waitcnt vmcnt(4)
    s_add_u32 s74, s66, 4096
    s_mov_b64 exec, 1
    buffer_store_dword v21, off, s[52:55], s74 sc1
    s_mov_b64 exec, -1
    s_waitcnt lgkmcnt(4)
    v_mfma_f32_16x16x32_bf16 a[92:95], a[200:203], a[152:155], a[92:95]
    ds_read_b64_tr_b16 a[216:217], v14 offset:2560
    v_add_f32 v53, 1.0, v53
    v_mfma_f32_16x16x32_bf16 a[92:95], a[204:207], a[156:159], a[92:95]
    v_exp_f32 v54, v54
    v_mfma_f32_16x16x32_bf16 a[88:91], a[204:207], a[148:151], a[88:91]
    ds_read_b64_tr_b16 a[218:219], v14 offset:23040
    v_accvgpr_read_b32 v152, a36
    v_mfma_f32_16x16x32_bf16 a[88:91], a[200:203], a[144:147], a[88:91]
    v_exp_f32 v55, v55
    v_mfma_f32_16x16x32_bf16 a[84:87], a[200:203], a[136:139], a[84:87]
    ds_read_b64_tr_b16 a[220:221], v14 offset:3584
    v_add_f32 v54, 1.0, v54
    v_mfma_f32_16x16x32_bf16 a[84:87], a[204:207], a[140:143], a[84:87]
    v_rcp_f32 v36, v36
    v_mfma_f32_16x16x32_bf16 a[80:83], a[204:207], a[132:135], a[80:83]
    ds_read_b64_tr_b16 a[222:223], v14 offset:24064
    v_add_f32 v55, 1.0, v55
    v_mfma_f32_16x16x32_bf16 a[80:83], a[200:203], a[128:131], a[80:83]
    v_accvgpr_read_b32 v153, a37
    s_waitcnt lgkmcnt(4)
    v_mfma_f32_16x16x32_bf16 a[80:83], a[208:211], a[160:163], a[80:83]
    ds_read_b64_tr_b16 a[192:193], v15 offset:8192
    v_accvgpr_read_b32 v154, a38
    v_mfma_f32_16x16x32_bf16 a[80:83], a[212:215], a[164:167], a[80:83]
    v_rcp_f32 v37, v37
    v_mfma_f32_16x16x32_bf16 a[84:87], a[212:215], a[172:175], a[84:87]
    ds_read_b64_tr_b16 a[194:195], v15 offset:28672
    v_accvgpr_read_b32 v155, a39
    v_mfma_f32_16x16x32_bf16 a[84:87], a[208:211], a[168:171], a[84:87]
    v_rcp_f32 v38, v38
    v_mfma_f32_16x16x32_bf16 a[88:91], a[208:211], a[176:179], a[88:91]
    ds_read_b64_tr_b16 a[196:197], v15 offset:9216
    v_accvgpr_read_b32 v156, a52
    v_mfma_f32_16x16x32_bf16 a[88:91], a[212:215], a[180:183], a[88:91]
    v_rcp_f32 v39, v39
    v_mfma_f32_16x16x32_bf16 a[92:95], a[212:215], a[188:191], a[92:95]
    ds_read_b64_tr_b16 a[198:199], v15 offset:29696
    v_accvgpr_read_b32 v157, a53
    v_mfma_f32_16x16x32_bf16 a[92:95], a[208:211], a[184:187], a[92:95]
    v_accvgpr_read_b32 v158, a54
    s_waitcnt lgkmcnt(4)
    v_mfma_f32_16x16x32_bf16 a[92:95], a[216:219], a[120:123], a[92:95]
    ds_read_b64_tr_b16 a[200:201], v16 offset:8192
    v_accvgpr_read_b32 v159, a55
    v_mfma_f32_16x16x32_bf16 a[92:95], a[220:223], a[124:127], a[92:95]
    v_rcp_f32 v52, v52
    v_mfma_f32_16x16x32_bf16 a[88:91], a[220:223], a[116:119], a[88:91]
    ds_read_b64_tr_b16 a[202:203], v16 offset:28672
    v_mul_f32 v36, v36, v152
    v_mfma_f32_16x16x32_bf16 a[88:91], a[216:219], a[112:115], a[88:91]
    v_rcp_f32 v53, v53
    v_mfma_f32_16x16x32_bf16 a[84:87], a[216:219], a[104:107], a[84:87]
    ds_read_b64_tr_b16 a[204:205], v16 offset:9216
    v_mul_f32 v37, v37, v153
    v_mfma_f32_16x16x32_bf16 a[84:87], a[220:223], a[108:111], a[84:87]
    v_rcp_f32 v54, v54
    v_mfma_f32_16x16x32_bf16 a[80:83], a[220:223], a[100:103], a[80:83]
    ds_read_b64_tr_b16 a[206:207], v16 offset:29696
    v_mul_f32 v38, v38, v154
    v_mfma_f32_16x16x32_bf16 a[80:83], a[216:219], a[96:99], a[80:83]
    v_mul_f32 v39, v39, v155
    s_waitcnt lgkmcnt(4)
    v_mfma_f32_16x16x32_bf16 v[192:195], a[192:195], a[128:131], v[192:195]
    ds_read_b64_tr_b16 a[208:209], v15 offset:18432
    v_mul_f32 v52, v52, v156
    v_mfma_f32_16x16x32_bf16 v[192:195], a[196:199], a[132:135], v[192:195]
    v_rcp_f32 v55, v55
    v_mfma_f32_16x16x32_bf16 v[196:199], a[196:199], a[140:143], v[196:199]
    ds_read_b64_tr_b16 a[210:211], v15 offset:38912
    v_mul_f32 v53, v53, v157
    v_mfma_f32_16x16x32_bf16 v[196:199], a[192:195], a[136:139], v[196:199]
    v_mul_f32 v54, v54, v158
    v_mul_f32 v55, v55, v159
    v_mfma_f32_16x16x32_bf16 v[200:203], a[192:195], a[144:147], v[200:203]
    ds_read_b64_tr_b16 a[212:213], v15 offset:19456
    v_cvt_pk_bf16_f32 v36, v36, v37
    v_mfma_f32_16x16x32_bf16 v[200:203], a[196:199], a[148:151], v[200:203]
    v_cvt_pk_bf16_f32 v37, v38, v39
    v_cvt_pk_bf16_f32 v38, v52, v53
    v_mfma_f32_16x16x32_bf16 v[204:207], a[196:199], a[156:159], v[204:207]
    ds_read_b64_tr_b16 a[214:215], v15 offset:39936
    v_cvt_pk_bf16_f32 v39, v54, v55
    v_mfma_f32_16x16x32_bf16 v[204:207], a[192:195], a[152:155], v[204:207]
    v_mul_f32 v40, s76, v40
    s_waitcnt lgkmcnt(4)
    v_mfma_f32_16x16x32_bf16 v[220:223], a[200:203], a[152:155], v[220:223]
    ds_read_b64_tr_b16 a[216:217], v16 offset:18432
    v_mul_f32 v41, s76, v41
    v_mfma_f32_16x16x32_bf16 v[220:223], a[204:207], a[156:159], v[220:223]
    buffer_store_dwordx4 v[36:39], v4, s[44:47], s80 offen offset:0 sc1
    v_mfma_f32_16x16x32_bf16 v[216:219], a[204:207], a[148:151], v[216:219]
    ds_read_b64_tr_b16 a[218:219], v16 offset:38912
    v_mul_f32 v42, s76, v42
    v_mfma_f32_16x16x32_bf16 v[216:219], a[200:203], a[144:147], v[216:219]
    v_exp_f32 v40, v40
    v_mfma_f32_16x16x32_bf16 v[212:215], a[200:203], a[136:139], v[212:215]
    ds_read_b64_tr_b16 a[220:221], v16 offset:19456
    v_mul_f32 v43, s76, v43
    v_mfma_f32_16x16x32_bf16 v[212:215], a[204:207], a[140:143], v[212:215]
    v_exp_f32 v41, v41
    v_mfma_f32_16x16x32_bf16 v[208:211], a[204:207], a[132:135], v[208:211]
    ds_read_b64_tr_b16 a[222:223], v16 offset:39936
    v_mul_f32 v56, s76, v56
    v_mfma_f32_16x16x32_bf16 v[208:211], a[200:203], a[128:131], v[208:211]
    v_add_u32 v15, 40960, v15
    v_add_u32 v16, 40960, v16
    s_waitcnt lgkmcnt(4)
    v_mfma_f32_16x16x32_bf16 v[224:227], a[208:211], a[128:131], v[224:227]
    ds_read_b64_tr_b16 a[192:193], v15 offset:8192
    v_mul_f32 v57, s76, v57
    v_mfma_f32_16x16x32_bf16 v[224:227], a[212:215], a[132:135], v[224:227]
    v_exp_f32 v42, v42
    v_mfma_f32_16x16x32_bf16 v[228:231], a[212:215], a[140:143], v[228:231]
    ds_read_b64_tr_b16 a[194:195], v15 offset:28672
    v_mul_f32 v58, s76, v58
    v_mfma_f32_16x16x32_bf16 v[228:231], a[208:211], a[136:139], v[228:231]
    v_exp_f32 v43, v43
    v_mfma_f32_16x16x32_bf16 v[232:235], a[208:211], a[144:147], v[232:235]
    ds_read_b64_tr_b16 a[196:197], v15 offset:9216
    v_mul_f32 v59, s76, v59
    v_mfma_f32_16x16x32_bf16 v[232:235], a[212:215], a[148:151], v[232:235]
    v_exp_f32 v56, v56
    v_mfma_f32_16x16x32_bf16 v[236:239], a[212:215], a[156:159], v[236:239]
    ds_read_b64_tr_b16 a[198:199], v15 offset:29696
    v_add_f32 v40, 1.0, v40
    v_mfma_f32_16x16x32_bf16 v[236:239], a[208:211], a[152:155], v[236:239]
    v_add_f32 v41, 1.0, v41
    s_waitcnt lgkmcnt(4)
    v_mfma_f32_16x16x32_bf16 v[252:255], a[216:219], a[152:155], v[252:255]
    ds_read_b64_tr_b16 a[200:201], v16 offset:8192
    v_add_f32 v42, 1.0, v42
    v_mfma_f32_16x16x32_bf16 v[252:255], a[220:223], a[156:159], v[252:255]
    v_exp_f32 v57, v57
    v_mfma_f32_16x16x32_bf16 v[248:251], a[220:223], a[148:151], v[248:251]
    ds_read_b64_tr_b16 a[202:203], v16 offset:28672
    v_add_f32 v43, 1.0, v43
    v_mfma_f32_16x16x32_bf16 v[248:251], a[216:219], a[144:147], v[248:251]
    v_exp_f32 v58, v58
    v_mfma_f32_16x16x32_bf16 v[244:247], a[216:219], a[136:139], v[244:247]
    ds_read_b64_tr_b16 a[204:205], v16 offset:9216
    v_add_f32 v56, 1.0, v56
    v_mfma_f32_16x16x32_bf16 v[244:247], a[220:223], a[140:143], v[244:247]
    v_exp_f32 v59, v59
    v_mfma_f32_16x16x32_bf16 v[240:243], a[220:223], a[132:135], v[240:243]
    ds_read_b64_tr_b16 a[206:207], v16 offset:29696
    v_add_f32 v57, 1.0, v57
    v_mfma_f32_16x16x32_bf16 v[240:243], a[216:219], a[128:131], v[240:243]
    v_add_f32 v58, 1.0, v58
    s_waitcnt lgkmcnt(4)
    v_mfma_f32_16x16x32_bf16 v[192:195], a[192:195], a[160:163], v[192:195]
    ds_read_b64_tr_b16 a[208:209], v15 offset:18432
    v_add_f32 v59, 1.0, v59
    v_mfma_f32_16x16x32_bf16 v[192:195], a[196:199], a[164:167], v[192:195]
    v_rcp_f32 v40, v40
    v_mfma_f32_16x16x32_bf16 v[196:199], a[196:199], a[172:175], v[196:199]
    ds_read_b64_tr_b16 a[210:211], v15 offset:38912
    v_accvgpr_read_b32 v176, a40
    v_mfma_f32_16x16x32_bf16 v[196:199], a[192:195], a[168:171], v[196:199]
    v_rcp_f32 v41, v41
    v_mfma_f32_16x16x32_bf16 v[200:203], a[192:195], a[176:179], v[200:203]
    ds_read_b64_tr_b16 a[212:213], v15 offset:19456
    v_accvgpr_read_b32 v177, a41
    v_mfma_f32_16x16x32_bf16 v[200:203], a[196:199], a[180:183], v[200:203]
    v_rcp_f32 v42, v42
    v_mfma_f32_16x16x32_bf16 v[204:207], a[196:199], a[188:191], v[204:207]
    ds_read_b64_tr_b16 a[214:215], v15 offset:39936
    v_accvgpr_read_b32 v178, a42
    v_mfma_f32_16x16x32_bf16 v[204:207], a[192:195], a[184:187], v[204:207]
    v_accvgpr_read_b32 v179, a43
    s_waitcnt lgkmcnt(4)
    v_mfma_f32_16x16x32_bf16 v[220:223], a[200:203], a[184:187], v[220:223]
    ds_read_b64_tr_b16 a[216:217], v16 offset:18432
    v_accvgpr_read_b32 v180, a56
    v_mfma_f32_16x16x32_bf16 v[220:223], a[204:207], a[188:191], v[220:223]
    v_rcp_f32 v43, v43
    v_mfma_f32_16x16x32_bf16 v[216:219], a[204:207], a[180:183], v[216:219]
    ds_read_b64_tr_b16 a[218:219], v16 offset:38912
    v_accvgpr_read_b32 v181, a57
    v_mfma_f32_16x16x32_bf16 v[216:219], a[200:203], a[176:179], v[216:219]
    v_rcp_f32 v56, v56
    v_mfma_f32_16x16x32_bf16 v[212:215], a[200:203], a[168:171], v[212:215]
    ds_read_b64_tr_b16 a[220:221], v16 offset:19456
    v_accvgpr_read_b32 v182, a58
    v_mfma_f32_16x16x32_bf16 v[212:215], a[204:207], a[172:175], v[212:215]
    v_rcp_f32 v57, v57
    v_mfma_f32_16x16x32_bf16 v[208:211], a[204:207], a[164:167], v[208:211]
    ds_read_b64_tr_b16 a[222:223], v16 offset:39936
    v_accvgpr_read_b32 v183, a59
    v_mfma_f32_16x16x32_bf16 v[208:211], a[200:203], a[160:163], v[208:211]
    v_add_u32 v15, 40960, v15
    v_add_u32 v16, 40960, v16
    s_waitcnt lgkmcnt(4)
    v_mfma_f32_16x16x32_bf16 v[224:227], a[208:211], a[160:163], v[224:227]
    ds_read_b64_tr_b16 a[192:193], v15 offset:8192
    v_mul_f32 v40, v40, v176
    v_mfma_f32_16x16x32_bf16 v[224:227], a[212:215], a[164:167], v[224:227]
    v_rcp_f32 v58, v58
    v_mfma_f32_16x16x32_bf16 v[228:231], a[212:215], a[172:175], v[228:231]
    ds_read_b64_tr_b16 a[194:195], v15 offset:28672
    v_mul_f32 v41, v41, v177
    v_mfma_f32_16x16x32_bf16 v[228:231], a[208:211], a[168:171], v[228:231]
    v_rcp_f32 v59, v59
    v_mfma_f32_16x16x32_bf16 v[232:235], a[208:211], a[176:179], v[232:235]
    ds_read_b64_tr_b16 a[196:197], v15 offset:9216
    v_mul_f32 v42, v42, v178
    v_mfma_f32_16x16x32_bf16 v[232:235], a[212:215], a[180:183], v[232:235]
    v_mul_f32 v43, v43, v179
    v_mul_f32 v56, v56, v180
    v_mfma_f32_16x16x32_bf16 v[236:239], a[212:215], a[188:191], v[236:239]
    ds_read_b64_tr_b16 a[198:199], v15 offset:29696
    v_mul_f32 v57, v57, v181
    v_mfma_f32_16x16x32_bf16 v[236:239], a[208:211], a[184:187], v[236:239]
    v_mul_f32 v58, v58, v182
    s_waitcnt lgkmcnt(4)
    v_mfma_f32_16x16x32_bf16 v[252:255], a[216:219], a[184:187], v[252:255]
    ds_read_b64_tr_b16 a[200:201], v16 offset:8192
    v_mul_f32 v59, v59, v183
    v_mfma_f32_16x16x32_bf16 v[252:255], a[220:223], a[188:191], v[252:255]
    v_cvt_pk_bf16_f32 v40, v40, v41
    v_cvt_pk_bf16_f32 v41, v42, v43
    v_mfma_f32_16x16x32_bf16 v[248:251], a[220:223], a[180:183], v[248:251]
    ds_read_b64_tr_b16 a[202:203], v16 offset:28672
    v_cvt_pk_bf16_f32 v42, v56, v57
    v_mfma_f32_16x16x32_bf16 v[248:251], a[216:219], a[176:179], v[248:251]
    v_cvt_pk_bf16_f32 v43, v58, v59
    v_mul_f32 v44, s76, v44
    v_mfma_f32_16x16x32_bf16 v[244:247], a[216:219], a[168:171], v[244:247]
    ds_read_b64_tr_b16 a[204:205], v16 offset:9216
    v_mul_f32 v45, s76, v45
    v_mfma_f32_16x16x32_bf16 v[244:247], a[220:223], a[172:175], v[244:247]
    buffer_store_dwordx4 v[40:43], v5, s[44:47], s80 offen offset:0 sc1
    v_mfma_f32_16x16x32_bf16 v[240:243], a[220:223], a[164:167], v[240:243]
    ds_read_b64_tr_b16 a[206:207], v16 offset:29696
    v_mul_f32 v46, s76, v46
    v_mfma_f32_16x16x32_bf16 v[240:243], a[216:219], a[160:163], v[240:243]
    v_mul_f32 v47, s76, v47
    s_waitcnt lgkmcnt(4)
    v_mfma_f32_16x16x32_bf16 v[192:195], a[192:195], a[96:99], v[192:195]
    ds_read_b64_tr_b16 a[208:209], v15 offset:18432
    v_mul_f32 v60, s76, v60
    v_mfma_f32_16x16x32_bf16 v[192:195], a[196:199], a[100:103], v[192:195]
    v_exp_f32 v44, v44
    v_mfma_f32_16x16x32_bf16 v[196:199], a[196:199], a[108:111], v[196:199]
    ds_read_b64_tr_b16 a[210:211], v15 offset:38912
    v_mul_f32 v61, s76, v61
    v_mfma_f32_16x16x32_bf16 v[196:199], a[192:195], a[104:107], v[196:199]
    v_exp_f32 v45, v45
    v_mfma_f32_16x16x32_bf16 v[200:203], a[192:195], a[112:115], v[200:203]
    ds_read_b64_tr_b16 a[212:213], v15 offset:19456
    v_mul_f32 v62, s76, v62
    v_mfma_f32_16x16x32_bf16 v[200:203], a[196:199], a[116:119], v[200:203]
    v_exp_f32 v46, v46
    v_mfma_f32_16x16x32_bf16 v[204:207], a[196:199], a[124:127], v[204:207]
    ds_read_b64_tr_b16 a[214:215], v15 offset:39936
    v_mul_f32 v63, s76, v63
    v_mfma_f32_16x16x32_bf16 v[204:207], a[192:195], a[120:123], v[204:207]
    v_add_f32 v44, 1.0, v44
    s_waitcnt lgkmcnt(4)
    v_mfma_f32_16x16x32_bf16 v[220:223], a[200:203], a[120:123], v[220:223]
    ds_read_b64_tr_b16 a[216:217], v16 offset:18432
    v_add_f32 v45, 1.0, v45
    v_mfma_f32_16x16x32_bf16 v[220:223], a[204:207], a[124:127], v[220:223]
    v_exp_f32 v47, v47
    v_mfma_f32_16x16x32_bf16 v[216:219], a[204:207], a[116:119], v[216:219]
    ds_read_b64_tr_b16 a[218:219], v16 offset:38912
    v_add_f32 v46, 1.0, v46
    v_mfma_f32_16x16x32_bf16 v[216:219], a[200:203], a[112:115], v[216:219]
    v_exp_f32 v60, v60
    v_mfma_f32_16x16x32_bf16 v[212:215], a[200:203], a[104:107], v[212:215]
    ds_read_b64_tr_b16 a[220:221], v16 offset:19456
    v_add_f32 v47, 1.0, v47
    v_mfma_f32_16x16x32_bf16 v[212:215], a[204:207], a[108:111], v[212:215]
    v_exp_f32 v61, v61
    v_mfma_f32_16x16x32_bf16 v[208:211], a[204:207], a[100:103], v[208:211]
    ds_read_b64_tr_b16 a[222:223], v16 offset:39936
    v_add_f32 v60, 1.0, v60
    v_mfma_f32_16x16x32_bf16 v[208:211], a[200:203], a[96:99], v[208:211]
    v_add_f32 v61, 1.0, v61
    s_waitcnt vmcnt(32)
    v_and_b32 v0, 3, v1
    v_lshlrev_b32 v0, 2, v0
    buffer_load_dword v0, v0, s[52:55], s67 offen offset:0 sc1
    s_waitcnt lgkmcnt(4)
    v_mfma_f32_16x16x32_bf16 v[224:227], a[208:211], a[96:99], v[224:227]
    v_exp_f32 v62, v62
    v_mfma_f32_16x16x32_bf16 v[224:227], a[212:215], a[100:103], v[224:227]
    v_exp_f32 v63, v63
    v_mfma_f32_16x16x32_bf16 v[228:231], a[212:215], a[108:111], v[228:231]
    v_rcp_f32 v44, v44
    v_mfma_f32_16x16x32_bf16 v[228:231], a[208:211], a[104:107], v[228:231]
    v_rcp_f32 v45, v45
    v_mfma_f32_16x16x32_bf16 v[232:235], a[208:211], a[112:115], v[232:235]
    v_rcp_f32 v46, v46
    v_mfma_f32_16x16x32_bf16 v[232:235], a[212:215], a[116:119], v[232:235]
    v_rcp_f32 v47, v47
    v_mfma_f32_16x16x32_bf16 v[236:239], a[212:215], a[124:127], v[236:239]
    v_rcp_f32 v60, v60
    v_mfma_f32_16x16x32_bf16 v[236:239], a[208:211], a[120:123], v[236:239]
    v_add_f32 v62, 1.0, v62
    s_waitcnt lgkmcnt(0)
    v_mfma_f32_16x16x32_bf16 v[252:255], a[216:219], a[120:123], v[252:255]
    v_rcp_f32 v61, v61
    v_mfma_f32_16x16x32_bf16 v[252:255], a[220:223], a[124:127], v[252:255]
    v_rcp_f32 v62, v62
    v_mfma_f32_16x16x32_bf16 v[248:251], a[220:223], a[116:119], v[248:251]
    v_add_f32 v63, 1.0, v63
    v_accvgpr_read_b32 v184, a44
    v_mfma_f32_16x16x32_bf16 v[248:251], a[216:219], a[112:115], v[248:251]
    v_rcp_f32 v63, v63
    v_mfma_f32_16x16x32_bf16 v[244:247], a[216:219], a[104:107], v[244:247]
    v_accvgpr_read_b32 v185, a45
    v_accvgpr_read_b32 v186, a46
    v_mfma_f32_16x16x32_bf16 v[244:247], a[220:223], a[108:111], v[244:247]
    v_accvgpr_read_b32 v187, a47
    v_accvgpr_read_b32 v188, a60
    v_mfma_f32_16x16x32_bf16 v[240:243], a[220:223], a[100:103], v[240:243]
    v_accvgpr_read_b32 v189, a61
    v_accvgpr_read_b32 v190, a62
    v_mfma_f32_16x16x32_bf16 v[240:243], a[216:219], a[96:99], v[240:243]
    v_accvgpr_read_b32 v191, a63
    s_waitcnt vmcnt(22)
    s_barrier
    v_pk_mul_f32 v[44:45], v[44:45], v[184:185]
    v_pk_mul_f32 v[46:47], v[46:47], v[186:187]
    v_pk_mul_f32 v[60:61], v[60:61], v[188:189]
    v_pk_mul_f32 v[62:63], v[62:63], v[190:191]
    v_cvt_pk_bf16_f32 v44, v44, v45
    v_cvt_pk_bf16_f32 v45, v46, v47
    v_cvt_pk_bf16_f32 v46, v60, v61
    v_cvt_pk_bf16_f32 v47, v62, v63
    buffer_store_dwordx4 v[44:47], v6, s[44:47], s80 offen offset:0 sc1
    v_accvgpr_read_b32 v64, a0
    v_accvgpr_read_b32 v65, a1
    v_accvgpr_read_b32 v66, a2
    v_accvgpr_read_b32 v67, a3
    v_accvgpr_read_b32 v68, a16
    v_accvgpr_read_b32 v69, a17
    v_accvgpr_read_b32 v70, a18
    v_accvgpr_read_b32 v71, a19
    v_pk_mul_f32 v[64:65], v[64:65], s[76:77] op_sel_hi:[1,0]
    v_pk_mul_f32 v[66:67], v[66:67], s[76:77] op_sel_hi:[1,0]
    v_pk_mul_f32 v[68:69], v[68:69], s[76:77] op_sel_hi:[1,0]
    v_pk_mul_f32 v[70:71], v[70:71], s[76:77] op_sel_hi:[1,0]
    v_exp_f32 v64, v64
    v_exp_f32 v65, v65
    s_add_u32 m0, s19, 40960
    s_lshl_b32 s11, s82, 4
    buffer_load_dwordx4 v17, s[56:59], s11 offen offset:0 lds
    v_exp_f32 v66, v66
    v_exp_f32 v67, v67
    v_exp_f32 v68, v68
    v_exp_f32 v69, v69
    v_exp_f32 v70, v70
    v_exp_f32 v71, v71
    v_pk_add_f32 v[64:65], v[64:65], 1.0 op_sel_hi:[1,0]
    v_pk_add_f32 v[66:67], v[66:67], 1.0 op_sel_hi:[1,0]
    v_pk_add_f32 v[68:69], v[68:69], 1.0 op_sel_hi:[1,0]
    v_pk_add_f32 v[70:71], v[70:71], 1.0 op_sel_hi:[1,0]
    v_rcp_f32 v64, v64
    v_rcp_f32 v65, v65
    v_rcp_f32 v66, v66
    v_rcp_f32 v67, v67
    v_rcp_f32 v68, v68
    buffer_load_dwordx4 v18, s[56:59], s11 offen offset:1024 lds
    v_rcp_f32 v69, v69
    v_rcp_f32 v70, v70
    v_rcp_f32 v71, v71
    v_accvgpr_read_b32 v72, a64
    v_accvgpr_read_b32 v73, a65
    v_accvgpr_read_b32 v74, a66
    v_accvgpr_read_b32 v75, a67
    v_accvgpr_read_b32 v76, a80
    v_accvgpr_read_b32 v77, a81
    v_accvgpr_read_b32 v78, a82
    v_accvgpr_read_b32 v79, a83
    v_pk_mul_f32 v[64:65], v[64:65], v[72:73]
    v_pk_mul_f32 v[66:67], v[66:67], v[74:75]
    v_pk_mul_f32 v[68:69], v[68:69], v[76:77]
    v_pk_mul_f32 v[70:71], v[70:71], v[78:79]
    v_cvt_pk_bf16_f32 v48, v64, v65
    v_cvt_pk_bf16_f32 v49, v66, v67
    v_cvt_pk_bf16_f32 v50, v68, v69
    v_cvt_pk_bf16_f32 v51, v70, v71
    buffer_store_dwordx4 v[48:51], v3, s[44:47], s80 offen offset:1024 sc1
    v_accvgpr_read_b32 v80, a4
    v_accvgpr_read_b32 v81, a5
    buffer_load_dwordx4 v19, s[56:59], s11 offen offset:2048 lds
    v_accvgpr_read_b32 v82, a6
    v_accvgpr_read_b32 v83, a7
    v_accvgpr_read_b32 v84, a20
    v_accvgpr_read_b32 v85, a21
    v_accvgpr_read_b32 v86, a22
    v_accvgpr_read_b32 v87, a23
    v_pk_mul_f32 v[80:81], v[80:81], s[76:77] op_sel_hi:[1,0]
    v_pk_mul_f32 v[82:83], v[82:83], s[76:77] op_sel_hi:[1,0]
    v_pk_mul_f32 v[84:85], v[84:85], s[76:77] op_sel_hi:[1,0]
    v_pk_mul_f32 v[86:87], v[86:87], s[76:77] op_sel_hi:[1,0]
    v_exp_f32 v80, v80
    v_exp_f32 v81, v81
    v_exp_f32 v82, v82
    v_exp_f32 v83, v83
    v_exp_f32 v84, v84
    v_exp_f32 v85, v85
    v_exp_f32 v86, v86
    v_exp_f32 v87, v87
    buffer_load_dwordx4 v20, s[56:59], s11 offen offset:3072 lds
    v_pk_add_f32 v[80:81], v[80:81], 1.0 op_sel_hi:[1,0]
    v_pk_add_f32 v[82:83], v[82:83], 1.0 op_sel_hi:[1,0]
    v_pk_add_f32 v[84:85], v[84:85], 1.0 op_sel_hi:[1,0]
    v_pk_add_f32 v[86:87], v[86:87], 1.0 op_sel_hi:[1,0]
    v_rcp_f32 v80, v80
    v_rcp_f32 v81, v81
    v_rcp_f32 v82, v82
    v_rcp_f32 v83, v83
    v_rcp_f32 v84, v84
    v_rcp_f32 v85, v85
    v_rcp_f32 v86, v86
    v_rcp_f32 v87, v87
    v_accvgpr_read_b32 v88, a68
    v_accvgpr_read_b32 v89, a69
    v_accvgpr_read_b32 v90, a70
    v_accvgpr_read_b32 v91, a71
    v_accvgpr_read_b32 v92, a84
    v_accvgpr_read_b32 v93, a85
    s_add_u32 m0, s19, 81920
    s_lshl_b32 s11, s84, 4
    buffer_load_dwordx4 v17, s[56:59], s11 offen offset:0 lds
    v_accvgpr_read_b32 v94, a86
    v_accvgpr_read_b32 v95, a87
    v_pk_mul_f32 v[80:81], v[80:81], v[88:89]
    v_pk_mul_f32 v[82:83], v[82:83], v[90:91]
    v_pk_mul_f32 v[84:85], v[84:85], v[92:93]
    v_pk_mul_f32 v[86:87], v[86:87], v[94:95]
    v_cvt_pk_bf16_f32 v52, v80, v81
    s_waitcnt vmcnt(7)
    v_cmp_ne_u32 vcc, s18, v0
    s_cbranch_vccnz L_pl5
L_pl5_b:
    v_cvt_pk_bf16_f32 v53, v82, v83
    v_cvt_pk_bf16_f32 v54, v84, v85
    v_cvt_pk_bf16_f32 v55, v86, v87
    buffer_store_dwordx4 v[52:55], v4, s[44:47], s80 offen offset:1024 sc1
    v_accvgpr_read_b32 v96, a8
    v_accvgpr_read_b32 v97, a9
    v_accvgpr_read_b32 v98, a10
    v_accvgpr_read_b32 v99, a11
    v_accvgpr_read_b32 v100, a24
    v_accvgpr_read_b32 v101, a25
    v_accvgpr_read_b32 v102, a26
    v_accvgpr_read_b32 v103, a27
    v_pk_mul_f32 v[96:97], v[96:97], s[76:77] op_sel_hi:[1,0]
    v_pk_mul_f32 v[98:99], v[98:99], s[76:77] op_sel_hi:[1,0]
    v_pk_mul_f32 v[100:101], v[100:101], s[76:77] op_sel_hi:[1,0]
    buffer_load_dwordx4 v18, s[56:59], s11 offen offset:1024 lds
    v_pk_mul_f32 v[102:103], v[102:103], s[76:77] op_sel_hi:[1,0]
    v_exp_f32 v96, v96
    v_exp_f32 v97, v97
    v_exp_f32 v98, v98
    v_exp_f32 v99, v99
    v_exp_f32 v100, v100
    v_exp_f32 v101, v101
    v_exp_f32 v102, v102
    v_exp_f32 v103, v103
    v_pk_add_f32 v[96:97], v[96:97], 1.0 op_sel_hi:[1,0]
    v_pk_add_f32 v[98:99], v[98:99], 1.0 op_sel_hi:[1,0]
    v_pk_add_f32 v[100:101], v[100:101], 1.0 op_sel_hi:[1,0]
    v_pk_add_f32 v[102:103], v[102:103], 1.0 op_sel_hi:[1,0]
    v_rcp_f32 v96, v96
    v_rcp_f32 v97, v97
    v_rcp_f32 v98, v98
    buffer_load_dwordx4 v19, s[56:59], s11 offen offset:2048 lds
    v_rcp_f32 v99, v99
    v_rcp_f32 v100, v100
    v_rcp_f32 v101, v101
    v_rcp_f32 v102, v102
    v_rcp_f32 v103, v103
    v_accvgpr_read_b32 v104, a72
    v_accvgpr_read_b32 v105, a73
    v_accvgpr_read_b32 v106, a74
    v_accvgpr_read_b32 v107, a75
    v_accvgpr_read_b32 v108, a88
    v_accvgpr_read_b32 v109, a89
    v_accvgpr_read_b32 v110, a90
    v_accvgpr_read_b32 v111, a91
    v_pk_mul_f32 v[96:97], v[96:97], v[104:105]
    v_pk_mul_f32 v[98:99], v[98:99], v[106:107]
    v_pk_mul_f32 v[100:101], v[100:101], v[108:109]
    v_pk_mul_f32 v[102:103], v[102:103], v[110:111]
    v_cvt_pk_bf16_f32 v56, v96, v97
    v_cvt_pk_bf16_f32 v57, v98, v99
    v_cvt_pk_bf16_f32 v58, v100, v101
    v_cvt_pk_bf16_f32 v59, v102, v103
    buffer_load_dwordx4 v20, s[56:59], s11 offen offset:3072 lds
    buffer_store_dwordx4 v[56:59], v5, s[44:47], s80 offen offset:1024 sc1
    v_accvgpr_read_b32 v112, a12
    v_accvgpr_read_b32 v113, a13
    v_accvgpr_read_b32 v114, a14
    v_accvgpr_read_b32 v115, a15
    v_accvgpr_read_b32 v116, a28
    v_accvgpr_read_b32 v117, a29
    v_accvgpr_read_b32 v118, a30
    v_accvgpr_read_b32 v119, a31
    v_pk_mul_f32 v[112:113], v[112:113], s[76:77] op_sel_hi:[1,0]
    v_pk_mul_f32 v[114:115], v[114:115], s[76:77] op_sel_hi:[1,0]
    v_pk_mul_f32 v[116:117], v[116:117], s[76:77] op_sel_hi:[1,0]
    v_pk_mul_f32 v[118:119], v[118:119], s[76:77] op_sel_hi:[1,0]
    v_exp_f32 v112, v112
    v_exp_f32 v113, v113
    v_exp_f32 v114, v114
    v_exp_f32 v115, v115
    v_exp_f32 v116, v116
    v_exp_f32 v117, v117
    buffer_load_dwordx4 a[32:35], v3, s[44:47], s83 offen offset:0 sc1
    v_exp_f32 v118, v118
    v_exp_f32 v119, v119
    v_pk_add_f32 v[112:113], v[112:113], 1.0 op_sel_hi:[1,0]
    v_pk_add_f32 v[114:115], v[114:115], 1.0 op_sel_hi:[1,0]
    v_pk_add_f32 v[116:117], v[116:117], 1.0 op_sel_hi:[1,0]
    v_pk_add_f32 v[118:119], v[118:119], 1.0 op_sel_hi:[1,0]
    v_rcp_f32 v112, v112
    v_rcp_f32 v113, v113
    v_rcp_f32 v114, v114
    v_rcp_f32 v115, v115
    v_rcp_f32 v116, v116
    v_rcp_f32 v117, v117
    v_rcp_f32 v118, v118
    v_rcp_f32 v119, v119
    v_accvgpr_read_b32 v120, a76
    v_accvgpr_read_b32 v121, a77
    buffer_load_dwordx4 a[36:39], v3, s[44:47], s83 offen offset:1024 sc1
    v_accvgpr_read_b32 v122, a78
    v_accvgpr_read_b32 v123, a79
    v_accvgpr_read_b32 v124, a92
    v_accvgpr_read_b32 v125, a93
    v_accvgpr_read_b32 v126, a94
    v_accvgpr_read_b32 v127, a95
    v_pk_mul_f32 v[112:113], v[112:113], v[120:121]
    v_pk_mul_f32 v[114:115], v[114:115], v[122:123]
    v_pk_mul_f32 v[116:117], v[116:117], v[124:125]
    v_pk_mul_f32 v[118:119], v[118:119], v[126:127]
    v_cvt_pk_bf16_f32 v60, v112, v113
    v_cvt_pk_bf16_f32 v61, v114, v115
    v_cvt_pk_bf16_f32 v62, v116, v117
    v_cvt_pk_bf16_f32 v63, v118, v119
    buffer_store_dwordx4 v[60:63], v6, s[44:47], s80 offen offset:1024 sc1
    v_cvt_pk_bf16_f32 v192, v192, v193
    v_cvt_pk_bf16_f32 v193, v194, v195
    v_cvt_pk_bf16_f32 v194, v208, v209
    v_cvt_pk_bf16_f32 v195, v210, v211
    v_cvt_pk_bf16_f32 v196, v196, v197
    v_cvt_pk_bf16_f32 v197, v198, v199
    v_cvt_pk_bf16_f32 v198, v212, v213
    v_cvt_pk_bf16_f32 v199, v214, v215
    v_cvt_pk_bf16_f32 v200, v200, v201
    v_cvt_pk_bf16_f32 v201, v202, v203
    v_cvt_pk_bf16_f32 v202, v216, v217
    v_cvt_pk_bf16_f32 v203, v218, v219
    v_cvt_pk_bf16_f32 v204, v204, v205
    v_cvt_pk_bf16_f32 v205, v206, v207
    v_cvt_pk_bf16_f32 v206, v220, v221
    v_cvt_pk_bf16_f32 v207, v222, v223
    v_cvt_pk_bf16_f32 v224, v224, v225
    v_cvt_pk_bf16_f32 v225, v226, v227
    v_cvt_pk_bf16_f32 v226, v240, v241
    v_cvt_pk_bf16_f32 v227, v242, v243
    v_cvt_pk_bf16_f32 v228, v228, v229
    v_cvt_pk_bf16_f32 v229, v230, v231
    v_cvt_pk_bf16_f32 v230, v244, v245
    v_cvt_pk_bf16_f32 v231, v246, v247
    v_cvt_pk_bf16_f32 v232, v232, v233
    v_cvt_pk_bf16_f32 v233, v234, v235
    buffer_load_dwordx4 a[40:43], v4, s[44:47], s83 offen offset:0 sc1
    v_cvt_pk_bf16_f32 v234, v248, v249
    v_cvt_pk_bf16_f32 v235, v250, v251
    v_cvt_pk_bf16_f32 v236, v236, v237
    v_cvt_pk_bf16_f32 v237, v238, v239
    v_cvt_pk_bf16_f32 v238, v252, v253
    v_cvt_pk_bf16_f32 v239, v254, v255
    v_mfma_f32_16x16x32_bf16 v[64:67], a[224:227], v[192:195], 0
    v_mfma_f32_16x16x32_bf16 v[68:71], a[228:231], v[192:195], 0
    v_mfma_f32_16x16x32_bf16 v[80:83], a[224:227], v[196:199], 0
    v_mfma_f32_16x16x32_bf16 v[84:87], a[228:231], v[196:199], 0
    v_mfma_f32_16x16x32_bf16 v[96:99], a[224:227], v[200:203], 0
    v_mfma_f32_16x16x32_bf16 v[100:103], a[228:231], v[200:203], 0
    v_mfma_f32_16x16x32_bf16 v[112:115], a[224:227], v[204:207], 0
    v_mfma_f32_16x16x32_bf16 v[116:119], a[228:231], v[204:207], 0
    s_nop 0
    v_max3_f32 v22, v64, v65, v66
    v_max3_f32 v23, -v64, -v65, -v66
    v_max3_f32 v22, v22, v67, v68
    v_max3_f32 v23, v23, -v67, -v68
    v_max3_f32 v22, v22, v69, v70
    v_max3_f32 v23, v23, -v69, -v70
    v_max_f32 v22, v22, v71
    v_max_f32_e64 v23, v23, -v71
    v_max3_f32 v24, v80, v81, v82
    v_max3_f32 v25, -v80, -v81, -v82
    v_max3_f32 v24, v24, v83, v84
    v_max3_f32 v25, v25, -v83, -v84
    v_max3_f32 v24, v24, v85, v86
    v_max3_f32 v25, v25, -v85, -v86
    v_max_f32 v24, v24, v87
    v_max_f32_e64 v25, v25, -v87
    v_max3_f32 v26, v96, v97, v98
    v_max3_f32 v27, -v96, -v97, -v98
    v_max3_f32 v26, v26, v99, v100
    v_max3_f32 v27, v27, -v99, -v100
    buffer_load_dwordx4 a[44:47], v4, s[44:47], s83 offen offset:1024 sc1
    v_max3_f32 v26, v26, v101, v102
    v_max3_f32 v27, v27, -v101, -v102
    v_max_f32 v26, v26, v103
    v_max_f32_e64 v27, v27, -v103
    v_max3_f32 v28, v112, v113, v114
    v_max3_f32 v29, -v112, -v113, -v114
    v_max3_f32 v28, v28, v115, v116
    v_max3_f32 v29, v29, -v115, -v116
    v_max3_f32 v28, v28, v117, v118
    v_max3_f32 v29, v29, -v117, -v118
    v_max_f32 v28, v28, v119
    v_max_f32_e64 v29, v29, -v119
    v_permlane32_swap_b32 v22, v23
    v_permlane32_swap_b32 v24, v25
    v_permlane32_swap_b32 v26, v27
    v_permlane32_swap_b32 v28, v29
    v_max_f32 v22, v22, v23
    v_max_f32 v24, v24, v25
    v_max_f32 v26, v26, v27
    v_max_f32 v28, v28, v29
    v_permlane16_swap_b32 v22, v24
    s_nop 0
    v_permlane16_swap_b32 v26, v28
    v_max_f32 v22, v22, v24
    v_max_f32 v26, v26, v28
    v_mul_f32 v22, s76, v22
    v_mul_f32 v26, s76, v26
    buffer_load_dwordx4 a[48:51], v5, s[44:47], s83 offen offset:0 sc1
    v_mov_b32 v24, v22
    v_mov_b32 v28, v26
    s_nop 0
    v_permlane16_swap_b32 v22, v24
    v_permlane16_swap_b32 v26, v28
    v_mov_b32 v23, v22
    v_mov_b32 v25, v24
    v_mov_b32 v27, v26
    v_mov_b32 v29, v28
    v_permlane32_swap_b32 v22, v23
    v_permlane32_swap_b32 v24, v25
    v_permlane32_swap_b32 v26, v27
    v_permlane32_swap_b32 v28, v29
    v_pk_fma_f32 v[72:73], v[64:65], s[76:77], v[22:23] op_sel:[0,1,0] op_sel_hi:[1,1,0]
    v_pk_fma_f32 v[74:75], v[66:67], s[76:77], v[22:23] op_sel:[0,1,0] op_sel_hi:[1,1,0]
    v_pk_fma_f32 v[76:77], v[68:69], s[76:77], v[22:23] op_sel:[0,1,0] op_sel_hi:[1,1,0]
    v_pk_fma_f32 v[78:79], v[70:71], s[76:77], v[22:23] op_sel:[0,1,0] op_sel_hi:[1,1,0]
    v_pk_fma_f32 v[64:65], v[64:65], s[76:77], v[22:23] op_sel:[0,0,1] op_sel_hi:[1,0,1]
    v_pk_fma_f32 v[66:67], v[66:67], s[76:77], v[22:23] op_sel:[0,0,1] op_sel_hi:[1,0,1]
    v_pk_fma_f32 v[68:69], v[68:69], s[76:77], v[22:23] op_sel:[0,0,1] op_sel_hi:[1,0,1]
    v_pk_fma_f32 v[70:71], v[70:71], s[76:77], v[22:23] op_sel:[0,0,1] op_sel_hi:[1,0,1]
    v_exp_f32 v72, v72
    v_exp_f32 v73, v73
    v_exp_f32 v74, v74
    buffer_load_dwordx4 a[52:55], v5, s[44:47], s83 offen offset:1024 sc1
    v_exp_f32 v75, v75
    v_exp_f32 v76, v76
    v_exp_f32 v77, v77
    v_exp_f32 v78, v78
    v_exp_f32 v79, v79
    v_exp_f32 v64, v64
    v_exp_f32 v65, v65
    v_exp_f32 v66, v66
    v_exp_f32 v67, v67
    v_exp_f32 v68, v68
    v_exp_f32 v69, v69
    v_exp_f32 v70, v70
    v_exp_f32 v71, v71
    buffer_load_dwordx4 a[56:59], v6, s[44:47], s83 offen offset:0 sc1
    v_pk_fma_f32 v[88:89], v[80:81], s[76:77], v[24:25] op_sel:[0,1,0] op_sel_hi:[1,1,0]
    v_pk_fma_f32 v[90:91], v[82:83], s[76:77], v[24:25] op_sel:[0,1,0] op_sel_hi:[1,1,0]
    v_pk_fma_f32 v[92:93], v[84:85], s[76:77], v[24:25] op_sel:[0,1,0] op_sel_hi:[1,1,0]
    v_pk_fma_f32 v[94:95], v[86:87], s[76:77], v[24:25] op_sel:[0,1,0] op_sel_hi:[1,1,0]
    v_pk_fma_f32 v[80:81], v[80:81], s[76:77], v[24:25] op_sel:[0,0,1] op_sel_hi:[1,0,1]
    v_pk_fma_f32 v[82:83], v[82:83], s[76:77], v[24:25] op_sel:[0,0,1] op_sel_hi:[1,0,1]
    v_pk_fma_f32 v[84:85], v[84:85], s[76:77], v[24:25] op_sel:[0,0,1] op_sel_hi:[1,0,1]
    v_pk_fma_f32 v[86:87], v[86:87], s[76:77], v[24:25] op_sel:[0,0,1] op_sel_hi:[1,0,1]
    v_exp_f32 v88, v88
    v_exp_f32 v89, v89
    v_exp_f32 v90, v90
    v_exp_f32 v91, v91
    v_exp_f32 v92, v92
    v_exp_f32 v93, v93
    v_exp_f32 v94, v94
    v_exp_f32 v95, v95
    v_exp_f32 v80, v80
    buffer_load_dwordx4 a[60:63], v6, s[44:47], s83 offen offset:1024 sc1
    v_exp_f32 v81, v81
    v_exp_f32 v82, v82
    v_exp_f32 v83, v83
    v_exp_f32 v84, v84
    v_exp_f32 v85, v85
    v_exp_f32 v86, v86
    v_exp_f32 v87, v87
    v_pk_fma_f32 v[104:105], v[96:97], s[76:77], v[26:27] op_sel:[0,1,0] op_sel_hi:[1,1,0]
    v_pk_fma_f32 v[106:107], v[98:99], s[76:77], v[26:27] op_sel:[0,1,0] op_sel_hi:[1,1,0]
    v_pk_fma_f32 v[108:109], v[100:101], s[76:77], v[26:27] op_sel:[0,1,0] op_sel_hi:[1,1,0]
    v_pk_fma_f32 v[110:111], v[102:103], s[76:77], v[26:27] op_sel:[0,1,0] op_sel_hi:[1,1,0]
    v_pk_fma_f32 v[96:97], v[96:97], s[76:77], v[26:27] op_sel:[0,0,1] op_sel_hi:[1,0,1]
    v_pk_fma_f32 v[98:99], v[98:99], s[76:77], v[26:27] op_sel:[0,0,1] op_sel_hi:[1,0,1]
    v_pk_fma_f32 v[100:101], v[100:101], s[76:77], v[26:27] op_sel:[0,0,1] op_sel_hi:[1,0,1]
    v_pk_fma_f32 v[102:103], v[102:103], s[76:77], v[26:27] op_sel:[0,0,1] op_sel_hi:[1,0,1]
    v_exp_f32 v104, v104
    v_exp_f32 v105, v105
    buffer_load_dwordx4 a[0:3], v3, s[44:47], s85 offen offset:0 sc1
    v_exp_f32 v106, v106
    v_exp_f32 v107, v107
    v_exp_f32 v108, v108
    v_exp_f32 v109, v109
    v_exp_f32 v110, v110
    v_exp_f32 v111, v111
    v_exp_f32 v96, v96
    v_exp_f32 v97, v97
    v_exp_f32 v98, v98
    v_exp_f32 v99, v99
    v_exp_f32 v100, v100
    v_exp_f32 v101, v101
    v_exp_f32 v102, v102
    buffer_load_dwordx4 a[4:7], v3, s[44:47], s85 offen offset:1024 sc1
    v_exp_f32 v103, v103
    v_pk_fma_f32 v[120:121], v[112:113], s[76:77], v[28:29] op_sel:[0,1,0] op_sel_hi:[1,1,0]
    v_pk_fma_f32 v[122:123], v[114:115], s[76:77], v[28:29] op_sel:[0,1,0] op_sel_hi:[1,1,0]
    v_pk_fma_f32 v[124:125], v[116:117], s[76:77], v[28:29] op_sel:[0,1,0] op_sel_hi:[1,1,0]
    v_pk_fma_f32 v[126:127], v[118:119], s[76:77], v[28:29] op_sel:[0,1,0] op_sel_hi:[1,1,0]
    v_pk_fma_f32 v[112:113], v[112:113], s[76:77], v[28:29] op_sel:[0,0,1] op_sel_hi:[1,0,1]
    v_pk_fma_f32 v[114:115], v[114:115], s[76:77], v[28:29] op_sel:[0,0,1] op_sel_hi:[1,0,1]
    v_pk_fma_f32 v[116:117], v[116:117], s[76:77], v[28:29] op_sel:[0,0,1] op_sel_hi:[1,0,1]
    v_pk_fma_f32 v[118:119], v[118:119], s[76:77], v[28:29] op_sel:[0,0,1] op_sel_hi:[1,0,1]
    v_exp_f32 v120, v120
    v_exp_f32 v121, v121
    v_exp_f32 v122, v122
    v_exp_f32 v123, v123
    v_exp_f32 v124, v124
    v_exp_f32 v125, v125
    v_exp_f32 v126, v126
    v_exp_f32 v127, v127
    buffer_load_dwordx4 a[8:11], v4, s[44:47], s85 offen offset:0 sc1
    v_exp_f32 v112, v112
    v_exp_f32 v113, v113
    v_exp_f32 v114, v114
    v_exp_f32 v115, v115
    v_exp_f32 v116, v116
    v_exp_f32 v117, v117
    v_exp_f32 v118, v118
    v_exp_f32 v119, v119
    v_cvt_pk_bf16_f32 v72, v72, v73
    v_cvt_pk_bf16_f32 v73, v74, v75
    v_cvt_pk_bf16_f32 v74, v76, v77
    v_cvt_pk_bf16_f32 v75, v78, v79
    v_cvt_pk_bf16_f32 v64, v64, v65
    v_cvt_pk_bf16_f32 v65, v66, v67
    v_cvt_pk_bf16_f32 v66, v68, v69
    v_cvt_pk_bf16_f32 v67, v70, v71
    v_accvgpr_write_b32 a64, v72
    v_accvgpr_write_b32 a65, v73
    buffer_load_dwordx4 a[12:15], v4, s[44:47], s85 offen offset:1024 sc1
    v_accvgpr_write_b32 a66, v74
    v_accvgpr_write_b32 a67, v75
    v_accvgpr_write_b32 a80, v64
    v_accvgpr_write_b32 a81, v65
    v_accvgpr_write_b32 a82, v66
    v_accvgpr_write_b32 a83, v67
    v_cvt_pk_bf16_f32 v88, v88, v89
    v_cvt_pk_bf16_f32 v89, v90, v91
    v_cvt_pk_bf16_f32 v90, v92, v93
    v_cvt_pk_bf16_f32 v91, v94, v95
    v_cvt_pk_bf16_f32 v80, v80, v81
    v_cvt_pk_bf16_f32 v81, v82, v83
    v_cvt_pk_bf16_f32 v82, v84, v85
    v_cvt_pk_bf16_f32 v83, v86, v87
    v_accvgpr_write_b32 a68, v88
    v_accvgpr_write_b32 a69, v89
    v_accvgpr_write_b32 a70, v90
    v_accvgpr_write_b32 a71, v91
    v_accvgpr_write_b32 a84, v80
    v_accvgpr_write_b32 a85, v81
    v_accvgpr_write_b32 a86, v82
    v_accvgpr_write_b32 a87, v83
    v_cvt_pk_bf16_f32 v104, v104, v105
    s_waitcnt vmcnt(10)
    s_add_u32 s74, s66, 57344
    s_mov_b64 exec, 1
    buffer_store_dword v21, off, s[52:55], s74 sc1
    s_mov_b64 exec, -1
    buffer_load_dwordx4 a[16:19], v5, s[44:47], s85 offen offset:0 sc1
    v_cvt_pk_bf16_f32 v105, v106, v107
    v_cvt_pk_bf16_f32 v106, v108, v109
    v_cvt_pk_bf16_f32 v107, v110, v111
    v_cvt_pk_bf16_f32 v96, v96, v97
    v_cvt_pk_bf16_f32 v97, v98, v99
    v_cvt_pk_bf16_f32 v98, v100, v101
    v_cvt_pk_bf16_f32 v99, v102, v103
    v_accvgpr_write_b32 a72, v104
    v_accvgpr_write_b32 a73, v105
    v_accvgpr_write_b32 a74, v106
    v_accvgpr_write_b32 a75, v107
    v_accvgpr_write_b32 a88, v96
    v_accvgpr_write_b32 a89, v97
    v_accvgpr_write_b32 a90, v98
    v_accvgpr_write_b32 a91, v99
    v_cvt_pk_bf16_f32 v120, v120, v121
    v_cvt_pk_bf16_f32 v121, v122, v123
    v_cvt_pk_bf16_f32 v122, v124, v125
    v_cvt_pk_bf16_f32 v123, v126, v127
    v_cvt_pk_bf16_f32 v112, v112, v113
    v_cvt_pk_bf16_f32 v113, v114, v115
    v_cvt_pk_bf16_f32 v114, v116, v117
    v_cvt_pk_bf16_f32 v115, v118, v119
    v_accvgpr_write_b32 a76, v120
    v_accvgpr_write_b32 a77, v121
    v_accvgpr_write_b32 a78, v122
    buffer_load_dwordx4 a[20:23], v5, s[44:47], s85 offen offset:1024 sc1
    v_accvgpr_write_b32 a79, v123
    v_accvgpr_write_b32 a92, v112
    v_accvgpr_write_b32 a93, v113
    v_accvgpr_write_b32 a94, v114
    v_accvgpr_write_b32 a95, v115
    ds_read_b64_tr_b16 a[192:193], v9 offset:4096
    ds_read_b64_tr_b16 a[194:195], v9 offset:24576
    ds_read_b64_tr_b16 a[196:197], v9 offset:5120
    ds_read_b64_tr_b16 a[198:199], v9 offset:25600
    ds_read_b64_tr_b16 a[200:201], v10 offset:4096
    ds_read_b64_tr_b16 a[202:203], v10 offset:24576
    ds_read_b64_tr_b16 a[204:205], v10 offset:5120
    ds_read_b64_tr_b16 a[206:207], v10 offset:25600
    s_waitcnt lgkmcnt(4)
    v_mfma_f32_16x16x32_bf16 v[64:67], a[192:195], v[128:131], 0
    ds_read_b64_tr_b16 a[208:209], v9 offset:4608
    v_mfma_f32_16x16x32_bf16 v[64:67], a[196:199], v[160:163], v[64:67]
    v_mfma_f32_16x16x32_bf16 v[68:71], a[196:199], v[164:167], 0
    ds_read_b64_tr_b16 a[210:211], v9 offset:25088
    v_mfma_f32_16x16x32_bf16 v[68:71], a[192:195], v[132:135], v[68:71]
    buffer_load_dwordx4 a[24:27], v6, s[44:47], s85 offen offset:0 sc1
    v_mfma_f32_16x16x32_bf16 v[72:75], a[192:195], v[136:139], 0
    ds_read_b64_tr_b16 a[212:213], v9 offset:5632
    v_mfma_f32_16x16x32_bf16 v[72:75], a[196:199], v[168:171], v[72:75]
    v_mfma_f32_16x16x32_bf16 v[76:79], a[196:199], v[172:175], 0
    ds_read_b64_tr_b16 a[214:215], v9 offset:26112
    v_mfma_f32_16x16x32_bf16 v[76:79], a[192:195], v[140:143], v[76:79]
    s_waitcnt vmcnt(51) lgkmcnt(4)
    s_barrier
    v_mfma_f32_16x16x32_bf16 v[92:95], a[200:203], v[140:143], 0
    ds_read_b64_tr_b16 a[216:217], v10 offset:4608
    v_mfma_f32_16x16x32_bf16 v[92:95], a[204:207], v[172:175], v[92:95]
    buffer_load_dwordx4 a[28:31], v6, s[44:47], s85 offen offset:1024 sc1
    v_mfma_f32_16x16x32_bf16 v[88:91], a[204:207], v[168:171], 0
    ds_read_b64_tr_b16 a[218:219], v10 offset:25088
    v_mfma_f32_16x16x32_bf16 v[88:91], a[200:203], v[136:139], v[88:91]
    v_mfma_f32_16x16x32_bf16 v[84:87], a[200:203], v[132:135], 0
    ds_read_b64_tr_b16 a[220:221], v10 offset:5632
    v_mfma_f32_16x16x32_bf16 v[84:87], a[204:207], v[164:167], v[84:87]
    buffer_load_dwordx4 a[160:163], v3, s[44:47], s87 offen offset:0 sc1
    v_mfma_f32_16x16x32_bf16 v[80:83], a[204:207], v[160:163], 0
    ds_read_b64_tr_b16 a[222:223], v10 offset:26112
    v_mfma_f32_16x16x32_bf16 v[80:83], a[200:203], v[128:131], v[80:83]
    s_waitcnt lgkmcnt(4)
    v_mfma_f32_16x16x32_bf16 v[96:99], a[208:211], v[128:131], 0
    ds_read_b64_tr_b16 a[192:193], v9 offset:6144
    v_mfma_f32_16x16x32_bf16 v[96:99], a[212:215], v[160:163], v[96:99]
    buffer_load_dwordx4 a[164:167], v3, s[44:47], s87 offen offset:1024 sc1
    v_mfma_f32_16x16x32_bf16 v[100:103], a[212:215], v[164:167], 0
    ds_read_b64_tr_b16 a[194:195], v9 offset:26624
    v_mfma_f32_16x16x32_bf16 v[100:103], a[208:211], v[132:135], v[100:103]
    v_mfma_f32_16x16x32_bf16 v[104:107], a[208:211], v[136:139], 0
    ds_read_b64_tr_b16 a[196:197], v9 offset:7168
    v_mfma_f32_16x16x32_bf16 v[104:107], a[212:215], v[168:171], v[104:107]
    buffer_load_dwordx4 a[168:171], v4, s[44:47], s87 offen offset:0 sc1
    v_mfma_f32_16x16x32_bf16 v[108:111], a[212:215], v[172:175], 0
    ds_read_b64_tr_b16 a[198:199], v9 offset:27648
    v_mfma_f32_16x16x32_bf16 v[108:111], a[208:211], v[140:143], v[108:111]
    s_waitcnt lgkmcnt(4)
    v_mfma_f32_16x16x32_bf16 v[124:127], a[216:219], v[140:143], 0
    ds_read_b64_tr_b16 a[200:201], v10 offset:6144
    v_mfma_f32_16x16x32_bf16 v[124:127], a[220:223], v[172:175], v[124:127]
    buffer_load_dwordx4 a[172:175], v4, s[44:47], s87 offen offset:1024 sc1
    v_mfma_f32_16x16x32_bf16 v[120:123], a[220:223], v[168:171], 0
    ds_read_b64_tr_b16 a[202:203], v10 offset:26624
    v_mfma_f32_16x16x32_bf16 v[120:123], a[216:219], v[136:139], v[120:123]
    v_mfma_f32_16x16x32_bf16 v[116:119], a[216:219], v[132:135], 0
    ds_read_b64_tr_b16 a[204:205], v10 offset:7168
    v_mfma_f32_16x16x32_bf16 v[116:119], a[220:223], v[164:167], v[116:119]
    buffer_load_dwordx4 a[176:179], v5, s[44:47], s87 offen offset:0 sc1
    v_mfma_f32_16x16x32_bf16 v[112:115], a[220:223], v[160:163], 0
    ds_read_b64_tr_b16 a[206:207], v10 offset:27648
    v_mfma_f32_16x16x32_bf16 v[112:115], a[216:219], v[128:131], v[112:115]
    s_waitcnt lgkmcnt(4)
    v_mfma_f32_16x16x32_bf16 v[144:147], a[192:195], v[128:131], 0
    ds_read_b64_tr_b16 a[208:209], v9 offset:6656
    v_mfma_f32_16x16x32_bf16 v[144:147], a[196:199], v[160:163], v[144:147]
    buffer_load_dwordx4 a[180:183], v5, s[44:47], s87 offen offset:1024 sc1
    v_mfma_f32_16x16x32_bf16 v[148:151], a[196:199], v[164:167], 0
    ds_read_b64_tr_b16 a[210:211], v9 offset:27136
    v_mfma_f32_16x16x32_bf16 v[148:151], a[192:195], v[132:135], v[148:151]
    v_mfma_f32_16x16x32_bf16 v[152:155], a[192:195], v[136:139], 0
    ds_read_b64_tr_b16 a[212:213], v9 offset:7680
    v_mfma_f32_16x16x32_bf16 v[152:155], a[196:199], v[168:171], v[152:155]
    buffer_load_dwordx4 a[184:187], v6, s[44:47], s87 offen offset:0 sc1
    v_mfma_f32_16x16x32_bf16 v[156:159], a[196:199], v[172:175], 0
    ds_read_b64_tr_b16 a[214:215], v9 offset:28160
    v_mfma_f32_16x16x32_bf16 v[156:159], a[192:195], v[140:143], v[156:159]
    s_waitcnt lgkmcnt(4)
    v_mfma_f32_16x16x32_bf16 v[188:191], a[200:203], v[140:143], 0
    ds_read_b64_tr_b16 a[216:217], v10 offset:6656
    v_mfma_f32_16x16x32_bf16 v[188:191], a[204:207], v[172:175], v[188:191]
    buffer_load_dwordx4 a[188:191], v6, s[44:47], s87 offen offset:1024 sc1
    v_mfma_f32_16x16x32_bf16 v[184:187], a[204:207], v[168:171], 0
    ds_read_b64_tr_b16 a[218:219], v10 offset:27136
    v_mfma_f32_16x16x32_bf16 v[184:187], a[200:203], v[136:139], v[184:187]
    v_mfma_f32_16x16x32_bf16 v[180:183], a[200:203], v[132:135], 0
    ds_read_b64_tr_b16 a[220:221], v10 offset:7680
    s_add_u32 m0, s19, 122880
    v_mfma_f32_16x16x32_bf16 v[180:183], a[204:207], v[164:167], v[180:183]
    s_lshl_b32 s11, s86, 4
    v_mfma_f32_16x16x32_bf16 v[176:179], a[204:207], v[160:163], 0
    ds_read_b64_tr_b16 a[222:223], v10 offset:28160
    v_mfma_f32_16x16x32_bf16 v[176:179], a[200:203], v[128:131], v[176:179]
    s_waitcnt lgkmcnt(4)
    v_mfma_f32_16x16x32_bf16 v[208:211], a[208:211], v[128:131], 0
    ds_read_b64_tr_b16 a[192:193], v11 offset:4096
    v_mfma_f32_16x16x32_bf16 v[208:211], a[212:215], v[160:163], v[208:211]
    buffer_load_dwordx4 v17, s[56:59], s11 offen offset:0 lds
    v_mfma_f32_16x16x32_bf16 v[212:215], a[212:215], v[164:167], 0
    ds_read_b64_tr_b16 a[194:195], v11 offset:24576
    v_mfma_f32_16x16x32_bf16 v[212:215], a[208:211], v[132:135], v[212:215]
    v_mfma_f32_16x16x32_bf16 v[216:219], a[208:211], v[136:139], 0
    ds_read_b64_tr_b16 a[196:197], v11 offset:5120
    v_mfma_f32_16x16x32_bf16 v[216:219], a[212:215], v[168:171], v[216:219]
    buffer_load_dwordx4 v18, s[56:59], s11 offen offset:1024 lds
    v_mfma_f32_16x16x32_bf16 v[220:223], a[212:215], v[172:175], 0
    ds_read_b64_tr_b16 a[198:199], v11 offset:25600
    v_mfma_f32_16x16x32_bf16 v[220:223], a[208:211], v[140:143], v[220:223]
    s_waitcnt lgkmcnt(4)
    v_mfma_f32_16x16x32_bf16 v[252:255], a[216:219], v[140:143], 0
    ds_read_b64_tr_b16 a[200:201], v12 offset:4096
    v_mfma_f32_16x16x32_bf16 v[252:255], a[220:223], v[172:175], v[252:255]
    buffer_load_dwordx4 v19, s[56:59], s11 offen offset:2048 lds
    v_mfma_f32_16x16x32_bf16 v[248:251], a[220:223], v[168:171], 0
    ds_read_b64_tr_b16 a[202:203], v12 offset:24576
    v_mfma_f32_16x16x32_bf16 v[248:251], a[216:219], v[136:139], v[248:251]
    v_mfma_f32_16x16x32_bf16 v[244:247], a[216:219], v[132:135], 0
    ds_read_b64_tr_b16 a[204:205], v12 offset:5120
    v_mfma_f32_16x16x32_bf16 v[244:247], a[220:223], v[164:167], v[244:247]
    buffer_load_dwordx4 v20, s[56:59], s11 offen offset:3072 lds
    v_mfma_f32_16x16x32_bf16 v[240:243], a[220:223], v[160:163], 0
    ds_read_b64_tr_b16 a[206:207], v12 offset:25600
    v_mfma_f32_16x16x32_bf16 v[240:243], a[216:219], v[128:131], v[240:243]
    s_waitcnt lgkmcnt(4)
    v_mfma_f32_16x16x32_bf16 v[64:67], a[192:195], v[32:35], v[64:67]
    ds_read_b64_tr_b16 a[208:209], v11 offset:4608
    s_add_u32 m0, s19, 90112
    v_mfma_f32_16x16x32_bf16 v[128:131], a[232:235], v[224:227], 0
    v_mfma_f32_16x16x32_bf16 v[132:135], a[236:239], v[224:227], 0
    v_mfma_f32_16x16x32_bf16 v[160:163], a[232:235], v[228:231], 0
    v_mfma_f32_16x16x32_bf16 v[164:167], a[236:239], v[228:231], 0
    v_mfma_f32_16x16x32_bf16 v[64:67], a[196:199], v[48:51], v[64:67]
    s_lshl_b32 s11, s92, 4
    v_mfma_f32_16x16x32_bf16 v[68:71], a[196:199], v[52:55], v[68:71]
    ds_read_b64_tr_b16 a[210:211], v11 offset:25088
    v_mfma_f32_16x16x32_bf16 v[68:71], a[192:195], v[36:39], v[68:71]
    buffer_load_dwordx4 v17, s[56:59], s11 offen offset:0 lds
    v_max3_f32 v22, v128, v129, v130
    v_mfma_f32_16x16x32_bf16 v[72:75], a[192:195], v[40:43], v[72:75]
    ds_read_b64_tr_b16 a[212:213], v11 offset:5632
    v_max3_f32 v23, -v128, -v129, -v130
    v_mfma_f32_16x16x32_bf16 v[72:75], a[196:199], v[56:59], v[72:75]
    v_max3_f32 v22, v22, v131, v132
    v_max3_f32 v23, v23, -v131, -v132
    v_mfma_f32_16x16x32_bf16 v[76:79], a[196:199], v[60:63], v[76:79]
    ds_read_b64_tr_b16 a[214:215], v11 offset:26112
    v_max3_f32 v22, v22, v133, v134
    v_mfma_f32_16x16x32_bf16 v[76:79], a[192:195], v[44:47], v[76:79]
    s_waitcnt vmcnt(59) lgkmcnt(4)
    s_barrier
    v_mfma_f32_16x16x32_bf16 v[92:95], a[200:203], v[44:47], v[92:95]
    ds_read_b64_tr_b16 a[216:217], v12 offset:4608
    v_max3_f32 v23, v23, -v133, -v134
    v_mfma_f32_16x16x32_bf16 v[92:95], a[204:207], v[60:63], v[92:95]
    buffer_load_dwordx4 v18, s[56:59], s11 offen offset:1024 lds
    v_max_f32 v22, v22, v135
    v_mfma_f32_16x16x32_bf16 v[88:91], a[204:207], v[56:59], v[88:91]
    ds_read_b64_tr_b16 a[218:219], v12 offset:25088
    v_max_f32_e64 v23, v23, -v135
    v_mfma_f32_16x16x32_bf16 v[88:91], a[200:203], v[40:43], v[88:91]
    v_max3_f32 v24, v160, v161, v162
    v_max3_f32 v25, -v160, -v161, -v162
    v_mfma_f32_16x16x32_bf16 v[84:87], a[200:203], v[36:39], v[84:87]
    ds_read_b64_tr_b16 a[220:221], v12 offset:5632
    s_add_u32 m0, s19, 129024
    v_mfma_f32_16x16x32_bf16 v[84:87], a[204:207], v[52:55], v[84:87]
    buffer_load_dwordx4 v19, s[56:59], s11 offen offset:2048 lds
    v_max3_f32 v24, v24, v163, v164
    v_mfma_f32_16x16x32_bf16 v[80:83], a[204:207], v[48:51], v[80:83]
    ds_read_b64_tr_b16 a[222:223], v12 offset:26112
    v_max3_f32 v25, v25, -v163, -v164
    v_mfma_f32_16x16x32_bf16 v[80:83], a[200:203], v[32:35], v[80:83]
    v_max3_f32 v24, v24, v165, v166
    s_waitcnt lgkmcnt(4)
    v_mfma_f32_16x16x32_bf16 v[96:99], a[208:211], v[32:35], v[96:99]
    ds_read_b64_tr_b16 a[192:193], v11 offset:6144
    v_max3_f32 v25, v25, -v165, -v166
    v_mfma_f32_16x16x32_bf16 v[96:99], a[212:215], v[48:51], v[96:99]
    buffer_load_dwordx4 v20, s[56:59], s11 offen offset:3072 lds
    v_max_f32 v24, v24, v167
    v_mfma_f32_16x16x32_bf16 v[100:103], a[212:215], v[52:55], v[100:103]
    ds_read_b64_tr_b16 a[194:195], v11 offset:26624
    v_max_f32_e64 v25, v25, -v167
    v_mfma_f32_16x16x32_bf16 v[100:103], a[208:211], v[36:39], v[100:103]
    v_permlane32_swap_b32 v22, v23
    v_permlane32_swap_b32 v24, v25
    v_mfma_f32_16x16x32_bf16 v[104:107], a[208:211], v[40:43], v[104:107]
    ds_read_b64_tr_b16 a[196:197], v11 offset:7168
    s_add_u32 m0, s19, 45056
    v_mfma_f32_16x16x32_bf16 v[104:107], a[212:215], v[56:59], v[104:107]
    s_lshl_b32 s11, s93, 4
    v_max_f32 v22, v22, v23
    v_mfma_f32_16x16x32_bf16 v[108:111], a[212:215], v[60:63], v[108:111]
    ds_read_b64_tr_b16 a[198:199], v11 offset:27648
    v_max_f32 v24, v24, v25
    v_mfma_f32_16x16x32_bf16 v[108:111], a[208:211], v[44:47], v[108:111]
    s_waitcnt lgkmcnt(4)
    v_mfma_f32_16x16x32_bf16 v[124:127], a[216:219], v[44:47], v[124:127]
    ds_read_b64_tr_b16 a[200:201], v12 offset:6144
    v_permlane16_swap_b32 v22, v24
    v_mfma_f32_16x16x32_bf16 v[124:127], a[220:223], v[60:63], v[124:127]
    buffer_load_dwordx4 v17, s[56:59], s11 offen offset:0 lds
    v_max_f32 v22, v22, v24
    v_mfma_f32_16x16x32_bf16 v[120:123], a[220:223], v[56:59], v[120:123]
    ds_read_b64_tr_b16 a[202:203], v12 offset:26624
    v_mul_f32 v22, s76, v22
    v_mfma_f32_16x16x32_bf16 v[120:123], a[216:219], v[40:43], v[120:123]
    v_mov_b32 v24, v22
    v_mfma_f32_16x16x32_bf16 v[116:119], a[216:219], v[36:39], v[116:119]
    ds_read_b64_tr_b16 a[204:205], v12 offset:7168
    v_permlane16_swap_b32 v22, v24
    v_mfma_f32_16x16x32_bf16 v[116:119], a[220:223], v[52:55], v[116:119]
    buffer_load_dwordx4 v18, s[56:59], s11 offen offset:1024 lds
    v_mov_b32 v23, v22
    v_mfma_f32_16x16x32_bf16 v[112:115], a[220:223], v[48:51], v[112:115]
    ds_read_b64_tr_b16 a[206:207], v12 offset:27648
    v_mov_b32 v25, v24
    v_mfma_f32_16x16x32_bf16 v[112:115], a[216:219], v[32:35], v[112:115]
    v_permlane32_swap_b32 v22, v23
    v_and_b32 v16, 3, v1
    v_lshlrev_b32 v16, 2, v16
    buffer_load_dword v16, v16, s[52:55], s73 offen offset:0 sc1
    s_waitcnt lgkmcnt(4)
    v_mfma_f32_16x16x32_bf16 v[144:147], a[192:195], v[32:35], v[144:147]
    ds_read_b64_tr_b16 a[208:209], v11 offset:6656
    v_permlane32_swap_b32 v24, v25
    v_mfma_f32_16x16x32_bf16 v[144:147], a[196:199], v[48:51], v[144:147]
    buffer_load_dwordx4 v19, s[56:59], s11 offen offset:2048 lds
    v_fma_f32 v136, v128, s77, v22
    v_mfma_f32_16x16x32_bf16 v[148:151], a[196:199], v[52:55], v[148:151]
    ds_read_b64_tr_b16 a[210:211], v11 offset:27136
    v_fma_f32 v137, v129, s77, v22
    v_mfma_f32_16x16x32_bf16 v[148:151], a[192:195], v[36:39], v[148:151]
    v_exp_f32 v136, v136
    v_mfma_f32_16x16x32_bf16 v[152:155], a[192:195], v[40:43], v[152:155]
    ds_read_b64_tr_b16 a[212:213], v11 offset:7680
    v_fma_f32 v138, v130, s77, v22
    v_mfma_f32_16x16x32_bf16 v[152:155], a[196:199], v[56:59], v[152:155]
    buffer_load_dwordx4 v20, s[56:59], s11 offen offset:3072 lds
    v_fma_f32 v139, v131, s77, v22
    v_mfma_f32_16x16x32_bf16 v[156:159], a[196:199], v[60:63], v[156:159]
    ds_read_b64_tr_b16 a[214:215], v11 offset:28160
    v_fma_f32 v140, v132, s77, v22
    v_mfma_f32_16x16x32_bf16 v[156:159], a[192:195], v[44:47], v[156:159]
    v_fma_f32 v141, v133, s77, v22
    s_waitcnt lgkmcnt(4)
    v_mfma_f32_16x16x32_bf16 v[188:191], a[200:203], v[44:47], v[188:191]
    ds_read_b64_tr_b16 a[216:217], v12 offset:6656
    v_fma_f32 v142, v134, s77, v22
    v_mfma_f32_16x16x32_bf16 v[188:191], a[204:207], v[60:63], v[188:191]
    v_exp_f32 v137, v137
    v_mfma_f32_16x16x32_bf16 v[184:187], a[204:207], v[56:59], v[184:187]
    ds_read_b64_tr_b16 a[218:219], v12 offset:27136
    v_fma_f32 v143, v135, s77, v22
    v_mfma_f32_16x16x32_bf16 v[184:187], a[200:203], v[40:43], v[184:187]
    v_exp_f32 v138, v138
    v_mfma_f32_16x16x32_bf16 v[180:183], a[200:203], v[36:39], v[180:183]
    ds_read_b64_tr_b16 a[220:221], v12 offset:7680
    v_fma_f32 v128, v128, s76, v23
    v_mfma_f32_16x16x32_bf16 v[180:183], a[204:207], v[52:55], v[180:183]
    v_exp_f32 v139, v139
    v_mfma_f32_16x16x32_bf16 v[176:179], a[204:207], v[48:51], v[176:179]
    ds_read_b64_tr_b16 a[222:223], v12 offset:28160
    v_fma_f32 v129, v129, s76, v23
    v_mfma_f32_16x16x32_bf16 v[176:179], a[200:203], v[32:35], v[176:179]
    v_fma_f32 v130, v130, s76, v23
    s_waitcnt lgkmcnt(4)
    v_mfma_f32_16x16x32_bf16 v[208:211], a[208:211], v[32:35], v[208:211]
    ds_read_b64_tr_b16 a[192:193], v13 offset:4096
    v_fma_f32 v131, v131, s76, v23
    v_mfma_f32_16x16x32_bf16 v[208:211], a[212:215], v[48:51], v[208:211]
    v_exp_f32 v140, v140
    v_mfma_f32_16x16x32_bf16 v[212:215], a[212:215], v[52:55], v[212:215]
    ds_read_b64_tr_b16 a[194:195], v13 offset:24576
    v_fma_f32 v132, v132, s76, v23
    v_mfma_f32_16x16x32_bf16 v[212:215], a[208:211], v[36:39], v[212:215]
    v_exp_f32 v141, v141
    v_mfma_f32_16x16x32_bf16 v[216:219], a[208:211], v[40:43], v[216:219]
    ds_read_b64_tr_b16 a[196:197], v13 offset:5120
    v_fma_f32 v133, v133, s76, v23
    v_mfma_f32_16x16x32_bf16 v[216:219], a[212:215], v[56:59], v[216:219]
    v_exp_f32 v142, v142
    v_mfma_f32_16x16x32_bf16 v[220:223], a[212:215], v[60:63], v[220:223]
    ds_read_b64_tr_b16 a[198:199], v13 offset:25600
    v_fma_f32 v134, v134, s76, v23
    v_mfma_f32_16x16x32_bf16 v[220:223], a[208:211], v[44:47], v[220:223]
    v_fma_f32 v135, v135, s76, v23
    s_waitcnt lgkmcnt(4)
    v_mfma_f32_16x16x32_bf16 v[252:255], a[216:219], v[44:47], v[252:255]
    ds_read_b64_tr_b16 a[200:201], v14 offset:4096
    v_fma_f32 v168, v160, s77, v24
    v_mfma_f32_16x16x32_bf16 v[252:255], a[220:223], v[60:63], v[252:255]
    v_exp_f32 v143, v143
    v_mfma_f32_16x16x32_bf16 v[248:251], a[220:223], v[56:59], v[248:251]
    ds_read_b64_tr_b16 a[202:203], v14 offset:24576
    v_fma_f32 v169, v161, s77, v24
    v_mfma_f32_16x16x32_bf16 v[248:251], a[216:219], v[40:43], v[248:251]
    v_exp_f32 v128, v128
    v_mfma_f32_16x16x32_bf16 v[244:247], a[216:219], v[36:39], v[244:247]
    ds_read_b64_tr_b16 a[204:205], v14 offset:5120
    v_fma_f32 v170, v162, s77, v24
    v_mfma_f32_16x16x32_bf16 v[244:247], a[220:223], v[52:55], v[244:247]
    v_exp_f32 v129, v129
    v_mfma_f32_16x16x32_bf16 v[240:243], a[220:223], v[48:51], v[240:243]
    ds_read_b64_tr_b16 a[206:207], v14 offset:25600
    v_fma_f32 v171, v163, s77, v24
    v_mfma_f32_16x16x32_bf16 v[240:243], a[216:219], v[32:35], v[240:243]
    v_fma_f32 v172, v164, s77, v24
    s_waitcnt vmcnt(2)
    v_cmp_ne_u32 vcc, s18, v16
    s_cbranch_vccnz L_pl6
L_pl6_b:
    s_waitcnt vmcnt(30) lgkmcnt(4)
    v_mfma_f32_16x16x32_bf16 v[64:67], a[192:195], a[32:35], v[64:67]
    ds_read_b64_tr_b16 a[208:209], v13 offset:4608
    v_lshrrev_b32 v32, 4, v1
    v_mfma_f32_16x16x32_bf16 v[64:67], a[196:199], a[36:39], v[64:67]
    v_exp_f32 v130, v130
    v_mfma_f32_16x16x32_bf16 v[68:71], a[196:199], a[44:47], v[68:71]
    ds_read_b64_tr_b16 a[210:211], v13 offset:25088
    v_bfe_u32 v33, v1, 2, 2
    v_mfma_f32_16x16x32_bf16 v[68:71], a[192:195], a[40:43], v[68:71]
    v_exp_f32 v131, v131
    v_mfma_f32_16x16x32_bf16 v[72:75], a[192:195], a[48:51], v[72:75]
    ds_read_b64_tr_b16 a[212:213], v13 offset:5632
    v_and_b32 v38, 1, v1
    v_mfma_f32_16x16x32_bf16 v[72:75], a[196:199], a[52:55], v[72:75]
    v_exp_f32 v132, v132
    v_mfma_f32_16x16x32_bf16 v[76:79], a[196:199], a[60:63], v[76:79]
    ds_read_b64_tr_b16 a[214:215], v13 offset:26112
    v_lshlrev_b32 v38, 4, v38
    v_mfma_f32_16x16x32_bf16 v[76:79], a[192:195], a[56:59], v[76:79]
    s_waitcnt vmcnt(61) lgkmcnt(4)
    s_barrier
    v_mfma_f32_16x16x32_bf16 v[92:95], a[200:203], a[56:59], v[92:95]
    ds_read_b64_tr_b16 a[216:217], v14 offset:4608
    s_add_u32 m0, s19, 86016
    v_mfma_f32_16x16x32_bf16 v[92:95], a[204:207], a[60:63], v[92:95]
    s_lshl_b32 s11, s88, 4
    v_mov_b32 v39, 0x3f80
    v_mfma_f32_16x16x32_bf16 v[88:91], a[204:207], a[52:55], v[88:91]
    ds_read_b64_tr_b16 a[218:219], v14 offset:25088
    v_lshlrev_b32 v39, v38, v39
    v_mfma_f32_16x16x32_bf16 v[88:91], a[200:203], a[48:51], v[88:91]
    buffer_load_dwordx4 v17, s[56:59], s11 offen offset:0 lds
    v_cmp_eq_u32 s[70:71], v32, v33
    v_mfma_f32_16x16x32_bf16 v[84:87], a[200:203], a[40:43], v[84:87]
    ds_read_b64_tr_b16 a[220:221], v14 offset:5632
    v_cndmask_b32 v39, 0, v39, s[70:71]
    v_mfma_f32_16x16x32_bf16 v[84:87], a[204:207], a[44:47], v[84:87]
    v_exp_f32 v133, v133
    v_mfma_f32_16x16x32_bf16 v[80:83], a[204:207], a[36:39], v[80:83]
    ds_read_b64_tr_b16 a[222:223], v14 offset:26112
    v_and_b32 v38, 2, v1
    v_mfma_f32_16x16x32_bf16 v[80:83], a[200:203], a[32:35], v[80:83]
    v_cmp_eq_u32 s[70:71], 0, v38
    s_waitcnt lgkmcnt(4)
    v_mfma_f32_16x16x32_bf16 v[96:99], a[208:211], a[32:35], v[96:99]
    ds_read_b64_tr_b16 a[192:193], v13 offset:6144
    v_cndmask_b32 v32, 0, v39, s[70:71]
    v_mfma_f32_16x16x32_bf16 v[96:99], a[212:215], a[36:39], v[96:99]
    buffer_load_dwordx4 v18, s[56:59], s11 offen offset:1024 lds
    v_cndmask_b32 v33, v39, 0, s[70:71]
    v_mfma_f32_16x16x32_bf16 v[100:103], a[212:215], a[44:47], v[100:103]
    ds_read_b64_tr_b16 a[194:195], v13 offset:26624
    v_mov_b32 v34, 0
    v_mfma_f32_16x16x32_bf16 v[100:103], a[208:211], a[40:43], v[100:103]
    v_exp_f32 v134, v134
    v_mfma_f32_16x16x32_bf16 v[104:107], a[208:211], a[48:51], v[104:107]
    ds_read_b64_tr_b16 a[196:197], v13 offset:7168
    v_mov_b32 v35, 0
    v_mfma_f32_16x16x32_bf16 v[104:107], a[212:215], a[52:55], v[104:107]
    buffer_load_dwordx4 v19, s[56:59], s11 offen offset:2048 lds
    v_mov_b32 v36, v32
    v_mfma_f32_16x16x32_bf16 v[108:111], a[212:215], a[60:63], v[108:111]
    ds_read_b64_tr_b16 a[198:199], v13 offset:27648
    v_mov_b32 v37, v33
    v_mfma_f32_16x16x32_bf16 v[108:111], a[208:211], a[56:59], v[108:111]
    v_and_b32 v48, 3, v1
    s_waitcnt lgkmcnt(4)
    v_mfma_f32_16x16x32_bf16 v[124:127], a[216:219], a[56:59], v[124:127]
    ds_read_b64_tr_b16 a[200:201], v14 offset:6144
    v_lshlrev_b32 v48, 4, v48
    v_mfma_f32_16x16x32_bf16 v[124:127], a[220:223], a[60:63], v[124:127]
    buffer_load_dwordx4 v20, s[56:59], s11 offen offset:3072 lds
    v_bfe_u32 v49, v1, 2, 1
    v_mfma_f32_16x16x32_bf16 v[120:123], a[220:223], a[52:55], v[120:123]
    ds_read_b64_tr_b16 a[202:203], v14 offset:26624
    v_lshl_add_u32 v48, v49, 3, v48
    v_mfma_f32_16x16x32_bf16 v[120:123], a[216:219], a[48:51], v[120:123]
    v_exp_f32 v135, v135
    v_mfma_f32_16x16x32_bf16 v[116:119], a[216:219], a[40:43], v[116:119]
    ds_read_b64_tr_b16 a[204:205], v14 offset:7168
    v_and_b32 v49, 7, v1
    v_mfma_f32_16x16x32_bf16 v[116:119], a[220:223], a[44:47], v[116:119]
    v_exp_f32 v168, v168
    v_mfma_f32_16x16x32_bf16 v[112:115], a[220:223], a[36:39], v[112:115]
    ds_read_b64_tr_b16 a[206:207], v14 offset:27648
    v_lshlrev_b32 v49, 3, v49
    v_mfma_f32_16x16x32_bf16 v[112:115], a[216:219], a[32:35], v[112:115]
    v_add_u32 v49, 64, v49
    s_waitcnt lgkmcnt(4)
    v_mfma_f32_16x16x32_bf16 v[144:147], a[192:195], a[32:35], v[144:147]
    ds_read_b64_tr_b16 a[208:209], v13 offset:6656
    v_and_b32 v50, 8, v1
    v_mfma_f32_16x16x32_bf16 v[144:147], a[196:199], a[36:39], v[144:147]
    v_exp_f32 v169, v169
    v_mfma_f32_16x16x32_bf16 v[148:151], a[196:199], a[44:47], v[148:151]
    ds_read_b64_tr_b16 a[210:211], v13 offset:27136
    v_cmp_eq_u32 s[70:71], 0, v50
    v_mfma_f32_16x16x32_bf16 v[148:151], a[192:195], a[40:43], v[148:151]
    v_exp_f32 v170, v170
    v_mfma_f32_16x16x32_bf16 v[152:155], a[192:195], a[48:51], v[152:155]
    ds_read_b64_tr_b16 a[212:213], v13 offset:7680
    v_cndmask_b32 v48, v49, v48, s[70:71]
    v_mfma_f32_16x16x32_bf16 v[152:155], a[196:199], a[52:55], v[152:155]
    v_exp_f32 v171, v171
    v_mfma_f32_16x16x32_bf16 v[156:159], a[196:199], a[60:63], v[156:159]
    ds_read_b64_tr_b16 a[214:215], v13 offset:28160
    v_add_u32 v48, s19, v48
    v_mfma_f32_16x16x32_bf16 v[156:159], a[192:195], a[56:59], v[156:159]
    v_lshrrev_b32 v51, 4, v1
    s_waitcnt lgkmcnt(4)
    v_mfma_f32_16x16x32_bf16 v[188:191], a[200:203], a[56:59], v[188:191]
    ds_read_b64_tr_b16 a[216:217], v14 offset:6656
    v_lshlrev_b32 v51, 4, v51
    v_mfma_f32_16x16x32_bf16 v[188:191], a[204:207], a[60:63], v[188:191]
    v_exp_f32 v172, v172
    v_mfma_f32_16x16x32_bf16 v[184:187], a[204:207], a[52:55], v[184:187]
    ds_read_b64_tr_b16 a[218:219], v14 offset:27136
    v_and_b32 v49, 3, v1
    v_mfma_f32_16x16x32_bf16 v[184:187], a[200:203], a[48:51], v[184:187]
    v_cmp_eq_u32 s[94:95], 1, v49
    v_fma_f32 v173, v165, s77, v24
    v_mfma_f32_16x16x32_bf16 v[180:183], a[200:203], a[40:43], v[180:183]
    ds_read_b64_tr_b16 a[220:221], v14 offset:7680
    v_cndmask_b32 v51, v51, 64, s[94:95]
    v_mfma_f32_16x16x32_bf16 v[180:183], a[204:207], a[44:47], v[180:183]
    v_exp_f32 v173, v173
    v_mfma_f32_16x16x32_bf16 v[176:179], a[204:207], a[36:39], v[176:179]
    ds_read_b64_tr_b16 a[222:223], v14 offset:28160
    v_add_u32 v51, 40960, v51
    v_mfma_f32_16x16x32_bf16 v[176:179], a[200:203], a[32:35], v[176:179]
    v_fma_f32 v174, v166, s77, v24
    v_and_b32 v15, 7, v1
    v_lshlrev_b32 v15, 2, v15
    buffer_load_dword v15, v15, s[52:55], s65 offen offset:0 sc1
    s_waitcnt lgkmcnt(4)
    v_mfma_f32_16x16x32_bf16 v[208:211], a[208:211], a[32:35], v[208:211]
    ds_read_b64_tr_b16 a[192:193], v7 offset:0
    v_fma_f32 v175, v167, s77, v24
    v_mfma_f32_16x16x32_bf16 v[208:211], a[212:215], a[36:39], v[208:211]
    v_exp_f32 v174, v174
    v_mfma_f32_16x16x32_bf16 v[212:215], a[212:215], a[44:47], v[212:215]
    ds_read_b64_tr_b16 a[194:195], v7 offset:20480
    v_fma_f32 v160, v160, s76, v25
    v_mfma_f32_16x16x32_bf16 v[212:215], a[208:211], a[40:43], v[212:215]
    v_exp_f32 v175, v175
    v_mfma_f32_16x16x32_bf16 v[216:219], a[208:211], a[48:51], v[216:219]
    ds_read_b64_tr_b16 a[196:197], v7 offset:1024
    v_fma_f32 v161, v161, s76, v25
    v_mfma_f32_16x16x32_bf16 v[216:219], a[212:215], a[52:55], v[216:219]
    v_exp_f32 v160, v160
    v_mfma_f32_16x16x32_bf16 v[220:223], a[212:215], a[60:63], v[220:223]
    ds_read_b64_tr_b16 a[198:199], v7 offset:21504
    v_fma_f32 v162, v162, s76, v25
    v_mfma_f32_16x16x32_bf16 v[220:223], a[208:211], a[56:59], v[220:223]
    v_fma_f32 v163, v163, s76, v25
    s_waitcnt lgkmcnt(4)
    v_mfma_f32_16x16x32_bf16 v[252:255], a[216:219], a[56:59], v[252:255]
    ds_read_b64_tr_b16 a[200:201], v8 offset:0
    v_fma_f32 v164, v164, s76, v25
    v_mfma_f32_16x16x32_bf16 v[252:255], a[220:223], a[60:63], v[252:255]
    v_exp_f32 v161, v161
    v_mfma_f32_16x16x32_bf16 v[248:251], a[220:223], a[52:55], v[248:251]
    ds_read_b64_tr_b16 a[202:203], v8 offset:20480
    v_fma_f32 v165, v165, s76, v25
    v_mfma_f32_16x16x32_bf16 v[248:251], a[216:219], a[48:51], v[248:251]
    v_exp_f32 v162, v162
    v_mfma_f32_16x16x32_bf16 v[244:247], a[216:219], a[40:43], v[244:247]
    ds_read_b64_tr_b16 a[204:205], v8 offset:1024
    v_fma_f32 v166, v166, s76, v25
    v_mfma_f32_16x16x32_bf16 v[244:247], a[220:223], a[44:47], v[244:247]
    v_exp_f32 v163, v163
    v_mfma_f32_16x16x32_bf16 v[240:243], a[220:223], a[36:39], v[240:243]
    ds_read_b64_tr_b16 a[206:207], v8 offset:21504
    v_fma_f32 v167, v167, s76, v25
    v_mfma_f32_16x16x32_bf16 v[240:243], a[216:219], a[32:35], v[240:243]
    v_cvt_pk_bf16_f32 v136, v136, v137
    s_waitcnt vmcnt(26) lgkmcnt(4)
    v_mfma_f32_16x16x32_bf16 v[64:67], a[192:195], a[0:3], v[64:67]
    ds_read_b64_tr_b16 a[208:209], v7 offset:512
    v_cvt_pk_bf16_f32 v137, v138, v139
    v_mfma_f32_16x16x32_bf16 v[64:67], a[196:199], a[4:7], v[64:67]
    buffer_load_dwordx4 a[32:35], v3, s[44:47], s82 offen offset:0 sc1
    v_cvt_pk_bf16_f32 v138, v140, v141
    v_mfma_f32_16x16x32_bf16 v[68:71], a[196:199], a[12:15], v[68:71]
    ds_read_b64_tr_b16 a[210:211], v7 offset:20992
    v_cvt_pk_bf16_f32 v139, v142, v143
    v_mfma_f32_16x16x32_bf16 v[68:71], a[192:195], a[8:11], v[68:71]
    v_exp_f32 v164, v164
    v_mfma_f32_16x16x32_bf16 v[72:75], a[192:195], a[16:19], v[72:75]
    ds_read_b64_tr_b16 a[212:213], v7 offset:1536
    v_cvt_pk_bf16_f32 v128, v128, v129
    v_mfma_f32_16x16x32_bf16 v[72:75], a[196:199], a[20:23], v[72:75]
    buffer_load_dwordx4 a[36:39], v3, s[44:47], s82 offen offset:1024 sc1
    v_cvt_pk_bf16_f32 v129, v130, v131
    v_mfma_f32_16x16x32_bf16 v[76:79], a[196:199], a[28:31], v[76:79]
    ds_read_b64_tr_b16 a[214:215], v7 offset:22016
    v_cvt_pk_bf16_f32 v130, v132, v133
    v_mfma_f32_16x16x32_bf16 v[76:79], a[192:195], a[24:27], v[76:79]
    s_waitcnt vmcnt(63) lgkmcnt(4)
    s_barrier
    v_mfma_f32_16x16x32_bf16 v[92:95], a[200:203], a[24:27], v[92:95]
    ds_read_b64_tr_b16 a[216:217], v8 offset:512
    v_cvt_pk_bf16_f32 v131, v134, v135
    v_mfma_f32_16x16x32_bf16 v[132:135], a[236:239], v[232:235], 0
    v_exp_f32 v165, v165
    v_mfma_f32_16x16x32_bf16 v[92:95], a[204:207], a[28:31], v[92:95]
    buffer_load_dwordx4 a[40:43], v4, s[44:47], s82 offen offset:0 sc1
    v_accvgpr_write_b32 a224, v136
    v_mfma_f32_16x16x32_bf16 v[88:91], a[204:207], a[20:23], v[88:91]
    ds_read_b64_tr_b16 a[218:219], v8 offset:20992
    v_accvgpr_write_b32 a225, v137
    v_mfma_f32_16x16x32_bf16 v[88:91], a[200:203], a[16:19], v[88:91]
    v_exp_f32 v166, v166
    v_mfma_f32_16x16x32_bf16 v[84:87], a[200:203], a[8:11], v[84:87]
    ds_read_b64_tr_b16 a[220:221], v8 offset:1536
    v_accvgpr_write_b32 a226, v138
    v_mfma_f32_16x16x32_bf16 v[84:87], a[204:207], a[12:15], v[84:87]
    buffer_load_dwordx4 a[44:47], v4, s[44:47], s82 offen offset:1024 sc1
    v_accvgpr_write_b32 a227, v139
    v_mfma_f32_16x16x32_bf16 v[80:83], a[204:207], a[4:7], v[80:83]
    ds_read_b64_tr_b16 a[222:223], v8 offset:22016
    v_accvgpr_write_b32 a240, v128
    v_mfma_f32_16x16x32_bf16 v[80:83], a[200:203], a[0:3], v[80:83]
    v_accvgpr_write_b32 a241, v129
    s_waitcnt lgkmcnt(4)
    v_mfma_f32_16x16x32_bf16 v[96:99], a[208:211], a[0:3], v[96:99]
    ds_read_b64_tr_b16 a[192:193], v7 offset:2048
    v_accvgpr_write_b32 a242, v130
    v_mfma_f32_16x16x32_bf16 v[96:99], a[212:215], a[4:7], v[96:99]
    buffer_load_dwordx4 a[48:51], v5, s[44:47], s82 offen offset:0 sc1
    v_accvgpr_write_b32 a243, v131
    v_mfma_f32_16x16x32_bf16 v[128:131], a[232:235], v[232:235], 0
    v_exp_f32 v167, v167
    v_mfma_f32_16x16x32_bf16 v[100:103], a[212:215], a[12:15], v[100:103]
    ds_read_b64_tr_b16 a[194:195], v7 offset:22528
    v_cvt_pk_bf16_f32 v168, v168, v169
    v_mfma_f32_16x16x32_bf16 v[100:103], a[208:211], a[8:11], v[100:103]
    v_cvt_pk_bf16_f32 v169, v170, v171
    v_cvt_pk_bf16_f32 v170, v172, v173
    v_mfma_f32_16x16x32_bf16 v[104:107], a[208:211], a[16:19], v[104:107]
    ds_read_b64_tr_b16 a[196:197], v7 offset:3072
    v_cvt_pk_bf16_f32 v171, v174, v175
    v_mfma_f32_16x16x32_bf16 v[104:107], a[212:215], a[20:23], v[104:107]
    buffer_load_dwordx4 a[52:55], v5, s[44:47], s82 offen offset:1024 sc1
    v_cvt_pk_bf16_f32 v160, v160, v161
    v_mfma_f32_16x16x32_bf16 v[108:111], a[212:215], a[28:31], v[108:111]
    ds_read_b64_tr_b16 a[198:199], v7 offset:23552
    v_cvt_pk_bf16_f32 v161, v162, v163
    v_mfma_f32_16x16x32_bf16 v[108:111], a[208:211], a[24:27], v[108:111]
    v_cvt_pk_bf16_f32 v162, v164, v165
    s_waitcnt lgkmcnt(4)
    v_mfma_f32_16x16x32_bf16 v[124:127], a[216:219], a[24:27], v[124:127]
    ds_read_b64_tr_b16 a[200:201], v8 offset:2048
    v_cvt_pk_bf16_f32 v163, v166, v167
    v_mfma_f32_16x16x32_bf16 v[164:167], a[236:239], v[236:239], 0
    v_accvgpr_write_b32 a228, v168
    v_accvgpr_write_b32 a229, v169
    v_mfma_f32_16x16x32_bf16 v[124:127], a[220:223], a[28:31], v[124:127]
    buffer_load_dwordx4 a[56:59], v6, s[44:47], s82 offen offset:0 sc1
    v_accvgpr_write_b32 a230, v170
    v_mfma_f32_16x16x32_bf16 v[120:123], a[220:223], a[20:23], v[120:123]
    ds_read_b64_tr_b16 a[202:203], v8 offset:22528
    v_accvgpr_write_b32 a231, v171
    v_mfma_f32_16x16x32_bf16 v[120:123], a[216:219], a[16:19], v[120:123]
    v_accvgpr_write_b32 a244, v160
    v_accvgpr_write_b32 a245, v161
    v_mfma_f32_16x16x32_bf16 v[116:119], a[216:219], a[8:11], v[116:119]
    ds_read_b64_tr_b16 a[204:205], v8 offset:3072
    v_accvgpr_write_b32 a246, v162
    v_mfma_f32_16x16x32_bf16 v[116:119], a[220:223], a[12:15], v[116:119]
    buffer_load_dwordx4 a[60:63], v6, s[44:47], s82 offen offset:1024 sc1
    v_accvgpr_write_b32 a247, v163
    v_mfma_f32_16x16x32_bf16 v[160:163], a[232:235], v[236:239], 0
    v_max3_f32 v22, v128, v129, v130
    v_max3_f32 v23, -v128, -v129, -v130
    v_mfma_f32_16x16x32_bf16 v[112:115], a[220:223], a[4:7], v[112:115]
    ds_read_b64_tr_b16 a[206:207], v8 offset:23552
    v_max3_f32 v22, v22, v131, v132
    v_mfma_f32_16x16x32_bf16 v[112:115], a[216:219], a[0:3], v[112:115]
    v_max3_f32 v23, v23, -v131, -v132
    s_waitcnt vmcnt(8)
    v_cmp_ne_u32 vcc, s18, v15
    s_cbranch_vccnz L_pl7
L_pl7_b:
    s_waitcnt lgkmcnt(4)
    v_mfma_f32_16x16x32_bf16 v[144:147], a[192:195], a[0:3], v[144:147]
    ds_read_b64_tr_b16 a[208:209], v7 offset:2560
    s_movk_i32 s69, 16384
    v_mfma_f32_16x16x32_bf16 v[144:147], a[196:199], a[4:7], v[144:147]
    buffer_load_dwordx4 v[52:55], v2, s[48:51], s69 offen sc1
    v_max3_f32 v22, v22, v133, v134
    v_mfma_f32_16x16x32_bf16 v[148:151], a[196:199], a[12:15], v[148:151]
    ds_read_b64_tr_b16 a[210:211], v7 offset:23040
    v_max3_f32 v23, v23, -v133, -v134
    v_mfma_f32_16x16x32_bf16 v[148:151], a[192:195], a[8:11], v[148:151]
    s_movk_i32 s69, 0
    v_max_f32 v22, v22, v135
    v_mfma_f32_16x16x32_bf16 v[152:155], a[192:195], a[16:19], v[152:155]
    ds_read_b64_tr_b16 a[212:213], v7 offset:3584
    v_max_f32_e64 v23, v23, -v135
    v_mfma_f32_16x16x32_bf16 v[152:155], a[196:199], a[20:23], v[152:155]
    buffer_load_dwordx4 a[96:99], v2, s[48:51], s69 offen offset:0 sc1
    v_max3_f32 v24, v160, v161, v162
    v_mfma_f32_16x16x32_bf16 v[156:159], a[196:199], a[28:31], v[156:159]
    ds_read_b64_tr_b16 a[214:215], v7 offset:24064
    v_max3_f32 v25, -v160, -v161, -v162
    v_mfma_f32_16x16x32_bf16 v[156:159], a[192:195], a[24:27], v[156:159]
    v_max3_f32 v24, v24, v163, v164
    s_waitcnt lgkmcnt(4)
    v_mfma_f32_16x16x32_bf16 v[188:191], a[200:203], a[24:27], v[188:191]
    ds_read_b64_tr_b16 a[216:217], v8 offset:2560
    v_max3_f32 v25, v25, -v163, -v164
    v_mfma_f32_16x16x32_bf16 v[188:191], a[204:207], a[28:31], v[188:191]
    buffer_load_dwordx4 a[100:103], v2, s[48:51], s69 offen offset:1024 sc1
    v_max3_f32 v24, v24, v165, v166
    v_mfma_f32_16x16x32_bf16 v[184:187], a[204:207], a[20:23], v[184:187]
    ds_read_b64_tr_b16 a[218:219], v8 offset:23040
    v_max3_f32 v25, v25, -v165, -v166
    v_mfma_f32_16x16x32_bf16 v[184:187], a[200:203], a[16:19], v[184:187]
    v_max_f32 v24, v24, v167
    v_max_f32_e64 v25, v25, -v167
    v_mfma_f32_16x16x32_bf16 v[180:183], a[200:203], a[8:11], v[180:183]
    ds_read_b64_tr_b16 a[220:221], v8 offset:3584
    v_permlane32_swap_b32 v22, v23
    v_mfma_f32_16x16x32_bf16 v[180:183], a[204:207], a[12:15], v[180:183]
    buffer_load_dwordx4 a[104:107], v2, s[48:51], s69 offen offset:2048 sc1
    v_permlane32_swap_b32 v24, v25
    v_mfma_f32_16x16x32_bf16 v[176:179], a[204:207], a[4:7], v[176:179]
    ds_read_b64_tr_b16 a[222:223], v8 offset:24064
    v_max_f32 v22, v22, v23
    v_mfma_f32_16x16x32_bf16 v[176:179], a[200:203], a[0:3], v[176:179]
    v_max_f32 v24, v24, v25
    s_waitcnt lgkmcnt(4)
    v_mfma_f32_16x16x32_bf16 v[208:211], a[208:211], a[0:3], v[208:211]
    ds_read_b64_tr_b16 a[192:193], v7 offset:4096
    v_permlane16_swap_b32 v22, v24
    v_mfma_f32_16x16x32_bf16 v[208:211], a[212:215], a[4:7], v[208:211]
    buffer_load_dwordx4 a[108:111], v2, s[48:51], s69 offen offset:3072 sc1
    v_max_f32 v22, v22, v24
    v_mfma_f32_16x16x32_bf16 v[212:215], a[212:215], a[12:15], v[212:215]
    ds_read_b64_tr_b16 a[194:195], v7 offset:24576
    v_mul_f32 v22, s76, v22
    v_mfma_f32_16x16x32_bf16 v[212:215], a[208:211], a[8:11], v[212:215]
    s_movk_i32 s69, 4096
    v_mov_b32 v24, v22
    v_mfma_f32_16x16x32_bf16 v[216:219], a[208:211], a[16:19], v[216:219]
    ds_read_b64_tr_b16 a[196:197], v7 offset:5120
    v_permlane16_swap_b32 v22, v24
    v_mfma_f32_16x16x32_bf16 v[216:219], a[212:215], a[20:23], v[216:219]
    buffer_load_dwordx4 a[112:115], v2, s[48:51], s69 offen offset:0 sc1
    v_mov_b32 v23, v22
    v_mfma_f32_16x16x32_bf16 v[220:223], a[212:215], a[28:31], v[220:223]
    ds_read_b64_tr_b16 a[198:199], v7 offset:25600
    v_mov_b32 v25, v24
    v_mfma_f32_16x16x32_bf16 v[220:223], a[208:211], a[24:27], v[220:223]
    v_permlane32_swap_b32 v22, v23
    s_waitcnt lgkmcnt(4)
    v_mfma_f32_16x16x32_bf16 v[252:255], a[216:219], a[24:27], v[252:255]
    ds_read_b64_tr_b16 a[200:201], v8 offset:4096
    v_permlane32_swap_b32 v24, v25
    v_mfma_f32_16x16x32_bf16 v[252:255], a[220:223], a[28:31], v[252:255]
    buffer_load_dwordx4 a[116:119], v2, s[48:51], s69 offen offset:1024 sc1
    v_fma_f32 v136, v128, s77, v22
    v_mfma_f32_16x16x32_bf16 v[248:251], a[220:223], a[20:23], v[248:251]
    ds_read_b64_tr_b16 a[202:203], v8 offset:24576
    v_fma_f32 v137, v129, s77, v22
    v_mfma_f32_16x16x32_bf16 v[248:251], a[216:219], a[16:19], v[248:251]
    v_exp_f32 v136, v136
    v_mfma_f32_16x16x32_bf16 v[244:247], a[216:219], a[8:11], v[244:247]
    ds_read_b64_tr_b16 a[204:205], v8 offset:5120
    v_fma_f32 v138, v130, s77, v22
    v_mfma_f32_16x16x32_bf16 v[244:247], a[220:223], a[12:15], v[244:247]
    buffer_load_dwordx4 a[120:123], v2, s[48:51], s69 offen offset:2048 sc1
    v_fma_f32 v139, v131, s77, v22
    v_mfma_f32_16x16x32_bf16 v[240:243], a[220:223], a[4:7], v[240:243]
    ds_read_b64_tr_b16 a[206:207], v8 offset:25600
    v_fma_f32 v140, v132, s77, v22
    v_mfma_f32_16x16x32_bf16 v[240:243], a[216:219], a[0:3], v[240:243]
    v_fma_f32 v141, v133, s77, v22
    v_pk_fma_f32 v[142:143], v[134:135], s[76:77], v[22:23] op_sel:[0,1,0] op_sel_hi:[1,1,0]
    v_pk_fma_f32 v[128:129], v[128:129], s[76:77], v[22:23] op_sel:[0,0,1] op_sel_hi:[1,0,1]
    v_pk_fma_f32 v[130:131], v[130:131], s[76:77], v[22:23] op_sel:[0,0,1] op_sel_hi:[1,0,1]
    v_pk_fma_f32 v[132:133], v[132:133], s[76:77], v[22:23] op_sel:[0,0,1] op_sel_hi:[1,0,1]
    v_pk_fma_f32 v[134:135], v[134:135], s[76:77], v[22:23] op_sel:[0,0,1] op_sel_hi:[1,0,1]
    v_exp_f32 v137, v137
    v_exp_f32 v138, v138
    v_exp_f32 v139, v139
    v_exp_f32 v140, v140
    v_exp_f32 v141, v141
    v_exp_f32 v142, v142
    v_exp_f32 v143, v143
    v_exp_f32 v128, v128
    v_exp_f32 v129, v129
    v_exp_f32 v130, v130
    v_exp_f32 v131, v131
    buffer_load_dwordx4 a[124:127], v2, s[48:51], s69 offen offset:3072 sc1
    v_exp_f32 v132, v132
    v_exp_f32 v133, v133
    v_exp_f32 v134, v134
    v_exp_f32 v135, v135
    v_pk_fma_f32 v[168:169], v[160:161], s[76:77], v[24:25] op_sel:[0,1,0] op_sel_hi:[1,1,0]
    v_pk_fma_f32 v[170:171], v[162:163], s[76:77], v[24:25] op_sel:[0,1,0] op_sel_hi:[1,1,0]
    v_pk_fma_f32 v[172:173], v[164:165], s[76:77], v[24:25] op_sel:[0,1,0] op_sel_hi:[1,1,0]
    v_pk_fma_f32 v[174:175], v[166:167], s[76:77], v[24:25] op_sel:[0,1,0] op_sel_hi:[1,1,0]
    v_pk_fma_f32 v[160:161], v[160:161], s[76:77], v[24:25] op_sel:[0,0,1] op_sel_hi:[1,0,1]
    v_pk_fma_f32 v[162:163], v[162:163], s[76:77], v[24:25] op_sel:[0,0,1] op_sel_hi:[1,0,1]
    v_pk_fma_f32 v[164:165], v[164:165], s[76:77], v[24:25] op_sel:[0,0,1] op_sel_hi:[1,0,1]
    v_pk_fma_f32 v[166:167], v[166:167], s[76:77], v[24:25] op_sel:[0,0,1] op_sel_hi:[1,0,1]
    v_exp_f32 v168, v168
    v_exp_f32 v169, v169
    v_exp_f32 v170, v170
    v_exp_f32 v171, v171
    v_exp_f32 v172, v172
    s_movk_i32 s69, 8192
    buffer_load_dwordx4 a[128:131], v2, s[48:51], s69 offen offset:0 sc1
    v_exp_f32 v173, v173
    v_exp_f32 v174, v174
    v_exp_f32 v175, v175
    v_exp_f32 v160, v160
    v_exp_f32 v161, v161
    v_exp_f32 v162, v162
    v_exp_f32 v163, v163
    v_exp_f32 v164, v164
    v_exp_f32 v165, v165
    v_exp_f32 v166, v166
    v_exp_f32 v167, v167
    v_cvt_pk_bf16_f32 v136, v136, v137
    v_cvt_pk_bf16_f32 v137, v138, v139
    v_cvt_pk_bf16_f32 v138, v140, v141
    v_cvt_pk_bf16_f32 v139, v142, v143
    buffer_load_dwordx4 a[132:135], v2, s[48:51], s69 offen offset:1024 sc1
    v_cvt_pk_bf16_f32 v128, v128, v129
    v_cvt_pk_bf16_f32 v129, v130, v131
    v_cvt_pk_bf16_f32 v130, v132, v133
    v_cvt_pk_bf16_f32 v131, v134, v135
    v_accvgpr_write_b32 a232, v136
    v_accvgpr_write_b32 a233, v137
    v_accvgpr_write_b32 a234, v138
    v_accvgpr_write_b32 a235, v139
    v_accvgpr_write_b32 a248, v128
    v_accvgpr_write_b32 a249, v129
    v_accvgpr_write_b32 a250, v130
    v_accvgpr_write_b32 a251, v131
    v_cvt_pk_bf16_f32 v168, v168, v169
    v_cvt_pk_bf16_f32 v169, v170, v171
    v_cvt_pk_bf16_f32 v170, v172, v173
    v_cvt_pk_bf16_f32 v171, v174, v175
    v_cvt_pk_bf16_f32 v160, v160, v161
    v_cvt_pk_bf16_f32 v161, v162, v163
    v_cvt_pk_bf16_f32 v162, v164, v165
    v_cvt_pk_bf16_f32 v163, v166, v167
    v_accvgpr_write_b32 a236, v168
    v_accvgpr_write_b32 a237, v169
    v_accvgpr_write_b32 a238, v170
    v_accvgpr_write_b32 a239, v171
    v_accvgpr_write_b32 a252, v160
    v_accvgpr_write_b32 a253, v161
    buffer_load_dwordx4 a[136:139], v2, s[48:51], s69 offen offset:2048 sc1
    v_accvgpr_write_b32 a254, v162
    v_accvgpr_write_b32 a255, v163
    v_and_b32 v16, 3, v1
    v_lshlrev_b32 v16, 2, v16
    buffer_load_dword v16, v16, s[52:55], s73 offen offset:64 sc1
    s_waitcnt vmcnt(39) lgkmcnt(4)
    v_mfma_f32_16x16x32_bf16 v[64:67], a[192:195], a[160:163], v[64:67]
    ds_read_b64_tr_b16 a[208:209], v7 offset:4608
    v_mfma_f32_16x16x32_bf16 v[64:67], a[196:199], a[164:167], v[64:67]
    v_mfma_f32_16x16x32_bf16 v[68:71], a[196:199], a[172:175], v[68:71]
    ds_read_b64_tr_b16 a[210:211], v7 offset:25088
    v_mfma_f32_16x16x32_bf16 v[68:71], a[192:195], a[168:171], v[68:71]
    buffer_load_dwordx4 a[140:143], v2, s[48:51], s69 offen offset:3072 sc1
    v_mfma_f32_16x16x32_bf16 v[72:75], a[192:195], a[176:179], v[72:75]
    ds_read_b64_tr_b16 a[212:213], v7 offset:5632
    v_mfma_f32_16x16x32_bf16 v[72:75], a[196:199], a[180:183], v[72:75]
    s_movk_i32 s69, 12288
    v_mfma_f32_16x16x32_bf16 v[76:79], a[196:199], a[188:191], v[76:79]
    ds_read_b64_tr_b16 a[214:215], v7 offset:26112
    v_mfma_f32_16x16x32_bf16 v[76:79], a[192:195], a[184:187], v[76:79]
    s_waitcnt vmcnt(63) lgkmcnt(4)
    s_barrier
    v_mfma_f32_16x16x32_bf16 v[92:95], a[200:203], a[184:187], v[92:95]
    ds_read_b64_tr_b16 a[216:217], v8 offset:4608
    v_mfma_f32_16x16x32_bf16 v[92:95], a[204:207], a[188:191], v[92:95]
    buffer_load_dwordx4 a[144:147], v2, s[48:51], s69 offen offset:0 sc1
    v_mfma_f32_16x16x32_bf16 v[88:91], a[204:207], a[180:183], v[88:91]
    ds_read_b64_tr_b16 a[218:219], v8 offset:25088
    v_mfma_f32_16x16x32_bf16 v[88:91], a[200:203], a[176:179], v[88:91]
    v_mfma_f32_16x16x32_bf16 v[84:87], a[200:203], a[168:171], v[84:87]
    ds_read_b64_tr_b16 a[220:221], v8 offset:5632
    v_mfma_f32_16x16x32_bf16 v[84:87], a[204:207], a[172:175], v[84:87]
    buffer_load_dwordx4 a[148:151], v2, s[48:51], s69 offen offset:1024 sc1
    v_mfma_f32_16x16x32_bf16 v[80:83], a[204:207], a[164:167], v[80:83]
    ds_read_b64_tr_b16 a[222:223], v8 offset:26112
    v_mfma_f32_16x16x32_bf16 v[80:83], a[200:203], a[160:163], v[80:83]
    s_waitcnt lgkmcnt(4)
    v_mfma_f32_16x16x32_bf16 v[96:99], a[208:211], a[160:163], v[96:99]
    ds_read_b64_tr_b16 a[192:193], v7 offset:6144
    v_mfma_f32_16x16x32_bf16 v[96:99], a[212:215], a[164:167], v[96:99]
    buffer_load_dwordx4 a[152:155], v2, s[48:51], s69 offen offset:2048 sc1
    v_mfma_f32_16x16x32_bf16 v[100:103], a[212:215], a[172:175], v[100:103]
    ds_read_b64_tr_b16 a[194:195], v7 offset:26624
    v_mfma_f32_16x16x32_bf16 v[100:103], a[208:211], a[168:171], v[100:103]
    v_mfma_f32_16x16x32_bf16 v[104:107], a[208:211], a[176:179], v[104:107]
    ds_read_b64_tr_b16 a[196:197], v7 offset:7168
    v_mfma_f32_16x16x32_bf16 v[104:107], a[212:215], a[180:183], v[104:107]
    buffer_load_dwordx4 a[156:159], v2, s[48:51], s69 offen offset:3072 sc1
    v_mfma_f32_16x16x32_bf16 v[108:111], a[212:215], a[188:191], v[108:111]
    ds_read_b64_tr_b16 a[198:199], v7 offset:27648
    v_mfma_f32_16x16x32_bf16 v[108:111], a[208:211], a[184:187], v[108:111]
    s_waitcnt lgkmcnt(4)
    v_mfma_f32_16x16x32_bf16 v[124:127], a[216:219], a[184:187], v[124:127]
    ds_read_b64_tr_b16 a[200:201], v8 offset:6144
    v_mfma_f32_16x16x32_bf16 v[124:127], a[220:223], a[188:191], v[124:127]
    buffer_load_dwordx4 a[0:3], v3, s[44:47], s84 offen offset:0 sc1
    v_mfma_f32_16x16x32_bf16 v[120:123], a[220:223], a[180:183], v[120:123]
    ds_read_b64_tr_b16 a[202:203], v8 offset:26624
    v_mfma_f32_16x16x32_bf16 v[120:123], a[216:219], a[176:179], v[120:123]
    v_mfma_f32_16x16x32_bf16 v[116:119], a[216:219], a[168:171], v[116:119]
    ds_read_b64_tr_b16 a[204:205], v8 offset:7168
    v_mfma_f32_16x16x32_bf16 v[116:119], a[220:223], a[172:175], v[116:119]
    buffer_load_dwordx4 a[4:7], v3, s[44:47], s84 offen offset:1024 sc1
    v_mfma_f32_16x16x32_bf16 v[112:115], a[220:223], a[164:167], v[112:115]
    ds_read_b64_tr_b16 a[206:207], v8 offset:27648
    v_mfma_f32_16x16x32_bf16 v[112:115], a[216:219], a[160:163], v[112:115]
    s_waitcnt vmcnt(11)
    v_mfma_f32_16x16x32_bf16 v[192:195], v[32:35], a[96:99], 0
    v_add_f32_dpp v52, v52, v52 row_ror:8 row_mask:0xf bank_mask:0xf
    v_mfma_f32_16x16x32_bf16 v[196:199], v[34:37], a[96:99], 0
    v_add_f32_dpp v53, v53, v53 row_ror:8 row_mask:0xf bank_mask:0xf
    v_mfma_f32_16x16x32_bf16 v[200:203], v[32:35], a[100:103], 0
    v_add_f32_dpp v54, v54, v54 row_ror:8 row_mask:0xf bank_mask:0xf
    v_mfma_f32_16x16x32_bf16 v[204:207], v[34:37], a[100:103], 0
    v_add_f32_dpp v55, v55, v55 row_ror:8 row_mask:0xf bank_mask:0xf
    v_mfma_f32_16x16x32_bf16 v[192:195], v[32:35], a[104:107], v[192:195]
    v_permlane32_swap_b32 v52, v54
    v_mfma_f32_16x16x32_bf16 v[196:199], v[34:37], a[104:107], v[196:199]
    v_permlane32_swap_b32 v53, v55
    v_mfma_f32_16x16x32_bf16 v[200:203], v[32:35], a[108:111], v[200:203]
    v_add_f32 v52, v52, v54
    v_mfma_f32_16x16x32_bf16 v[204:207], v[34:37], a[108:111], v[204:207]
    v_add_f32 v53, v53, v55
    v_mfma_f32_16x16x32_bf16 v[192:195], v[32:35], a[112:115], v[192:195]
    v_mov_b32 v54, 0x3f803f80
    v_mfma_f32_16x16x32_bf16 v[196:199], v[34:37], a[112:115], v[196:199]
    v_permlane16_swap_b32 v52, v53
    v_mfma_f32_16x16x32_bf16 v[200:203], v[32:35], a[116:119], v[200:203]
    v_add_f32 v52, v52, v53
    v_mfma_f32_16x16x32_bf16 v[204:207], v[34:37], a[116:119], v[204:207]
    v_mov_b32 v53, v52
    v_mfma_f32_16x16x32_bf16 v[192:195], v[32:35], a[120:123], v[192:195]
    v_add_u32 v50, s19, v2
    v_mfma_f32_16x16x32_bf16 v[196:199], v[34:37], a[120:123], v[196:199]
    v_permlane16_swap_b32 v52, v53
    v_mfma_f32_16x16x32_bf16 v[200:203], v[32:35], a[124:127], v[200:203]
    v_cvt_pk_bf16_f32 v52, v52, v53
    v_mfma_f32_16x16x32_bf16 v[204:207], v[34:37], a[124:127], v[204:207]
    v_mov_b32 v53, v52
    s_waitcnt lgkmcnt(4)
    v_mfma_f32_16x16x32_bf16 v[144:147], a[192:195], a[160:163], v[144:147]
    ds_read_b64_tr_b16 a[208:209], v7 offset:6656
    v_permlane32_swap_b32 v52, v53
    v_mfma_f32_16x16x32_bf16 v[144:147], a[196:199], a[164:167], v[144:147]
    buffer_load_dwordx4 a[8:11], v4, s[44:47], s84 offen offset:0 sc1
    v_cndmask_b32 v52, v54, v52, s[70:71]
    v_mfma_f32_16x16x32_bf16 v[148:151], a[196:199], a[172:175], v[148:151]
    ds_read_b64_tr_b16 a[210:211], v7 offset:27136
    v_cndmask_b32 v53, v54, v53, s[70:71]
    v_mfma_f32_16x16x32_bf16 v[148:151], a[192:195], a[168:171], v[148:151]
    ds_write_b64 v48, v[52:53] offset:49152
    v_mfma_f32_16x16x32_bf16 v[152:155], a[192:195], a[176:179], v[152:155]
    ds_read_b64_tr_b16 a[212:213], v7 offset:7680
    v_mfma_f32_16x16x32_bf16 v[152:155], a[196:199], a[180:183], v[152:155]
    buffer_load_dwordx4 a[12:15], v4, s[44:47], s84 offen offset:1024 sc1
    v_mfma_f32_16x16x32_bf16 v[156:159], a[196:199], a[188:191], v[156:159]
    ds_read_b64_tr_b16 a[214:215], v7 offset:28160
    v_mfma_f32_16x16x32_bf16 v[156:159], a[192:195], a[184:187], v[156:159]
    s_waitcnt lgkmcnt(5)
    v_mfma_f32_16x16x32_bf16 v[188:191], a[200:203], a[184:187], v[188:191]
    ds_read_b64_tr_b16 a[216:217], v8 offset:6656
    v_mfma_f32_16x16x32_bf16 v[188:191], a[204:207], a[188:191], v[188:191]
    buffer_load_dwordx4 a[16:19], v5, s[44:47], s84 offen offset:0 sc1
    v_mfma_f32_16x16x32_bf16 v[184:187], a[204:207], a[180:183], v[184:187]
    ds_read_b64_tr_b16 a[218:219], v8 offset:27136
    v_mfma_f32_16x16x32_bf16 v[184:187], a[200:203], a[176:179], v[184:187]
    v_mfma_f32_16x16x32_bf16 v[180:183], a[200:203], a[168:171], v[180:183]
    ds_read_b64_tr_b16 a[220:221], v8 offset:7680
    v_mfma_f32_16x16x32_bf16 v[180:183], a[204:207], a[172:175], v[180:183]
    buffer_load_dwordx4 a[20:23], v5, s[44:47], s84 offen offset:1024 sc1
    v_mfma_f32_16x16x32_bf16 v[176:179], a[204:207], a[164:167], v[176:179]
    ds_read_b64_tr_b16 a[222:223], v8 offset:28160
    v_mfma_f32_16x16x32_bf16 v[176:179], a[200:203], a[160:163], v[176:179]
    s_waitcnt lgkmcnt(4)
    v_mfma_f32_16x16x32_bf16 v[208:211], a[208:211], a[160:163], v[208:211]
    ds_read_b64_tr_b16 a[192:193], v9 offset:0
    v_mfma_f32_16x16x32_bf16 v[208:211], a[212:215], a[164:167], v[208:211]
    buffer_load_dwordx4 a[24:27], v6, s[44:47], s84 offen offset:0 sc1
    v_mfma_f32_16x16x32_bf16 v[212:215], a[212:215], a[172:175], v[212:215]
    ds_read_b64_tr_b16 a[194:195], v9 offset:20480
    v_mfma_f32_16x16x32_bf16 v[212:215], a[208:211], a[168:171], v[212:215]
    v_mfma_f32_16x16x32_bf16 v[216:219], a[208:211], a[176:179], v[216:219]
    ds_read_b64_tr_b16 a[196:197], v9 offset:1024
    v_mfma_f32_16x16x32_bf16 v[216:219], a[212:215], a[180:183], v[216:219]
    buffer_load_dwordx4 a[28:31], v6, s[44:47], s84 offen offset:1024 sc1
    s_waitcnt vmcnt(8)
    v_mfma_f32_16x16x32_bf16 v[192:195], v[32:35], a[128:131], v[192:195]
    v_mfma_f32_16x16x32_bf16 v[196:199], v[34:37], a[128:131], v[196:199]
    v_mfma_f32_16x16x32_bf16 v[200:203], v[32:35], a[132:135], v[200:203]
    v_mfma_f32_16x16x32_bf16 v[204:207], v[34:37], a[132:135], v[204:207]
    v_mfma_f32_16x16x32_bf16 v[192:195], v[32:35], a[136:139], v[192:195]
    v_mfma_f32_16x16x32_bf16 v[196:199], v[34:37], a[136:139], v[196:199]
    v_mfma_f32_16x16x32_bf16 v[200:203], v[32:35], a[140:143], v[200:203]
    v_mfma_f32_16x16x32_bf16 v[204:207], v[34:37], a[140:143], v[204:207]
    v_mfma_f32_16x16x32_bf16 v[192:195], v[32:35], a[144:147], v[192:195]
    v_mfma_f32_16x16x32_bf16 v[196:199], v[34:37], a[144:147], v[196:199]
    v_mfma_f32_16x16x32_bf16 v[200:203], v[32:35], a[148:151], v[200:203]
    v_mfma_f32_16x16x32_bf16 v[204:207], v[34:37], a[148:151], v[204:207]
    v_mfma_f32_16x16x32_bf16 v[192:195], v[32:35], a[152:155], v[192:195]
    v_mfma_f32_16x16x32_bf16 v[196:199], v[34:37], a[152:155], v[196:199]
    v_mfma_f32_16x16x32_bf16 v[200:203], v[32:35], a[156:159], v[200:203]
    v_mfma_f32_16x16x32_bf16 v[204:207], v[34:37], a[156:159], v[204:207]
    v_mfma_f32_16x16x32_bf16 v[220:223], a[212:215], a[188:191], v[220:223]
    ds_read_b64_tr_b16 a[198:199], v9 offset:21504
    v_mfma_f32_16x16x32_bf16 v[220:223], a[208:211], a[184:187], v[220:223]
    s_waitcnt lgkmcnt(4)
    v_mfma_f32_16x16x32_bf16 v[252:255], a[216:219], a[184:187], v[252:255]
    ds_read_b64_tr_b16 a[200:201], v10 offset:0
    v_cvt_pk_bf16_f32 v40, v192, v193
    v_mfma_f32_16x16x32_bf16 v[252:255], a[220:223], a[188:191], v[252:255]
    buffer_load_dwordx4 a[128:131], v3, s[44:47], s86 offen offset:0 sc1
    v_cvt_pk_bf16_f32 v41, v194, v195
    v_mfma_f32_16x16x32_bf16 v[248:251], a[220:223], a[180:183], v[248:251]
    ds_read_b64_tr_b16 a[202:203], v10 offset:20480
    v_cvt_pk_bf16_f32 v42, v196, v197
    v_mfma_f32_16x16x32_bf16 v[248:251], a[216:219], a[176:179], v[248:251]
    v_cvt_pk_bf16_f32 v43, v198, v199
    v_cvt_pk_bf16_f32 v44, v200, v201
    v_mfma_f32_16x16x32_bf16 v[244:247], a[216:219], a[168:171], v[244:247]
    ds_read_b64_tr_b16 a[204:205], v10 offset:1024
    v_cvt_pk_bf16_f32 v45, v202, v203
    v_mfma_f32_16x16x32_bf16 v[244:247], a[220:223], a[172:175], v[244:247]
    buffer_load_dwordx4 a[132:135], v3, s[44:47], s86 offen offset:1024 sc1
    v_cvt_pk_bf16_f32 v46, v204, v205
    v_mfma_f32_16x16x32_bf16 v[240:243], a[220:223], a[164:167], v[240:243]
    ds_read_b64_tr_b16 a[206:207], v10 offset:21504
    v_cvt_pk_bf16_f32 v47, v206, v207
    v_mfma_f32_16x16x32_bf16 v[240:243], a[216:219], a[160:163], v[240:243]
    s_waitcnt vmcnt(15)
    v_cmp_ne_u32 vcc, s18, v16
    s_cbranch_vccnz L_pl8
L_pl8_b:
    s_waitcnt vmcnt(28) lgkmcnt(4)
    v_mfma_f32_16x16x32_bf16 v[64:67], a[192:195], a[32:35], v[64:67]
    ds_read_b64_tr_b16 a[208:209], v9 offset:512
    v_mfma_f32_16x16x32_bf16 v[64:67], a[196:199], a[36:39], v[64:67]
    buffer_load_dwordx4 a[136:139], v4, s[44:47], s86 offen offset:0 sc1
    v_mfma_f32_16x16x32_bf16 v[68:71], a[196:199], a[44:47], v[68:71]
    ds_read_b64_tr_b16 a[210:211], v9 offset:20992
    v_mfma_f32_16x16x32_bf16 v[68:71], a[192:195], a[40:43], v[68:71]
    ds_write_b128 v50, v[40:43] offset:8192
    v_mfma_f32_16x16x32_bf16 v[72:75], a[192:195], a[48:51], v[72:75]
    ds_read_b64_tr_b16 a[212:213], v9 offset:1536
    v_mfma_f32_16x16x32_bf16 v[72:75], a[196:199], a[52:55], v[72:75]
    buffer_load_dwordx4 a[140:143], v4, s[44:47], s86 offen offset:1024 sc1
    v_mfma_f32_16x16x32_bf16 v[76:79], a[196:199], a[60:63], v[76:79]
    ds_read_b64_tr_b16 a[214:215], v9 offset:22016
    v_mfma_f32_16x16x32_bf16 v[76:79], a[192:195], a[56:59], v[76:79]
    s_waitcnt vmcnt(63) lgkmcnt(2)
    s_barrier
    v_mfma_f32_16x16x32_bf16 v[92:95], a[200:203], a[56:59], v[92:95]
    ds_read_b64_tr_b16 a[216:217], v10 offset:512
    v_mfma_f32_16x16x32_bf16 v[92:95], a[204:207], a[60:63], v[92:95]
    buffer_load_dwordx4 a[144:147], v5, s[44:47], s86 offen offset:0 sc1
    v_mfma_f32_16x16x32_bf16 v[88:91], a[204:207], a[52:55], v[88:91]
    ds_read_b64_tr_b16 a[218:219], v10 offset:20992
    v_mfma_f32_16x16x32_bf16 v[88:91], a[200:203], a[48:51], v[88:91]
    ds_write_b128 v50, v[44:47] offset:9216
    v_mfma_f32_16x16x32_bf16 v[84:87], a[200:203], a[40:43], v[84:87]
    ds_read_b64_tr_b16 a[220:221], v10 offset:1536
    v_mfma_f32_16x16x32_bf16 v[84:87], a[204:207], a[44:47], v[84:87]
    buffer_load_dwordx4 a[148:151], v5, s[44:47], s86 offen offset:1024 sc1
    v_mfma_f32_16x16x32_bf16 v[80:83], a[204:207], a[36:39], v[80:83]
    ds_read_b64_tr_b16 a[222:223], v10 offset:22016
    v_mfma_f32_16x16x32_bf16 v[80:83], a[200:203], a[32:35], v[80:83]
    s_waitcnt lgkmcnt(5)
    v_mfma_f32_16x16x32_bf16 v[96:99], a[208:211], a[32:35], v[96:99]
    ds_read_b64_tr_b16 a[192:193], v9 offset:2048
    v_mfma_f32_16x16x32_bf16 v[96:99], a[212:215], a[36:39], v[96:99]
    buffer_load_dwordx4 a[152:155], v6, s[44:47], s86 offen offset:0 sc1
    v_mfma_f32_16x16x32_bf16 v[100:103], a[212:215], a[44:47], v[100:103]
    ds_read_b64_tr_b16 a[194:195], v9 offset:22528
    v_mfma_f32_16x16x32_bf16 v[100:103], a[208:211], a[40:43], v[100:103]
    s_waitcnt lgkmcnt(4)
    s_barrier
    v_mfma_f32_16x16x32_bf16 v[104:107], a[208:211], a[48:51], v[104:107]
    ds_read_b64_tr_b16 a[196:197], v9 offset:3072
    ds_read_b128 v[128:131], v2 offset:8192
    v_mfma_f32_16x16x32_bf16 v[104:107], a[212:215], a[52:55], v[104:107]
    buffer_load_dwordx4 a[156:159], v6, s[44:47], s86 offen offset:1024 sc1
    ds_read_b128 v[132:135], v2 offset:9216
    v_mfma_f32_16x16x32_bf16 v[108:111], a[212:215], a[60:63], v[108:111]
    ds_read_b64_tr_b16 a[198:199], v9 offset:23552
    ds_read_b128 v[136:139], v51 offset:8192
    v_mfma_f32_16x16x32_bf16 v[108:111], a[208:211], a[56:59], v[108:111]
    ds_read_b128 v[140:143], v2 offset:18432
    s_waitcnt lgkmcnt(8)
    v_mfma_f32_16x16x32_bf16 v[124:127], a[216:219], a[56:59], v[124:127]
    ds_read_b64_tr_b16 a[200:201], v10 offset:2048
    ds_read_b128 v[160:163], v2 offset:19456
    v_mfma_f32_16x16x32_bf16 v[124:127], a[220:223], a[60:63], v[124:127]
    buffer_load_dwordx4 a[160:163], v3, s[44:47], s92 offen offset:0 sc1
    ds_read_b128 v[164:167], v51 offset:18432
    v_mfma_f32_16x16x32_bf16 v[120:123], a[220:223], a[52:55], v[120:123]
    ds_read_b64_tr_b16 a[202:203], v10 offset:22528
    ds_read_b128 v[168:171], v2 offset:28672
    v_mfma_f32_16x16x32_bf16 v[120:123], a[216:219], a[48:51], v[120:123]
    ds_read_b128 v[172:175], v2 offset:29696
    ds_read_b128 v[192:195], v51 offset:28672
    v_mfma_f32_16x16x32_bf16 v[116:119], a[216:219], a[40:43], v[116:119]
    ds_read_b64_tr_b16 a[204:205], v10 offset:3072
    ds_read_b128 v[196:199], v2 offset:38912
    v_mfma_f32_16x16x32_bf16 v[116:119], a[220:223], a[44:47], v[116:119]
    buffer_load_dwordx4 a[164:167], v3, s[44:47], s92 offen offset:1024 sc1
    ds_read_b128 v[200:203], v2 offset:39936
    v_mfma_f32_16x16x32_bf16 v[112:115], a[220:223], a[36:39], v[112:115]
    ds_read_b64_tr_b16 a[206:207], v10 offset:23552
    ds_read_b128 v[204:207], v51 offset:38912
    v_mfma_f32_16x16x32_bf16 v[112:115], a[216:219], a[32:35], v[112:115]
    s_waitcnt lgkmcnt(14)
    v_mfma_f32_16x16x32_bf16 v[144:147], a[192:195], a[32:35], v[144:147]
    ds_read_b64_tr_b16 a[208:209], v9 offset:2560
    v_mfma_f32_16x16x32_bf16 v[144:147], a[196:199], a[36:39], v[144:147]
    buffer_load_dwordx4 a[168:171], v4, s[44:47], s92 offen offset:0 sc1
    v_mfma_f32_16x16x32_bf16 v[148:151], a[196:199], a[44:47], v[148:151]
    ds_read_b64_tr_b16 a[210:211], v9 offset:23040
    v_mfma_f32_16x16x32_bf16 v[148:151], a[192:195], a[40:43], v[148:151]
    v_mfma_f32_16x16x32_bf16 v[152:155], a[192:195], a[48:51], v[152:155]
    ds_read_b64_tr_b16 a[212:213], v9 offset:3584
    v_mfma_f32_16x16x32_bf16 v[152:155], a[196:199], a[52:55], v[152:155]
    buffer_load_dwordx4 a[172:175], v4, s[44:47], s92 offen offset:1024 sc1
    v_mfma_f32_16x16x32_bf16 v[156:159], a[196:199], a[60:63], v[156:159]
    ds_read_b64_tr_b16 a[214:215], v9 offset:24064
    s_waitcnt lgkmcnt(4)
    v_mfma_f32_16x16x32_bf16 v[48:51], v[136:139], a[64:67], 0
    v_mfma_f32_16x16x32_bf16 v[52:55], v[164:167], a[80:83], 0
    v_mfma_f32_16x16x32_bf16 v[32:35], v[128:131], a[64:67], 0
    v_mfma_f32_16x16x32_bf16 v[36:39], v[132:135], a[64:67], 0
    v_mfma_f32_16x16x32_bf16 v[40:43], v[140:143], a[80:83], 0
    v_mfma_f32_16x16x32_bf16 v[44:47], v[160:163], a[80:83], 0
    v_mfma_f32_16x16x32_bf16 v[56:59], v[136:139], a[68:71], 0
    v_mfma_f32_16x16x32_bf16 v[60:63], v[164:167], a[84:87], 0
    v_mfma_f32_16x16x32_bf16 v[224:227], v[128:131], a[68:71], 0
    v_mul_f32 v50, s97, v49
    v_add_f32 v50, v50, v48
    v_mfma_f32_16x16x32_bf16 v[228:231], v[132:135], a[68:71], 0
    v_mul_f32 v50, v50, v53
    v_fmac_f32 v50, v52, v49
    v_mfma_f32_16x16x32_bf16 v[232:235], v[140:143], a[84:87], 0
    v_rcp_f32 v50, v50
    v_mfma_f32_16x16x32_bf16 v[236:239], v[160:163], a[84:87], 0
    v_mul_f32 v54, v53, v50
    v_mul_f32 v55, v49, v50
    v_mfma_f32_16x16x32_bf16 v[48:51], v[136:139], a[72:75], 0
    v_mul_f32 v32, v32, v54
    v_mul_f32 v33, v33, v54
    v_mfma_f32_16x16x32_bf16 v[156:159], a[192:195], a[56:59], v[156:159]
    v_mul_f32 v34, v34, v54
    s_waitcnt lgkmcnt(5)
    v_mfma_f32_16x16x32_bf16 v[188:191], a[200:203], a[56:59], v[188:191]
    ds_read_b64_tr_b16 a[216:217], v10 offset:2560
    v_mul_f32 v35, v35, v54
    v_mfma_f32_16x16x32_bf16 v[188:191], a[204:207], a[60:63], v[188:191]
    buffer_load_dwordx4 a[176:179], v5, s[44:47], s92 offen offset:0 sc1
    v_mul_f32 v36, v36, v54
    v_mfma_f32_16x16x32_bf16 v[184:187], a[204:207], a[52:55], v[184:187]
    ds_read_b64_tr_b16 a[218:219], v10 offset:23040
    v_mul_f32 v37, v37, v54
    v_mfma_f32_16x16x32_bf16 v[184:187], a[200:203], a[48:51], v[184:187]
    v_mul_f32 v38, v38, v54
    v_mul_f32 v39, v39, v54
    v_mfma_f32_16x16x32_bf16 v[180:183], a[200:203], a[40:43], v[180:183]
    ds_read_b64_tr_b16 a[220:221], v10 offset:3584
    v_fma_f32 v32, v40, v55, v32
    v_mfma_f32_16x16x32_bf16 v[180:183], a[204:207], a[44:47], v[180:183]
    buffer_load_dwordx4 a[180:183], v5, s[44:47], s92 offen offset:1024 sc1
    v_fma_f32 v33, v41, v55, v33
    v_mfma_f32_16x16x32_bf16 v[176:179], a[204:207], a[36:39], v[176:179]
    ds_read_b64_tr_b16 a[222:223], v10 offset:24064
    v_fma_f32 v34, v42, v55, v34
    v_mfma_f32_16x16x32_bf16 v[176:179], a[200:203], a[32:35], v[176:179]
    v_fma_f32 v35, v43, v55, v35
    v_mfma_f32_16x16x32_bf16 v[40:43], v[140:143], a[88:91], 0
    v_fma_f32 v36, v44, v55, v36
    s_waitcnt lgkmcnt(4)
    v_mfma_f32_16x16x32_bf16 v[208:211], a[208:211], a[32:35], v[208:211]
    ds_read_b64_tr_b16 a[192:193], v11 offset:0
    v_fma_f32 v37, v45, v55, v37
    v_mfma_f32_16x16x32_bf16 v[208:211], a[212:215], a[36:39], v[208:211]
    buffer_load_dwordx4 a[184:187], v6, s[44:47], s92 offen offset:0 sc1
    v_fma_f32 v38, v46, v55, v38
    v_mfma_f32_16x16x32_bf16 v[212:215], a[212:215], a[44:47], v[212:215]
    ds_read_b64_tr_b16 a[194:195], v11 offset:20480
    v_fma_f32 v39, v47, v55, v39
    v_mfma_f32_16x16x32_bf16 v[52:55], v[164:167], a[88:91], 0
    v_cvt_pk_bf16_f32 v24, v32, v33
    v_cvt_pk_bf16_f32 v25, v34, v35
    v_mfma_f32_16x16x32_bf16 v[32:35], v[128:131], a[72:75], 0
    v_cvt_pk_bf16_f32 v26, v36, v37
    v_cvt_pk_bf16_f32 v27, v38, v39
    v_mfma_f32_16x16x32_bf16 v[36:39], v[132:135], a[72:75], 0
    buffer_store_dwordx4 v[24:27], v3, s[44:47], s96 offen offset:0 sc1
    v_mfma_f32_16x16x32_bf16 v[44:47], v[160:163], a[88:91], 0
    v_mul_f32 v58, s97, v57
    v_add_f32 v58, v58, v56
    v_mfma_f32_16x16x32_bf16 v[212:215], a[208:211], a[40:43], v[212:215]
    v_mul_f32 v58, v58, v61
    v_fmac_f32 v58, v60, v57
    v_mfma_f32_16x16x32_bf16 v[216:219], a[208:211], a[48:51], v[216:219]
    ds_read_b64_tr_b16 a[196:197], v11 offset:1024
    v_mul_f32 v50, s97, v49
    v_mfma_f32_16x16x32_bf16 v[216:219], a[212:215], a[52:55], v[216:219]
    buffer_load_dwordx4 a[188:191], v6, s[44:47], s92 offen offset:1024 sc1
    v_add_f32 v50, v50, v48
    v_mfma_f32_16x16x32_bf16 v[220:223], a[212:215], a[60:63], v[220:223]
    ds_read_b64_tr_b16 a[198:199], v11 offset:21504
    v_mul_f32 v50, v50, v53
    v_mfma_f32_16x16x32_bf16 v[220:223], a[208:211], a[56:59], v[220:223]
    v_fmac_f32 v50, v52, v49
    s_waitcnt lgkmcnt(4)
    v_mfma_f32_16x16x32_bf16 v[252:255], a[216:219], a[56:59], v[252:255]
    ds_read_b64_tr_b16 a[200:201], v12 offset:0
    v_rcp_f32 v58, v58
    v_mfma_f32_16x16x32_bf16 v[252:255], a[220:223], a[60:63], v[252:255]
    buffer_load_dwordx4 a[96:99], v3, s[44:47], s93 offen offset:0 sc1
    v_mul_f32 v62, v61, v58
    v_mfma_f32_16x16x32_bf16 v[248:251], a[220:223], a[52:55], v[248:251]
    ds_read_b64_tr_b16 a[202:203], v12 offset:20480
    v_mul_f32 v63, v57, v58
    v_mfma_f32_16x16x32_bf16 v[56:59], v[136:139], a[76:79], 0
    v_rcp_f32 v50, v50
    v_mfma_f32_16x16x32_bf16 v[248:251], a[216:219], a[48:51], v[248:251]
    v_mul_f32 v224, v224, v62
    v_mul_f32 v225, v225, v62
    v_mfma_f32_16x16x32_bf16 v[244:247], a[216:219], a[40:43], v[244:247]
    ds_read_b64_tr_b16 a[204:205], v12 offset:1024
    v_mul_f32 v226, v226, v62
    v_mfma_f32_16x16x32_bf16 v[244:247], a[220:223], a[44:47], v[244:247]
    buffer_load_dwordx4 a[100:103], v3, s[44:47], s93 offen offset:1024 sc1
    v_mul_f32 v227, v227, v62
    v_mfma_f32_16x16x32_bf16 v[240:243], a[220:223], a[36:39], v[240:243]
    ds_read_b64_tr_b16 a[206:207], v12 offset:21504
    v_mul_f32 v228, v228, v62
    v_mfma_f32_16x16x32_bf16 v[240:243], a[216:219], a[32:35], v[240:243]
    v_mul_f32 v229, v229, v62
    s_waitcnt vmcnt(19) lgkmcnt(4)
    v_mfma_f32_16x16x32_bf16 v[64:67], a[192:195], a[0:3], v[64:67]
    ds_read_b64_tr_b16 a[208:209], v11 offset:512
    v_mul_f32 v230, v230, v62
    v_mfma_f32_16x16x32_bf16 v[64:67], a[196:199], a[4:7], v[64:67]
    buffer_load_dwordx4 a[104:107], v4, s[44:47], s93 offen offset:0 sc1
    v_mul_f32 v231, v231, v62
    v_mfma_f32_16x16x32_bf16 v[68:71], a[196:199], a[12:15], v[68:71]
    ds_read_b64_tr_b16 a[210:211], v11 offset:20992
    v_fma_f32 v224, v232, v63, v224
    v_mfma_f32_16x16x32_bf16 v[68:71], a[192:195], a[8:11], v[68:71]
    v_fma_f32 v225, v233, v63, v225
    v_fma_f32 v226, v234, v63, v226
    v_mfma_f32_16x16x32_bf16 v[72:75], a[192:195], a[16:19], v[72:75]
    ds_read_b64_tr_b16 a[212:213], v11 offset:1536
    v_fma_f32 v227, v235, v63, v227
    v_mfma_f32_16x16x32_bf16 v[232:235], v[140:143], a[92:95], 0
    v_fma_f32 v228, v236, v63, v228
    v_fma_f32 v229, v237, v63, v229
    v_mfma_f32_16x16x32_bf16 v[72:75], a[196:199], a[20:23], v[72:75]
    buffer_load_dwordx4 a[108:111], v4, s[44:47], s93 offen offset:1024 sc1
    v_fma_f32 v230, v238, v63, v230
    v_mfma_f32_16x16x32_bf16 v[76:79], a[196:199], a[28:31], v[76:79]
    ds_read_b64_tr_b16 a[214:215], v11 offset:22016
    v_fma_f32 v231, v239, v63, v231
    v_mfma_f32_16x16x32_bf16 v[60:63], v[164:167], a[92:95], 0
    v_cvt_pk_bf16_f32 v24, v224, v225
    v_cvt_pk_bf16_f32 v25, v226, v227
    v_mfma_f32_16x16x32_bf16 v[224:227], v[128:131], a[76:79], 0
    v_cvt_pk_bf16_f32 v26, v228, v229
    v_cvt_pk_bf16_f32 v27, v230, v231
    v_mfma_f32_16x16x32_bf16 v[228:231], v[132:135], a[76:79], 0
    buffer_store_dwordx4 v[24:27], v4, s[44:47], s96 offen offset:0 sc1
    v_mfma_f32_16x16x32_bf16 v[236:239], v[160:163], a[92:95], 0
    v_mul_f32 v54, v53, v50
    v_mul_f32 v55, v49, v50
    v_mfma_f32_16x16x32_bf16 v[48:51], v[192:195], a[224:227], 0
    v_mul_f32 v32, v32, v54
    v_mul_f32 v33, v33, v54
    v_mfma_f32_16x16x32_bf16 v[76:79], a[192:195], a[24:27], v[76:79]
    s_waitcnt vmcnt(63) lgkmcnt(4)
    s_barrier
    v_mfma_f32_16x16x32_bf16 v[92:95], a[200:203], a[24:27], v[92:95]
    ds_read_b64_tr_b16 a[216:217], v12 offset:512
    v_mul_f32 v34, v34, v54
    v_mfma_f32_16x16x32_bf16 v[92:95], a[204:207], a[28:31], v[92:95]
    buffer_load_dwordx4 a[112:115], v5, s[44:47], s93 offen offset:0 sc1
    v_mul_f32 v35, v35, v54
    v_mfma_f32_16x16x32_bf16 v[88:91], a[204:207], a[20:23], v[88:91]
    ds_read_b64_tr_b16 a[218:219], v12 offset:20992
    v_mul_f32 v36, v36, v54
    v_mfma_f32_16x16x32_bf16 v[88:91], a[200:203], a[16:19], v[88:91]
    v_mul_f32 v37, v37, v54
    v_mul_f32 v38, v38, v54
    v_mfma_f32_16x16x32_bf16 v[84:87], a[200:203], a[8:11], v[84:87]
    ds_read_b64_tr_b16 a[220:221], v12 offset:1536
    v_mul_f32 v39, v39, v54
    v_mfma_f32_16x16x32_bf16 v[84:87], a[204:207], a[12:15], v[84:87]
    buffer_load_dwordx4 a[116:119], v5, s[44:47], s93 offen offset:1024 sc1
    v_fma_f32 v32, v40, v55, v32
    v_mfma_f32_16x16x32_bf16 v[80:83], a[204:207], a[4:7], v[80:83]
    ds_read_b64_tr_b16 a[222:223], v12 offset:22016
    v_fma_f32 v33, v41, v55, v33
    v_mfma_f32_16x16x32_bf16 v[80:83], a[200:203], a[0:3], v[80:83]
    v_fma_f32 v34, v42, v55, v34
    s_waitcnt lgkmcnt(4)
    v_mfma_f32_16x16x32_bf16 v[96:99], a[208:211], a[0:3], v[96:99]
    ds_read_b64_tr_b16 a[192:193], v11 offset:2048
    v_fma_f32 v35, v43, v55, v35
    v_mfma_f32_16x16x32_bf16 v[40:43], v[196:199], a[240:243], 0
    v_fma_f32 v36, v44, v55, v36
    v_fma_f32 v37, v45, v55, v37
    v_mfma_f32_16x16x32_bf16 v[96:99], a[212:215], a[4:7], v[96:99]
    buffer_load_dwordx4 a[120:123], v6, s[44:47], s93 offen offset:0 sc1
    v_fma_f32 v38, v46, v55, v38
    v_mfma_f32_16x16x32_bf16 v[100:103], a[212:215], a[12:15], v[100:103]
    ds_read_b64_tr_b16 a[194:195], v11 offset:22528
    v_fma_f32 v39, v47, v55, v39
    v_mfma_f32_16x16x32_bf16 v[52:55], v[204:207], a[240:243], 0
    v_cvt_pk_bf16_f32 v24, v32, v33
    v_cvt_pk_bf16_f32 v25, v34, v35
    v_mfma_f32_16x16x32_bf16 v[32:35], v[168:171], a[224:227], 0
    v_cvt_pk_bf16_f32 v26, v36, v37
    v_cvt_pk_bf16_f32 v27, v38, v39
    v_mfma_f32_16x16x32_bf16 v[36:39], v[172:175], a[224:227], 0
    buffer_store_dwordx4 v[24:27], v5, s[44:47], s96 offen offset:0 sc1
    v_mfma_f32_16x16x32_bf16 v[44:47], v[200:203], a[240:243], 0
    v_mul_f32 v58, s97, v57
    v_add_f32 v58, v58, v56
    v_mfma_f32_16x16x32_bf16 v[100:103], a[208:211], a[8:11], v[100:103]
    v_mul_f32 v58, v58, v61
    v_fmac_f32 v58, v60, v57
    v_mfma_f32_16x16x32_bf16 v[104:107], a[208:211], a[16:19], v[104:107]
    ds_read_b64_tr_b16 a[196:197], v11 offset:3072
    v_mul_f32 v50, s97, v49
    v_mfma_f32_16x16x32_bf16 v[104:107], a[212:215], a[20:23], v[104:107]
    buffer_load_dwordx4 a[124:127], v6, s[44:47], s93 offen offset:1024 sc1
    v_add_f32 v50, v50, v48
    v_mfma_f32_16x16x32_bf16 v[108:111], a[212:215], a[28:31], v[108:111]
    ds_read_b64_tr_b16 a[198:199], v11 offset:23552
    v_mul_f32 v50, v50, v53
    v_mfma_f32_16x16x32_bf16 v[108:111], a[208:211], a[24:27], v[108:111]
    v_fmac_f32 v50, v52, v49
    s_waitcnt lgkmcnt(4)
    v_mfma_f32_16x16x32_bf16 v[124:127], a[216:219], a[24:27], v[124:127]
    ds_read_b64_tr_b16 a[200:201], v12 offset:2048
    s_add_u32 m0, s19, 126976
    v_mfma_f32_16x16x32_bf16 v[124:127], a[220:223], a[28:31], v[124:127]
    s_lshl_b32 s11, s89, 4
    v_rcp_f32 v58, v58
    v_mfma_f32_16x16x32_bf16 v[120:123], a[220:223], a[20:23], v[120:123]
    ds_read_b64_tr_b16 a[202:203], v12 offset:22528
    v_mul_f32 v62, v61, v58
    v_mfma_f32_16x16x32_bf16 v[120:123], a[216:219], a[16:19], v[120:123]
    buffer_load_dwordx4 v17, s[56:59], s11 offen offset:0 lds
    v_mul_f32 v63, v57, v58
    v_mfma_f32_16x16x32_bf16 v[56:59], v[192:195], a[228:231], 0
    v_rcp_f32 v50, v50
    v_mfma_f32_16x16x32_bf16 v[116:119], a[216:219], a[8:11], v[116:119]
    ds_read_b64_tr_b16 a[204:205], v12 offset:3072
    v_mul_f32 v224, v224, v62
    v_mfma_f32_16x16x32_bf16 v[116:119], a[220:223], a[12:15], v[116:119]
    v_mul_f32 v225, v225, v62
    v_mul_f32 v226, v226, v62
    v_mfma_f32_16x16x32_bf16 v[112:115], a[220:223], a[4:7], v[112:115]
    ds_read_b64_tr_b16 a[206:207], v12 offset:23552
    v_mul_f32 v227, v227, v62
    v_mfma_f32_16x16x32_bf16 v[112:115], a[216:219], a[0:3], v[112:115]
    v_mul_f32 v228, v228, v62
    s_waitcnt lgkmcnt(4)
    v_mfma_f32_16x16x32_bf16 v[144:147], a[192:195], a[0:3], v[144:147]
    ds_read_b64_tr_b16 a[208:209], v11 offset:2560
    v_mul_f32 v229, v229, v62
    v_mfma_f32_16x16x32_bf16 v[144:147], a[196:199], a[4:7], v[144:147]
    buffer_load_dwordx4 v18, s[56:59], s11 offen offset:1024 lds
    v_mul_f32 v230, v230, v62
    v_mfma_f32_16x16x32_bf16 v[148:151], a[196:199], a[12:15], v[148:151]
    ds_read_b64_tr_b16 a[210:211], v11 offset:23040
    v_mul_f32 v231, v231, v62
    v_mfma_f32_16x16x32_bf16 v[148:151], a[192:195], a[8:11], v[148:151]
    v_fma_f32 v224, v232, v63, v224
    v_fma_f32 v225, v233, v63, v225
    v_mfma_f32_16x16x32_bf16 v[152:155], a[192:195], a[16:19], v[152:155]
    ds_read_b64_tr_b16 a[212:213], v11 offset:3584
    v_fma_f32 v226, v234, v63, v226
    v_mfma_f32_16x16x32_bf16 v[152:155], a[196:199], a[20:23], v[152:155]
    buffer_load_dwordx4 v19, s[56:59], s11 offen offset:2048 lds
    v_fma_f32 v227, v235, v63, v227
    v_mfma_f32_16x16x32_bf16 v[232:235], v[196:199], a[244:247], 0
    v_fma_f32 v228, v236, v63, v228
    v_fma_f32 v229, v237, v63, v229
    v_mfma_f32_16x16x32_bf16 v[156:159], a[196:199], a[28:31], v[156:159]
    ds_read_b64_tr_b16 a[214:215], v11 offset:24064
    v_fma_f32 v230, v238, v63, v230
    v_mfma_f32_16x16x32_bf16 v[156:159], a[192:195], a[24:27], v[156:159]
    v_fma_f32 v231, v239, v63, v231
    v_mfma_f32_16x16x32_bf16 v[60:63], v[204:207], a[244:247], 0
    v_cvt_pk_bf16_f32 v24, v224, v225
    v_mfma_f32_16x16x32_bf16 v[236:239], v[200:203], a[244:247], 0
    v_cvt_pk_bf16_f32 v25, v226, v227
    v_mfma_f32_16x16x32_bf16 v[224:227], v[168:171], a[228:231], 0
    v_cvt_pk_bf16_f32 v26, v228, v229
    s_waitcnt lgkmcnt(4)
    v_mfma_f32_16x16x32_bf16 v[188:191], a[200:203], a[24:27], v[188:191]
    ds_read_b64_tr_b16 a[216:217], v12 offset:2560
    v_cvt_pk_bf16_f32 v27, v230, v231
    v_mfma_f32_16x16x32_bf16 v[228:231], v[172:175], a[228:231], 0
    buffer_store_dwordx4 v[24:27], v6, s[44:47], s96 offen offset:0 sc1
    v_mfma_f32_16x16x32_bf16 v[188:191], a[204:207], a[28:31], v[188:191]
    buffer_load_dwordx4 v20, s[56:59], s11 offen offset:3072 lds
    v_mul_f32 v54, v53, v50
    v_mfma_f32_16x16x32_bf16 v[184:187], a[204:207], a[20:23], v[184:187]
    ds_read_b64_tr_b16 a[218:219], v12 offset:23040
    v_mul_f32 v55, v49, v50
    v_mfma_f32_16x16x32_bf16 v[48:51], v[192:195], a[232:235], 0
    v_mul_f32 v32, v32, v54
    v_mul_f32 v33, v33, v54
    v_mfma_f32_16x16x32_bf16 v[184:187], a[200:203], a[16:19], v[184:187]
    v_mul_f32 v34, v34, v54
    v_mul_f32 v35, v35, v54
    v_mfma_f32_16x16x32_bf16 v[180:183], a[200:203], a[8:11], v[180:183]
    ds_read_b64_tr_b16 a[220:221], v12 offset:3584
    s_add_u32 m0, s19, 0
    v_mfma_f32_16x16x32_bf16 v[180:183], a[204:207], a[12:15], v[180:183]
    s_lshl_b32 s11, s90, 4
    v_mul_f32 v36, v36, v54
    v_mfma_f32_16x16x32_bf16 v[176:179], a[204:207], a[4:7], v[176:179]
    ds_read_b64_tr_b16 a[222:223], v12 offset:24064
    v_mul_f32 v37, v37, v54
    v_mfma_f32_16x16x32_bf16 v[176:179], a[200:203], a[0:3], v[176:179]
    v_mul_f32 v38, v38, v54
    s_waitcnt lgkmcnt(4)
    v_mfma_f32_16x16x32_bf16 v[208:211], a[208:211], a[0:3], v[208:211]
    ds_read_b64_tr_b16 a[192:193], v13 offset:0
    v_mul_f32 v39, v39, v54
    v_mfma_f32_16x16x32_bf16 v[208:211], a[212:215], a[4:7], v[208:211]
    buffer_load_dwordx4 v17, s[56:59], s11 offen offset:0 lds
    v_fma_f32 v32, v40, v55, v32
    v_mfma_f32_16x16x32_bf16 v[212:215], a[212:215], a[12:15], v[212:215]
    ds_read_b64_tr_b16 a[194:195], v13 offset:20480
    v_fma_f32 v33, v41, v55, v33
    v_mfma_f32_16x16x32_bf16 v[212:215], a[208:211], a[8:11], v[212:215]
    v_fma_f32 v34, v42, v55, v34
    v_fma_f32 v35, v43, v55, v35
    v_mfma_f32_16x16x32_bf16 v[40:43], v[196:199], a[248:251], 0
    v_fma_f32 v36, v44, v55, v36
    v_fma_f32 v37, v45, v55, v37
    v_mfma_f32_16x16x32_bf16 v[216:219], a[208:211], a[16:19], v[216:219]
    ds_read_b64_tr_b16 a[196:197], v13 offset:1024
    v_fma_f32 v38, v46, v55, v38
    v_mfma_f32_16x16x32_bf16 v[216:219], a[212:215], a[20:23], v[216:219]
    buffer_load_dwordx4 v18, s[56:59], s11 offen offset:1024 lds
    v_fma_f32 v39, v47, v55, v39
    v_mfma_f32_16x16x32_bf16 v[52:55], v[204:207], a[248:251], 0
    v_cvt_pk_bf16_f32 v24, v32, v33
    v_cvt_pk_bf16_f32 v25, v34, v35
    v_mfma_f32_16x16x32_bf16 v[32:35], v[168:171], a[232:235], 0
    v_cvt_pk_bf16_f32 v26, v36, v37
    v_cvt_pk_bf16_f32 v27, v38, v39
    v_mfma_f32_16x16x32_bf16 v[36:39], v[172:175], a[232:235], 0
    buffer_store_dwordx4 v[24:27], v3, s[44:47], s96 offen offset:1024 sc1
    v_mfma_f32_16x16x32_bf16 v[44:47], v[200:203], a[248:251], 0
    v_mul_f32 v58, s97, v57
    v_add_f32 v58, v58, v56
    v_mfma_f32_16x16x32_bf16 v[220:223], a[212:215], a[28:31], v[220:223]
    ds_read_b64_tr_b16 a[198:199], v13 offset:21504
    v_mul_f32 v58, v58, v61
    v_mfma_f32_16x16x32_bf16 v[220:223], a[208:211], a[24:27], v[220:223]
    v_fmac_f32 v58, v60, v57
    s_waitcnt lgkmcnt(4)
    v_mfma_f32_16x16x32_bf16 v[252:255], a[216:219], a[24:27], v[252:255]
    ds_read_b64_tr_b16 a[200:201], v14 offset:0
    v_mul_f32 v50, s97, v49
    v_mfma_f32_16x16x32_bf16 v[252:255], a[220:223], a[28:31], v[252:255]
    buffer_load_dwordx4 v19, s[56:59], s11 offen offset:2048 lds
    v_add_f32 v50, v50, v48
    v_mfma_f32_16x16x32_bf16 v[248:251], a[220:223], a[20:23], v[248:251]
    ds_read_b64_tr_b16 a[202:203], v14 offset:20480
    v_mul_f32 v50, v50, v53
    v_mfma_f32_16x16x32_bf16 v[248:251], a[216:219], a[16:19], v[248:251]
    v_rcp_f32 v58, v58
    v_mfma_f32_16x16x32_bf16 v[244:247], a[216:219], a[8:11], v[244:247]
    ds_read_b64_tr_b16 a[204:205], v14 offset:1024
    v_mul_f32 v62, v61, v58
    v_mfma_f32_16x16x32_bf16 v[244:247], a[220:223], a[12:15], v[244:247]
    buffer_load_dwordx4 v20, s[56:59], s11 offen offset:3072 lds
    v_mul_f32 v63, v57, v58
    v_mfma_f32_16x16x32_bf16 v[56:59], v[192:195], a[236:239], 0
    v_mul_f32 v224, v224, v62
    v_mul_f32 v225, v225, v62
    v_mfma_f32_16x16x32_bf16 v[240:243], a[220:223], a[4:7], v[240:243]
    ds_read_b64_tr_b16 a[206:207], v14 offset:21504
    v_mul_f32 v226, v226, v62
    v_mfma_f32_16x16x32_bf16 v[240:243], a[216:219], a[0:3], v[240:243]
    v_mul_f32 v227, v227, v62
    v_pk_mul_f32 v[228:229], v[228:229], v[62:63] op_sel_hi:[1,0]
    v_pk_mul_f32 v[230:231], v[230:231], v[62:63] op_sel_hi:[1,0]
    v_pk_fma_f32 v[224:225], v[232:233], v[62:63], v[224:225] op_sel:[0,1,0]
    v_pk_fma_f32 v[226:227], v[234:235], v[62:63], v[226:227] op_sel:[0,1,0]
    v_pk_fma_f32 v[228:229], v[236:237], v[62:63], v[228:229] op_sel:[0,1,0]
    v_pk_fma_f32 v[230:231], v[238:239], v[62:63], v[230:231] op_sel:[0,1,0]
    v_cvt_pk_bf16_f32 v24, v224, v225
    v_cvt_pk_bf16_f32 v25, v226, v227
    v_cvt_pk_bf16_f32 v26, v228, v229
    v_cvt_pk_bf16_f32 v27, v230, v231
    buffer_store_dwordx4 v[24:27], v4, s[44:47], s96 offen offset:1024 sc1
    v_mfma_f32_16x16x32_bf16 v[60:63], v[204:207], a[252:255], 0
    v_mfma_f32_16x16x32_bf16 v[224:227], v[168:171], a[236:239], 0
    v_mfma_f32_16x16x32_bf16 v[228:231], v[172:175], a[236:239], 0
    v_mfma_f32_16x16x32_bf16 v[232:235], v[196:199], a[252:255], 0
    v_mfma_f32_16x16x32_bf16 v[236:239], v[200:203], a[252:255], 0
    v_fmac_f32 v50, v52, v49
    v_rcp_f32 v50, v50
    s_nop 0
    v_mul_f32 v54, v53, v50
    v_mul_f32 v55, v49, v50
    v_pk_mul_f32 v[32:33], v[32:33], v[54:55] op_sel_hi:[1,0]
    v_pk_mul_f32 v[34:35], v[34:35], v[54:55] op_sel_hi:[1,0]
    v_pk_mul_f32 v[36:37], v[36:37], v[54:55] op_sel_hi:[1,0]
    v_pk_mul_f32 v[38:39], v[38:39], v[54:55] op_sel_hi:[1,0]
    v_pk_fma_f32 v[32:33], v[40:41], v[54:55], v[32:33] op_sel:[0,1,0]
    v_pk_fma_f32 v[34:35], v[42:43], v[54:55], v[34:35] op_sel:[0,1,0]
    v_pk_fma_f32 v[36:37], v[44:45], v[54:55], v[36:37] op_sel:[0,1,0]
    v_pk_fma_f32 v[38:39], v[46:47], v[54:55], v[38:39] op_sel:[0,1,0]
    v_cvt_pk_bf16_f32 v24, v32, v33
    v_cvt_pk_bf16_f32 v25, v34, v35
    v_cvt_pk_bf16_f32 v26, v36, v37
    v_cvt_pk_bf16_f32 v27, v38, v39
    buffer_store_dwordx4 v[24:27], v5, s[44:47], s96 offen offset:1024 sc1
    v_mul_f32 v58, s97, v57
    v_add_f32 v58, v58, v56
    v_mul_f32 v58, v58, v61
    v_fmac_f32 v58, v60, v57
    v_rcp_f32 v58, v58
    s_nop 0
    v_mul_f32 v62, v61, v58
    v_mul_f32 v63, v57, v58
    v_pk_mul_f32 v[224:225], v[224:225], v[62:63] op_sel_hi:[1,0]
    v_pk_mul_f32 v[226:227], v[226:227], v[62:63] op_sel_hi:[1,0]
    v_pk_mul_f32 v[228:229], v[228:229], v[62:63] op_sel_hi:[1,0]
    v_pk_mul_f32 v[230:231], v[230:231], v[62:63] op_sel_hi:[1,0]
    v_pk_fma_f32 v[224:225], v[232:233], v[62:63], v[224:225] op_sel:[0,1,0]
    v_pk_fma_f32 v[226:227], v[234:235], v[62:63], v[226:227] op_sel:[0,1,0]
    v_pk_fma_f32 v[228:229], v[236:237], v[62:63], v[228:229] op_sel:[0,1,0]
    v_pk_fma_f32 v[230:231], v[238:239], v[62:63], v[230:231] op_sel:[0,1,0]
    v_cvt_pk_bf16_f32 v24, v224, v225
    v_cvt_pk_bf16_f32 v25, v226, v227
    v_cvt_pk_bf16_f32 v26, v228, v229
    v_cvt_pk_bf16_f32 v27, v230, v231
    buffer_store_dwordx4 v[24:27], v6, s[44:47], s96 offen offset:1024 sc1
    s_waitcnt vmcnt(32) lgkmcnt(4)
    v_mfma_f32_16x16x32_bf16 v[64:67], a[192:195], a[128:131], v[64:67]
    ds_read_b64_tr_b16 a[208:209], v13 offset:512
    s_add_u32 m0, s19, 4096
    v_mfma_f32_16x16x32_bf16 v[64:67], a[196:199], a[132:135], v[64:67]
    s_lshl_b32 s11, s91, 4
    v_mfma_f32_16x16x32_bf16 v[68:71], a[196:199], a[140:143], v[68:71]
    ds_read_b64_tr_b16 a[210:211], v13 offset:20992
    v_mfma_f32_16x16x32_bf16 v[68:71], a[192:195], a[136:139], v[68:71]
    buffer_load_dwordx4 v17, s[56:59], s11 offen offset:0 lds
    v_mfma_f32_16x16x32_bf16 v[72:75], a[192:195], a[144:147], v[72:75]
    ds_read_b64_tr_b16 a[212:213], v13 offset:1536
    v_mfma_f32_16x16x32_bf16 v[72:75], a[196:199], a[148:151], v[72:75]
    v_mfma_f32_16x16x32_bf16 v[76:79], a[196:199], a[156:159], v[76:79]
    ds_read_b64_tr_b16 a[214:215], v13 offset:22016
    v_mfma_f32_16x16x32_bf16 v[76:79], a[192:195], a[152:155], v[76:79]
    s_waitcnt vmcnt(63) lgkmcnt(4)
    s_barrier
    v_mfma_f32_16x16x32_bf16 v[92:95], a[200:203], a[152:155], v[92:95]
    ds_read_b64_tr_b16 a[216:217], v14 offset:512
    v_mfma_f32_16x16x32_bf16 v[92:95], a[204:207], a[156:159], v[92:95]
    buffer_load_dwordx4 v18, s[56:59], s11 offen offset:1024 lds
    v_mfma_f32_16x16x32_bf16 v[88:91], a[204:207], a[148:151], v[88:91]
    ds_read_b64_tr_b16 a[218:219], v14 offset:20992
    v_mfma_f32_16x16x32_bf16 v[88:91], a[200:203], a[144:147], v[88:91]
    v_mfma_f32_16x16x32_bf16 v[84:87], a[200:203], a[136:139], v[84:87]
    ds_read_b64_tr_b16 a[220:221], v14 offset:1536
    v_mfma_f32_16x16x32_bf16 v[84:87], a[204:207], a[140:143], v[84:87]
    buffer_load_dwordx4 v19, s[56:59], s11 offen offset:2048 lds
    v_mfma_f32_16x16x32_bf16 v[80:83], a[204:207], a[132:135], v[80:83]
    ds_read_b64_tr_b16 a[222:223], v14 offset:22016
    v_mfma_f32_16x16x32_bf16 v[80:83], a[200:203], a[128:131], v[80:83]
    v_bfe_u32 v30, v1, 4, 1
    v_lshrrev_b32 v15, 5, v1
    v_lshlrev_b32 v30, 5, v30
    v_lshl_add_u32 v30, v15, 4, v30
    v_and_b32 v15, 15, v1
    v_lshl_add_u32 v30, v15, 11, v30
    s_waitcnt lgkmcnt(4)
    v_mfma_f32_16x16x32_bf16 v[96:99], a[208:211], a[128:131], v[96:99]
    ds_read_b64_tr_b16 a[192:193], v13 offset:2048
    v_mfma_f32_16x16x32_bf16 v[96:99], a[212:215], a[132:135], v[96:99]
    buffer_load_dwordx4 v20, s[56:59], s11 offen offset:3072 lds
    v_mfma_f32_16x16x32_bf16 v[100:103], a[212:215], a[140:143], v[100:103]
    ds_read_b64_tr_b16 a[194:195], v13 offset:22528
    v_mfma_f32_16x16x32_bf16 v[100:103], a[208:211], a[136:139], v[100:103]
    v_mfma_f32_16x16x32_bf16 v[104:107], a[208:211], a[144:147], v[104:107]
    ds_read_b64_tr_b16 a[196:197], v13 offset:3072
    v_mfma_f32_16x16x32_bf16 v[104:107], a[212:215], a[148:151], v[104:107]
    buffer_load_dwordx4 v[224:227], v30, s[28:31], 0 offen offset:0 sc1
    v_mfma_f32_16x16x32_bf16 v[108:111], a[212:215], a[156:159], v[108:111]
    ds_read_b64_tr_b16 a[198:199], v13 offset:23552
    v_mfma_f32_16x16x32_bf16 v[108:111], a[208:211], a[152:155], v[108:111]
    s_waitcnt lgkmcnt(4)
    v_mfma_f32_16x16x32_bf16 v[124:127], a[216:219], a[152:155], v[124:127]
    ds_read_b64_tr_b16 a[200:201], v14 offset:2048
    v_mfma_f32_16x16x32_bf16 v[124:127], a[220:223], a[156:159], v[124:127]
    buffer_load_dwordx4 v[228:231], v30, s[28:31], 0 offen offset:64 sc1
    v_mfma_f32_16x16x32_bf16 v[120:123], a[220:223], a[148:151], v[120:123]
    ds_read_b64_tr_b16 a[202:203], v14 offset:22528
    v_mfma_f32_16x16x32_bf16 v[120:123], a[216:219], a[144:147], v[120:123]
    v_mfma_f32_16x16x32_bf16 v[116:119], a[216:219], a[136:139], v[116:119]
    ds_read_b64_tr_b16 a[204:205], v14 offset:3072
    v_mfma_f32_16x16x32_bf16 v[116:119], a[220:223], a[140:143], v[116:119]
    buffer_load_dwordx4 v[232:235], v30, s[28:31], 0 offen offset:128 sc1
    v_mfma_f32_16x16x32_bf16 v[112:115], a[220:223], a[132:135], v[112:115]
    ds_read_b64_tr_b16 a[206:207], v14 offset:23552
    v_mfma_f32_16x16x32_bf16 v[112:115], a[216:219], a[128:131], v[112:115]
    s_waitcnt lgkmcnt(4)
    v_mfma_f32_16x16x32_bf16 v[144:147], a[192:195], a[128:131], v[144:147]
    ds_read_b64_tr_b16 a[208:209], v13 offset:2560
    v_mfma_f32_16x16x32_bf16 v[144:147], a[196:199], a[132:135], v[144:147]
    buffer_load_dwordx4 v[236:239], v30, s[28:31], 0 offen offset:192 sc1
    v_mfma_f32_16x16x32_bf16 v[148:151], a[196:199], a[140:143], v[148:151]
    ds_read_b64_tr_b16 a[210:211], v13 offset:23040
    v_mfma_f32_16x16x32_bf16 v[148:151], a[192:195], a[136:139], v[148:151]
    v_mfma_f32_16x16x32_bf16 v[152:155], a[192:195], a[144:147], v[152:155]
    ds_read_b64_tr_b16 a[212:213], v13 offset:3584
    s_add_u32 m0, s19, 40960
    v_mfma_f32_16x16x32_bf16 v[152:155], a[196:199], a[148:151], v[152:155]
    s_mov_b32 s11, 0
    v_mfma_f32_16x16x32_bf16 v[156:159], a[196:199], a[156:159], v[156:159]
    ds_read_b64_tr_b16 a[214:215], v13 offset:24064
    v_mfma_f32_16x16x32_bf16 v[156:159], a[192:195], a[152:155], v[156:159]
    s_waitcnt lgkmcnt(4)
    v_mfma_f32_16x16x32_bf16 v[188:191], a[200:203], a[152:155], v[188:191]
    ds_read_b64_tr_b16 a[216:217], v14 offset:2560
    v_mfma_f32_16x16x32_bf16 v[188:191], a[204:207], a[156:159], v[188:191]
    buffer_load_dwordx4 v17, s[36:39], s11 offen offset:0 lds
    v_mfma_f32_16x16x32_bf16 v[184:187], a[204:207], a[148:151], v[184:187]
    ds_read_b64_tr_b16 a[218:219], v14 offset:23040
    v_mfma_f32_16x16x32_bf16 v[184:187], a[200:203], a[144:147], v[184:187]
    v_mfma_f32_16x16x32_bf16 v[180:183], a[200:203], a[136:139], v[180:183]
    ds_read_b64_tr_b16 a[220:221], v14 offset:3584
    v_mfma_f32_16x16x32_bf16 v[180:183], a[204:207], a[140:143], v[180:183]
    buffer_load_dwordx4 v18, s[36:39], s11 offen offset:1024 lds
    v_mfma_f32_16x16x32_bf16 v[176:179], a[204:207], a[132:135], v[176:179]
    ds_read_b64_tr_b16 a[222:223], v14 offset:24064
    v_mfma_f32_16x16x32_bf16 v[176:179], a[200:203], a[128:131], v[176:179]
    s_waitcnt vmcnt(63)
    v_and_b32 v0, 3, v1
    v_lshlrev_b32 v0, 2, v0
    buffer_load_dword v0, v0, s[52:55], s67 offen offset:64 sc1
    s_waitcnt lgkmcnt(4)
    v_mfma_f32_16x16x32_bf16 v[208:211], a[208:211], a[128:131], v[208:211]
    ds_read_b64_tr_b16 a[192:193], v11 offset:8192
    v_mfma_f32_16x16x32_bf16 v[208:211], a[212:215], a[132:135], v[208:211]
    buffer_load_dwordx4 v19, s[36:39], s11 offen offset:2048 lds
    v_mfma_f32_16x16x32_bf16 v[212:215], a[212:215], a[140:143], v[212:215]
    ds_read_b64_tr_b16 a[194:195], v11 offset:28672
    v_mfma_f32_16x16x32_bf16 v[212:215], a[208:211], a[136:139], v[212:215]
    v_mfma_f32_16x16x32_bf16 v[216:219], a[208:211], a[144:147], v[216:219]
    ds_read_b64_tr_b16 a[196:197], v11 offset:9216
    v_mfma_f32_16x16x32_bf16 v[216:219], a[212:215], a[148:151], v[216:219]
    buffer_load_dwordx4 v20, s[36:39], s11 offen offset:3072 lds
    v_mfma_f32_16x16x32_bf16 v[220:223], a[212:215], a[156:159], v[220:223]
    ds_read_b64_tr_b16 a[198:199], v11 offset:29696
    v_mfma_f32_16x16x32_bf16 v[220:223], a[208:211], a[152:155], v[220:223]
    s_waitcnt lgkmcnt(4)
    v_mfma_f32_16x16x32_bf16 v[252:255], a[216:219], a[152:155], v[252:255]
    ds_read_b64_tr_b16 a[200:201], v12 offset:8192
    s_add_u32 m0, s19, 81920
    v_mfma_f32_16x16x32_bf16 v[252:255], a[220:223], a[156:159], v[252:255]
    s_mov_b32 s11, 131072
    v_mfma_f32_16x16x32_bf16 v[248:251], a[220:223], a[148:151], v[248:251]
    ds_read_b64_tr_b16 a[202:203], v12 offset:28672
    v_mfma_f32_16x16x32_bf16 v[248:251], a[216:219], a[144:147], v[248:251]
    buffer_load_dwordx4 v17, s[36:39], s11 offen offset:0 lds
    v_mfma_f32_16x16x32_bf16 v[244:247], a[216:219], a[136:139], v[244:247]
    ds_read_b64_tr_b16 a[204:205], v12 offset:9216
    v_mfma_f32_16x16x32_bf16 v[244:247], a[220:223], a[140:143], v[244:247]
    v_mfma_f32_16x16x32_bf16 v[240:243], a[220:223], a[132:135], v[240:243]
    ds_read_b64_tr_b16 a[206:207], v12 offset:29696
    v_mfma_f32_16x16x32_bf16 v[240:243], a[216:219], a[128:131], v[240:243]
    s_waitcnt vmcnt(37) lgkmcnt(4)
    v_mfma_f32_16x16x32_bf16 v[64:67], a[192:195], a[160:163], v[64:67]
    ds_read_b64_tr_b16 a[208:209], v11 offset:8704
    v_mfma_f32_16x16x32_bf16 v[64:67], a[196:199], a[164:167], v[64:67]
    buffer_load_dwordx4 v18, s[36:39], s11 offen offset:1024 lds
    v_mfma_f32_16x16x32_bf16 v[68:71], a[196:199], a[172:175], v[68:71]
    ds_read_b64_tr_b16 a[210:211], v11 offset:29184
    v_mfma_f32_16x16x32_bf16 v[68:71], a[192:195], a[168:171], v[68:71]
    v_mfma_f32_16x16x32_bf16 v[72:75], a[192:195], a[176:179], v[72:75]
    ds_read_b64_tr_b16 a[212:213], v11 offset:9728
    v_mfma_f32_16x16x32_bf16 v[72:75], a[196:199], a[180:183], v[72:75]
    buffer_load_dwordx4 v19, s[36:39], s11 offen offset:2048 lds
    v_mfma_f32_16x16x32_bf16 v[76:79], a[196:199], a[188:191], v[76:79]
    ds_read_b64_tr_b16 a[214:215], v11 offset:30208
    v_mfma_f32_16x16x32_bf16 v[76:79], a[192:195], a[184:187], v[76:79]
    s_waitcnt vmcnt(63) lgkmcnt(4)
    s_barrier
    v_mfma_f32_16x16x32_bf16 v[92:95], a[200:203], a[184:187], v[92:95]
    ds_read_b64_tr_b16 a[216:217], v12 offset:8704
    v_mfma_f32_16x16x32_bf16 v[92:95], a[204:207], a[188:191], v[92:95]
    buffer_load_dwordx4 v20, s[36:39], s11 offen offset:3072 lds
    v_mfma_f32_16x16x32_bf16 v[88:91], a[204:207], a[180:183], v[88:91]
    ds_read_b64_tr_b16 a[218:219], v12 offset:29184
    v_mfma_f32_16x16x32_bf16 v[88:91], a[200:203], a[176:179], v[88:91]
    v_mfma_f32_16x16x32_bf16 v[84:87], a[200:203], a[168:171], v[84:87]
    ds_read_b64_tr_b16 a[220:221], v12 offset:9728
    v_mfma_f32_16x16x32_bf16 v[84:87], a[204:207], a[172:175], v[84:87]
    v_mfma_f32_16x16x32_bf16 v[80:83], a[204:207], a[164:167], v[80:83]
    ds_read_b64_tr_b16 a[222:223], v12 offset:30208
    v_mfma_f32_16x16x32_bf16 v[80:83], a[200:203], a[160:163], v[80:83]
    s_waitcnt vmcnt(17)
    s_add_u32 s74, s66, 8192
    s_mov_b64 exec, 1
    buffer_store_dword v21, off, s[52:55], s74 sc1
    s_mov_b64 exec, -1
    s_waitcnt lgkmcnt(4)
    v_mfma_f32_16x16x32_bf16 v[96:99], a[208:211], a[160:163], v[96:99]
    ds_read_b64_tr_b16 a[192:193], v13 offset:8192
    s_add_u32 m0, s19, 8192
    v_mfma_f32_16x16x32_bf16 v[96:99], a[212:215], a[164:167], v[96:99]
    s_mov_b32 s11, 262144
    v_mfma_f32_16x16x32_bf16 v[100:103], a[212:215], a[172:175], v[100:103]
    ds_read_b64_tr_b16 a[194:195], v13 offset:28672
    v_mfma_f32_16x16x32_bf16 v[100:103], a[208:211], a[168:171], v[100:103]
    buffer_load_dwordx4 v17, s[36:39], s11 offen offset:0 lds
    v_mfma_f32_16x16x32_bf16 v[104:107], a[208:211], a[176:179], v[104:107]
    ds_read_b64_tr_b16 a[196:197], v13 offset:9216
    v_mfma_f32_16x16x32_bf16 v[104:107], a[212:215], a[180:183], v[104:107]
    v_mfma_f32_16x16x32_bf16 v[108:111], a[212:215], a[188:191], v[108:111]
    ds_read_b64_tr_b16 a[198:199], v13 offset:29696
    v_mfma_f32_16x16x32_bf16 v[108:111], a[208:211], a[184:187], v[108:111]
    s_waitcnt lgkmcnt(4)
    v_mfma_f32_16x16x32_bf16 v[124:127], a[216:219], a[184:187], v[124:127]
    ds_read_b64_tr_b16 a[200:201], v14 offset:8192
    v_mfma_f32_16x16x32_bf16 v[124:127], a[220:223], a[188:191], v[124:127]
    buffer_load_dwordx4 v18, s[36:39], s11 offen offset:1024 lds
    v_mfma_f32_16x16x32_bf16 v[120:123], a[220:223], a[180:183], v[120:123]
    ds_read_b64_tr_b16 a[202:203], v14 offset:28672
    v_mfma_f32_16x16x32_bf16 v[120:123], a[216:219], a[176:179], v[120:123]
    v_mfma_f32_16x16x32_bf16 v[116:119], a[216:219], a[168:171], v[116:119]
    ds_read_b64_tr_b16 a[204:205], v14 offset:9216
    s_add_u32 m0, s19, 47104
    v_mfma_f32_16x16x32_bf16 v[116:119], a[220:223], a[172:175], v[116:119]
    buffer_load_dwordx4 v19, s[36:39], s11 offen offset:2048 lds
    v_mfma_f32_16x16x32_bf16 v[112:115], a[220:223], a[164:167], v[112:115]
    ds_read_b64_tr_b16 a[206:207], v14 offset:29696
    v_mfma_f32_16x16x32_bf16 v[112:115], a[216:219], a[160:163], v[112:115]
    s_waitcnt vmcnt(10)
    v_cmp_ne_u32 vcc, s18, v0
    s_cbranch_vccnz L_pl9
L_pl9_b:
    s_waitcnt lgkmcnt(4)
    v_mfma_f32_16x16x32_bf16 v[144:147], a[192:195], a[160:163], v[144:147]
    ds_read_b64_tr_b16 a[208:209], v13 offset:8704
    v_mfma_f32_16x16x32_bf16 v[144:147], a[196:199], a[164:167], v[144:147]
    buffer_load_dwordx4 v20, s[36:39], s11 offen offset:3072 lds
    v_mfma_f32_16x16x32_bf16 v[148:151], a[196:199], a[172:175], v[148:151]
    ds_read_b64_tr_b16 a[210:211], v13 offset:29184
    v_mfma_f32_16x16x32_bf16 v[148:151], a[192:195], a[168:171], v[148:151]
    v_mfma_f32_16x16x32_bf16 v[152:155], a[192:195], a[176:179], v[152:155]
    ds_read_b64_tr_b16 a[212:213], v13 offset:9728
    v_mfma_f32_16x16x32_bf16 v[152:155], a[196:199], a[180:183], v[152:155]
    buffer_load_dwordx4 a[0:3], v3, s[44:47], s88 offen offset:0 sc1
    v_mfma_f32_16x16x32_bf16 v[156:159], a[196:199], a[188:191], v[156:159]
    ds_read_b64_tr_b16 a[214:215], v13 offset:30208
    v_mfma_f32_16x16x32_bf16 v[156:159], a[192:195], a[184:187], v[156:159]
    s_waitcnt lgkmcnt(4)
    v_mfma_f32_16x16x32_bf16 v[188:191], a[200:203], a[184:187], v[188:191]
    ds_read_b64_tr_b16 a[216:217], v14 offset:8704
    v_mfma_f32_16x16x32_bf16 v[188:191], a[204:207], a[188:191], v[188:191]
    buffer_load_dwordx4 a[4:7], v3, s[44:47], s88 offen offset:1024 sc1
    v_mfma_f32_16x16x32_bf16 v[184:187], a[204:207], a[180:183], v[184:187]
    ds_read_b64_tr_b16 a[218:219], v14 offset:29184
    v_mfma_f32_16x16x32_bf16 v[184:187], a[200:203], a[176:179], v[184:187]
    v_mfma_f32_16x16x32_bf16 v[180:183], a[200:203], a[168:171], v[180:183]
    ds_read_b64_tr_b16 a[220:221], v14 offset:9728
    v_mfma_f32_16x16x32_bf16 v[180:183], a[204:207], a[172:175], v[180:183]
    buffer_load_dwordx4 a[8:11], v4, s[44:47], s88 offen offset:0 sc1
    v_mfma_f32_16x16x32_bf16 v[176:179], a[204:207], a[164:167], v[176:179]
    ds_read_b64_tr_b16 a[222:223], v14 offset:30208
    v_mfma_f32_16x16x32_bf16 v[176:179], a[200:203], a[160:163], v[176:179]
    s_waitcnt lgkmcnt(4)
    v_mfma_f32_16x16x32_bf16 v[208:211], a[208:211], a[160:163], v[208:211]
    ds_read_b64_tr_b16 a[192:193], v9 offset:4096
    v_mfma_f32_16x16x32_bf16 v[208:211], a[212:215], a[164:167], v[208:211]
    buffer_load_dwordx4 a[12:15], v4, s[44:47], s88 offen offset:1024 sc1
    v_mfma_f32_16x16x32_bf16 v[212:215], a[212:215], a[172:175], v[212:215]
    ds_read_b64_tr_b16 a[194:195], v9 offset:24576
    v_mfma_f32_16x16x32_bf16 v[212:215], a[208:211], a[168:171], v[212:215]
    v_mfma_f32_16x16x32_bf16 v[216:219], a[208:211], a[176:179], v[216:219]
    ds_read_b64_tr_b16 a[196:197], v9 offset:5120
    v_mfma_f32_16x16x32_bf16 v[216:219], a[212:215], a[180:183], v[216:219]
    buffer_load_dwordx4 a[16:19], v5, s[44:47], s88 offen offset:0 sc1
    v_mfma_f32_16x16x32_bf16 v[220:223], a[212:215], a[188:191], v[220:223]
    ds_read_b64_tr_b16 a[198:199], v9 offset:25600
    v_mfma_f32_16x16x32_bf16 v[220:223], a[208:211], a[184:187], v[220:223]
    s_waitcnt lgkmcnt(4)
    v_mfma_f32_16x16x32_bf16 v[252:255], a[216:219], a[184:187], v[252:255]
    ds_read_b64_tr_b16 a[200:201], v10 offset:4096
    v_mfma_f32_16x16x32_bf16 v[252:255], a[220:223], a[188:191], v[252:255]
    buffer_load_dwordx4 a[20:23], v5, s[44:47], s88 offen offset:1024 sc1
    v_mfma_f32_16x16x32_bf16 v[248:251], a[220:223], a[180:183], v[248:251]
    ds_read_b64_tr_b16 a[202:203], v10 offset:24576
    v_mfma_f32_16x16x32_bf16 v[248:251], a[216:219], a[176:179], v[248:251]
    v_mfma_f32_16x16x32_bf16 v[244:247], a[216:219], a[168:171], v[244:247]
    ds_read_b64_tr_b16 a[204:205], v10 offset:5120
    v_mfma_f32_16x16x32_bf16 v[244:247], a[220:223], a[172:175], v[244:247]
    buffer_load_dwordx4 a[24:27], v6, s[44:47], s88 offen offset:0 sc1
    v_mfma_f32_16x16x32_bf16 v[240:243], a[220:223], a[164:167], v[240:243]
    ds_read_b64_tr_b16 a[206:207], v10 offset:25600
    v_mfma_f32_16x16x32_bf16 v[240:243], a[216:219], a[160:163], v[240:243]
    s_getpc_b64 s[94:95]
L_ct9681:
    s_lshr_b32 s74, s2, 4
    s_lshl_b32 s74, s74, 2
    s_add_u32 s74, s74, s3
    s_mul_i32 s74, s74, 256
    v_min_u32 v22, 1, v1
    v_lshl_add_u32 v22, v22, 7, s74
    v_add_u32 v22, L_P2-L_ct9681, v22
    v_min_u32 v22, L_end-L_ct9681-4, v22
    v_mov_b32 v23, s95
    v_add_co_u32 v22, vcc, s94, v22
    s_nop 1
    v_addc_co_u32 v23, vcc, 0, v23, vcc
    global_load_dword v0, v[22:23], off
    s_waitcnt vmcnt(43) lgkmcnt(4)
    v_mfma_f32_16x16x32_bf16 v[64:67], a[192:195], a[96:99], v[64:67]
    ds_read_b64_tr_b16 a[208:209], v9 offset:4608
    v_mfma_f32_16x16x32_bf16 v[64:67], a[196:199], a[100:103], v[64:67]
    buffer_load_dwordx4 a[28:31], v6, s[44:47], s88 offen offset:1024 sc1
    v_mfma_f32_16x16x32_bf16 v[68:71], a[196:199], a[108:111], v[68:71]
    ds_read_b64_tr_b16 a[210:211], v9 offset:25088
    v_mfma_f32_16x16x32_bf16 v[68:71], a[192:195], a[104:107], v[68:71]
    v_mfma_f32_16x16x32_bf16 v[72:75], a[192:195], a[112:115], v[72:75]
    ds_read_b64_tr_b16 a[212:213], v9 offset:5632
    s_add_u32 m0, s19, 122880
    v_mfma_f32_16x16x32_bf16 v[72:75], a[196:199], a[116:119], v[72:75]
    s_mov_b32 s11, 393216
    v_mfma_f32_16x16x32_bf16 v[76:79], a[196:199], a[124:127], v[76:79]
    ds_read_b64_tr_b16 a[214:215], v9 offset:26112
    v_mfma_f32_16x16x32_bf16 v[76:79], a[192:195], a[120:123], v[76:79]
    s_waitcnt vmcnt(63) lgkmcnt(4)
    s_barrier
    v_mfma_f32_16x16x32_bf16 v[92:95], a[200:203], a[120:123], v[92:95]
    ds_read_b64_tr_b16 a[216:217], v10 offset:4608
    v_mfma_f32_16x16x32_bf16 v[92:95], a[204:207], a[124:127], v[92:95]
    buffer_load_dwordx4 v17, s[36:39], s11 offen offset:0 lds
    v_mfma_f32_16x16x32_bf16 v[88:91], a[204:207], a[116:119], v[88:91]
    ds_read_b64_tr_b16 a[218:219], v10 offset:25088
    v_mfma_f32_16x16x32_bf16 v[88:91], a[200:203], a[112:115], v[88:91]
    v_mfma_f32_16x16x32_bf16 v[84:87], a[200:203], a[104:107], v[84:87]
    ds_read_b64_tr_b16 a[220:221], v10 offset:5632
    v_mfma_f32_16x16x32_bf16 v[84:87], a[204:207], a[108:111], v[84:87]
    buffer_load_dwordx4 v18, s[36:39], s11 offen offset:1024 lds
    v_mfma_f32_16x16x32_bf16 v[80:83], a[204:207], a[100:103], v[80:83]
    ds_read_b64_tr_b16 a[222:223], v10 offset:26112
    v_mfma_f32_16x16x32_bf16 v[80:83], a[200:203], a[96:99], v[80:83]
    s_waitcnt lgkmcnt(4)
    v_mfma_f32_16x16x32_bf16 v[96:99], a[208:211], a[96:99], v[96:99]
    ds_read_b64_tr_b16 a[192:193], v9 offset:6144
    v_mfma_f32_16x16x32_bf16 v[96:99], a[212:215], a[100:103], v[96:99]
    buffer_load_dwordx4 v19, s[36:39], s11 offen offset:2048 lds
    v_mfma_f32_16x16x32_bf16 v[100:103], a[212:215], a[108:111], v[100:103]
    ds_read_b64_tr_b16 a[194:195], v9 offset:26624
    v_mfma_f32_16x16x32_bf16 v[100:103], a[208:211], a[104:107], v[100:103]
    v_mfma_f32_16x16x32_bf16 v[104:107], a[208:211], a[112:115], v[104:107]
    ds_read_b64_tr_b16 a[196:197], v9 offset:7168
    v_mfma_f32_16x16x32_bf16 v[104:107], a[212:215], a[116:119], v[104:107]
    buffer_load_dwordx4 v20, s[36:39], s11 offen offset:3072 lds
    v_mfma_f32_16x16x32_bf16 v[108:111], a[212:215], a[124:127], v[108:111]
    ds_read_b64_tr_b16 a[198:199], v9 offset:27648
    v_mfma_f32_16x16x32_bf16 v[108:111], a[208:211], a[120:123], v[108:111]
    s_waitcnt lgkmcnt(4)
    v_mfma_f32_16x16x32_bf16 v[124:127], a[216:219], a[120:123], v[124:127]
    ds_read_b64_tr_b16 a[200:201], v10 offset:6144
    s_add_u32 m0, s19, 90112
    v_mfma_f32_16x16x32_bf16 v[124:127], a[220:223], a[124:127], v[124:127]
    s_mov_b32 s11, 524288
    v_mfma_f32_16x16x32_bf16 v[120:123], a[220:223], a[116:119], v[120:123]
    ds_read_b64_tr_b16 a[202:203], v10 offset:26624
    v_mfma_f32_16x16x32_bf16 v[120:123], a[216:219], a[112:115], v[120:123]
    buffer_load_dwordx4 v17, s[36:39], s11 offen offset:0 lds
    v_mfma_f32_16x16x32_bf16 v[116:119], a[216:219], a[104:107], v[116:119]
    ds_read_b64_tr_b16 a[204:205], v10 offset:7168
    v_mfma_f32_16x16x32_bf16 v[116:119], a[220:223], a[108:111], v[116:119]
    v_mfma_f32_16x16x32_bf16 v[112:115], a[220:223], a[100:103], v[112:115]
    ds_read_b64_tr_b16 a[206:207], v10 offset:27648
    v_mfma_f32_16x16x32_bf16 v[112:115], a[216:219], a[96:99], v[112:115]
    s_waitcnt lgkmcnt(4)
    v_mfma_f32_16x16x32_bf16 v[144:147], a[192:195], a[96:99], v[144:147]
    ds_read_b64_tr_b16 a[208:209], v9 offset:6656
    v_mfma_f32_16x16x32_bf16 v[144:147], a[196:199], a[100:103], v[144:147]
    buffer_load_dwordx4 v18, s[36:39], s11 offen offset:1024 lds
    v_mfma_f32_16x16x32_bf16 v[148:151], a[196:199], a[108:111], v[148:151]
    ds_read_b64_tr_b16 a[210:211], v9 offset:27136
    v_mfma_f32_16x16x32_bf16 v[148:151], a[192:195], a[104:107], v[148:151]
    v_mfma_f32_16x16x32_bf16 v[152:155], a[192:195], a[112:115], v[152:155]
    ds_read_b64_tr_b16 a[212:213], v9 offset:7680
    s_add_u32 m0, s19, 129024
    v_mfma_f32_16x16x32_bf16 v[152:155], a[196:199], a[116:119], v[152:155]
    buffer_load_dwordx4 v19, s[36:39], s11 offen offset:2048 lds
    v_mfma_f32_16x16x32_bf16 v[156:159], a[196:199], a[124:127], v[156:159]
    ds_read_b64_tr_b16 a[214:215], v9 offset:28160
    v_mfma_f32_16x16x32_bf16 v[156:159], a[192:195], a[120:123], v[156:159]
    s_waitcnt lgkmcnt(4)
    v_mfma_f32_16x16x32_bf16 v[188:191], a[200:203], a[120:123], v[188:191]
    ds_read_b64_tr_b16 a[216:217], v10 offset:6656
    v_mfma_f32_16x16x32_bf16 v[188:191], a[204:207], a[124:127], v[188:191]
    buffer_load_dwordx4 v20, s[36:39], s11 offen offset:3072 lds
    v_mfma_f32_16x16x32_bf16 v[184:187], a[204:207], a[116:119], v[184:187]
    ds_read_b64_tr_b16 a[218:219], v10 offset:27136
    v_mfma_f32_16x16x32_bf16 v[184:187], a[200:203], a[112:115], v[184:187]
    v_mfma_f32_16x16x32_bf16 v[180:183], a[200:203], a[104:107], v[180:183]
    ds_read_b64_tr_b16 a[220:221], v10 offset:7680
    v_mfma_f32_16x16x32_bf16 v[180:183], a[204:207], a[108:111], v[180:183]
    v_mfma_f32_16x16x32_bf16 v[176:179], a[204:207], a[100:103], v[176:179]
    ds_read_b64_tr_b16 a[222:223], v10 offset:28160
    v_mfma_f32_16x16x32_bf16 v[176:179], a[200:203], a[96:99], v[176:179]
    s_waitcnt lgkmcnt(4)
    v_mfma_f32_16x16x32_bf16 v[208:211], a[208:211], a[96:99], v[208:211]
    ds_read_b64_tr_b16 a[192:193], v11 offset:4096
    v_mfma_f32_16x16x32_bf16 v[208:211], a[212:215], a[100:103], v[208:211]
    v_mfma_f32_16x16x32_bf16 v[212:215], a[212:215], a[108:111], v[212:215]
    ds_read_b64_tr_b16 a[194:195], v11 offset:24576
    v_mfma_f32_16x16x32_bf16 v[212:215], a[208:211], a[104:107], v[212:215]
    v_mfma_f32_16x16x32_bf16 v[216:219], a[208:211], a[112:115], v[216:219]
    ds_read_b64_tr_b16 a[196:197], v11 offset:5120
    v_mfma_f32_16x16x32_bf16 v[216:219], a[212:215], a[116:119], v[216:219]
    v_mfma_f32_16x16x32_bf16 v[220:223], a[212:215], a[124:127], v[220:223]
    ds_read_b64_tr_b16 a[198:199], v11 offset:25600
    v_mfma_f32_16x16x32_bf16 v[220:223], a[208:211], a[120:123], v[220:223]
    s_waitcnt lgkmcnt(4)
    v_mfma_f32_16x16x32_bf16 v[252:255], a[216:219], a[120:123], v[252:255]
    ds_read_b64_tr_b16 a[200:201], v12 offset:4096
    v_mfma_f32_16x16x32_bf16 v[252:255], a[220:223], a[124:127], v[252:255]
    v_mfma_f32_16x16x32_bf16 v[248:251], a[220:223], a[116:119], v[248:251]
    ds_read_b64_tr_b16 a[202:203], v12 offset:24576
    v_mfma_f32_16x16x32_bf16 v[248:251], a[216:219], a[112:115], v[248:251]
    v_mfma_f32_16x16x32_bf16 v[244:247], a[216:219], a[104:107], v[244:247]
    ds_read_b64_tr_b16 a[204:205], v12 offset:5120
    v_mfma_f32_16x16x32_bf16 v[244:247], a[220:223], a[108:111], v[244:247]
    v_mfma_f32_16x16x32_bf16 v[240:243], a[220:223], a[100:103], v[240:243]
    ds_read_b64_tr_b16 a[206:207], v12 offset:25600
    v_mfma_f32_16x16x32_bf16 v[240:243], a[216:219], a[96:99], v[240:243]
    v_and_b32 v16, 15, v1
    v_lshlrev_b32 v16, 2, v16
    buffer_load_dword v16, v16, s[52:55], s64 offen offset:0 sc1
    s_waitcnt vmcnt(9) lgkmcnt(4)
    v_mfma_f32_16x16x32_bf16 v[64:67], a[192:195], a[0:3], v[64:67]
    ds_read_b64_tr_b16 a[208:209], v11 offset:4608
    v_mfma_f32_16x16x32_bf16 v[64:67], a[196:199], a[4:7], v[64:67]
    buffer_load_dwordx4 a[96:99], v3, s[44:47], s89 offen offset:0 sc1
    v_mfma_f32_16x16x32_bf16 v[68:71], a[196:199], a[12:15], v[68:71]
    ds_read_b64_tr_b16 a[210:211], v11 offset:25088
    v_mfma_f32_16x16x32_bf16 v[68:71], a[192:195], a[8:11], v[68:71]
    v_mfma_f32_16x16x32_bf16 v[72:75], a[192:195], a[16:19], v[72:75]
    ds_read_b64_tr_b16 a[212:213], v11 offset:5632
    v_mfma_f32_16x16x32_bf16 v[72:75], a[196:199], a[20:23], v[72:75]
    buffer_load_dwordx4 a[100:103], v3, s[44:47], s89 offen offset:1024 sc1
    v_mfma_f32_16x16x32_bf16 v[76:79], a[196:199], a[28:31], v[76:79]
    ds_read_b64_tr_b16 a[214:215], v11 offset:26112
    v_mfma_f32_16x16x32_bf16 v[76:79], a[192:195], a[24:27], v[76:79]
    s_waitcnt vmcnt(50) lgkmcnt(4)
    s_barrier
    v_mfma_f32_16x16x32_bf16 v[92:95], a[200:203], a[24:27], v[92:95]
    ds_read_b64_tr_b16 a[216:217], v12 offset:4608
    v_mfma_f32_16x16x32_bf16 v[92:95], a[204:207], a[28:31], v[92:95]
    buffer_load_dwordx4 a[104:107], v4, s[44:47], s89 offen offset:0 sc1
    v_mfma_f32_16x16x32_bf16 v[88:91], a[204:207], a[20:23], v[88:91]
    ds_read_b64_tr_b16 a[218:219], v12 offset:25088
    v_mfma_f32_16x16x32_bf16 v[88:91], a[200:203], a[16:19], v[88:91]
    v_mfma_f32_16x16x32_bf16 v[84:87], a[200:203], a[8:11], v[84:87]
    ds_read_b64_tr_b16 a[220:221], v12 offset:5632
    v_mfma_f32_16x16x32_bf16 v[84:87], a[204:207], a[12:15], v[84:87]
    buffer_load_dwordx4 a[108:111], v4, s[44:47], s89 offen offset:1024 sc1
    v_mfma_f32_16x16x32_bf16 v[80:83], a[204:207], a[4:7], v[80:83]
    ds_read_b64_tr_b16 a[222:223], v12 offset:26112
    v_mfma_f32_16x16x32_bf16 v[80:83], a[200:203], a[0:3], v[80:83]
    s_waitcnt lgkmcnt(4)
    v_mfma_f32_16x16x32_bf16 v[96:99], a[208:211], a[0:3], v[96:99]
    ds_read_b64_tr_b16 a[192:193], v11 offset:6144
    v_mfma_f32_16x16x32_bf16 v[96:99], a[212:215], a[4:7], v[96:99]
    buffer_load_dwordx4 a[112:115], v5, s[44:47], s89 offen offset:0 sc1
    v_mfma_f32_16x16x32_bf16 v[100:103], a[212:215], a[12:15], v[100:103]
    ds_read_b64_tr_b16 a[194:195], v11 offset:26624
    v_mfma_f32_16x16x32_bf16 v[100:103], a[208:211], a[8:11], v[100:103]
    v_mfma_f32_16x16x32_bf16 v[104:107], a[208:211], a[16:19], v[104:107]
    ds_read_b64_tr_b16 a[196:197], v11 offset:7168
    v_mfma_f32_16x16x32_bf16 v[104:107], a[212:215], a[20:23], v[104:107]
    buffer_load_dwordx4 a[116:119], v5, s[44:47], s89 offen offset:1024 sc1
    v_mfma_f32_16x16x32_bf16 v[108:111], a[212:215], a[28:31], v[108:111]
    ds_read_b64_tr_b16 a[198:199], v11 offset:27648
    v_mfma_f32_16x16x32_bf16 v[108:111], a[208:211], a[24:27], v[108:111]
    s_waitcnt lgkmcnt(4)
    v_mfma_f32_16x16x32_bf16 v[124:127], a[216:219], a[24:27], v[124:127]
    ds_read_b64_tr_b16 a[200:201], v12 offset:6144
    v_mfma_f32_16x16x32_bf16 v[124:127], a[220:223], a[28:31], v[124:127]
    buffer_load_dwordx4 a[120:123], v6, s[44:47], s89 offen offset:0 sc1
    v_mfma_f32_16x16x32_bf16 v[120:123], a[220:223], a[20:23], v[120:123]
    ds_read_b64_tr_b16 a[202:203], v12 offset:26624
    v_mfma_f32_16x16x32_bf16 v[120:123], a[216:219], a[16:19], v[120:123]
    v_mfma_f32_16x16x32_bf16 v[116:119], a[216:219], a[8:11], v[116:119]
    ds_read_b64_tr_b16 a[204:205], v12 offset:7168
    v_mfma_f32_16x16x32_bf16 v[116:119], a[220:223], a[12:15], v[116:119]
    buffer_load_dwordx4 a[124:127], v6, s[44:47], s89 offen offset:1024 sc1
    v_mfma_f32_16x16x32_bf16 v[112:115], a[220:223], a[4:7], v[112:115]
    ds_read_b64_tr_b16 a[206:207], v12 offset:27648
    v_mfma_f32_16x16x32_bf16 v[112:115], a[216:219], a[0:3], v[112:115]
    s_waitcnt lgkmcnt(4)
    v_mfma_f32_16x16x32_bf16 v[144:147], a[192:195], a[0:3], v[144:147]
    ds_read_b64_tr_b16 a[208:209], v11 offset:6656
    v_mfma_f32_16x16x32_bf16 v[144:147], a[196:199], a[4:7], v[144:147]
    buffer_load_dwordx4 a[128:131], v3, s[44:47], s90 offen offset:0 sc1
    v_mfma_f32_16x16x32_bf16 v[148:151], a[196:199], a[12:15], v[148:151]
    ds_read_b64_tr_b16 a[210:211], v11 offset:27136
    v_mfma_f32_16x16x32_bf16 v[148:151], a[192:195], a[8:11], v[148:151]
    v_mfma_f32_16x16x32_bf16 v[152:155], a[192:195], a[16:19], v[152:155]
    ds_read_b64_tr_b16 a[212:213], v11 offset:7680
    v_mfma_f32_16x16x32_bf16 v[152:155], a[196:199], a[20:23], v[152:155]
    buffer_load_dwordx4 a[132:135], v3, s[44:47], s90 offen offset:1024 sc1
    v_mfma_f32_16x16x32_bf16 v[156:159], a[196:199], a[28:31], v[156:159]
    ds_read_b64_tr_b16 a[214:215], v11 offset:28160
    v_mfma_f32_16x16x32_bf16 v[156:159], a[192:195], a[24:27], v[156:159]
    s_waitcnt lgkmcnt(4)
    v_mfma_f32_16x16x32_bf16 v[188:191], a[200:203], a[24:27], v[188:191]
    ds_read_b64_tr_b16 a[216:217], v12 offset:6656
    v_mfma_f32_16x16x32_bf16 v[188:191], a[204:207], a[28:31], v[188:191]
    buffer_load_dwordx4 a[136:139], v4, s[44:47], s90 offen offset:0 sc1
    v_mfma_f32_16x16x32_bf16 v[184:187], a[204:207], a[20:23], v[184:187]
    ds_read_b64_tr_b16 a[218:219], v12 offset:27136
    v_mfma_f32_16x16x32_bf16 v[184:187], a[200:203], a[16:19], v[184:187]
    v_mfma_f32_16x16x32_bf16 v[180:183], a[200:203], a[8:11], v[180:183]
    ds_read_b64_tr_b16 a[220:221], v12 offset:7680
    v_mfma_f32_16x16x32_bf16 v[180:183], a[204:207], a[12:15], v[180:183]
    buffer_load_dwordx4 a[140:143], v4, s[44:47], s90 offen offset:1024 sc1
    v_mfma_f32_16x16x32_bf16 v[176:179], a[204:207], a[4:7], v[176:179]
    ds_read_b64_tr_b16 a[222:223], v12 offset:28160
    v_mfma_f32_16x16x32_bf16 v[176:179], a[200:203], a[0:3], v[176:179]
    s_waitcnt lgkmcnt(4)
    v_mfma_f32_16x16x32_bf16 v[208:211], a[208:211], a[0:3], v[208:211]
    ds_read_b64_tr_b16 a[192:193], v13 offset:4096
    v_mfma_f32_16x16x32_bf16 v[208:211], a[212:215], a[4:7], v[208:211]
    buffer_load_dwordx4 a[144:147], v5, s[44:47], s90 offen offset:0 sc1
    v_mfma_f32_16x16x32_bf16 v[212:215], a[212:215], a[12:15], v[212:215]
    ds_read_b64_tr_b16 a[194:195], v13 offset:24576
    v_mfma_f32_16x16x32_bf16 v[212:215], a[208:211], a[8:11], v[212:215]
    v_mfma_f32_16x16x32_bf16 v[216:219], a[208:211], a[16:19], v[216:219]
    ds_read_b64_tr_b16 a[196:197], v13 offset:5120
    v_mfma_f32_16x16x32_bf16 v[216:219], a[212:215], a[20:23], v[216:219]
    buffer_load_dwordx4 a[148:151], v5, s[44:47], s90 offen offset:1024 sc1
    v_mfma_f32_16x16x32_bf16 v[220:223], a[212:215], a[28:31], v[220:223]
    ds_read_b64_tr_b16 a[198:199], v13 offset:25600
    v_mfma_f32_16x16x32_bf16 v[220:223], a[208:211], a[24:27], v[220:223]
    s_waitcnt lgkmcnt(4)
    v_mfma_f32_16x16x32_bf16 v[252:255], a[216:219], a[24:27], v[252:255]
    ds_read_b64_tr_b16 a[200:201], v14 offset:4096
    v_mfma_f32_16x16x32_bf16 v[252:255], a[220:223], a[28:31], v[252:255]
    buffer_load_dwordx4 a[152:155], v6, s[44:47], s90 offen offset:0 sc1
    v_mfma_f32_16x16x32_bf16 v[248:251], a[220:223], a[20:23], v[248:251]
    ds_read_b64_tr_b16 a[202:203], v14 offset:24576
    v_mfma_f32_16x16x32_bf16 v[248:251], a[216:219], a[16:19], v[248:251]
    v_mfma_f32_16x16x32_bf16 v[244:247], a[216:219], a[8:11], v[244:247]
    ds_read_b64_tr_b16 a[204:205], v14 offset:5120
    v_mfma_f32_16x16x32_bf16 v[244:247], a[220:223], a[12:15], v[244:247]
    buffer_load_dwordx4 a[156:159], v6, s[44:47], s90 offen offset:1024 sc1
    v_mfma_f32_16x16x32_bf16 v[240:243], a[220:223], a[4:7], v[240:243]
    ds_read_b64_tr_b16 a[206:207], v14 offset:25600
    v_mfma_f32_16x16x32_bf16 v[240:243], a[216:219], a[0:3], v[240:243]
    buffer_load_dwordx4 a[160:163], v3, s[44:47], s91 offen offset:0 sc1
    buffer_load_dwordx4 a[164:167], v3, s[44:47], s91 offen offset:1024 sc1
    buffer_load_dwordx4 a[168:171], v4, s[44:47], s91 offen offset:0 sc1
    buffer_load_dwordx4 a[172:175], v4, s[44:47], s91 offen offset:1024 sc1
    buffer_load_dwordx4 a[176:179], v5, s[44:47], s91 offen offset:0 sc1
    buffer_load_dwordx4 a[180:183], v5, s[44:47], s91 offen offset:1024 sc1
    buffer_load_dwordx4 a[184:187], v6, s[44:47], s91 offen offset:0 sc1
    buffer_load_dwordx4 a[188:191], v6, s[44:47], s91 offen offset:1024 sc1
L_P2:
    s_waitcnt vmcnt(16)
    v_cmp_ne_u32 vcc, s18, v16
    s_cbranch_vccnz L_pl10
L_pl10_b:
    s_waitcnt vmcnt(16) lgkmcnt(4)
    v_mfma_f32_16x16x32_bf16 v[64:67], a[192:195], a[96:99], v[64:67]
    ds_read_b64_tr_b16 a[208:209], v13 offset:4608
    v_mfma_f32_16x16x32_bf16 v[64:67], a[196:199], a[100:103], v[64:67]
    v_mfma_f32_16x16x32_bf16 v[68:71], a[196:199], a[108:111], v[68:71]
    ds_read_b64_tr_b16 a[210:211], v13 offset:25088
    s_mov_b32 s10, 458752
    v_mfma_f32_16x16x32_bf16 v[68:71], a[192:195], a[104:107], v[68:71]
    buffer_load_dwordx4 a[32:35], v3, s[44:47], s10 offen offset:0 sc1
    v_mfma_f32_16x16x32_bf16 v[72:75], a[192:195], a[112:115], v[72:75]
    ds_read_b64_tr_b16 a[212:213], v13 offset:5632
    v_mfma_f32_16x16x32_bf16 v[72:75], a[196:199], a[116:119], v[72:75]
    v_mfma_f32_16x16x32_bf16 v[76:79], a[196:199], a[124:127], v[76:79]
    ds_read_b64_tr_b16 a[214:215], v13 offset:26112
    v_mfma_f32_16x16x32_bf16 v[76:79], a[192:195], a[120:123], v[76:79]
    s_waitcnt vmcnt(56) lgkmcnt(4)
    s_barrier
    v_mfma_f32_16x16x32_bf16 v[92:95], a[200:203], a[120:123], v[92:95]
    ds_read_b64_tr_b16 a[216:217], v14 offset:4608
    v_mfma_f32_16x16x32_bf16 v[92:95], a[204:207], a[124:127], v[92:95]
    buffer_load_dwordx4 a[36:39], v3, s[44:47], s10 offen offset:1024 sc1
    v_mfma_f32_16x16x32_bf16 v[88:91], a[204:207], a[116:119], v[88:91]
    ds_read_b64_tr_b16 a[218:219], v14 offset:25088
    v_mfma_f32_16x16x32_bf16 v[88:91], a[200:203], a[112:115], v[88:91]
    v_mfma_f32_16x16x32_bf16 v[84:87], a[200:203], a[104:107], v[84:87]
    ds_read_b64_tr_b16 a[220:221], v14 offset:5632
    s_mov_b32 s10, 466944
    v_mfma_f32_16x16x32_bf16 v[84:87], a[204:207], a[108:111], v[84:87]
    buffer_load_dwordx4 a[40:43], v3, s[44:47], s10 offen offset:0 sc1
    v_mfma_f32_16x16x32_bf16 v[80:83], a[204:207], a[100:103], v[80:83]
    ds_read_b64_tr_b16 a[222:223], v14 offset:26112
    v_mfma_f32_16x16x32_bf16 v[80:83], a[200:203], a[96:99], v[80:83]
    s_waitcnt lgkmcnt(4)
    v_mfma_f32_16x16x32_bf16 v[96:99], a[208:211], a[96:99], v[96:99]
    ds_read_b64_tr_b16 a[192:193], v13 offset:6144
    v_mfma_f32_16x16x32_bf16 v[96:99], a[212:215], a[100:103], v[96:99]
    buffer_load_dwordx4 a[44:47], v3, s[44:47], s10 offen offset:1024 sc1
    v_mfma_f32_16x16x32_bf16 v[100:103], a[212:215], a[108:111], v[100:103]
    ds_read_b64_tr_b16 a[194:195], v13 offset:26624
    v_mfma_f32_16x16x32_bf16 v[100:103], a[208:211], a[104:107], v[100:103]
    v_mfma_f32_16x16x32_bf16 v[104:107], a[208:211], a[112:115], v[104:107]
    ds_read_b64_tr_b16 a[196:197], v13 offset:7168
    s_mov_b32 s10, 475136
    v_mfma_f32_16x16x32_bf16 v[104:107], a[212:215], a[116:119], v[104:107]
    buffer_load_dwordx4 a[48:51], v3, s[44:47], s10 offen offset:0 sc1
    v_mfma_f32_16x16x32_bf16 v[108:111], a[212:215], a[124:127], v[108:111]
    ds_read_b64_tr_b16 a[198:199], v13 offset:27648
    v_mfma_f32_16x16x32_bf16 v[108:111], a[208:211], a[120:123], v[108:111]
    s_waitcnt lgkmcnt(4)
    v_mfma_f32_16x16x32_bf16 v[124:127], a[216:219], a[120:123], v[124:127]
    ds_read_b64_tr_b16 a[200:201], v14 offset:6144
    v_mfma_f32_16x16x32_bf16 v[124:127], a[220:223], a[124:127], v[124:127]
    buffer_load_dwordx4 a[52:55], v3, s[44:47], s10 offen offset:1024 sc1
    v_mfma_f32_16x16x32_bf16 v[120:123], a[220:223], a[116:119], v[120:123]
    ds_read_b64_tr_b16 a[202:203], v14 offset:26624
    v_mfma_f32_16x16x32_bf16 v[120:123], a[216:219], a[112:115], v[120:123]
    v_mfma_f32_16x16x32_bf16 v[116:119], a[216:219], a[104:107], v[116:119]
    ds_read_b64_tr_b16 a[204:205], v14 offset:7168
    s_mov_b32 s10, 483328
    v_mfma_f32_16x16x32_bf16 v[116:119], a[220:223], a[108:111], v[116:119]
    buffer_load_dwordx4 a[56:59], v3, s[44:47], s10 offen offset:0 sc1
    v_mfma_f32_16x16x32_bf16 v[112:115], a[220:223], a[100:103], v[112:115]
    ds_read_b64_tr_b16 a[206:207], v14 offset:27648
    v_mfma_f32_16x16x32_bf16 v[112:115], a[216:219], a[96:99], v[112:115]
    s_waitcnt lgkmcnt(4)
    v_mfma_f32_16x16x32_bf16 v[144:147], a[192:195], a[96:99], v[144:147]
    ds_read_b64_tr_b16 a[208:209], v13 offset:6656
    v_mfma_f32_16x16x32_bf16 v[144:147], a[196:199], a[100:103], v[144:147]
    buffer_load_dwordx4 a[60:63], v3, s[44:47], s10 offen offset:1024 sc1
    v_mfma_f32_16x16x32_bf16 v[148:151], a[196:199], a[108:111], v[148:151]
    ds_read_b64_tr_b16 a[210:211], v13 offset:27136
    v_mfma_f32_16x16x32_bf16 v[148:151], a[192:195], a[104:107], v[148:151]
    v_mfma_f32_16x16x32_bf16 v[152:155], a[192:195], a[112:115], v[152:155]
    ds_read_b64_tr_b16 a[212:213], v13 offset:7680
    s_mov_b32 s10, 491520
    v_mfma_f32_16x16x32_bf16 v[152:155], a[196:199], a[116:119], v[152:155]
    buffer_load_dwordx4 a[0:3], v3, s[44:47], s10 offen offset:0 sc1
    v_mfma_f32_16x16x32_bf16 v[156:159], a[196:199], a[124:127], v[156:159]
    ds_read_b64_tr_b16 a[214:215], v13 offset:28160
    v_mfma_f32_16x16x32_bf16 v[156:159], a[192:195], a[120:123], v[156:159]
    s_waitcnt lgkmcnt(4)
    v_mfma_f32_16x16x32_bf16 v[188:191], a[200:203], a[120:123], v[188:191]
    ds_read_b64_tr_b16 a[216:217], v14 offset:6656
    v_mfma_f32_16x16x32_bf16 v[188:191], a[204:207], a[124:127], v[188:191]
    buffer_load_dwordx4 a[4:7], v3, s[44:47], s10 offen offset:1024 sc1
    v_mfma_f32_16x16x32_bf16 v[184:187], a[204:207], a[116:119], v[184:187]
    ds_read_b64_tr_b16 a[218:219], v14 offset:27136
    v_mfma_f32_16x16x32_bf16 v[184:187], a[200:203], a[112:115], v[184:187]
    v_mfma_f32_16x16x32_bf16 v[180:183], a[200:203], a[104:107], v[180:183]
    ds_read_b64_tr_b16 a[220:221], v14 offset:7680
    s_mov_b32 s10, 499712
    v_mfma_f32_16x16x32_bf16 v[180:183], a[204:207], a[108:111], v[180:183]
    buffer_load_dwordx4 a[8:11], v3, s[44:47], s10 offen offset:0 sc1
    v_mfma_f32_16x16x32_bf16 v[176:179], a[204:207], a[100:103], v[176:179]
    ds_read_b64_tr_b16 a[222:223], v14 offset:28160
    v_mfma_f32_16x16x32_bf16 v[176:179], a[200:203], a[96:99], v[176:179]
    s_waitcnt lgkmcnt(4)
    v_mfma_f32_16x16x32_bf16 v[208:211], a[208:211], a[96:99], v[208:211]
    ds_read_b64_tr_b16 a[192:193], v7 offset:0
    v_mfma_f32_16x16x32_bf16 v[208:211], a[212:215], a[100:103], v[208:211]
    buffer_load_dwordx4 a[12:15], v3, s[44:47], s10 offen offset:1024 sc1
    v_mfma_f32_16x16x32_bf16 v[212:215], a[212:215], a[108:111], v[212:215]
    ds_read_b64_tr_b16 a[194:195], v7 offset:20480
    v_mfma_f32_16x16x32_bf16 v[212:215], a[208:211], a[104:107], v[212:215]
    v_mfma_f32_16x16x32_bf16 v[216:219], a[208:211], a[112:115], v[216:219]
    ds_read_b64_tr_b16 a[196:197], v7 offset:1024
    s_mov_b32 s10, 507904
    v_mfma_f32_16x16x32_bf16 v[216:219], a[212:215], a[116:119], v[216:219]
    buffer_load_dwordx4 a[16:19], v3, s[44:47], s10 offen offset:0 sc1
    v_mfma_f32_16x16x32_bf16 v[220:223], a[212:215], a[124:127], v[220:223]
    ds_read_b64_tr_b16 a[198:199], v7 offset:21504
    v_mfma_f32_16x16x32_bf16 v[220:223], a[208:211], a[120:123], v[220:223]
    s_waitcnt lgkmcnt(4)
    v_mfma_f32_16x16x32_bf16 v[252:255], a[216:219], a[120:123], v[252:255]
    ds_read_b64_tr_b16 a[200:201], v8 offset:0
    v_mfma_f32_16x16x32_bf16 v[252:255], a[220:223], a[124:127], v[252:255]
    buffer_load_dwordx4 a[20:23], v3, s[44:47], s10 offen offset:1024 sc1
    v_mfma_f32_16x16x32_bf16 v[248:251], a[220:223], a[116:119], v[248:251]
    ds_read_b64_tr_b16 a[202:203], v8 offset:20480
    v_mfma_f32_16x16x32_bf16 v[248:251], a[216:219], a[112:115], v[248:251]
    v_mfma_f32_16x16x32_bf16 v[244:247], a[216:219], a[104:107], v[244:247]
    ds_read_b64_tr_b16 a[204:205], v8 offset:1024
    s_mov_b32 s10, 516096
    v_mfma_f32_16x16x32_bf16 v[244:247], a[220:223], a[108:111], v[244:247]
    buffer_load_dwordx4 a[24:27], v3, s[44:47], s10 offen offset:0 sc1
    v_mfma_f32_16x16x32_bf16 v[240:243], a[220:223], a[100:103], v[240:243]
    ds_read_b64_tr_b16 a[206:207], v8 offset:21504
    v_mfma_f32_16x16x32_bf16 v[240:243], a[216:219], a[96:99], v[240:243]
    s_waitcnt vmcnt(23) lgkmcnt(4)
    v_mfma_f32_16x16x32_bf16 v[64:67], a[192:195], a[128:131], v[64:67]
    ds_read_b64_tr_b16 a[208:209], v7 offset:512
    v_mfma_f32_16x16x32_bf16 v[64:67], a[196:199], a[132:135], v[64:67]
    buffer_load_dwordx4 a[28:31], v3, s[44:47], s10 offen offset:1024 sc1
    v_mfma_f32_16x16x32_bf16 v[68:71], a[196:199], a[140:143], v[68:71]
    ds_read_b64_tr_b16 a[210:211], v7 offset:20992
    v_mfma_f32_16x16x32_bf16 v[68:71], a[192:195], a[136:139], v[68:71]
    v_mfma_f32_16x16x32_bf16 v[72:75], a[192:195], a[144:147], v[72:75]
    ds_read_b64_tr_b16 a[212:213], v7 offset:1536
    s_add_u32 m0, s19, 45056
    v_mfma_f32_16x16x32_bf16 v[72:75], a[196:199], a[148:151], v[72:75]
    s_mov_b32 s11, 655360
    v_mfma_f32_16x16x32_bf16 v[76:79], a[196:199], a[156:159], v[76:79]
    ds_read_b64_tr_b16 a[214:215], v7 offset:22016
    v_mfma_f32_16x16x32_bf16 v[76:79], a[192:195], a[152:155], v[76:79]
    s_waitcnt vmcnt(63) lgkmcnt(4)
    s_barrier
    v_mfma_f32_16x16x32_bf16 v[92:95], a[200:203], a[152:155], v[92:95]
    ds_read_b64_tr_b16 a[216:217], v8 offset:512
    v_mfma_f32_16x16x32_bf16 v[92:95], a[204:207], a[156:159], v[92:95]
    buffer_load_dwordx4 v17, s[36:39], s11 offen offset:0 lds
    v_mfma_f32_16x16x32_bf16 v[88:91], a[204:207], a[148:151], v[88:91]
    ds_read_b64_tr_b16 a[218:219], v8 offset:20992
    v_mfma_f32_16x16x32_bf16 v[88:91], a[200:203], a[144:147], v[88:91]
    v_mfma_f32_16x16x32_bf16 v[84:87], a[200:203], a[136:139], v[84:87]
    ds_read_b64_tr_b16 a[220:221], v8 offset:1536
    v_mfma_f32_16x16x32_bf16 v[84:87], a[204:207], a[140:143], v[84:87]
    buffer_load_dwordx4 v18, s[36:39], s11 offen offset:1024 lds
    v_mfma_f32_16x16x32_bf16 v[80:83], a[204:207], a[132:135], v[80:83]
    ds_read_b64_tr_b16 a[222:223], v8 offset:22016
    v_mfma_f32_16x16x32_bf16 v[80:83], a[200:203], a[128:131], v[80:83]
    s_waitcnt lgkmcnt(4)
    v_mfma_f32_16x16x32_bf16 v[96:99], a[208:211], a[128:131], v[96:99]
    ds_read_b64_tr_b16 a[192:193], v7 offset:2048
    ds_read_b64_tr_b16 a[224:225], v7 offset:6144
    v_mfma_f32_16x16x32_bf16 v[96:99], a[212:215], a[132:135], v[96:99]
    buffer_load_dwordx4 v19, s[36:39], s11 offen offset:2048 lds
    v_mfma_f32_16x16x32_bf16 v[100:103], a[212:215], a[140:143], v[100:103]
    ds_read_b64_tr_b16 a[194:195], v7 offset:22528
    ds_read_b64_tr_b16 a[226:227], v7 offset:26624
    v_mfma_f32_16x16x32_bf16 v[100:103], a[208:211], a[136:139], v[100:103]
    v_mfma_f32_16x16x32_bf16 v[104:107], a[208:211], a[144:147], v[104:107]
    ds_read_b64_tr_b16 a[196:197], v7 offset:3072
    ds_read_b64_tr_b16 a[228:229], v7 offset:7168
    v_mfma_f32_16x16x32_bf16 v[104:107], a[212:215], a[148:151], v[104:107]
    buffer_load_dwordx4 v20, s[36:39], s11 offen offset:3072 lds
    v_mfma_f32_16x16x32_bf16 v[108:111], a[212:215], a[156:159], v[108:111]
    ds_read_b64_tr_b16 a[198:199], v7 offset:23552
    ds_read_b64_tr_b16 a[230:231], v7 offset:27648
    v_mfma_f32_16x16x32_bf16 v[108:111], a[208:211], a[152:155], v[108:111]
    s_waitcnt lgkmcnt(8)
    v_mfma_f32_16x16x32_bf16 v[124:127], a[216:219], a[152:155], v[124:127]
    ds_read_b64_tr_b16 a[200:201], v8 offset:2048
    ds_read_b64_tr_b16 a[232:233], v8 offset:6144
    v_mfma_f32_16x16x32_bf16 v[124:127], a[220:223], a[156:159], v[124:127]
    s_add_u32 m0, s19, 86016
    s_mov_b32 s11, 786432
    v_mfma_f32_16x16x32_bf16 v[120:123], a[220:223], a[148:151], v[120:123]
    ds_read_b64_tr_b16 a[202:203], v8 offset:22528
    ds_read_b64_tr_b16 a[234:235], v8 offset:26624
    v_mfma_f32_16x16x32_bf16 v[120:123], a[216:219], a[144:147], v[120:123]
    buffer_load_dwordx4 v17, s[36:39], s11 offen offset:0 lds
    v_mfma_f32_16x16x32_bf16 v[116:119], a[216:219], a[136:139], v[116:119]
    ds_read_b64_tr_b16 a[204:205], v8 offset:3072
    ds_read_b64_tr_b16 a[236:237], v8 offset:7168
    v_mfma_f32_16x16x32_bf16 v[116:119], a[220:223], a[140:143], v[116:119]
    v_mfma_f32_16x16x32_bf16 v[112:115], a[220:223], a[132:135], v[112:115]
    ds_read_b64_tr_b16 a[206:207], v8 offset:23552
    ds_read_b64_tr_b16 a[238:239], v8 offset:27648
    v_mfma_f32_16x16x32_bf16 v[112:115], a[216:219], a[128:131], v[112:115]
    s_waitcnt lgkmcnt(9)
    v_mfma_f32_16x16x32_bf16 v[144:147], a[192:195], a[128:131], v[144:147]
    ds_read_b64_tr_b16 a[208:209], v7 offset:2560
    ds_read_b64_tr_b16 a[240:241], v7 offset:6656
    v_mfma_f32_16x16x32_bf16 v[144:147], a[196:199], a[132:135], v[144:147]
    buffer_load_dwordx4 v18, s[36:39], s11 offen offset:1024 lds
    v_mfma_f32_16x16x32_bf16 v[148:151], a[196:199], a[140:143], v[148:151]
    ds_read_b64_tr_b16 a[210:211], v7 offset:23040
    ds_read_b64_tr_b16 a[242:243], v7 offset:27136
    v_mfma_f32_16x16x32_bf16 v[148:151], a[192:195], a[136:139], v[148:151]
    v_mfma_f32_16x16x32_bf16 v[152:155], a[192:195], a[144:147], v[152:155]
    ds_read_b64_tr_b16 a[212:213], v7 offset:3584
    ds_read_b64_tr_b16 a[244:245], v7 offset:7680
    v_mfma_f32_16x16x32_bf16 v[152:155], a[196:199], a[148:151], v[152:155]
    buffer_load_dwordx4 v19, s[36:39], s11 offen offset:2048 lds
    v_mfma_f32_16x16x32_bf16 v[156:159], a[196:199], a[156:159], v[156:159]
    ds_read_b64_tr_b16 a[214:215], v7 offset:24064
    ds_read_b64_tr_b16 a[246:247], v7 offset:28160
    v_mfma_f32_16x16x32_bf16 v[156:159], a[192:195], a[152:155], v[156:159]
    s_waitcnt lgkmcnt(9)
    v_mfma_f32_16x16x32_bf16 v[188:191], a[200:203], a[152:155], v[188:191]
    ds_read_b64_tr_b16 a[216:217], v8 offset:2560
    ds_read_b64_tr_b16 a[248:249], v8 offset:6656
    v_mfma_f32_16x16x32_bf16 v[188:191], a[204:207], a[156:159], v[188:191]
    buffer_load_dwordx4 v20, s[36:39], s11 offen offset:3072 lds
    v_mfma_f32_16x16x32_bf16 v[184:187], a[204:207], a[148:151], v[184:187]
    ds_read_b64_tr_b16 a[218:219], v8 offset:23040
    ds_read_b64_tr_b16 a[250:251], v8 offset:27136
    v_mfma_f32_16x16x32_bf16 v[184:187], a[200:203], a[144:147], v[184:187]
    v_mfma_f32_16x16x32_bf16 v[180:183], a[200:203], a[136:139], v[180:183]
    ds_read_b64_tr_b16 a[220:221], v8 offset:3584
    ds_read_b64_tr_b16 a[252:253], v8 offset:7680
    v_mfma_f32_16x16x32_bf16 v[180:183], a[204:207], a[140:143], v[180:183]
    s_add_u32 m0, s19, 126976
    s_mov_b32 s11, 917504
    v_mfma_f32_16x16x32_bf16 v[176:179], a[204:207], a[132:135], v[176:179]
    ds_read_b64_tr_b16 a[222:223], v8 offset:24064
    ds_read_b64_tr_b16 a[254:255], v8 offset:28160
    v_mfma_f32_16x16x32_bf16 v[176:179], a[200:203], a[128:131], v[176:179]
    s_waitcnt lgkmcnt(9)
    v_mfma_f32_16x16x32_bf16 v[208:211], a[208:211], a[128:131], v[208:211]
    ds_read_b64_tr_b16 a[192:193], v7 offset:4096
    v_mfma_f32_16x16x32_bf16 v[208:211], a[212:215], a[132:135], v[208:211]
    buffer_load_dwordx4 v17, s[36:39], s11 offen offset:0 lds
    v_mfma_f32_16x16x32_bf16 v[212:215], a[212:215], a[140:143], v[212:215]
    ds_read_b64_tr_b16 a[194:195], v7 offset:24576
    v_mfma_f32_16x16x32_bf16 v[212:215], a[208:211], a[136:139], v[212:215]
    v_mfma_f32_16x16x32_bf16 v[216:219], a[208:211], a[144:147], v[216:219]
    ds_read_b64_tr_b16 a[196:197], v7 offset:5120
    v_mfma_f32_16x16x32_bf16 v[216:219], a[212:215], a[148:151], v[216:219]
    buffer_load_dwordx4 v18, s[36:39], s11 offen offset:1024 lds
    v_mfma_f32_16x16x32_bf16 v[220:223], a[212:215], a[156:159], v[220:223]
    ds_read_b64_tr_b16 a[198:199], v7 offset:25600
    v_mfma_f32_16x16x32_bf16 v[220:223], a[208:211], a[152:155], v[220:223]
    s_waitcnt lgkmcnt(5)
    v_mfma_f32_16x16x32_bf16 v[252:255], a[216:219], a[152:155], v[252:255]
    ds_read_b64_tr_b16 a[200:201], v8 offset:4096
    v_mfma_f32_16x16x32_bf16 v[252:255], a[220:223], a[156:159], v[252:255]
    buffer_load_dwordx4 v19, s[36:39], s11 offen offset:2048 lds
    v_mfma_f32_16x16x32_bf16 v[248:251], a[220:223], a[148:151], v[248:251]
    ds_read_b64_tr_b16 a[202:203], v8 offset:24576
    v_mfma_f32_16x16x32_bf16 v[248:251], a[216:219], a[144:147], v[248:251]
    v_mfma_f32_16x16x32_bf16 v[244:247], a[216:219], a[136:139], v[244:247]
    ds_read_b64_tr_b16 a[204:205], v8 offset:5120
    v_mfma_f32_16x16x32_bf16 v[244:247], a[220:223], a[140:143], v[244:247]
    buffer_load_dwordx4 v20, s[36:39], s11 offen offset:3072 lds
    v_mfma_f32_16x16x32_bf16 v[240:243], a[220:223], a[132:135], v[240:243]
    ds_read_b64_tr_b16 a[206:207], v8 offset:25600
    v_mfma_f32_16x16x32_bf16 v[240:243], a[216:219], a[128:131], v[240:243]
    s_waitcnt vmcnt(28) lgkmcnt(15)
    v_mfma_f32_16x16x32_bf16 v[156:159], a[224:227], a[184:187], v[156:159]
    ds_read_b64_tr_b16 a[208:209], v7 offset:4608
    ds_read_b64_tr_b16 a[210:211], v7 offset:25088
    v_mfma_f32_16x16x32_bf16 v[156:159], a[228:231], a[188:191], v[156:159]
    ds_read_b64_tr_b16 a[212:213], v7 offset:5632
    ds_read_b64_tr_b16 a[214:215], v7 offset:26112
    s_waitcnt vmcnt(45) lgkmcnt(15)
    s_barrier
    v_mfma_f32_16x16x32_bf16 v[188:191], a[232:235], a[184:187], v[188:191]
    ds_read_b64_tr_b16 a[216:217], v8 offset:4608
    ds_read_b64_tr_b16 a[218:219], v8 offset:25088
    v_mfma_f32_16x16x32_bf16 v[188:191], a[236:239], a[188:191], v[188:191]
    ds_read_b64_tr_b16 a[220:221], v8 offset:5632
    ds_read_b64_tr_b16 a[222:223], v8 offset:26112
    s_waitcnt lgkmcnt(15)
    v_mfma_f32_16x16x32_bf16 v[220:223], a[240:243], a[184:187], v[220:223]
    s_mov_b32 s10, 524288
    v_mfma_f32_16x16x32_bf16 v[220:223], a[244:247], a[188:191], v[220:223]
    buffer_load_dwordx4 a[96:99], v3, s[44:47], s10 offen offset:0 sc1
    s_waitcnt lgkmcnt(15)
    v_mfma_f32_16x16x32_bf16 v[252:255], a[248:251], a[184:187], v[252:255]
    v_mfma_f32_16x16x32_bf16 v[252:255], a[252:255], a[188:191], v[252:255]
    buffer_load_dwordx4 a[100:103], v3, s[44:47], s10 offen offset:1024 sc1
    s_waitcnt lgkmcnt(12)
    v_mfma_f32_16x16x32_bf16 v[76:79], a[192:195], a[184:187], v[76:79]
    s_mov_b32 s10, 532480
    v_mfma_f32_16x16x32_bf16 v[76:79], a[196:199], a[188:191], v[76:79]
    buffer_load_dwordx4 a[104:107], v3, s[44:47], s10 offen offset:0 sc1
    s_waitcnt lgkmcnt(8)
    v_mfma_f32_16x16x32_bf16 v[92:95], a[200:203], a[184:187], v[92:95]
    v_mfma_f32_16x16x32_bf16 v[92:95], a[204:207], a[188:191], v[92:95]
    buffer_load_dwordx4 a[108:111], v3, s[44:47], s10 offen offset:1024 sc1
    s_waitcnt lgkmcnt(4)
    v_mfma_f32_16x16x32_bf16 v[108:111], a[208:211], a[184:187], v[108:111]
    s_mov_b32 s10, 540672
    v_mfma_f32_16x16x32_bf16 v[108:111], a[212:215], a[188:191], v[108:111]
    buffer_load_dwordx4 a[112:115], v3, s[44:47], s10 offen offset:0 sc1
    s_waitcnt lgkmcnt(0)
    v_mfma_f32_16x16x32_bf16 v[124:127], a[216:219], a[184:187], v[124:127]
    v_mfma_f32_16x16x32_bf16 v[124:127], a[220:223], a[188:191], v[124:127]
    buffer_load_dwordx4 a[116:119], v3, s[44:47], s10 offen offset:1024 sc1
    v_cvt_pk_bf16_f32 v156, v156, v157
    s_mov_b32 s10, 548864
    buffer_load_dwordx4 a[120:123], v3, s[44:47], s10 offen offset:0 sc1
    buffer_load_dwordx4 a[124:127], v3, s[44:47], s10 offen offset:1024 sc1
    v_mfma_f32_16x16x32_bf16 v[152:155], a[224:227], a[176:179], v[152:155]
    v_cvt_pk_bf16_f32 v157, v158, v159
    v_cvt_pk_bf16_f32 v158, v188, v189
    v_mfma_f32_16x16x32_bf16 v[152:155], a[228:231], a[180:183], v[152:155]
    v_cvt_pk_bf16_f32 v159, v190, v191
    v_cvt_pk_bf16_f32 v220, v220, v221
    v_mfma_f32_16x16x32_bf16 v[184:187], a[232:235], a[176:179], v[184:187]
    buffer_store_dwordx4 v[156:159], v2, s[24:27], s42 offen offset:2048 sc1
    v_mfma_f32_16x16x32_bf16 v[184:187], a[236:239], a[180:183], v[184:187]
    v_cvt_pk_bf16_f32 v221, v222, v223
    v_cvt_pk_bf16_f32 v222, v252, v253
    v_mfma_f32_16x16x32_bf16 v[216:219], a[240:243], a[176:179], v[216:219]
    v_cvt_pk_bf16_f32 v223, v254, v255
    v_cvt_pk_bf16_f32 v76, v76, v77
    v_mfma_f32_16x16x32_bf16 v[216:219], a[244:247], a[180:183], v[216:219]
    v_cvt_pk_bf16_f32 v77, v78, v79
    v_cvt_pk_bf16_f32 v78, v92, v93
    v_mfma_f32_16x16x32_bf16 v[248:251], a[248:251], a[176:179], v[248:251]
    v_cvt_pk_bf16_f32 v79, v94, v95
    v_cvt_pk_bf16_f32 v108, v108, v109
    v_mfma_f32_16x16x32_bf16 v[248:251], a[252:255], a[180:183], v[248:251]
    v_cvt_pk_bf16_f32 v109, v110, v111
    v_cvt_pk_bf16_f32 v110, v124, v125
    v_mfma_f32_16x16x32_bf16 v[72:75], a[192:195], a[176:179], v[72:75]
    v_cvt_pk_bf16_f32 v111, v126, v127
    v_cvt_pk_bf16_f32 v152, v152, v153
    v_mfma_f32_16x16x32_bf16 v[72:75], a[196:199], a[180:183], v[72:75]
    v_cvt_pk_bf16_f32 v153, v154, v155
    v_cvt_pk_bf16_f32 v154, v184, v185
    v_mfma_f32_16x16x32_bf16 v[88:91], a[200:203], a[176:179], v[88:91]
    buffer_store_dwordx4 v[220:223], v2, s[24:27], s42 offen offset:3072 sc1
    v_mfma_f32_16x16x32_bf16 v[88:91], a[204:207], a[180:183], v[88:91]
    v_cvt_pk_bf16_f32 v155, v186, v187
    v_cvt_pk_bf16_f32 v216, v216, v217
    v_mfma_f32_16x16x32_bf16 v[104:107], a[208:211], a[176:179], v[104:107]
    v_cvt_pk_bf16_f32 v217, v218, v219
    v_cvt_pk_bf16_f32 v218, v248, v249
    v_mfma_f32_16x16x32_bf16 v[104:107], a[212:215], a[180:183], v[104:107]
    v_cvt_pk_bf16_f32 v219, v250, v251
    v_mfma_f32_16x16x32_bf16 v[120:123], a[216:219], a[176:179], v[120:123]
    v_cvt_pk_bf16_f32 v72, v72, v73
    v_cvt_pk_bf16_f32 v73, v74, v75
    v_mfma_f32_16x16x32_bf16 v[120:123], a[220:223], a[180:183], v[120:123]
    v_cvt_pk_bf16_f32 v74, v88, v89
    v_cvt_pk_bf16_f32 v75, v90, v91
    v_mfma_f32_16x16x32_bf16 v[148:151], a[224:227], a[168:171], v[148:151]
    v_mfma_f32_16x16x32_bf16 v[148:151], a[228:231], a[172:175], v[148:151]
    v_mfma_f32_16x16x32_bf16 v[180:183], a[232:235], a[168:171], v[180:183]
    buffer_store_dwordx4 v[76:79], v2, s[24:27], s42 offen offset:0 sc1
    v_mfma_f32_16x16x32_bf16 v[180:183], a[236:239], a[172:175], v[180:183]
    v_cvt_pk_bf16_f32 v104, v104, v105
    v_cvt_pk_bf16_f32 v105, v106, v107
    v_mfma_f32_16x16x32_bf16 v[212:215], a[240:243], a[168:171], v[212:215]
    v_cvt_pk_bf16_f32 v106, v120, v121
    v_cvt_pk_bf16_f32 v107, v122, v123
    v_mfma_f32_16x16x32_bf16 v[212:215], a[244:247], a[172:175], v[212:215]
    v_mfma_f32_16x16x32_bf16 v[244:247], a[248:251], a[168:171], v[244:247]
    v_cvt_pk_bf16_f32 v148, v148, v149
    v_cvt_pk_bf16_f32 v149, v150, v151
    v_mfma_f32_16x16x32_bf16 v[244:247], a[252:255], a[172:175], v[244:247]
    v_cvt_pk_bf16_f32 v150, v180, v181
    v_cvt_pk_bf16_f32 v151, v182, v183
    v_mfma_f32_16x16x32_bf16 v[68:71], a[192:195], a[168:171], v[68:71]
    v_mfma_f32_16x16x32_bf16 v[68:71], a[196:199], a[172:175], v[68:71]
    v_mfma_f32_16x16x32_bf16 v[84:87], a[200:203], a[168:171], v[84:87]
    buffer_store_dwordx4 v[108:111], v2, s[24:27], s42 offen offset:1024 sc1
    v_mfma_f32_16x16x32_bf16 v[84:87], a[204:207], a[172:175], v[84:87]
    v_cvt_pk_bf16_f32 v212, v212, v213
    v_cvt_pk_bf16_f32 v213, v214, v215
    v_mfma_f32_16x16x32_bf16 v[100:103], a[208:211], a[168:171], v[100:103]
    v_cvt_pk_bf16_f32 v214, v244, v245
    v_cvt_pk_bf16_f32 v215, v246, v247
    v_mfma_f32_16x16x32_bf16 v[100:103], a[212:215], a[172:175], v[100:103]
    v_mfma_f32_16x16x32_bf16 v[116:119], a[216:219], a[168:171], v[116:119]
    v_cvt_pk_bf16_f32 v68, v68, v69
    v_cvt_pk_bf16_f32 v69, v70, v71
    v_mfma_f32_16x16x32_bf16 v[116:119], a[220:223], a[172:175], v[116:119]
    v_cvt_pk_bf16_f32 v70, v84, v85
    v_cvt_pk_bf16_f32 v71, v86, v87
    v_mfma_f32_16x16x32_bf16 v[64:67], a[192:195], a[160:163], v[64:67]
    v_mfma_f32_16x16x32_bf16 v[64:67], a[196:199], a[164:167], v[64:67]
    v_mfma_f32_16x16x32_bf16 v[80:83], a[200:203], a[160:163], v[80:83]
    buffer_store_dwordx4 v[152:155], v2, s[24:27], s41 offen offset:2048 sc1
    v_mfma_f32_16x16x32_bf16 v[80:83], a[204:207], a[164:167], v[80:83]
    v_cvt_pk_bf16_f32 v100, v100, v101
    v_cvt_pk_bf16_f32 v101, v102, v103
    v_mfma_f32_16x16x32_bf16 v[96:99], a[208:211], a[160:163], v[96:99]
    v_cvt_pk_bf16_f32 v102, v116, v117
    v_cvt_pk_bf16_f32 v103, v118, v119
    v_mfma_f32_16x16x32_bf16 v[96:99], a[212:215], a[164:167], v[96:99]
    v_mfma_f32_16x16x32_bf16 v[112:115], a[216:219], a[160:163], v[112:115]
    v_mfma_f32_16x16x32_bf16 v[112:115], a[220:223], a[164:167], v[112:115]
    v_mfma_f32_16x16x32_bf16 v[144:147], a[224:227], a[160:163], v[144:147]
    ds_read_b64_tr_b16 a[192:193], v9 offset:0
    ds_read_b64_tr_b16 a[194:195], v9 offset:20480
    v_mfma_f32_16x16x32_bf16 v[144:147], a[228:231], a[164:167], v[144:147]
    ds_read_b64_tr_b16 a[196:197], v9 offset:1024
    ds_read_b64_tr_b16 a[198:199], v9 offset:21504
    v_mfma_f32_16x16x32_bf16 v[176:179], a[232:235], a[160:163], v[176:179]
    ds_read_b64_tr_b16 a[200:201], v10 offset:0
    ds_read_b64_tr_b16 a[202:203], v10 offset:20480
    v_mfma_f32_16x16x32_bf16 v[176:179], a[236:239], a[164:167], v[176:179]
    ds_read_b64_tr_b16 a[204:205], v10 offset:1024
    ds_read_b64_tr_b16 a[206:207], v10 offset:21504
    v_mfma_f32_16x16x32_bf16 v[208:211], a[240:243], a[160:163], v[208:211]
    ds_read_b64_tr_b16 a[208:209], v9 offset:512
    ds_read_b64_tr_b16 a[210:211], v9 offset:20992
    v_mfma_f32_16x16x32_bf16 v[208:211], a[244:247], a[164:167], v[208:211]
    ds_read_b64_tr_b16 a[212:213], v9 offset:1536
    ds_read_b64_tr_b16 a[214:215], v9 offset:22016
    v_mfma_f32_16x16x32_bf16 v[240:243], a[248:251], a[160:163], v[240:243]
    ds_read_b64_tr_b16 a[216:217], v10 offset:512
    ds_read_b64_tr_b16 a[218:219], v10 offset:20992
    v_mfma_f32_16x16x32_bf16 v[240:243], a[252:255], a[164:167], v[240:243]
    ds_read_b64_tr_b16 a[220:221], v10 offset:1536
    ds_read_b64_tr_b16 a[222:223], v10 offset:22016
    s_waitcnt vmcnt(33) lgkmcnt(12)
    v_mfma_f32_16x16x32_bf16 v[32:35], a[192:195], a[32:35], 0
    ds_read_b64_tr_b16 a[224:225], v9 offset:2048
    ds_read_b64_tr_b16 a[226:227], v9 offset:22528
    v_mfma_f32_16x16x32_bf16 v[32:35], a[196:199], a[36:39], v[32:35]
    ds_read_b64_tr_b16 a[228:229], v9 offset:3072
    ds_read_b64_tr_b16 a[230:231], v9 offset:23552
    buffer_store_dwordx4 v[216:219], v2, s[24:27], s41 offen offset:3072 sc1
    s_waitcnt lgkmcnt(12)
    v_mfma_f32_16x16x32_bf16 v[36:39], a[200:203], a[32:35], 0
    ds_read_b64_tr_b16 a[232:233], v10 offset:2048
    ds_read_b64_tr_b16 a[234:235], v10 offset:22528
    v_mfma_f32_16x16x32_bf16 v[36:39], a[204:207], a[36:39], v[36:39]
    ds_read_b64_tr_b16 a[236:237], v10 offset:3072
    ds_read_b64_tr_b16 a[238:239], v10 offset:23552
    s_waitcnt lgkmcnt(12)
    v_mfma_f32_16x16x32_bf16 v[40:43], a[208:211], a[32:35], 0
    ds_read_b64_tr_b16 a[240:241], v9 offset:2560
    ds_read_b64_tr_b16 a[242:243], v9 offset:23040
    v_mfma_f32_16x16x32_bf16 v[40:43], a[212:215], a[36:39], v[40:43]
    ds_read_b64_tr_b16 a[244:245], v9 offset:3584
    ds_read_b64_tr_b16 a[246:247], v9 offset:24064
    s_waitcnt lgkmcnt(12)
    v_mfma_f32_16x16x32_bf16 v[44:47], a[216:219], a[32:35], 0
    ds_read_b64_tr_b16 a[248:249], v10 offset:2560
    ds_read_b64_tr_b16 a[250:251], v10 offset:23040
    v_mfma_f32_16x16x32_bf16 v[44:47], a[220:223], a[36:39], v[44:47]
    ds_read_b64_tr_b16 a[252:253], v10 offset:3584
    ds_read_b64_tr_b16 a[254:255], v10 offset:24064
    s_waitcnt lgkmcnt(12)
    v_mfma_f32_16x16x32_bf16 v[48:51], a[224:227], a[32:35], 0
    ds_read_b64_tr_b16 a[192:193], v11 offset:0
    ds_read_b64_tr_b16 a[194:195], v11 offset:20480
    v_mfma_f32_16x16x32_bf16 v[48:51], a[228:231], a[36:39], v[48:51]
    ds_read_b64_tr_b16 a[196:197], v11 offset:1024
    ds_read_b64_tr_b16 a[198:199], v11 offset:21504
    buffer_store_dwordx4 v[72:75], v2, s[24:27], s41 offen offset:0 sc1
    s_waitcnt lgkmcnt(12)
    v_mfma_f32_16x16x32_bf16 v[52:55], a[232:235], a[32:35], 0
    ds_read_b64_tr_b16 a[200:201], v12 offset:0
    ds_read_b64_tr_b16 a[202:203], v12 offset:20480
    v_mfma_f32_16x16x32_bf16 v[52:55], a[236:239], a[36:39], v[52:55]
    ds_read_b64_tr_b16 a[204:205], v12 offset:1024
    ds_read_b64_tr_b16 a[206:207], v12 offset:21504
    s_waitcnt lgkmcnt(12)
    v_mfma_f32_16x16x32_bf16 v[56:59], a[240:243], a[32:35], 0
    ds_read_b64_tr_b16 a[208:209], v11 offset:512
    ds_read_b64_tr_b16 a[210:211], v11 offset:20992
    v_mfma_f32_16x16x32_bf16 v[56:59], a[244:247], a[36:39], v[56:59]
    ds_read_b64_tr_b16 a[212:213], v11 offset:1536
    ds_read_b64_tr_b16 a[214:215], v11 offset:22016
    s_waitcnt lgkmcnt(12)
    v_mfma_f32_16x16x32_bf16 v[60:63], a[248:251], a[32:35], 0
    ds_read_b64_tr_b16 a[216:217], v12 offset:512
    ds_read_b64_tr_b16 a[218:219], v12 offset:20992
    v_mfma_f32_16x16x32_bf16 v[60:63], a[252:255], a[36:39], v[60:63]
    ds_read_b64_tr_b16 a[220:221], v12 offset:1536
    ds_read_b64_tr_b16 a[222:223], v12 offset:22016
    s_waitcnt lgkmcnt(12)
    v_mfma_f32_16x16x32_bf16 v[32:35], a[192:195], a[40:43], v[32:35]
    ds_read_b64_tr_b16 a[224:225], v11 offset:2048
    ds_read_b64_tr_b16 a[226:227], v11 offset:22528
    v_mfma_f32_16x16x32_bf16 v[32:35], a[196:199], a[44:47], v[32:35]
    ds_read_b64_tr_b16 a[228:229], v11 offset:3072
    ds_read_b64_tr_b16 a[230:231], v11 offset:23552
    buffer_store_dwordx4 v[104:107], v2, s[24:27], s41 offen offset:1024 sc1
    s_waitcnt lgkmcnt(12)
    v_mfma_f32_16x16x32_bf16 v[36:39], a[200:203], a[40:43], v[36:39]
    ds_read_b64_tr_b16 a[232:233], v12 offset:2048
    ds_read_b64_tr_b16 a[234:235], v12 offset:22528
    v_mfma_f32_16x16x32_bf16 v[36:39], a[204:207], a[44:47], v[36:39]
    ds_read_b64_tr_b16 a[236:237], v12 offset:3072
    ds_read_b64_tr_b16 a[238:239], v12 offset:23552
    s_waitcnt lgkmcnt(12)
    v_mfma_f32_16x16x32_bf16 v[40:43], a[208:211], a[40:43], v[40:43]
    ds_read_b64_tr_b16 a[240:241], v11 offset:2560
    ds_read_b64_tr_b16 a[242:243], v11 offset:23040
    v_mfma_f32_16x16x32_bf16 v[40:43], a[212:215], a[44:47], v[40:43]
    ds_read_b64_tr_b16 a[244:245], v11 offset:3584
    ds_read_b64_tr_b16 a[246:247], v11 offset:24064
    s_add_u32 m0, s19, 0
    s_mov_b32 s11, 1048576
    buffer_load_dwordx4 v17, s[36:39], s11 offen offset:0 lds
    s_waitcnt lgkmcnt(12)
    v_mfma_f32_16x16x32_bf16 v[44:47], a[216:219], a[40:43], v[44:47]
    ds_read_b64_tr_b16 a[248:249], v12 offset:2560
    ds_read_b64_tr_b16 a[250:251], v12 offset:23040
    v_mfma_f32_16x16x32_bf16 v[44:47], a[220:223], a[44:47], v[44:47]
    ds_read_b64_tr_b16 a[252:253], v12 offset:3584
    ds_read_b64_tr_b16 a[254:255], v12 offset:24064
    s_waitcnt lgkmcnt(12)
    v_mfma_f32_16x16x32_bf16 v[48:51], a[224:227], a[40:43], v[48:51]
    ds_read_b64_tr_b16 a[192:193], v7 offset:8192
    ds_read_b64_tr_b16 a[194:195], v7 offset:28672
    v_mfma_f32_16x16x32_bf16 v[48:51], a[228:231], a[44:47], v[48:51]
    ds_read_b64_tr_b16 a[196:197], v7 offset:9216
    ds_read_b64_tr_b16 a[198:199], v7 offset:29696
    buffer_store_dwordx4 v[148:151], v2, s[24:27], s40 offen offset:2048 sc1
    s_waitcnt lgkmcnt(12)
    v_mfma_f32_16x16x32_bf16 v[52:55], a[232:235], a[40:43], v[52:55]
    ds_read_b64_tr_b16 a[200:201], v8 offset:8192
    ds_read_b64_tr_b16 a[202:203], v8 offset:28672
    v_mfma_f32_16x16x32_bf16 v[52:55], a[236:239], a[44:47], v[52:55]
    ds_read_b64_tr_b16 a[204:205], v8 offset:9216
    ds_read_b64_tr_b16 a[206:207], v8 offset:29696
    s_waitcnt lgkmcnt(12)
    v_mfma_f32_16x16x32_bf16 v[56:59], a[240:243], a[40:43], v[56:59]
    ds_read_b64_tr_b16 a[208:209], v7 offset:8704
    ds_read_b64_tr_b16 a[210:211], v7 offset:29184
    v_mfma_f32_16x16x32_bf16 v[56:59], a[244:247], a[44:47], v[56:59]
    ds_read_b64_tr_b16 a[212:213], v7 offset:9728
    ds_read_b64_tr_b16 a[214:215], v7 offset:30208
    buffer_load_dwordx4 v18, s[36:39], s11 offen offset:1024 lds
    s_waitcnt lgkmcnt(12)
    v_mfma_f32_16x16x32_bf16 v[60:63], a[248:251], a[40:43], v[60:63]
    ds_read_b64_tr_b16 a[216:217], v8 offset:8704
    ds_read_b64_tr_b16 a[218:219], v8 offset:29184
    v_mfma_f32_16x16x32_bf16 v[60:63], a[252:255], a[44:47], v[60:63]
    ds_read_b64_tr_b16 a[220:221], v8 offset:9728
    ds_read_b64_tr_b16 a[222:223], v8 offset:30208
    s_waitcnt lgkmcnt(12)
    v_mfma_f32_16x16x32_bf16 v[32:35], a[192:195], a[48:51], v[32:35]
    ds_read_b64_tr_b16 a[224:225], v9 offset:8192
    ds_read_b64_tr_b16 a[226:227], v9 offset:28672
    v_mfma_f32_16x16x32_bf16 v[32:35], a[196:199], a[52:55], v[32:35]
    ds_read_b64_tr_b16 a[228:229], v9 offset:9216
    ds_read_b64_tr_b16 a[230:231], v9 offset:29696
    buffer_store_dwordx4 v[212:215], v2, s[24:27], s40 offen offset:3072 sc1
    s_waitcnt vmcnt(20) lgkmcnt(12)
    s_barrier
    v_mfma_f32_16x16x32_bf16 v[36:39], a[200:203], a[48:51], v[36:39]
    ds_read_b64_tr_b16 a[232:233], v10 offset:8192
    ds_read_b64_tr_b16 a[234:235], v10 offset:28672
    v_mfma_f32_16x16x32_bf16 v[36:39], a[204:207], a[52:55], v[36:39]
    ds_read_b64_tr_b16 a[236:237], v10 offset:9216
    ds_read_b64_tr_b16 a[238:239], v10 offset:29696
    s_waitcnt lgkmcnt(12)
    v_mfma_f32_16x16x32_bf16 v[40:43], a[208:211], a[48:51], v[40:43]
    ds_read_b64_tr_b16 a[240:241], v9 offset:8704
    ds_read_b64_tr_b16 a[242:243], v9 offset:29184
    v_mfma_f32_16x16x32_bf16 v[40:43], a[212:215], a[52:55], v[40:43]
    ds_read_b64_tr_b16 a[244:245], v9 offset:9728
    ds_read_b64_tr_b16 a[246:247], v9 offset:30208
    buffer_load_dwordx4 v19, s[36:39], s11 offen offset:2048 lds
    s_waitcnt lgkmcnt(12)
    v_mfma_f32_16x16x32_bf16 v[44:47], a[216:219], a[48:51], v[44:47]
    ds_read_b64_tr_b16 a[248:249], v10 offset:8704
    ds_read_b64_tr_b16 a[250:251], v10 offset:29184
    v_mfma_f32_16x16x32_bf16 v[44:47], a[220:223], a[52:55], v[44:47]
    ds_read_b64_tr_b16 a[252:253], v10 offset:9728
    ds_read_b64_tr_b16 a[254:255], v10 offset:30208
    s_waitcnt lgkmcnt(12)
    v_mfma_f32_16x16x32_bf16 v[48:51], a[224:227], a[48:51], v[48:51]
    ds_read_b64_tr_b16 a[192:193], v13 offset:0
    ds_read_b64_tr_b16 a[194:195], v13 offset:20480
    v_mfma_f32_16x16x32_bf16 v[48:51], a[228:231], a[52:55], v[48:51]
    ds_read_b64_tr_b16 a[196:197], v13 offset:1024
    ds_read_b64_tr_b16 a[198:199], v13 offset:21504
    buffer_store_dwordx4 v[68:71], v2, s[24:27], s40 offen offset:0 sc1
    s_waitcnt lgkmcnt(12)
    v_mfma_f32_16x16x32_bf16 v[52:55], a[232:235], a[48:51], v[52:55]
    ds_read_b64_tr_b16 a[200:201], v14 offset:0
    ds_read_b64_tr_b16 a[202:203], v14 offset:20480
    v_mfma_f32_16x16x32_bf16 v[52:55], a[236:239], a[52:55], v[52:55]
    ds_read_b64_tr_b16 a[204:205], v14 offset:1024
    ds_read_b64_tr_b16 a[206:207], v14 offset:21504
    s_waitcnt lgkmcnt(12)
    v_mfma_f32_16x16x32_bf16 v[56:59], a[240:243], a[48:51], v[56:59]
    ds_read_b64_tr_b16 a[208:209], v13 offset:512
    ds_read_b64_tr_b16 a[210:211], v13 offset:20992
    v_mfma_f32_16x16x32_bf16 v[56:59], a[244:247], a[52:55], v[56:59]
    ds_read_b64_tr_b16 a[212:213], v13 offset:1536
    ds_read_b64_tr_b16 a[214:215], v13 offset:22016
    buffer_load_dwordx4 v20, s[36:39], s11 offen offset:3072 lds
    s_waitcnt lgkmcnt(12)
    v_mfma_f32_16x16x32_bf16 v[60:63], a[248:251], a[48:51], v[60:63]
    ds_read_b64_tr_b16 a[216:217], v14 offset:512
    ds_read_b64_tr_b16 a[218:219], v14 offset:20992
    v_mfma_f32_16x16x32_bf16 v[60:63], a[252:255], a[52:55], v[60:63]
    ds_read_b64_tr_b16 a[220:221], v14 offset:1536
    ds_read_b64_tr_b16 a[222:223], v14 offset:22016
    s_waitcnt lgkmcnt(12)
    v_mfma_f32_16x16x32_bf16 v[32:35], a[192:195], a[56:59], v[32:35]
    ds_read_b64_tr_b16 a[224:225], v13 offset:2048
    ds_read_b64_tr_b16 a[226:227], v13 offset:22528
    v_mfma_f32_16x16x32_bf16 v[32:35], a[196:199], a[60:63], v[32:35]
    ds_read_b64_tr_b16 a[228:229], v13 offset:3072
    ds_read_b64_tr_b16 a[230:231], v13 offset:23552
    buffer_store_dwordx4 v[100:103], v2, s[24:27], s40 offen offset:1024 sc1
    s_waitcnt lgkmcnt(12)
    v_mfma_f32_16x16x32_bf16 v[36:39], a[200:203], a[56:59], v[36:39]
    ds_read_b64_tr_b16 a[232:233], v14 offset:2048
    ds_read_b64_tr_b16 a[234:235], v14 offset:22528
    v_mfma_f32_16x16x32_bf16 v[36:39], a[204:207], a[60:63], v[36:39]
    ds_read_b64_tr_b16 a[236:237], v14 offset:3072
    ds_read_b64_tr_b16 a[238:239], v14 offset:23552
    s_waitcnt lgkmcnt(12)
    v_mfma_f32_16x16x32_bf16 v[40:43], a[208:211], a[56:59], v[40:43]
    ds_read_b64_tr_b16 a[240:241], v13 offset:2560
    ds_read_b64_tr_b16 a[242:243], v13 offset:23040
    v_mfma_f32_16x16x32_bf16 v[40:43], a[212:215], a[60:63], v[40:43]
    ds_read_b64_tr_b16 a[244:245], v13 offset:3584
    ds_read_b64_tr_b16 a[246:247], v13 offset:24064
    s_add_u32 m0, s19, 4096
    s_mov_b32 s11, 1179648
    buffer_load_dwordx4 v17, s[36:39], s11 offen offset:0 lds
    s_waitcnt lgkmcnt(12)
    v_mfma_f32_16x16x32_bf16 v[44:47], a[216:219], a[56:59], v[44:47]
    ds_read_b64_tr_b16 a[248:249], v14 offset:2560
    ds_read_b64_tr_b16 a[250:251], v14 offset:23040
    v_mfma_f32_16x16x32_bf16 v[44:47], a[220:223], a[60:63], v[44:47]
    ds_read_b64_tr_b16 a[252:253], v14 offset:3584
    ds_read_b64_tr_b16 a[254:255], v14 offset:24064
    s_waitcnt lgkmcnt(12)
    v_mfma_f32_16x16x32_bf16 v[48:51], a[224:227], a[56:59], v[48:51]
    ds_read_b64_tr_b16 a[192:193], v11 offset:8192
    ds_read_b64_tr_b16 a[194:195], v11 offset:28672
    v_mfma_f32_16x16x32_bf16 v[48:51], a[228:231], a[60:63], v[48:51]
    ds_read_b64_tr_b16 a[196:197], v11 offset:9216
    ds_read_b64_tr_b16 a[198:199], v11 offset:29696
    buffer_load_dwordx4 v18, s[36:39], s11 offen offset:1024 lds
    s_waitcnt lgkmcnt(12)
    v_mfma_f32_16x16x32_bf16 v[52:55], a[232:235], a[56:59], v[52:55]
    ds_read_b64_tr_b16 a[200:201], v12 offset:8192
    ds_read_b64_tr_b16 a[202:203], v12 offset:28672
    v_mfma_f32_16x16x32_bf16 v[52:55], a[236:239], a[60:63], v[52:55]
    ds_read_b64_tr_b16 a[204:205], v12 offset:9216
    ds_read_b64_tr_b16 a[206:207], v12 offset:29696
    s_waitcnt lgkmcnt(12)
    v_mfma_f32_16x16x32_bf16 v[56:59], a[240:243], a[56:59], v[56:59]
    ds_read_b64_tr_b16 a[208:209], v11 offset:8704
    ds_read_b64_tr_b16 a[210:211], v11 offset:29184
    v_mfma_f32_16x16x32_bf16 v[56:59], a[244:247], a[60:63], v[56:59]
    ds_read_b64_tr_b16 a[212:213], v11 offset:9728
    ds_read_b64_tr_b16 a[214:215], v11 offset:30208
    buffer_load_dwordx4 v19, s[36:39], s11 offen offset:2048 lds
    s_waitcnt lgkmcnt(12)
    v_mfma_f32_16x16x32_bf16 v[60:63], a[248:251], a[56:59], v[60:63]
    ds_read_b64_tr_b16 a[216:217], v12 offset:8704
    ds_read_b64_tr_b16 a[218:219], v12 offset:29184
    v_mfma_f32_16x16x32_bf16 v[60:63], a[252:255], a[60:63], v[60:63]
    ds_read_b64_tr_b16 a[220:221], v12 offset:9728
    ds_read_b64_tr_b16 a[222:223], v12 offset:30208
    s_waitcnt vmcnt(39) lgkmcnt(12)
    v_mfma_f32_16x16x32_bf16 v[32:35], a[192:195], a[0:3], v[32:35]
    ds_read_b64_tr_b16 a[224:225], v13 offset:8192
    ds_read_b64_tr_b16 a[226:227], v13 offset:28672
    v_mfma_f32_16x16x32_bf16 v[32:35], a[196:199], a[4:7], v[32:35]
    ds_read_b64_tr_b16 a[228:229], v13 offset:9216
    ds_read_b64_tr_b16 a[230:231], v13 offset:29696
    buffer_load_dwordx4 v20, s[36:39], s11 offen offset:3072 lds
    s_waitcnt lgkmcnt(12)
    v_mfma_f32_16x16x32_bf16 v[36:39], a[200:203], a[0:3], v[36:39]
    ds_read_b64_tr_b16 a[232:233], v14 offset:8192
    ds_read_b64_tr_b16 a[234:235], v14 offset:28672
    v_mfma_f32_16x16x32_bf16 v[36:39], a[204:207], a[4:7], v[36:39]
    ds_read_b64_tr_b16 a[236:237], v14 offset:9216
    ds_read_b64_tr_b16 a[238:239], v14 offset:29696
    s_waitcnt lgkmcnt(12)
    v_mfma_f32_16x16x32_bf16 v[40:43], a[208:211], a[0:3], v[40:43]
    ds_read_b64_tr_b16 a[240:241], v13 offset:8704
    ds_read_b64_tr_b16 a[242:243], v13 offset:29184
    v_mfma_f32_16x16x32_bf16 v[40:43], a[212:215], a[4:7], v[40:43]
    ds_read_b64_tr_b16 a[244:245], v13 offset:9728
    ds_read_b64_tr_b16 a[246:247], v13 offset:30208
    s_add_u32 m0, s19, 40960
    s_mov_b32 s11, 1310720
    buffer_load_dwordx4 v17, s[36:39], s11 offen offset:0 lds
    s_waitcnt lgkmcnt(12)
    v_mfma_f32_16x16x32_bf16 v[44:47], a[216:219], a[0:3], v[44:47]
    ds_read_b64_tr_b16 a[248:249], v14 offset:8704
    ds_read_b64_tr_b16 a[250:251], v14 offset:29184
    v_mfma_f32_16x16x32_bf16 v[44:47], a[220:223], a[4:7], v[44:47]
    ds_read_b64_tr_b16 a[252:253], v14 offset:9728
    ds_read_b64_tr_b16 a[254:255], v14 offset:30208
    s_waitcnt lgkmcnt(12)
    v_mfma_f32_16x16x32_bf16 v[48:51], a[224:227], a[0:3], v[48:51]
    ds_read_b64_tr_b16 a[192:193], v9 offset:4096
    ds_read_b64_tr_b16 a[194:195], v9 offset:24576
    v_mfma_f32_16x16x32_bf16 v[48:51], a[228:231], a[4:7], v[48:51]
    ds_read_b64_tr_b16 a[196:197], v9 offset:5120
    ds_read_b64_tr_b16 a[198:199], v9 offset:25600
    buffer_load_dwordx4 v18, s[36:39], s11 offen offset:1024 lds
    s_waitcnt lgkmcnt(12)
    v_mfma_f32_16x16x32_bf16 v[52:55], a[232:235], a[0:3], v[52:55]
    ds_read_b64_tr_b16 a[200:201], v10 offset:4096
    ds_read_b64_tr_b16 a[202:203], v10 offset:24576
    v_mfma_f32_16x16x32_bf16 v[52:55], a[236:239], a[4:7], v[52:55]
    ds_read_b64_tr_b16 a[204:205], v10 offset:5120
    ds_read_b64_tr_b16 a[206:207], v10 offset:25600
    s_waitcnt lgkmcnt(12)
    v_mfma_f32_16x16x32_bf16 v[56:59], a[240:243], a[0:3], v[56:59]
    ds_read_b64_tr_b16 a[208:209], v9 offset:4608
    ds_read_b64_tr_b16 a[210:211], v9 offset:25088
    v_mfma_f32_16x16x32_bf16 v[56:59], a[244:247], a[4:7], v[56:59]
    ds_read_b64_tr_b16 a[212:213], v9 offset:5632
    ds_read_b64_tr_b16 a[214:215], v9 offset:26112
    buffer_load_dwordx4 v19, s[36:39], s11 offen offset:2048 lds
    s_waitcnt lgkmcnt(12)
    v_mfma_f32_16x16x32_bf16 v[60:63], a[248:251], a[0:3], v[60:63]
    ds_read_b64_tr_b16 a[216:217], v10 offset:4608
    ds_read_b64_tr_b16 a[218:219], v10 offset:25088
    v_mfma_f32_16x16x32_bf16 v[60:63], a[252:255], a[4:7], v[60:63]
    ds_read_b64_tr_b16 a[220:221], v10 offset:5632
    ds_read_b64_tr_b16 a[222:223], v10 offset:26112
    s_waitcnt lgkmcnt(12)
    v_mfma_f32_16x16x32_bf16 v[32:35], a[192:195], a[8:11], v[32:35]
    ds_read_b64_tr_b16 a[224:225], v9 offset:6144
    ds_read_b64_tr_b16 a[226:227], v9 offset:26624
    v_mfma_f32_16x16x32_bf16 v[32:35], a[196:199], a[12:15], v[32:35]
    ds_read_b64_tr_b16 a[228:229], v9 offset:7168
    ds_read_b64_tr_b16 a[230:231], v9 offset:27648
    buffer_load_dwordx4 v20, s[36:39], s11 offen offset:3072 lds
    s_waitcnt lgkmcnt(12)
    v_mfma_f32_16x16x32_bf16 v[36:39], a[200:203], a[8:11], v[36:39]
    ds_read_b64_tr_b16 a[232:233], v10 offset:6144
    ds_read_b64_tr_b16 a[234:235], v10 offset:26624
    v_mfma_f32_16x16x32_bf16 v[36:39], a[204:207], a[12:15], v[36:39]
    ds_read_b64_tr_b16 a[236:237], v10 offset:7168
    ds_read_b64_tr_b16 a[238:239], v10 offset:27648
    s_waitcnt lgkmcnt(12)
    v_mfma_f32_16x16x32_bf16 v[40:43], a[208:211], a[8:11], v[40:43]
    ds_read_b64_tr_b16 a[240:241], v9 offset:6656
    ds_read_b64_tr_b16 a[242:243], v9 offset:27136
    v_mfma_f32_16x16x32_bf16 v[40:43], a[212:215], a[12:15], v[40:43]
    ds_read_b64_tr_b16 a[244:245], v9 offset:7680
    ds_read_b64_tr_b16 a[246:247], v9 offset:28160
    s_add_u32 m0, s19, 81920
    s_mov_b32 s11, 1441792
    buffer_load_dwordx4 v17, s[36:39], s11 offen offset:0 lds
    s_waitcnt lgkmcnt(12)
    v_mfma_f32_16x16x32_bf16 v[44:47], a[216:219], a[8:11], v[44:47]
    ds_read_b64_tr_b16 a[248:249], v10 offset:6656
    ds_read_b64_tr_b16 a[250:251], v10 offset:27136
    v_mfma_f32_16x16x32_bf16 v[44:47], a[220:223], a[12:15], v[44:47]
    ds_read_b64_tr_b16 a[252:253], v10 offset:7680
    ds_read_b64_tr_b16 a[254:255], v10 offset:28160
    s_waitcnt lgkmcnt(12)
    v_mfma_f32_16x16x32_bf16 v[48:51], a[224:227], a[8:11], v[48:51]
    ds_read_b64_tr_b16 a[192:193], v11 offset:4096
    ds_read_b64_tr_b16 a[194:195], v11 offset:24576
    v_mfma_f32_16x16x32_bf16 v[48:51], a[228:231], a[12:15], v[48:51]
    ds_read_b64_tr_b16 a[196:197], v11 offset:5120
    ds_read_b64_tr_b16 a[198:199], v11 offset:25600
    buffer_load_dwordx4 v18, s[36:39], s11 offen offset:1024 lds
    s_waitcnt lgkmcnt(12)
    v_mfma_f32_16x16x32_bf16 v[52:55], a[232:235], a[8:11], v[52:55]
    ds_read_b64_tr_b16 a[200:201], v12 offset:4096
    ds_read_b64_tr_b16 a[202:203], v12 offset:24576
    v_mfma_f32_16x16x32_bf16 v[52:55], a[236:239], a[12:15], v[52:55]
    ds_read_b64_tr_b16 a[204:205], v12 offset:5120
    ds_read_b64_tr_b16 a[206:207], v12 offset:25600
    s_waitcnt lgkmcnt(12)
    v_mfma_f32_16x16x32_bf16 v[56:59], a[240:243], a[8:11], v[56:59]
    ds_read_b64_tr_b16 a[208:209], v11 offset:4608
    ds_read_b64_tr_b16 a[210:211], v11 offset:25088
    v_mfma_f32_16x16x32_bf16 v[56:59], a[244:247], a[12:15], v[56:59]
    ds_read_b64_tr_b16 a[212:213], v11 offset:5632
    ds_read_b64_tr_b16 a[214:215], v11 offset:26112
    buffer_load_dwordx4 v19, s[36:39], s11 offen offset:2048 lds
    s_waitcnt lgkmcnt(12)
    v_mfma_f32_16x16x32_bf16 v[60:63], a[248:251], a[8:11], v[60:63]
    ds_read_b64_tr_b16 a[216:217], v12 offset:4608
    ds_read_b64_tr_b16 a[218:219], v12 offset:25088
    v_mfma_f32_16x16x32_bf16 v[60:63], a[252:255], a[12:15], v[60:63]
    ds_read_b64_tr_b16 a[220:221], v12 offset:5632
    ds_read_b64_tr_b16 a[222:223], v12 offset:26112
    s_waitcnt vmcnt(11)
    s_add_u32 s74, s63, s68
    s_mov_b64 exec, 1
    buffer_store_dword v21, off, s[52:55], s74 sc1
    s_mov_b64 exec, -1
    s_waitcnt lgkmcnt(12)
    v_mfma_f32_16x16x32_bf16 v[32:35], a[192:195], a[16:19], v[32:35]
    ds_read_b64_tr_b16 a[224:225], v11 offset:6144
    ds_read_b64_tr_b16 a[226:227], v11 offset:26624
    v_mfma_f32_16x16x32_bf16 v[32:35], a[196:199], a[20:23], v[32:35]
    ds_read_b64_tr_b16 a[228:229], v11 offset:7168
    ds_read_b64_tr_b16 a[230:231], v11 offset:27648
    buffer_load_dwordx4 v20, s[36:39], s11 offen offset:3072 lds
    s_waitcnt vmcnt(14) lgkmcnt(12)
    s_barrier
    v_mfma_f32_16x16x32_bf16 v[36:39], a[200:203], a[16:19], v[36:39]
    ds_read_b64_tr_b16 a[232:233], v12 offset:6144
    ds_read_b64_tr_b16 a[234:235], v12 offset:26624
    v_mfma_f32_16x16x32_bf16 v[36:39], a[204:207], a[20:23], v[36:39]
    ds_read_b64_tr_b16 a[236:237], v12 offset:7168
    ds_read_b64_tr_b16 a[238:239], v12 offset:27648
    s_waitcnt lgkmcnt(12)
    v_mfma_f32_16x16x32_bf16 v[40:43], a[208:211], a[16:19], v[40:43]
    ds_read_b64_tr_b16 a[240:241], v11 offset:6656
    ds_read_b64_tr_b16 a[242:243], v11 offset:27136
    v_mfma_f32_16x16x32_bf16 v[40:43], a[212:215], a[20:23], v[40:43]
    ds_read_b64_tr_b16 a[244:245], v11 offset:7680
    ds_read_b64_tr_b16 a[246:247], v11 offset:28160
    s_add_u32 m0, s19, 8192
    s_mov_b32 s11, 1572864
    buffer_load_dwordx4 v17, s[36:39], s11 offen offset:0 lds
    s_waitcnt lgkmcnt(12)
    v_mfma_f32_16x16x32_bf16 v[44:47], a[216:219], a[16:19], v[44:47]
    ds_read_b64_tr_b16 a[248:249], v12 offset:6656
    ds_read_b64_tr_b16 a[250:251], v12 offset:27136
    v_mfma_f32_16x16x32_bf16 v[44:47], a[220:223], a[20:23], v[44:47]
    ds_read_b64_tr_b16 a[252:253], v12 offset:7680
    ds_read_b64_tr_b16 a[254:255], v12 offset:28160
    s_waitcnt lgkmcnt(12)
    v_mfma_f32_16x16x32_bf16 v[48:51], a[224:227], a[16:19], v[48:51]
    ds_read_b64_tr_b16 a[192:193], v13 offset:4096
    ds_read_b64_tr_b16 a[194:195], v13 offset:24576
    v_mfma_f32_16x16x32_bf16 v[48:51], a[228:231], a[20:23], v[48:51]
    ds_read_b64_tr_b16 a[196:197], v13 offset:5120
    ds_read_b64_tr_b16 a[198:199], v13 offset:25600
    buffer_load_dwordx4 v18, s[36:39], s11 offen offset:1024 lds
    s_waitcnt lgkmcnt(12)
    v_mfma_f32_16x16x32_bf16 v[52:55], a[232:235], a[16:19], v[52:55]
    ds_read_b64_tr_b16 a[200:201], v14 offset:4096
    ds_read_b64_tr_b16 a[202:203], v14 offset:24576
    v_mfma_f32_16x16x32_bf16 v[52:55], a[236:239], a[20:23], v[52:55]
    ds_read_b64_tr_b16 a[204:205], v14 offset:5120
    ds_read_b64_tr_b16 a[206:207], v14 offset:25600
    s_waitcnt lgkmcnt(12)
    v_mfma_f32_16x16x32_bf16 v[56:59], a[240:243], a[16:19], v[56:59]
    ds_read_b64_tr_b16 a[208:209], v13 offset:4608
    ds_read_b64_tr_b16 a[210:211], v13 offset:25088
    v_mfma_f32_16x16x32_bf16 v[56:59], a[244:247], a[20:23], v[56:59]
    ds_read_b64_tr_b16 a[212:213], v13 offset:5632
    ds_read_b64_tr_b16 a[214:215], v13 offset:26112
    s_add_u32 m0, s19, 47104
    s_nop 0
    buffer_load_dwordx4 v19, s[36:39], s11 offen offset:2048 lds
    s_waitcnt lgkmcnt(12)
    v_mfma_f32_16x16x32_bf16 v[60:63], a[248:251], a[16:19], v[60:63]
    ds_read_b64_tr_b16 a[216:217], v14 offset:4608
    ds_read_b64_tr_b16 a[218:219], v14 offset:25088
    v_mfma_f32_16x16x32_bf16 v[60:63], a[252:255], a[20:23], v[60:63]
    ds_read_b64_tr_b16 a[220:221], v14 offset:5632
    ds_read_b64_tr_b16 a[222:223], v14 offset:26112
    s_waitcnt lgkmcnt(12)
    v_mfma_f32_16x16x32_bf16 v[32:35], a[192:195], a[24:27], v[32:35]
    ds_read_b64_tr_b16 a[224:225], v13 offset:6144
    ds_read_b64_tr_b16 a[226:227], v13 offset:26624
    v_mfma_f32_16x16x32_bf16 v[32:35], a[196:199], a[28:31], v[32:35]
    ds_read_b64_tr_b16 a[228:229], v13 offset:7168
    ds_read_b64_tr_b16 a[230:231], v13 offset:27648
    buffer_load_dwordx4 v20, s[36:39], s11 offen offset:3072 lds
    s_waitcnt lgkmcnt(12)
    v_mfma_f32_16x16x32_bf16 v[36:39], a[200:203], a[24:27], v[36:39]
    ds_read_b64_tr_b16 a[232:233], v14 offset:6144
    ds_read_b64_tr_b16 a[234:235], v14 offset:26624
    v_mfma_f32_16x16x32_bf16 v[36:39], a[204:207], a[28:31], v[36:39]
    ds_read_b64_tr_b16 a[236:237], v14 offset:7168
    ds_read_b64_tr_b16 a[238:239], v14 offset:27648
    s_waitcnt lgkmcnt(12)
    v_mfma_f32_16x16x32_bf16 v[40:43], a[208:211], a[24:27], v[40:43]
    ds_read_b64_tr_b16 a[240:241], v13 offset:6656
    ds_read_b64_tr_b16 a[242:243], v13 offset:27136
    v_mfma_f32_16x16x32_bf16 v[40:43], a[212:215], a[28:31], v[40:43]
    ds_read_b64_tr_b16 a[244:245], v13 offset:7680
    ds_read_b64_tr_b16 a[246:247], v13 offset:28160
    s_mov_b32 s10, 557056
    buffer_load_dwordx4 a[128:131], v3, s[44:47], s10 offen offset:0 sc1
    s_waitcnt lgkmcnt(12)
    v_mfma_f32_16x16x32_bf16 v[44:47], a[216:219], a[24:27], v[44:47]
    ds_read_b64_tr_b16 a[248:249], v14 offset:6656
    ds_read_b64_tr_b16 a[250:251], v14 offset:27136
    v_mfma_f32_16x16x32_bf16 v[44:47], a[220:223], a[28:31], v[44:47]
    ds_read_b64_tr_b16 a[252:253], v14 offset:7680
    ds_read_b64_tr_b16 a[254:255], v14 offset:28160
    s_waitcnt lgkmcnt(12)
    v_mfma_f32_16x16x32_bf16 v[48:51], a[224:227], a[24:27], v[48:51]
    ds_read_b64_tr_b16 a[192:193], v7 offset:0
    ds_read_b64_tr_b16 a[194:195], v7 offset:20480
    v_mfma_f32_16x16x32_bf16 v[48:51], a[228:231], a[28:31], v[48:51]
    ds_read_b64_tr_b16 a[196:197], v7 offset:1024
    ds_read_b64_tr_b16 a[198:199], v7 offset:21504
    buffer_load_dwordx4 a[132:135], v3, s[44:47], s10 offen offset:1024 sc1
    s_waitcnt lgkmcnt(12)
    v_mfma_f32_16x16x32_bf16 v[52:55], a[232:235], a[24:27], v[52:55]
    ds_read_b64_tr_b16 a[200:201], v8 offset:0
    ds_read_b64_tr_b16 a[202:203], v8 offset:20480
    v_mfma_f32_16x16x32_bf16 v[52:55], a[236:239], a[28:31], v[52:55]
    ds_read_b64_tr_b16 a[204:205], v8 offset:1024
    ds_read_b64_tr_b16 a[206:207], v8 offset:21504
    s_waitcnt lgkmcnt(12)
    v_mfma_f32_16x16x32_bf16 v[56:59], a[240:243], a[24:27], v[56:59]
    ds_read_b64_tr_b16 a[208:209], v7 offset:512
    ds_read_b64_tr_b16 a[210:211], v7 offset:20992
    v_mfma_f32_16x16x32_bf16 v[56:59], a[244:247], a[28:31], v[56:59]
    ds_read_b64_tr_b16 a[212:213], v7 offset:1536
    ds_read_b64_tr_b16 a[214:215], v7 offset:22016
    s_mov_b32 s10, 565248
    buffer_load_dwordx4 a[136:139], v3, s[44:47], s10 offen offset:0 sc1
    s_waitcnt lgkmcnt(12)
    v_mfma_f32_16x16x32_bf16 v[60:63], a[248:251], a[24:27], v[60:63]
    ds_read_b64_tr_b16 a[216:217], v8 offset:512
    ds_read_b64_tr_b16 a[218:219], v8 offset:20992
    v_mfma_f32_16x16x32_bf16 v[60:63], a[252:255], a[28:31], v[60:63]
    ds_read_b64_tr_b16 a[220:221], v8 offset:1536
    ds_read_b64_tr_b16 a[222:223], v8 offset:22016
    s_waitcnt vmcnt(36) lgkmcnt(12)
    v_mfma_f32_16x16x32_bf16 v[32:35], a[192:195], a[96:99], v[32:35]
    ds_read_b64_tr_b16 a[224:225], v7 offset:2048
    ds_read_b64_tr_b16 a[226:227], v7 offset:22528
    v_mfma_f32_16x16x32_bf16 v[32:35], a[196:199], a[100:103], v[32:35]
    ds_read_b64_tr_b16 a[228:229], v7 offset:3072
    ds_read_b64_tr_b16 a[230:231], v7 offset:23552
    buffer_load_dwordx4 a[140:143], v3, s[44:47], s10 offen offset:1024 sc1
    s_waitcnt vmcnt(13) lgkmcnt(12)
    s_barrier
    v_mfma_f32_16x16x32_bf16 v[36:39], a[200:203], a[96:99], v[36:39]
    ds_read_b64_tr_b16 a[232:233], v8 offset:2048
    ds_read_b64_tr_b16 a[234:235], v8 offset:22528
    v_mfma_f32_16x16x32_bf16 v[36:39], a[204:207], a[100:103], v[36:39]
    ds_read_b64_tr_b16 a[236:237], v8 offset:3072
    ds_read_b64_tr_b16 a[238:239], v8 offset:23552
    s_waitcnt lgkmcnt(12)
    v_mfma_f32_16x16x32_bf16 v[40:43], a[208:211], a[96:99], v[40:43]
    ds_read_b64_tr_b16 a[240:241], v7 offset:2560
    ds_read_b64_tr_b16 a[242:243], v7 offset:23040
    v_mfma_f32_16x16x32_bf16 v[40:43], a[212:215], a[100:103], v[40:43]
    ds_read_b64_tr_b16 a[244:245], v7 offset:3584
    ds_read_b64_tr_b16 a[246:247], v7 offset:24064
    s_mov_b32 s10, 573440
    buffer_load_dwordx4 a[144:147], v3, s[44:47], s10 offen offset:0 sc1
    s_waitcnt lgkmcnt(12)
    v_mfma_f32_16x16x32_bf16 v[44:47], a[216:219], a[96:99], v[44:47]
    ds_read_b64_tr_b16 a[248:249], v8 offset:2560
    ds_read_b64_tr_b16 a[250:251], v8 offset:23040
    v_mfma_f32_16x16x32_bf16 v[44:47], a[220:223], a[100:103], v[44:47]
    ds_read_b64_tr_b16 a[252:253], v8 offset:3584
    ds_read_b64_tr_b16 a[254:255], v8 offset:24064
    s_waitcnt lgkmcnt(12)
    v_mfma_f32_16x16x32_bf16 v[48:51], a[224:227], a[96:99], v[48:51]
    ds_read_b64_tr_b16 a[192:193], v7 offset:4096
    ds_read_b64_tr_b16 a[194:195], v7 offset:24576
    v_mfma_f32_16x16x32_bf16 v[48:51], a[228:231], a[100:103], v[48:51]
    ds_read_b64_tr_b16 a[196:197], v7 offset:5120
    ds_read_b64_tr_b16 a[198:199], v7 offset:25600
    buffer_load_dwordx4 a[148:151], v3, s[44:47], s10 offen offset:1024 sc1
    s_waitcnt lgkmcnt(12)
    v_mfma_f32_16x16x32_bf16 v[52:55], a[232:235], a[96:99], v[52:55]
    ds_read_b64_tr_b16 a[200:201], v8 offset:4096
    ds_read_b64_tr_b16 a[202:203], v8 offset:24576
    v_mfma_f32_16x16x32_bf16 v[52:55], a[236:239], a[100:103], v[52:55]
    ds_read_b64_tr_b16 a[204:205], v8 offset:5120
    ds_read_b64_tr_b16 a[206:207], v8 offset:25600
    s_waitcnt lgkmcnt(12)
    v_mfma_f32_16x16x32_bf16 v[56:59], a[240:243], a[96:99], v[56:59]
    ds_read_b64_tr_b16 a[208:209], v7 offset:4608
    ds_read_b64_tr_b16 a[210:211], v7 offset:25088
    v_mfma_f32_16x16x32_bf16 v[56:59], a[244:247], a[100:103], v[56:59]
    ds_read_b64_tr_b16 a[212:213], v7 offset:5632
    ds_read_b64_tr_b16 a[214:215], v7 offset:26112
    s_mov_b32 s10, 581632
    buffer_load_dwordx4 a[152:155], v3, s[44:47], s10 offen offset:0 sc1
    s_waitcnt lgkmcnt(12)
    v_mfma_f32_16x16x32_bf16 v[60:63], a[248:251], a[96:99], v[60:63]
    ds_read_b64_tr_b16 a[216:217], v8 offset:4608
    ds_read_b64_tr_b16 a[218:219], v8 offset:25088
    v_mfma_f32_16x16x32_bf16 v[60:63], a[252:255], a[100:103], v[60:63]
    ds_read_b64_tr_b16 a[220:221], v8 offset:5632
    ds_read_b64_tr_b16 a[222:223], v8 offset:26112
    s_waitcnt lgkmcnt(12)
    v_mfma_f32_16x16x32_bf16 v[32:35], a[192:195], a[104:107], v[32:35]
    ds_read_b64_tr_b16 a[224:225], v7 offset:6144
    ds_read_b64_tr_b16 a[226:227], v7 offset:26624
    v_mfma_f32_16x16x32_bf16 v[32:35], a[196:199], a[108:111], v[32:35]
    ds_read_b64_tr_b16 a[228:229], v7 offset:7168
    ds_read_b64_tr_b16 a[230:231], v7 offset:27648
    buffer_load_dwordx4 a[156:159], v3, s[44:47], s10 offen offset:1024 sc1
    s_waitcnt lgkmcnt(12)
    v_mfma_f32_16x16x32_bf16 v[36:39], a[200:203], a[104:107], v[36:39]
    ds_read_b64_tr_b16 a[232:233], v8 offset:6144
    ds_read_b64_tr_b16 a[234:235], v8 offset:26624
    v_mfma_f32_16x16x32_bf16 v[36:39], a[204:207], a[108:111], v[36:39]
    ds_read_b64_tr_b16 a[236:237], v8 offset:7168
    ds_read_b64_tr_b16 a[238:239], v8 offset:27648
    s_waitcnt lgkmcnt(12)
    v_mfma_f32_16x16x32_bf16 v[40:43], a[208:211], a[104:107], v[40:43]
    ds_read_b64_tr_b16 a[240:241], v7 offset:6656
    ds_read_b64_tr_b16 a[242:243], v7 offset:27136
    v_mfma_f32_16x16x32_bf16 v[40:43], a[212:215], a[108:111], v[40:43]
    ds_read_b64_tr_b16 a[244:245], v7 offset:7680
    ds_read_b64_tr_b16 a[246:247], v7 offset:28160
    s_add_u32 m0, s19, 122880
    s_mov_b32 s11, 1703936
    buffer_load_dwordx4 v17, s[36:39], s11 offen offset:0 lds
    s_waitcnt lgkmcnt(12)
    v_mfma_f32_16x16x32_bf16 v[44:47], a[216:219], a[104:107], v[44:47]
    ds_read_b64_tr_b16 a[248:249], v8 offset:6656
    ds_read_b64_tr_b16 a[250:251], v8 offset:27136
    v_mfma_f32_16x16x32_bf16 v[44:47], a[220:223], a[108:111], v[44:47]
    ds_read_b64_tr_b16 a[252:253], v8 offset:7680
    ds_read_b64_tr_b16 a[254:255], v8 offset:28160
    s_waitcnt lgkmcnt(12)
    v_mfma_f32_16x16x32_bf16 v[48:51], a[224:227], a[104:107], v[48:51]
    ds_read_b64_tr_b16 a[192:193], v9 offset:0
    ds_read_b64_tr_b16 a[194:195], v9 offset:20480
    v_mfma_f32_16x16x32_bf16 v[48:51], a[228:231], a[108:111], v[48:51]
    ds_read_b64_tr_b16 a[196:197], v9 offset:1024
    ds_read_b64_tr_b16 a[198:199], v9 offset:21504
    buffer_load_dwordx4 v18, s[36:39], s11 offen offset:1024 lds
    s_waitcnt lgkmcnt(12)
    v_mfma_f32_16x16x32_bf16 v[52:55], a[232:235], a[104:107], v[52:55]
    ds_read_b64_tr_b16 a[200:201], v10 offset:0
    ds_read_b64_tr_b16 a[202:203], v10 offset:20480
    v_mfma_f32_16x16x32_bf16 v[52:55], a[236:239], a[108:111], v[52:55]
    ds_read_b64_tr_b16 a[204:205], v10 offset:1024
    ds_read_b64_tr_b16 a[206:207], v10 offset:21504
    s_waitcnt lgkmcnt(12)
    v_mfma_f32_16x16x32_bf16 v[56:59], a[240:243], a[104:107], v[56:59]
    ds_read_b64_tr_b16 a[208:209], v9 offset:512
    ds_read_b64_tr_b16 a[210:211], v9 offset:20992
    v_mfma_f32_16x16x32_bf16 v[56:59], a[244:247], a[108:111], v[56:59]
    ds_read_b64_tr_b16 a[212:213], v9 offset:1536
    ds_read_b64_tr_b16 a[214:215], v9 offset:22016
    buffer_load_dwordx4 v19, s[36:39], s11 offen offset:2048 lds
    s_waitcnt lgkmcnt(12)
    v_mfma_f32_16x16x32_bf16 v[60:63], a[248:251], a[104:107], v[60:63]
    ds_read_b64_tr_b16 a[216:217], v10 offset:512
    ds_read_b64_tr_b16 a[218:219], v10 offset:20992
    v_mfma_f32_16x16x32_bf16 v[60:63], a[252:255], a[108:111], v[60:63]
    ds_read_b64_tr_b16 a[220:221], v10 offset:1536
    ds_read_b64_tr_b16 a[222:223], v10 offset:22016
    s_waitcnt lgkmcnt(12)
    v_mfma_f32_16x16x32_bf16 v[32:35], a[192:195], a[112:115], v[32:35]
    ds_read_b64_tr_b16 a[224:225], v9 offset:2048
    ds_read_b64_tr_b16 a[226:227], v9 offset:22528
    v_mfma_f32_16x16x32_bf16 v[32:35], a[196:199], a[116:119], v[32:35]
    ds_read_b64_tr_b16 a[228:229], v9 offset:3072
    ds_read_b64_tr_b16 a[230:231], v9 offset:23552
    buffer_load_dwordx4 v20, s[36:39], s11 offen offset:3072 lds
    s_waitcnt vmcnt(12) lgkmcnt(12)
    s_barrier
    v_mfma_f32_16x16x32_bf16 v[36:39], a[200:203], a[112:115], v[36:39]
    ds_read_b64_tr_b16 a[232:233], v10 offset:2048
    ds_read_b64_tr_b16 a[234:235], v10 offset:22528
    v_mfma_f32_16x16x32_bf16 v[36:39], a[204:207], a[116:119], v[36:39]
    ds_read_b64_tr_b16 a[236:237], v10 offset:3072
    ds_read_b64_tr_b16 a[238:239], v10 offset:23552
    s_waitcnt lgkmcnt(12)
    v_mfma_f32_16x16x32_bf16 v[40:43], a[208:211], a[112:115], v[40:43]
    ds_read_b64_tr_b16 a[240:241], v9 offset:2560
    ds_read_b64_tr_b16 a[242:243], v9 offset:23040
    v_mfma_f32_16x16x32_bf16 v[40:43], a[212:215], a[116:119], v[40:43]
    ds_read_b64_tr_b16 a[244:245], v9 offset:3584
    ds_read_b64_tr_b16 a[246:247], v9 offset:24064
    s_add_u32 m0, s19, 90112
    s_mov_b32 s11, 1835008
    buffer_load_dwordx4 v17, s[36:39], s11 offen offset:0 lds
    s_waitcnt lgkmcnt(12)
    v_mfma_f32_16x16x32_bf16 v[44:47], a[216:219], a[112:115], v[44:47]
    ds_read_b64_tr_b16 a[248:249], v10 offset:2560
    ds_read_b64_tr_b16 a[250:251], v10 offset:23040
    v_mfma_f32_16x16x32_bf16 v[44:47], a[220:223], a[116:119], v[44:47]
    ds_read_b64_tr_b16 a[252:253], v10 offset:3584
    ds_read_b64_tr_b16 a[254:255], v10 offset:24064
    s_waitcnt lgkmcnt(12)
    v_mfma_f32_16x16x32_bf16 v[48:51], a[224:227], a[112:115], v[48:51]
    ds_read_b64_tr_b16 a[192:193], v11 offset:0
    ds_read_b64_tr_b16 a[194:195], v11 offset:20480
    v_mfma_f32_16x16x32_bf16 v[48:51], a[228:231], a[116:119], v[48:51]
    ds_read_b64_tr_b16 a[196:197], v11 offset:1024
    ds_read_b64_tr_b16 a[198:199], v11 offset:21504
    buffer_load_dwordx4 v18, s[36:39], s11 offen offset:1024 lds
    s_waitcnt lgkmcnt(12)
    v_mfma_f32_16x16x32_bf16 v[52:55], a[232:235], a[112:115], v[52:55]
    ds_read_b64_tr_b16 a[200:201], v12 offset:0
    ds_read_b64_tr_b16 a[202:203], v12 offset:20480
    v_mfma_f32_16x16x32_bf16 v[52:55], a[236:239], a[116:119], v[52:55]
    ds_read_b64_tr_b16 a[204:205], v12 offset:1024
    ds_read_b64_tr_b16 a[206:207], v12 offset:21504
    s_waitcnt lgkmcnt(12)
    v_mfma_f32_16x16x32_bf16 v[56:59], a[240:243], a[112:115], v[56:59]
    ds_read_b64_tr_b16 a[208:209], v11 offset:512
    ds_read_b64_tr_b16 a[210:211], v11 offset:20992
    v_mfma_f32_16x16x32_bf16 v[56:59], a[244:247], a[116:119], v[56:59]
    ds_read_b64_tr_b16 a[212:213], v11 offset:1536
    ds_read_b64_tr_b16 a[214:215], v11 offset:22016
    s_add_u32 m0, s19, 129024
    s_nop 0
    buffer_load_dwordx4 v19, s[36:39], s11 offen offset:2048 lds
    s_waitcnt lgkmcnt(12)
    v_mfma_f32_16x16x32_bf16 v[60:63], a[248:251], a[112:115], v[60:63]
    ds_read_b64_tr_b16 a[216:217], v12 offset:512
    ds_read_b64_tr_b16 a[218:219], v12 offset:20992
    v_mfma_f32_16x16x32_bf16 v[60:63], a[252:255], a[116:119], v[60:63]
    ds_read_b64_tr_b16 a[220:221], v12 offset:1536
    ds_read_b64_tr_b16 a[222:223], v12 offset:22016
    v_and_b32 v16, 3, v1
    v_lshlrev_b32 v16, 2, v16
    buffer_load_dword v16, v16, s[52:55], s68 offen offset:0 sc1
    s_waitcnt lgkmcnt(12)
    v_mfma_f32_16x16x32_bf16 v[32:35], a[192:195], a[120:123], v[32:35]
    ds_read_b64_tr_b16 a[224:225], v11 offset:2048
    ds_read_b64_tr_b16 a[226:227], v11 offset:22528
    v_mfma_f32_16x16x32_bf16 v[32:35], a[196:199], a[124:127], v[32:35]
    ds_read_b64_tr_b16 a[228:229], v11 offset:3072
    ds_read_b64_tr_b16 a[230:231], v11 offset:23552
    buffer_load_dwordx4 v20, s[36:39], s11 offen offset:3072 lds
    s_waitcnt lgkmcnt(12)
    v_mfma_f32_16x16x32_bf16 v[36:39], a[200:203], a[120:123], v[36:39]
    ds_read_b64_tr_b16 a[232:233], v12 offset:2048
    ds_read_b64_tr_b16 a[234:235], v12 offset:22528
    v_mfma_f32_16x16x32_bf16 v[36:39], a[204:207], a[124:127], v[36:39]
    ds_read_b64_tr_b16 a[236:237], v12 offset:3072
    ds_read_b64_tr_b16 a[238:239], v12 offset:23552
    s_waitcnt lgkmcnt(12)
    v_mfma_f32_16x16x32_bf16 v[40:43], a[208:211], a[120:123], v[40:43]
    ds_read_b64_tr_b16 a[240:241], v11 offset:2560
    ds_read_b64_tr_b16 a[242:243], v11 offset:23040
    v_mfma_f32_16x16x32_bf16 v[40:43], a[212:215], a[124:127], v[40:43]
    ds_read_b64_tr_b16 a[244:245], v11 offset:3584
    ds_read_b64_tr_b16 a[246:247], v11 offset:24064
    s_add_u32 m0, s19, 45056
    s_mov_b32 s11, 1966080
    buffer_load_dwordx4 v17, s[36:39], s11 offen offset:0 lds
    s_waitcnt lgkmcnt(12)
    v_mfma_f32_16x16x32_bf16 v[44:47], a[216:219], a[120:123], v[44:47]
    ds_read_b64_tr_b16 a[248:249], v12 offset:2560
    ds_read_b64_tr_b16 a[250:251], v12 offset:23040
    v_mfma_f32_16x16x32_bf16 v[44:47], a[220:223], a[124:127], v[44:47]
    ds_read_b64_tr_b16 a[252:253], v12 offset:3584
    ds_read_b64_tr_b16 a[254:255], v12 offset:24064
    s_waitcnt lgkmcnt(12)
    v_mfma_f32_16x16x32_bf16 v[48:51], a[224:227], a[120:123], v[48:51]
    ds_read_b64_tr_b16 a[192:193], v7 offset:8192
    ds_read_b64_tr_b16 a[194:195], v7 offset:28672
    v_mfma_f32_16x16x32_bf16 v[48:51], a[228:231], a[124:127], v[48:51]
    ds_read_b64_tr_b16 a[196:197], v7 offset:9216
    ds_read_b64_tr_b16 a[198:199], v7 offset:29696
    buffer_load_dwordx4 v18, s[36:39], s11 offen offset:1024 lds
    s_waitcnt lgkmcnt(12)
    v_mfma_f32_16x16x32_bf16 v[52:55], a[232:235], a[120:123], v[52:55]
    ds_read_b64_tr_b16 a[200:201], v8 offset:8192
    ds_read_b64_tr_b16 a[202:203], v8 offset:28672
    v_mfma_f32_16x16x32_bf16 v[52:55], a[236:239], a[124:127], v[52:55]
    ds_read_b64_tr_b16 a[204:205], v8 offset:9216
    ds_read_b64_tr_b16 a[206:207], v8 offset:29696
    s_waitcnt lgkmcnt(12)
    v_mfma_f32_16x16x32_bf16 v[56:59], a[240:243], a[120:123], v[56:59]
    ds_read_b64_tr_b16 a[208:209], v7 offset:8704
    ds_read_b64_tr_b16 a[210:211], v7 offset:29184
    v_mfma_f32_16x16x32_bf16 v[56:59], a[244:247], a[124:127], v[56:59]
    ds_read_b64_tr_b16 a[212:213], v7 offset:9728
    ds_read_b64_tr_b16 a[214:215], v7 offset:30208
    buffer_load_dwordx4 v19, s[36:39], s11 offen offset:2048 lds
    s_waitcnt lgkmcnt(12)
    v_mfma_f32_16x16x32_bf16 v[60:63], a[248:251], a[120:123], v[60:63]
    ds_read_b64_tr_b16 a[216:217], v8 offset:8704
    ds_read_b64_tr_b16 a[218:219], v8 offset:29184
    v_mfma_f32_16x16x32_bf16 v[60:63], a[252:255], a[124:127], v[60:63]
    ds_read_b64_tr_b16 a[220:221], v8 offset:9728
    ds_read_b64_tr_b16 a[222:223], v8 offset:30208
    s_waitcnt vmcnt(12) lgkmcnt(12)
    v_mfma_f32_16x16x32_bf16 v[32:35], a[192:195], a[128:131], v[32:35]
    ds_read_b64_tr_b16 a[224:225], v9 offset:8192
    ds_read_b64_tr_b16 a[226:227], v9 offset:28672
    v_mfma_f32_16x16x32_bf16 v[32:35], a[196:199], a[132:135], v[32:35]
    ds_read_b64_tr_b16 a[228:229], v9 offset:9216
    ds_read_b64_tr_b16 a[230:231], v9 offset:29696
    buffer_load_dwordx4 v20, s[36:39], s11 offen offset:3072 lds
    s_waitcnt vmcnt(9) lgkmcnt(12)
    s_barrier
    v_mfma_f32_16x16x32_bf16 v[36:39], a[200:203], a[128:131], v[36:39]
    ds_read_b64_tr_b16 a[232:233], v10 offset:8192
    ds_read_b64_tr_b16 a[234:235], v10 offset:28672
    v_mfma_f32_16x16x32_bf16 v[36:39], a[204:207], a[132:135], v[36:39]
    ds_read_b64_tr_b16 a[236:237], v10 offset:9216
    ds_read_b64_tr_b16 a[238:239], v10 offset:29696
    s_waitcnt lgkmcnt(12)
    v_mfma_f32_16x16x32_bf16 v[40:43], a[208:211], a[128:131], v[40:43]
    ds_read_b64_tr_b16 a[240:241], v9 offset:8704
    ds_read_b64_tr_b16 a[242:243], v9 offset:29184
    v_mfma_f32_16x16x32_bf16 v[40:43], a[212:215], a[132:135], v[40:43]
    ds_read_b64_tr_b16 a[244:245], v9 offset:9728
    ds_read_b64_tr_b16 a[246:247], v9 offset:30208
    s_waitcnt lgkmcnt(12)
    v_mfma_f32_16x16x32_bf16 v[44:47], a[216:219], a[128:131], v[44:47]
    ds_read_b64_tr_b16 a[248:249], v10 offset:8704
    ds_read_b64_tr_b16 a[250:251], v10 offset:29184
    v_mfma_f32_16x16x32_bf16 v[44:47], a[220:223], a[132:135], v[44:47]
    ds_read_b64_tr_b16 a[252:253], v10 offset:9728
    ds_read_b64_tr_b16 a[254:255], v10 offset:30208
    s_waitcnt lgkmcnt(12)
    v_mfma_f32_16x16x32_bf16 v[48:51], a[224:227], a[128:131], v[48:51]
    ds_read_b64_tr_b16 a[192:193], v13 offset:0
    ds_read_b64_tr_b16 a[194:195], v13 offset:20480
    v_mfma_f32_16x16x32_bf16 v[48:51], a[228:231], a[132:135], v[48:51]
    ds_read_b64_tr_b16 a[196:197], v13 offset:1024
    ds_read_b64_tr_b16 a[198:199], v13 offset:21504
    s_waitcnt lgkmcnt(12)
    v_mfma_f32_16x16x32_bf16 v[52:55], a[232:235], a[128:131], v[52:55]
    ds_read_b64_tr_b16 a[200:201], v14 offset:0
    ds_read_b64_tr_b16 a[202:203], v14 offset:20480
    v_mfma_f32_16x16x32_bf16 v[52:55], a[236:239], a[132:135], v[52:55]
    ds_read_b64_tr_b16 a[204:205], v14 offset:1024
    ds_read_b64_tr_b16 a[206:207], v14 offset:21504
    s_waitcnt lgkmcnt(12)
    v_mfma_f32_16x16x32_bf16 v[56:59], a[240:243], a[128:131], v[56:59]
    ds_read_b64_tr_b16 a[208:209], v13 offset:512
    ds_read_b64_tr_b16 a[210:211], v13 offset:20992
    v_mfma_f32_16x16x32_bf16 v[56:59], a[244:247], a[132:135], v[56:59]
    ds_read_b64_tr_b16 a[212:213], v13 offset:1536
    ds_read_b64_tr_b16 a[214:215], v13 offset:22016
    s_waitcnt lgkmcnt(12)
    v_mfma_f32_16x16x32_bf16 v[60:63], a[248:251], a[128:131], v[60:63]
    ds_read_b64_tr_b16 a[216:217], v14 offset:512
    ds_read_b64_tr_b16 a[218:219], v14 offset:20992
    v_mfma_f32_16x16x32_bf16 v[60:63], a[252:255], a[132:135], v[60:63]
    ds_read_b64_tr_b16 a[220:221], v14 offset:1536
    ds_read_b64_tr_b16 a[222:223], v14 offset:22016
    s_waitcnt vmcnt(5)
    v_cmp_ne_u32 vcc, s18, v16
    s_cbranch_vccnz L_pl11
L_pl11_b:
    s_waitcnt lgkmcnt(12)
    v_mfma_f32_16x16x32_bf16 v[32:35], a[192:195], a[136:139], v[32:35]
    ds_read_b64_tr_b16 a[224:225], v13 offset:2048
    ds_read_b64_tr_b16 a[226:227], v13 offset:22528
    v_mfma_f32_16x16x32_bf16 v[32:35], a[196:199], a[140:143], v[32:35]
    ds_read_b64_tr_b16 a[228:229], v13 offset:3072
    ds_read_b64_tr_b16 a[230:231], v13 offset:23552
    buffer_load_dwordx4 v[128:131], v2, s[24:27], s60 offen offset:0 sc1
    s_waitcnt vmcnt(5) lgkmcnt(12)
    s_barrier
    v_mfma_f32_16x16x32_bf16 v[36:39], a[200:203], a[136:139], v[36:39]
    ds_read_b64_tr_b16 a[232:233], v14 offset:2048
    ds_read_b64_tr_b16 a[234:235], v14 offset:22528
    v_mfma_f32_16x16x32_bf16 v[36:39], a[204:207], a[140:143], v[36:39]
    ds_read_b64_tr_b16 a[236:237], v14 offset:3072
    ds_read_b64_tr_b16 a[238:239], v14 offset:23552
    buffer_load_dwordx4 v[160:163], v2, s[24:27], s61 offen offset:0 sc1
    s_waitcnt lgkmcnt(12)
    v_mfma_f32_16x16x32_bf16 v[40:43], a[208:211], a[136:139], v[40:43]
    ds_read_b64_tr_b16 a[240:241], v13 offset:2560
    ds_read_b64_tr_b16 a[242:243], v13 offset:23040
    v_mfma_f32_16x16x32_bf16 v[40:43], a[212:215], a[140:143], v[40:43]
    ds_read_b64_tr_b16 a[244:245], v13 offset:3584
    ds_read_b64_tr_b16 a[246:247], v13 offset:24064
    buffer_load_dwordx4 v[192:195], v2, s[24:27], s62 offen offset:0 sc1
    s_waitcnt lgkmcnt(12)
    v_mfma_f32_16x16x32_bf16 v[44:47], a[216:219], a[136:139], v[44:47]
    ds_read_b64_tr_b16 a[248:249], v14 offset:2560
    ds_read_b64_tr_b16 a[250:251], v14 offset:23040
    v_mfma_f32_16x16x32_bf16 v[44:47], a[220:223], a[140:143], v[44:47]
    ds_read_b64_tr_b16 a[252:253], v14 offset:3584
    ds_read_b64_tr_b16 a[254:255], v14 offset:24064
    buffer_load_dwordx4 v[132:135], v2, s[24:27], s60 offen offset:1024 sc1
    s_waitcnt lgkmcnt(12)
    v_mfma_f32_16x16x32_bf16 v[48:51], a[224:227], a[136:139], v[48:51]
    ds_read_b64_tr_b16 a[192:193], v11 offset:8192
    ds_read_b64_tr_b16 a[194:195], v11 offset:28672
    v_mfma_f32_16x16x32_bf16 v[48:51], a[228:231], a[140:143], v[48:51]
    ds_read_b64_tr_b16 a[196:197], v11 offset:9216
    ds_read_b64_tr_b16 a[198:199], v11 offset:29696
    buffer_load_dwordx4 v[164:167], v2, s[24:27], s61 offen offset:1024 sc1
    s_waitcnt lgkmcnt(12)
    v_mfma_f32_16x16x32_bf16 v[52:55], a[232:235], a[136:139], v[52:55]
    ds_read_b64_tr_b16 a[200:201], v12 offset:8192
    ds_read_b64_tr_b16 a[202:203], v12 offset:28672
    v_mfma_f32_16x16x32_bf16 v[52:55], a[236:239], a[140:143], v[52:55]
    ds_read_b64_tr_b16 a[204:205], v12 offset:9216
    ds_read_b64_tr_b16 a[206:207], v12 offset:29696
    buffer_load_dwordx4 v[196:199], v2, s[24:27], s62 offen offset:1024 sc1
    s_waitcnt lgkmcnt(12)
    v_mfma_f32_16x16x32_bf16 v[56:59], a[240:243], a[136:139], v[56:59]
    ds_read_b64_tr_b16 a[208:209], v11 offset:8704
    ds_read_b64_tr_b16 a[210:211], v11 offset:29184
    v_mfma_f32_16x16x32_bf16 v[56:59], a[244:247], a[140:143], v[56:59]
    ds_read_b64_tr_b16 a[212:213], v11 offset:9728
    ds_read_b64_tr_b16 a[214:215], v11 offset:30208
    buffer_load_dwordx4 v[136:139], v2, s[24:27], s60 offen offset:2048 sc1
    s_waitcnt lgkmcnt(12)
    v_mfma_f32_16x16x32_bf16 v[60:63], a[248:251], a[136:139], v[60:63]
    ds_read_b64_tr_b16 a[216:217], v12 offset:8704
    ds_read_b64_tr_b16 a[218:219], v12 offset:29184
    v_mfma_f32_16x16x32_bf16 v[60:63], a[252:255], a[140:143], v[60:63]
    ds_read_b64_tr_b16 a[220:221], v12 offset:9728
    ds_read_b64_tr_b16 a[222:223], v12 offset:30208
    buffer_load_dwordx4 v[168:171], v2, s[24:27], s61 offen offset:2048 sc1
    s_waitcnt lgkmcnt(12)
    v_mfma_f32_16x16x32_bf16 v[32:35], a[192:195], a[144:147], v[32:35]
    ds_read_b64_tr_b16 a[224:225], v13 offset:8192
    ds_read_b64_tr_b16 a[226:227], v13 offset:28672
    v_mfma_f32_16x16x32_bf16 v[32:35], a[196:199], a[148:151], v[32:35]
    ds_read_b64_tr_b16 a[228:229], v13 offset:9216
    ds_read_b64_tr_b16 a[230:231], v13 offset:29696
    buffer_load_dwordx4 v[200:203], v2, s[24:27], s62 offen offset:2048 sc1
    s_waitcnt vmcnt(9) lgkmcnt(12)
    s_barrier
    v_mfma_f32_16x16x32_bf16 v[36:39], a[200:203], a[144:147], v[36:39]
    ds_read_b64_tr_b16 a[232:233], v14 offset:8192
    ds_read_b64_tr_b16 a[234:235], v14 offset:28672
    v_mfma_f32_16x16x32_bf16 v[36:39], a[204:207], a[148:151], v[36:39]
    ds_read_b64_tr_b16 a[236:237], v14 offset:9216
    ds_read_b64_tr_b16 a[238:239], v14 offset:29696
    buffer_load_dwordx4 v[140:143], v2, s[24:27], s60 offen offset:3072 sc1
    s_waitcnt lgkmcnt(12)
    v_mfma_f32_16x16x32_bf16 v[40:43], a[208:211], a[144:147], v[40:43]
    ds_read_b64_tr_b16 a[240:241], v13 offset:8704
    ds_read_b64_tr_b16 a[242:243], v13 offset:29184
    v_mfma_f32_16x16x32_bf16 v[40:43], a[212:215], a[148:151], v[40:43]
    ds_read_b64_tr_b16 a[244:245], v13 offset:9728
    ds_read_b64_tr_b16 a[246:247], v13 offset:30208
    buffer_load_dwordx4 v[172:175], v2, s[24:27], s61 offen offset:3072 sc1
    s_waitcnt lgkmcnt(12)
    v_mfma_f32_16x16x32_bf16 v[44:47], a[216:219], a[144:147], v[44:47]
    ds_read_b64_tr_b16 a[248:249], v14 offset:8704
    ds_read_b64_tr_b16 a[250:251], v14 offset:29184
    v_mfma_f32_16x16x32_bf16 v[44:47], a[220:223], a[148:151], v[44:47]
    ds_read_b64_tr_b16 a[252:253], v14 offset:9728
    ds_read_b64_tr_b16 a[254:255], v14 offset:30208
    buffer_load_dwordx4 v[204:207], v2, s[24:27], s62 offen offset:3072 sc1
    s_waitcnt lgkmcnt(12)
    v_mfma_f32_16x16x32_bf16 v[48:51], a[224:227], a[144:147], v[48:51]
    ds_read_b64_tr_b16 a[192:193], v9 offset:4096
    ds_read_b64_tr_b16 a[194:195], v9 offset:24576
    v_mfma_f32_16x16x32_bf16 v[48:51], a[228:231], a[148:151], v[48:51]
    ds_read_b64_tr_b16 a[196:197], v9 offset:5120
    ds_read_b64_tr_b16 a[198:199], v9 offset:25600
    s_waitcnt lgkmcnt(12)
    v_mfma_f32_16x16x32_bf16 v[52:55], a[232:235], a[144:147], v[52:55]
    ds_read_b64_tr_b16 a[200:201], v10 offset:4096
    ds_read_b64_tr_b16 a[202:203], v10 offset:24576
    v_mfma_f32_16x16x32_bf16 v[52:55], a[236:239], a[148:151], v[52:55]
    ds_read_b64_tr_b16 a[204:205], v10 offset:5120
    ds_read_b64_tr_b16 a[206:207], v10 offset:25600
    s_waitcnt lgkmcnt(12)
    v_mfma_f32_16x16x32_bf16 v[56:59], a[240:243], a[144:147], v[56:59]
    ds_read_b64_tr_b16 a[208:209], v9 offset:4608
    ds_read_b64_tr_b16 a[210:211], v9 offset:25088
    v_mfma_f32_16x16x32_bf16 v[56:59], a[244:247], a[148:151], v[56:59]
    ds_read_b64_tr_b16 a[212:213], v9 offset:5632
    ds_read_b64_tr_b16 a[214:215], v9 offset:26112
    s_waitcnt lgkmcnt(12)
    v_mfma_f32_16x16x32_bf16 v[60:63], a[248:251], a[144:147], v[60:63]
    ds_read_b64_tr_b16 a[216:217], v10 offset:4608
    ds_read_b64_tr_b16 a[218:219], v10 offset:25088
    v_mfma_f32_16x16x32_bf16 v[60:63], a[252:255], a[148:151], v[60:63]
    ds_read_b64_tr_b16 a[220:221], v10 offset:5632
    ds_read_b64_tr_b16 a[222:223], v10 offset:26112
    s_waitcnt lgkmcnt(12)
    v_mfma_f32_16x16x32_bf16 v[32:35], a[192:195], a[152:155], v[32:35]
    ds_read_b64_tr_b16 a[224:225], v9 offset:6144
    ds_read_b64_tr_b16 a[226:227], v9 offset:26624
    v_mfma_f32_16x16x32_bf16 v[32:35], a[196:199], a[156:159], v[32:35]
    ds_read_b64_tr_b16 a[228:229], v9 offset:7168
    ds_read_b64_tr_b16 a[230:231], v9 offset:27648
    s_waitcnt lgkmcnt(12)
    v_mfma_f32_16x16x32_bf16 v[36:39], a[200:203], a[152:155], v[36:39]
    ds_read_b64_tr_b16 a[232:233], v10 offset:6144
    ds_read_b64_tr_b16 a[234:235], v10 offset:26624
    v_mfma_f32_16x16x32_bf16 v[36:39], a[204:207], a[156:159], v[36:39]
    ds_read_b64_tr_b16 a[236:237], v10 offset:7168
    ds_read_b64_tr_b16 a[238:239], v10 offset:27648
    s_waitcnt lgkmcnt(12)
    v_mfma_f32_16x16x32_bf16 v[40:43], a[208:211], a[152:155], v[40:43]
    ds_read_b64_tr_b16 a[240:241], v9 offset:6656
    ds_read_b64_tr_b16 a[242:243], v9 offset:27136
    v_mfma_f32_16x16x32_bf16 v[40:43], a[212:215], a[156:159], v[40:43]
    ds_read_b64_tr_b16 a[244:245], v9 offset:7680
    ds_read_b64_tr_b16 a[246:247], v9 offset:28160
    s_waitcnt lgkmcnt(12)
    v_mfma_f32_16x16x32_bf16 v[44:47], a[216:219], a[152:155], v[44:47]
    ds_read_b64_tr_b16 a[248:249], v10 offset:6656
    ds_read_b64_tr_b16 a[250:251], v10 offset:27136
    v_mfma_f32_16x16x32_bf16 v[44:47], a[220:223], a[156:159], v[44:47]
    ds_read_b64_tr_b16 a[252:253], v10 offset:7680
    ds_read_b64_tr_b16 a[254:255], v10 offset:28160
    s_waitcnt lgkmcnt(12)
    v_mfma_f32_16x16x32_bf16 v[48:51], a[224:227], a[152:155], v[48:51]
    v_mfma_f32_16x16x32_bf16 v[48:51], a[228:231], a[156:159], v[48:51]
    s_waitcnt lgkmcnt(8)
    v_mfma_f32_16x16x32_bf16 v[52:55], a[232:235], a[152:155], v[52:55]
    v_mfma_f32_16x16x32_bf16 v[52:55], a[236:239], a[156:159], v[52:55]
    s_waitcnt lgkmcnt(4)
    v_mfma_f32_16x16x32_bf16 v[56:59], a[240:243], a[152:155], v[56:59]
    v_mfma_f32_16x16x32_bf16 v[56:59], a[244:247], a[156:159], v[56:59]
    s_waitcnt lgkmcnt(0)
    v_mfma_f32_16x16x32_bf16 v[60:63], a[248:251], a[152:155], v[60:63]
    v_mfma_f32_16x16x32_bf16 v[60:63], a[252:255], a[156:159], v[60:63]
    s_mov_b32 s97, 0xffff0000
    s_waitcnt vmcnt(63)
    v_permlane16_swap_b32 v224, v226
    v_permlane16_swap_b32 v225, v227
    v_permlane16_swap_b32 v228, v230
    v_permlane16_swap_b32 v229, v231
    v_permlane16_swap_b32 v232, v234
    v_permlane16_swap_b32 v233, v235
    v_permlane16_swap_b32 v236, v238
    v_permlane16_swap_b32 v237, v239
    s_waitcnt vmcnt(9)
    v_lshlrev_b32 v68, 16, v128
    v_and_b32 v69, s97, v128
    v_lshlrev_b32 v70, 16, v129
    v_and_b32 v71, s97, v129
    v_pk_add_f32 v[64:65], v[64:65], v[68:69]
    v_pk_add_f32 v[66:67], v[66:67], v[70:71]
    v_lshlrev_b32 v68, 16, v160
    v_and_b32 v69, s97, v160
    v_lshlrev_b32 v70, 16, v161
    v_and_b32 v71, s97, v161
    v_pk_add_f32 v[64:65], v[64:65], v[68:69]
    v_pk_add_f32 v[66:67], v[66:67], v[70:71]
    v_lshlrev_b32 v68, 16, v192
    v_and_b32 v69, s97, v192
    v_lshlrev_b32 v70, 16, v193
    v_and_b32 v71, s97, v193
    v_pk_add_f32 v[64:65], v[64:65], v[68:69]
    v_pk_add_f32 v[66:67], v[66:67], v[70:71]
    v_pk_mul_f32 v[72:73], v[64:65], s[76:77] op_sel_hi:[1,0]
    v_pk_mul_f32 v[74:75], v[66:67], s[76:77] op_sel_hi:[1,0]
    v_exp_f32 v72, v72
    v_exp_f32 v73, v73
    v_exp_f32 v74, v74
    v_exp_f32 v75, v75
    v_pk_mul_f32 v[64:65], v[64:65], v[32:33]
    v_pk_mul_f32 v[66:67], v[66:67], v[34:35]
    v_pk_add_f32 v[72:73], v[72:73], 1.0 op_sel_hi:[1,0]
    v_pk_add_f32 v[74:75], v[74:75], 1.0 op_sel_hi:[1,0]
    v_rcp_f32 v72, v72
    v_rcp_f32 v73, v73
    v_rcp_f32 v74, v74
    v_rcp_f32 v75, v75
    v_lshlrev_b32 v76, 16, v224
    v_and_b32 v77, s97, v224
    v_lshlrev_b32 v78, 16, v225
    v_and_b32 v79, s97, v225
    v_pk_fma_f32 v[64:65], v[64:65], v[72:73], v[76:77]
    v_pk_fma_f32 v[66:67], v[66:67], v[74:75], v[78:79]
    v_cvt_pk_bf16_f32 v32, v64, v65
    v_cvt_pk_bf16_f32 v33, v66, v67
    v_lshlrev_b32 v84, 16, v130
    v_and_b32 v85, s97, v130
    v_lshlrev_b32 v86, 16, v131
    v_and_b32 v87, s97, v131
    v_pk_add_f32 v[80:81], v[80:81], v[84:85]
    v_pk_add_f32 v[82:83], v[82:83], v[86:87]
    v_lshlrev_b32 v84, 16, v162
    v_and_b32 v85, s97, v162
    v_lshlrev_b32 v86, 16, v163
    v_and_b32 v87, s97, v163
    v_pk_add_f32 v[80:81], v[80:81], v[84:85]
    v_pk_add_f32 v[82:83], v[82:83], v[86:87]
    v_lshlrev_b32 v84, 16, v194
    v_and_b32 v85, s97, v194
    v_lshlrev_b32 v86, 16, v195
    v_and_b32 v87, s97, v195
    v_pk_add_f32 v[80:81], v[80:81], v[84:85]
    v_pk_add_f32 v[82:83], v[82:83], v[86:87]
    v_pk_mul_f32 v[88:89], v[80:81], s[76:77] op_sel_hi:[1,0]
    v_pk_mul_f32 v[90:91], v[82:83], s[76:77] op_sel_hi:[1,0]
    v_exp_f32 v88, v88
    v_exp_f32 v89, v89
    v_exp_f32 v90, v90
    v_exp_f32 v91, v91
    v_pk_mul_f32 v[80:81], v[80:81], v[36:37]
    v_pk_mul_f32 v[82:83], v[82:83], v[38:39]
    v_pk_add_f32 v[88:89], v[88:89], 1.0 op_sel_hi:[1,0]
    v_pk_add_f32 v[90:91], v[90:91], 1.0 op_sel_hi:[1,0]
    v_rcp_f32 v88, v88
    v_rcp_f32 v89, v89
    v_rcp_f32 v90, v90
    v_rcp_f32 v91, v91
    v_lshlrev_b32 v92, 16, v226
    v_and_b32 v93, s97, v226
    v_lshlrev_b32 v94, 16, v227
    v_and_b32 v95, s97, v227
    v_pk_fma_f32 v[80:81], v[80:81], v[88:89], v[92:93]
    v_pk_fma_f32 v[82:83], v[82:83], v[90:91], v[94:95]
    v_cvt_pk_bf16_f32 v34, v80, v81
    v_cvt_pk_bf16_f32 v35, v82, v83
    s_nop 0
    v_permlane16_swap_b32 v32, v34
    v_permlane16_swap_b32 v33, v35
    buffer_store_dwordx4 v[32:35], v30, s[32:35], 0 offen offset:0 sc1
    s_waitcnt vmcnt(7)
    v_lshlrev_b32 v100, 16, v132
    v_and_b32 v101, s97, v132
    v_lshlrev_b32 v102, 16, v133
    v_and_b32 v103, s97, v133
    v_pk_add_f32 v[96:97], v[96:97], v[100:101]
    v_pk_add_f32 v[98:99], v[98:99], v[102:103]
    v_lshlrev_b32 v100, 16, v164
    v_and_b32 v101, s97, v164
    v_lshlrev_b32 v102, 16, v165
    v_and_b32 v103, s97, v165
    v_pk_add_f32 v[96:97], v[96:97], v[100:101]
    v_pk_add_f32 v[98:99], v[98:99], v[102:103]
    v_lshlrev_b32 v100, 16, v196
    v_and_b32 v101, s97, v196
    v_lshlrev_b32 v102, 16, v197
    v_and_b32 v103, s97, v197
    v_pk_add_f32 v[96:97], v[96:97], v[100:101]
    v_pk_add_f32 v[98:99], v[98:99], v[102:103]
    v_pk_mul_f32 v[104:105], v[96:97], s[76:77] op_sel_hi:[1,0]
    v_pk_mul_f32 v[106:107], v[98:99], s[76:77] op_sel_hi:[1,0]
    v_exp_f32 v104, v104
    v_exp_f32 v105, v105
    v_exp_f32 v106, v106
    v_exp_f32 v107, v107
    v_pk_mul_f32 v[96:97], v[96:97], v[40:41]
    v_pk_mul_f32 v[98:99], v[98:99], v[42:43]
    v_pk_add_f32 v[104:105], v[104:105], 1.0 op_sel_hi:[1,0]
    v_pk_add_f32 v[106:107], v[106:107], 1.0 op_sel_hi:[1,0]
    v_rcp_f32 v104, v104
    v_rcp_f32 v105, v105
    v_rcp_f32 v106, v106
    v_rcp_f32 v107, v107
    v_lshlrev_b32 v108, 16, v228
    v_and_b32 v109, s97, v228
    v_lshlrev_b32 v110, 16, v229
    v_and_b32 v111, s97, v229
    v_pk_fma_f32 v[96:97], v[96:97], v[104:105], v[108:109]
    v_pk_fma_f32 v[98:99], v[98:99], v[106:107], v[110:111]
    v_cvt_pk_bf16_f32 v40, v96, v97
    v_cvt_pk_bf16_f32 v41, v98, v99
    v_lshlrev_b32 v116, 16, v134
    v_and_b32 v117, s97, v134
    v_lshlrev_b32 v118, 16, v135
    v_and_b32 v119, s97, v135
    v_pk_add_f32 v[112:113], v[112:113], v[116:117]
    v_pk_add_f32 v[114:115], v[114:115], v[118:119]
    v_lshlrev_b32 v116, 16, v166
    v_and_b32 v117, s97, v166
    v_lshlrev_b32 v118, 16, v167
    v_and_b32 v119, s97, v167
    v_pk_add_f32 v[112:113], v[112:113], v[116:117]
    v_pk_add_f32 v[114:115], v[114:115], v[118:119]
    v_lshlrev_b32 v116, 16, v198
    v_and_b32 v117, s97, v198
    v_lshlrev_b32 v118, 16, v199
    v_and_b32 v119, s97, v199
    v_pk_add_f32 v[112:113], v[112:113], v[116:117]
    v_pk_add_f32 v[114:115], v[114:115], v[118:119]
    v_pk_mul_f32 v[120:121], v[112:113], s[76:77] op_sel_hi:[1,0]
    v_pk_mul_f32 v[122:123], v[114:115], s[76:77] op_sel_hi:[1,0]
    v_exp_f32 v120, v120
    v_exp_f32 v121, v121
    v_exp_f32 v122, v122
    v_exp_f32 v123, v123
    v_pk_mul_f32 v[112:113], v[112:113], v[44:45]
    v_pk_mul_f32 v[114:115], v[114:115], v[46:47]
    v_pk_add_f32 v[120:121], v[120:121], 1.0 op_sel_hi:[1,0]
    v_pk_add_f32 v[122:123], v[122:123], 1.0 op_sel_hi:[1,0]
    v_rcp_f32 v120, v120
    v_rcp_f32 v121, v121
    v_rcp_f32 v122, v122
    v_rcp_f32 v123, v123
    v_lshlrev_b32 v124, 16, v230
    v_and_b32 v125, s97, v230
    v_lshlrev_b32 v126, 16, v231
    v_and_b32 v127, s97, v231
    v_pk_fma_f32 v[112:113], v[112:113], v[120:121], v[124:125]
    v_pk_fma_f32 v[114:115], v[114:115], v[122:123], v[126:127]
    v_cvt_pk_bf16_f32 v42, v112, v113
    v_cvt_pk_bf16_f32 v43, v114, v115
    s_nop 0
    v_permlane16_swap_b32 v40, v42
    v_permlane16_swap_b32 v41, v43
    buffer_store_dwordx4 v[40:43], v30, s[32:35], 0 offen offset:64 sc1
    s_waitcnt vmcnt(5)
    v_lshlrev_b32 v148, 16, v136
    v_and_b32 v149, s97, v136
    v_lshlrev_b32 v150, 16, v137
    v_and_b32 v151, s97, v137
    v_pk_add_f32 v[144:145], v[144:145], v[148:149]
    v_pk_add_f32 v[146:147], v[146:147], v[150:151]
    v_lshlrev_b32 v148, 16, v168
    v_and_b32 v149, s97, v168
    v_lshlrev_b32 v150, 16, v169
    v_and_b32 v151, s97, v169
    v_pk_add_f32 v[144:145], v[144:145], v[148:149]
    v_pk_add_f32 v[146:147], v[146:147], v[150:151]
    v_lshlrev_b32 v148, 16, v200
    v_and_b32 v149, s97, v200
    v_lshlrev_b32 v150, 16, v201
    v_and_b32 v151, s97, v201
    v_pk_add_f32 v[144:145], v[144:145], v[148:149]
    v_pk_add_f32 v[146:147], v[146:147], v[150:151]
    v_pk_mul_f32 v[152:153], v[144:145], s[76:77] op_sel_hi:[1,0]
    v_pk_mul_f32 v[154:155], v[146:147], s[76:77] op_sel_hi:[1,0]
    v_exp_f32 v152, v152
    v_exp_f32 v153, v153
    v_exp_f32 v154, v154
    v_exp_f32 v155, v155
    v_pk_mul_f32 v[144:145], v[144:145], v[48:49]
    v_pk_mul_f32 v[146:147], v[146:147], v[50:51]
    v_pk_add_f32 v[152:153], v[152:153], 1.0 op_sel_hi:[1,0]
    v_pk_add_f32 v[154:155], v[154:155], 1.0 op_sel_hi:[1,0]
    v_rcp_f32 v152, v152
    v_rcp_f32 v153, v153
    v_rcp_f32 v154, v154
    v_rcp_f32 v155, v155
    v_lshlrev_b32 v156, 16, v232
    v_and_b32 v157, s97, v232
    v_lshlrev_b32 v158, 16, v233
    v_and_b32 v159, s97, v233
    v_pk_fma_f32 v[144:145], v[144:145], v[152:153], v[156:157]
    v_pk_fma_f32 v[146:147], v[146:147], v[154:155], v[158:159]
    v_cvt_pk_bf16_f32 v48, v144, v145
    v_cvt_pk_bf16_f32 v49, v146, v147
    v_lshlrev_b32 v180, 16, v138
    v_and_b32 v181, s97, v138
    v_lshlrev_b32 v182, 16, v139
    v_and_b32 v183, s97, v139
    v_pk_add_f32 v[176:177], v[176:177], v[180:181]
    v_pk_add_f32 v[178:179], v[178:179], v[182:183]
    v_lshlrev_b32 v180, 16, v170
    v_and_b32 v181, s97, v170
    v_lshlrev_b32 v182, 16, v171
    v_and_b32 v183, s97, v171
    v_pk_add_f32 v[176:177], v[176:177], v[180:181]
    v_pk_add_f32 v[178:179], v[178:179], v[182:183]
    v_lshlrev_b32 v180, 16, v202
    v_and_b32 v181, s97, v202
    v_lshlrev_b32 v182, 16, v203
    v_and_b32 v183, s97, v203
    v_pk_add_f32 v[176:177], v[176:177], v[180:181]
    v_pk_add_f32 v[178:179], v[178:179], v[182:183]
    v_pk_mul_f32 v[184:185], v[176:177], s[76:77] op_sel_hi:[1,0]
    v_pk_mul_f32 v[186:187], v[178:179], s[76:77] op_sel_hi:[1,0]
    v_exp_f32 v184, v184
    v_exp_f32 v185, v185
    v_exp_f32 v186, v186
    v_exp_f32 v187, v187
    v_pk_mul_f32 v[176:177], v[176:177], v[52:53]
    v_pk_mul_f32 v[178:179], v[178:179], v[54:55]
    v_pk_add_f32 v[184:185], v[184:185], 1.0 op_sel_hi:[1,0]
    v_pk_add_f32 v[186:187], v[186:187], 1.0 op_sel_hi:[1,0]
    v_rcp_f32 v184, v184
    v_rcp_f32 v185, v185
    v_rcp_f32 v186, v186
    v_rcp_f32 v187, v187
    v_lshlrev_b32 v188, 16, v234
    v_and_b32 v189, s97, v234
    v_lshlrev_b32 v190, 16, v235
    v_and_b32 v191, s97, v235
    v_pk_fma_f32 v[176:177], v[176:177], v[184:185], v[188:189]
    v_pk_fma_f32 v[178:179], v[178:179], v[186:187], v[190:191]
    v_cvt_pk_bf16_f32 v50, v176, v177
    v_cvt_pk_bf16_f32 v51, v178, v179
    s_nop 0
    v_permlane16_swap_b32 v48, v50
    v_permlane16_swap_b32 v49, v51
    buffer_store_dwordx4 v[48:51], v30, s[32:35], 0 offen offset:128 sc1
    s_waitcnt vmcnt(3)
    v_lshlrev_b32 v212, 16, v140
    v_and_b32 v213, s97, v140
    v_lshlrev_b32 v214, 16, v141
    v_and_b32 v215, s97, v141
    v_pk_add_f32 v[208:209], v[208:209], v[212:213]
    v_pk_add_f32 v[210:211], v[210:211], v[214:215]
    v_lshlrev_b32 v212, 16, v172
    v_and_b32 v213, s97, v172
    v_lshlrev_b32 v214, 16, v173
    v_and_b32 v215, s97, v173
    v_pk_add_f32 v[208:209], v[208:209], v[212:213]
    v_pk_add_f32 v[210:211], v[210:211], v[214:215]
    v_lshlrev_b32 v212, 16, v204
    v_and_b32 v213, s97, v204
    v_lshlrev_b32 v214, 16, v205
    v_and_b32 v215, s97, v205
    v_pk_add_f32 v[208:209], v[208:209], v[212:213]
    v_pk_add_f32 v[210:211], v[210:211], v[214:215]
    v_pk_mul_f32 v[216:217], v[208:209], s[76:77] op_sel_hi:[1,0]
    v_pk_mul_f32 v[218:219], v[210:211], s[76:77] op_sel_hi:[1,0]
    v_exp_f32 v216, v216
    v_exp_f32 v217, v217
    v_exp_f32 v218, v218
    v_exp_f32 v219, v219
    v_pk_mul_f32 v[208:209], v[208:209], v[56:57]
    v_pk_mul_f32 v[210:211], v[210:211], v[58:59]
    v_pk_add_f32 v[216:217], v[216:217], 1.0 op_sel_hi:[1,0]
    v_pk_add_f32 v[218:219], v[218:219], 1.0 op_sel_hi:[1,0]
    v_rcp_f32 v216, v216
    v_rcp_f32 v217, v217
    v_rcp_f32 v218, v218
    v_rcp_f32 v219, v219
    v_lshlrev_b32 v220, 16, v236
    v_and_b32 v221, s97, v236
    v_lshlrev_b32 v222, 16, v237
    v_and_b32 v223, s97, v237
    v_pk_fma_f32 v[208:209], v[208:209], v[216:217], v[220:221]
    v_pk_fma_f32 v[210:211], v[210:211], v[218:219], v[222:223]
    v_cvt_pk_bf16_f32 v56, v208, v209
    v_cvt_pk_bf16_f32 v57, v210, v211
    v_lshlrev_b32 v244, 16, v142
    v_and_b32 v245, s97, v142
    v_lshlrev_b32 v246, 16, v143
    v_and_b32 v247, s97, v143
    v_pk_add_f32 v[240:241], v[240:241], v[244:245]
    v_pk_add_f32 v[242:243], v[242:243], v[246:247]
    v_lshlrev_b32 v244, 16, v174
    v_and_b32 v245, s97, v174
    v_lshlrev_b32 v246, 16, v175
    v_and_b32 v247, s97, v175
    v_pk_add_f32 v[240:241], v[240:241], v[244:245]
    v_pk_add_f32 v[242:243], v[242:243], v[246:247]
    v_lshlrev_b32 v244, 16, v206
    v_and_b32 v245, s97, v206
    v_lshlrev_b32 v246, 16, v207
    v_and_b32 v247, s97, v207
    v_pk_add_f32 v[240:241], v[240:241], v[244:245]
    v_pk_add_f32 v[242:243], v[242:243], v[246:247]
    v_pk_mul_f32 v[248:249], v[240:241], s[76:77] op_sel_hi:[1,0]
    v_pk_mul_f32 v[250:251], v[242:243], s[76:77] op_sel_hi:[1,0]
    v_exp_f32 v248, v248
    v_exp_f32 v249, v249
    v_exp_f32 v250, v250
    v_exp_f32 v251, v251
    v_pk_mul_f32 v[240:241], v[240:241], v[60:61]
    v_pk_mul_f32 v[242:243], v[242:243], v[62:63]
    v_pk_add_f32 v[248:249], v[248:249], 1.0 op_sel_hi:[1,0]
    v_pk_add_f32 v[250:251], v[250:251], 1.0 op_sel_hi:[1,0]
    v_rcp_f32 v248, v248
    v_rcp_f32 v249, v249
    v_rcp_f32 v250, v250
    v_rcp_f32 v251, v251
    v_lshlrev_b32 v252, 16, v238
    v_and_b32 v253, s97, v238
    v_lshlrev_b32 v254, 16, v239
    v_and_b32 v255, s97, v239
    v_pk_fma_f32 v[240:241], v[240:241], v[248:249], v[252:253]
    v_pk_fma_f32 v[242:243], v[242:243], v[250:251], v[254:255]
    v_cvt_pk_bf16_f32 v58, v240, v241
    v_cvt_pk_bf16_f32 v59, v242, v243
    s_nop 0
    v_permlane16_swap_b32 v56, v58
    v_permlane16_swap_b32 v57, v59
    buffer_store_dwordx4 v[56:59], v30, s[32:35], 0 offen offset:192 sc1
    s_or_b32 s10, s2, s3
    s_cmp_lg_u32 s10, 0
    s_cbranch_scc1 L_nogen
    s_mov_b32 s10, 65536
    s_mov_b64 exec, 1
    buffer_store_dword v21, off, s[52:55], s10 sc1
    s_mov_b64 exec, -1
L_nogen:
    s_endpgm
L_px_d:
    s_mov_b32 s10, 0x40000
L_px_l_d:
    buffer_load_dword v23, v22, s[52:55], s95 offen sc1
    s_sub_u32 s10, s10, 1
    s_cbranch_scc1 L_px_b_d
    s_waitcnt vmcnt(0)
    v_cmp_ne_u32 vcc, s18, v23
    s_cbranch_vccnz L_px_l_d
    s_branch L_px_b_d
L_pl5:
    s_mov_b32 s75, 0x40000
L_pl5_l:
    v_and_b32 v0, 3, v1
    v_lshlrev_b32 v0, 2, v0
    buffer_load_dword v0, v0, s[52:55], s67 offen offset:0 sc1
    s_sub_u32 s75, s75, 1
    s_cbranch_scc1 L_pl5_b
    s_waitcnt vmcnt(0)
    v_cmp_ne_u32 vcc, s18, v0
    s_cbranch_vccnz L_pl5_l
    s_branch L_pl5_b
L_pl6:
    s_mov_b32 s75, 0x40000
L_pl6_l:
    v_and_b32 v16, 3, v1
    v_lshlrev_b32 v16, 2, v16
    buffer_load_dword v16, v16, s[52:55], s73 offen offset:0 sc1
    s_sub_u32 s75, s75, 1
    s_cbranch_scc1 L_pl6_b
    s_waitcnt vmcnt(0)
    v_cmp_ne_u32 vcc, s18, v16
    s_cbranch_vccnz L_pl6_l
    s_branch L_pl6_b
L_pl7:
    s_mov_b32 s75, 0x40000
L_pl7_l:
    v_and_b32 v15, 7, v1
    v_lshlrev_b32 v15, 2, v15
    buffer_load_dword v15, v15, s[52:55], s65 offen offset:0 sc1
    s_sub_u32 s75, s75, 1
    s_cbranch_scc1 L_pl7_b
    s_waitcnt vmcnt(0)
    v_cmp_ne_u32 vcc, s18, v15
    s_cbranch_vccnz L_pl7_l
    s_branch L_pl7_b
L_pl8:
    s_mov_b32 s75, 0x40000
L_pl8_l:
    v_and_b32 v16, 3, v1
    v_lshlrev_b32 v16, 2, v16
    buffer_load_dword v16, v16, s[52:55], s73 offen offset:64 sc1
    s_sub_u32 s75, s75, 1
    s_cbranch_scc1 L_pl8_b
    s_waitcnt vmcnt(0)
    v_cmp_ne_u32 vcc, s18, v16
    s_cbranch_vccnz L_pl8_l
    s_branch L_pl8_b
L_pl9:
    s_mov_b32 s75, 0x40000
L_pl9_l:
    v_and_b32 v0, 3, v1
    v_lshlrev_b32 v0, 2, v0
    buffer_load_dword v0, v0, s[52:55], s67 offen offset:64 sc1
    s_sub_u32 s75, s75, 1
    s_cbranch_scc1 L_pl9_b
    s_waitcnt vmcnt(0)
    v_cmp_ne_u32 vcc, s18, v0
    s_cbranch_vccnz L_pl9_l
    s_branch L_pl9_b
L_pl10:
    s_mov_b32 s75, 0x40000
L_pl10_l:
    v_and_b32 v16, 15, v1
    v_lshlrev_b32 v16, 2, v16
    buffer_load_dword v16, v16, s[52:55], s64 offen offset:0 sc1
    s_sub_u32 s75, s75, 1
    s_cbranch_scc1 L_pl10_b
    s_waitcnt vmcnt(0)
    v_cmp_ne_u32 vcc, s18, v16
    s_cbranch_vccnz L_pl10_l
    s_branch L_pl10_b
L_pl11:
    s_mov_b32 s75, 0x40000
L_pl11_l:
    v_and_b32 v16, 3, v1
    v_lshlrev_b32 v16, 2, v16
    buffer_load_dword v16, v16, s[52:55], s68 offen offset:0 sc1
    s_sub_u32 s75, s75, 1
    s_cbranch_scc1 L_pl11_b
    s_waitcnt vmcnt(0)
    v_cmp_ne_u32 vcc, s18, v16
    s_cbranch_vccnz L_pl11_l
    s_branch L_pl11_b
L_end:
    s_endpgm
.section .rodata,"a"
.p2align 6
.amdhsa_kernel recurrent_scan__linear_kernel_hedgehog__glu_gated_glu__prompt_kernel
  .amdhsa_next_free_vgpr 512
  .amdhsa_next_free_sgpr 102
  .amdhsa_accum_offset 256
  .amdhsa_group_segment_fixed_size 0
  .amdhsa_kernarg_size 88
  .amdhsa_user_sgpr_count 2
  .amdhsa_user_sgpr_kernarg_segment_ptr 1
  .amdhsa_system_sgpr_workgroup_id_x 1
  .amdhsa_float_denorm_mode_32 3
.end_amdhsa_kernel
```
